```python
import torch

def _softmax(x, axis=-1):
    return torch.softmax(x, dim=axis)
def _gelu(x):
    return torch.nn.functional.gelu(x, approximate="tanh")
def _silu(x):
    return torch.nn.functional.silu(x)
def _sigmoid(x):
    return torch.sigmoid(x)
def _layernorm(x, axis=-1, eps=1e-5):
    m = x.mean(dim=axis, keepdim=True)
    v = x.var(dim=axis, keepdim=True, unbiased=False)
    return (x - m) / torch.sqrt(v + eps)
def _scatter_add(tgt, idx, src, axis=0):
    return tgt.clone().index_add_(axis, idx, src)
def _segment_sum(src, seg, n):
    out = torch.zeros((n,) + src.shape[1:], dtype=src.dtype)
    return out.index_add_(0, seg, src)
def _pad(x, pw):
    flat = tuple(v for pair in reversed(pw) for v in pair)
    return torch.nn.functional.pad(x, flat)

kernel_name = 'standalone__geglu_ffn__prompt'

def setup_inputs():

    _w = (lambda a: (lambda t: t.to(torch.bfloat16) if t.is_floating_point() else t)(torch.as_tensor(a)))
    B, S, D, F = 1, 2048, 576, 4608
    return {
        "x": _w((lambda *s: torch.randn(*s, dtype=torch.bfloat16) * 0.05)(B, S, D)),
        "w_gate": _w((lambda *s: torch.randn(*s, dtype=torch.bfloat16) * 0.05)(D, F)),
        "w_up": _w((lambda *s: torch.randn(*s, dtype=torch.bfloat16) * 0.05)(D, F)),
        "w_down": _w((lambda *s: torch.randn(*s, dtype=torch.bfloat16) * 0.05)(F, D)),
    }

def reference(x, w_gate, w_up, w_down):
    return (_gelu(x @ w_gate) * (x @ w_up)) @ w_down
```

```asm
; @launch grid=(256,1,1) block=(256,1,1) lds=163840
.amdgcn_target "amdgcn-amd-amdhsa--gfx950"
.text

.globl standalone__geglu_ffn__prompt_kernel
.p2align 8
.type standalone__geglu_ffn__prompt_kernel,@function
standalone__geglu_ffn__prompt_kernel:
    s_load_dwordx8 s[76:83], s[0:1], 0
    s_load_dwordx4 s[92:95], s[0:1], 32
    s_load_dwordx2 s[88:89], s[0:1], 48
    s_getpc_b64 s[98:99]
L_pcref:
    s_lshr_b32 s3, s2, 3
    s_and_b32 s3, s3, 31
    s_lshl_b32 s3, s3, 11
    v_lshrrev_b32 v1, 4, v0
    v_lshlrev_b32 v1, 7, v1
    v_add_u32 v1, s3, v1
    v_min_u32 v2, L_fastend-L_pcref-4, v1
    global_load_dword v255, v2, s[98:99] offset:0
    s_cmp_ge_u32 s2, 256
    s_cbranch_scc1 L_end
    v_lshrrev_b32 v192, 6, v0
    v_and_b32 v247, 63, v0
    s_and_b32 s38, s2, 3
    v_readfirstlane_b32 s36, v192
    s_lshr_b32 s39, s2, 3
    s_and_b32 s39, s39, 3
    s_lshr_b32 s37, s2, 5
    s_lshr_b32 s72, s2, 2
    s_and_b32 s72, s72, 1
    s_lshl_b32 s72, s72, 3
    s_add_u32 s37, s37, s72
    v_lshrrev_b32 v192, 3, v247
    v_mul_u32_u24 v192, 1152, v192
    v_and_b32 v193, 7, v247
    v_lshrrev_b32 v194, 4, v247
    v_xor_b32 v193, v193, v194
    v_lshlrev_b32 v194, 4, v193
    v_add_u32 v222, v192, v194
    v_xor_b32 v193, 4, v193
    v_lshlrev_b32 v194, 4, v193
    v_add_u32 v223, v192, v194
    v_add_u32 v224, 16384, v222
    v_add_u32 v225, 24576, v223
    v_add_u32 v223, 8192, v223
    v_lshrrev_b32 v192, 3, v247
    v_mul_u32_u24 v192, 9216, v192
    v_and_b32 v193, 1, v247
    v_lshlrev_b32 v193, 4, v193
    v_add_u32 v192, v192, v193
    v_bfe_u32 v193, v247, 1, 2
    v_bfe_u32 v194, v247, 4, 1
    v_xor_b32 v193, v193, v194
    v_lshlrev_b32 v194, 5, v193
    v_add_u32 v210, v192, v194
    v_xor_b32 v193, 2, v193
    v_lshlrev_b32 v194, 5, v193
    v_add_u32 v211, v192, v194
    v_add_u32 v211, 72704, v211
    s_lshl_b32 s40, s36, 12
    s_lshl_b32 s43, s37, 7
    s_lshl_b32 s73, s36, 5
    s_add_u32 s43, s43, s73
    s_mul_i32 s43, s43, 1152
    s_lshl_b32 s74, s38, 2
    s_add_u32 s74, s74, s39
    s_and_b32 s75, s39, 1
    s_mul_i32 s44, s74, 576
    s_mul_i32 s73, s36, 147456
    s_add_u32 s44, s44, s73
    s_lshl_b32 s73, s75, 9
    s_add_u32 s45, s44, 512
    s_sub_u32 s45, s45, s73
    s_lshl_b32 s73, s75, 6
    s_add_u32 s44, s44, s73
    s_waitcnt lgkmcnt(0)
    s_mov_b32 s4, s76
    s_mov_b32 s5, s77
    s_mov_b32 s6, 2359296
    s_mov_b32 s7, 0x20000
    s_mov_b32 s8, s78
    s_mov_b32 s9, s79
    s_mov_b32 s10, 5308416
    s_mov_b32 s11, 0x20000
    s_mov_b32 s12, s80
    s_mov_b32 s13, s81
    s_mov_b32 s14, 5308416
    s_mov_b32 s15, 0x20000
    s_add_u32 m0, s40, 0
    s_add_u32 s70, s43, 0
    buffer_load_dwordx4 v222, s[4:7], s70 offen lds
    buffer_load_dwordx4 v223, s[4:7], s70 offen offset:1024 lds
    buffer_load_dwordx4 v224, s[4:7], s70 offen offset:2048 lds
    buffer_load_dwordx4 v225, s[4:7], s70 offen offset:3072 lds
    s_lshl_b32 s41, s36, 11
    v_lshrrev_b32 v192, 2, v247
    v_mul_u32_u24 v192, 9216, v192
    v_and_b32 v193, 1, v247
    v_lshlrev_b32 v193, 4, v193
    v_add_u32 v192, v192, v193
    v_bfe_u32 v193, v247, 1, 1
    v_lshrrev_b32 v194, 5, v247
    v_xor_b32 v193, v193, v194
    v_lshlrev_b32 v193, 5, v193
    v_add_u32 v212, v192, v193
    s_add_u32 m0, s40, 16384
    s_add_u32 s71, s44, 0
    buffer_load_dwordx4 v210, s[8:11], s71 offen lds
    s_add_u32 s28, s88, 33554432
    s_addc_u32 s29, s89, 0
    s_mov_b32 s30, 32768
    s_mov_b32 s31, 0x20000
    s_lshl_b32 s72, s37, 7
    s_add_u32 s72, s72, 16384
    v_mov_b32 v253, s72
    buffer_load_dword v244, v253, s[28:31], 0 offen sc1
    s_mov_b32 s16, s82
    s_mov_b32 s17, s83
    s_mov_b32 s18, 5308416
    s_mov_b32 s19, 0x20000
    s_mov_b32 s32, s92
    s_mov_b32 s33, s93
    buffer_load_dwordx4 v211, s[8:11], s71 offen offset:1024 lds
    s_mov_b32 s34, 2359296
    s_mov_b32 s35, 0x20000
    s_lshr_b32 s76, s36, 1
    s_and_b32 s77, s36, 1
    s_lshl_b32 s78, s38, 2
    s_add_u32 s78, s78, s39
    s_and_b32 s79, s39, 1
    s_lshl_b32 s41, s36, 11
    s_mul_i32 s42, s36, 9216
    v_bfe_u32 v192, v247, 4, 1
    v_bfe_u32 v193, v247, 2, 2
    v_lshl_add_u32 v193, v192, 3, v193
    v_and_b32 v194, 3, v247
    v_lshlrev_b32 v194, 3, v194
    s_add_u32 m0, s40, 18432
    s_nop 0
    buffer_load_dwordx4 v210, s[12:15], s71 offen lds
    v_lshrrev_b32 v195, 5, v247
    v_bfe_u32 v196, v247, 3, 1
    v_lshl_add_u32 v196, v192, 1, v196
    v_lshlrev_b32 v197, 12, v195
    v_lshl_add_u32 v197, v193, 7, v197
    v_add_u32 v197, v197, v194
    s_lshl_b32 s72, s77, 1
    v_xor_b32 v196, s72, v196
    v_lshlrev_b32 v198, 5, v196
    v_add_u32 v213, v197, v198
    v_xor_b32 v196, 1, v196
    v_lshlrev_b32 v198, 5, v196
    v_add_u32 v216, v197, v198
    v_add_u32 v214, 65536, v213
    buffer_load_dwordx4 v211, s[12:15], s71 offen offset:1024 lds
    v_add_u32 v215, 131072, v213
    v_add_u32 v217, 65536, v216
    v_add_u32 v218, 131072, v216
    v_and_b32 v192, 15, v247
    v_lshrrev_b32 v193, 4, v247
    v_bfe_u32 v194, v247, 1, 3
    v_xor_b32 v193, v193, v194
    v_lshlrev_b32 v193, 4, v193
    s_lshl_b32 s72, s76, 6
    v_add_u32 v192, s72, v192
    v_lshlrev_b32 v192, 7, v192
    v_add_u32 v195, v192, v193
    v_xor_b32 v196, 64, v195
    s_lshl_b32 s72, s77, 12
    s_add_u32 m0, s41, 32768
    s_add_u32 s70, s45, 0
    buffer_load_dwordx4 v212, s[8:11], s70 offen lds
    v_add_u32 v226, s72, v195
    v_add_u32 v228, s72, v196
    s_xor_b32 s72, s72, 4096
    v_add_u32 v227, s72, v195
    v_add_u32 v229, s72, v196
    s_lshl_b32 s81, s37, 2
    s_add_u32 s82, s81, s38
    s_lshl_b32 s82, s82, 7
    v_and_b32 v192, 3, v247
    v_lshlrev_b32 v193, 2, v192
    v_add_u32 v243, s82, v193
    s_lshl_b32 s72, s39, 2
    s_add_u32 s82, s82, s72
    s_cmp_eq_u32 s36, 0
    s_cselect_b32 s82, s82, 0x80000000
    s_add_u32 m0, s41, 33792
    s_nop 0
    buffer_load_dwordx4 v212, s[12:15], s70 offen lds
    v_mov_b32 v241, 0x80000000
    v_writelane_b32 v241, s82, 0
    s_lshl_b32 s81, s81, 7
    s_add_u32 s81, s81, s72
    v_lshlrev_b32 v193, 7, v192
    v_add_u32 v246, s81, v193
    v_lshlrev_b32 v209, 4, v247
    v_mov_b32 v208, 0xbdd2d3e8
    s_lshl_b32 s82, s38, 2
    v_add_u32 v192, 0, v247
    v_mul_u32_u24 v193, 3641, v192
    v_lshrrev_b32 v193, 16, v193
    v_mul_u32_u24 v194, 18, v193
    v_sub_u32 v194, v192, v194
    s_add_u32 m0, s40, 40960
    s_add_u32 s71, s43, 128
    buffer_load_dwordx4 v222, s[4:7], s71 offen lds
    v_add_u32 v195, s82, v194
    v_and_b32 v195, 15, v195
    v_cmp_gt_u32 vcc, 16, v194
    v_mul_u32_u24 v193, 1152, v193
    s_nop 0
    v_cndmask_b32 v194, v194, v195, vcc
    v_lshl_add_u32 v232, v194, 4, v193
    v_add_u32 v192, 64, v247
    v_mul_u32_u24 v193, 3641, v192
    v_lshrrev_b32 v193, 16, v193
    v_mul_u32_u24 v194, 18, v193
    v_sub_u32 v194, v192, v194
    v_add_u32 v195, s82, v194
    v_and_b32 v195, 15, v195
    v_cmp_gt_u32 vcc, 16, v194
    buffer_load_dwordx4 v223, s[4:7], s71 offen offset:1024 lds
    v_mul_u32_u24 v193, 1152, v193
    v_cndmask_b32 v194, v194, v195, vcc
    v_lshl_add_u32 v233, v194, 4, v193
    v_subrev_u32 v233, 1024, v233
    v_add_u32 v192, 128, v247
    v_mul_u32_u24 v193, 3641, v192
    v_lshrrev_b32 v193, 16, v193
    v_mul_u32_u24 v194, 18, v193
    v_sub_u32 v194, v192, v194
    v_add_u32 v195, s82, v194
    v_and_b32 v195, 15, v195
    v_cmp_gt_u32 vcc, 16, v194
    v_mul_u32_u24 v193, 1152, v193
    s_nop 0
    v_cndmask_b32 v194, v194, v195, vcc
    buffer_load_dwordx4 v224, s[4:7], s71 offen offset:2048 lds
    v_lshl_add_u32 v234, v194, 4, v193
    v_subrev_u32 v234, 2048, v234
    v_add_u32 v192, 192, v247
    v_mul_u32_u24 v193, 3641, v192
    v_lshrrev_b32 v193, 16, v193
    v_mul_u32_u24 v194, 18, v193
    v_sub_u32 v194, v192, v194
    v_add_u32 v195, s82, v194
    v_and_b32 v195, 15, v195
    v_cmp_gt_u32 vcc, 16, v194
    v_mul_u32_u24 v193, 1152, v193
    s_nop 0
    v_cndmask_b32 v194, v194, v195, vcc
    v_lshl_add_u32 v235, v194, 4, v193
    v_subrev_u32 v235, 3072, v235
    buffer_load_dwordx4 v225, s[4:7], s71 offen offset:3072 lds
    v_add_u32 v192, 256, v247
    v_mul_u32_u24 v193, 3641, v192
    v_lshrrev_b32 v193, 16, v193
    v_mul_u32_u24 v194, 18, v193
    v_sub_u32 v194, v192, v194
    v_add_u32 v195, s82, v194
    v_and_b32 v195, 15, v195
    v_cmp_gt_u32 vcc, 16, v194
    v_mul_u32_u24 v193, 1152, v193
    s_nop 0
    v_cndmask_b32 v194, v194, v195, vcc
    v_lshl_add_u32 v236, v194, 4, v193
    v_add_u32 v192, 320, v247
    v_mul_u32_u24 v193, 3641, v192
    v_lshrrev_b32 v193, 16, v193
    s_add_u32 m0, s40, 57344
    s_add_u32 s70, s44, 589824
    buffer_load_dwordx4 v210, s[8:11], s70 offen lds
    v_mul_u32_u24 v194, 18, v193
    v_sub_u32 v194, v192, v194
    v_add_u32 v195, s82, v194
    v_and_b32 v195, 15, v195
    v_cmp_gt_u32 vcc, 16, v194
    v_mul_u32_u24 v193, 1152, v193
    s_nop 0
    v_cndmask_b32 v194, v194, v195, vcc
    v_lshl_add_u32 v237, v194, 4, v193
    v_subrev_u32 v237, 1024, v237
    v_add_u32 v192, 384, v247
    v_mul_u32_u24 v193, 3641, v192
    v_lshrrev_b32 v193, 16, v193
    v_mul_u32_u24 v194, 18, v193
    v_sub_u32 v194, v192, v194
    buffer_load_dwordx4 v211, s[8:11], s70 offen offset:1024 lds
    v_add_u32 v195, s82, v194
    v_and_b32 v195, 15, v195
    v_cmp_gt_u32 vcc, 16, v194
    v_mul_u32_u24 v193, 1152, v193
    s_nop 0
    v_cndmask_b32 v194, v194, v195, vcc
    v_lshl_add_u32 v238, v194, 4, v193
    v_subrev_u32 v238, 2048, v238
    v_add_u32 v192, 448, v247
    v_mul_u32_u24 v193, 3641, v192
    v_lshrrev_b32 v193, 16, v193
    v_mul_u32_u24 v194, 18, v193
    v_sub_u32 v194, v192, v194
    v_add_u32 v195, s82, v194
    v_and_b32 v195, 15, v195
    s_add_u32 m0, s40, 59392
    s_nop 0
    buffer_load_dwordx4 v210, s[12:15], s70 offen lds
    v_cmp_gt_u32 vcc, 16, v194
    v_mul_u32_u24 v193, 1152, v193
    s_nop 0
    v_cndmask_b32 v194, v194, v195, vcc
    v_lshl_add_u32 v239, v194, 4, v193
    v_subrev_u32 v239, 3072, v239
    v_add_u32 v192, 512, v247
    v_mul_u32_u24 v193, 3641, v192
    v_lshrrev_b32 v193, 16, v193
    v_mul_u32_u24 v194, 18, v193
    v_sub_u32 v194, v192, v194
    v_add_u32 v195, s82, v194
    v_and_b32 v195, 15, v195
    v_cmp_gt_u32 vcc, 16, v194
    v_mul_u32_u24 v193, 1152, v193
    s_nop 0
    v_cndmask_b32 v194, v194, v195, vcc
    buffer_load_dwordx4 v211, s[12:15], s70 offen offset:1024 lds
    v_lshl_add_u32 v240, v194, 4, v193
    v_lshrrev_b32 v192, 4, v247
    v_bfe_u32 v193, v247, 2, 2
    v_lshl_add_u32 v192, v192, 2, v193
    v_mul_u32_u24 v192, 288, v192
    v_and_b32 v193, 3, v247
    v_lshl_add_u32 v219, v193, 3, v192
    v_add_u32 v220, 65536, v219
    v_add_u32 v221, 131072, v219
    v_mov_b32 v248, -1
    v_mov_b32 v249, -1
    v_mov_b32 v250, -1
    v_mov_b32 v251, -1
    s_and_b32 s72, s37, 7
    s_add_u32 m0, s41, 73728
    s_add_u32 s71, s45, 589824
    buffer_load_dwordx4 v212, s[8:11], s71 offen lds
    s_mul_i32 s72, s72, 72
    s_mul_i32 s81, s36, 18
    s_add_u32 s72, s72, s81
    v_add_u32 v192, s72, v247
    v_mul_u32_u24 v192, 9216, v192
    v_cmp_gt_u32 vcc, 18, v247
    v_mov_b32 v193, 0x80000000
    s_nop 0
    v_cndmask_b32 v254, v193, v192, vcc
    v_bfe_u32 v192, v247, 4, 1
    v_bfe_u32 v193, v247, 2, 2
    v_lshl_add_u32 v193, v192, 3, v193
    v_and_b32 v194, 3, v247
    v_lshlrev_b32 v194, 3, v194
    s_add_u32 m0, s41, 74752
    s_nop 0
    buffer_load_dwordx4 v212, s[12:15], s71 offen lds
    v_lshrrev_b32 v195, 5, v247
    v_lshlrev_b32 v197, 11, v195
    v_lshl_add_u32 v197, v193, 6, v197
    v_add_u32 v197, v197, v194
    v_lshl_add_u32 v230, v192, 5, v197
    v_xor_b32 v198, 1, v192
    v_lshl_add_u32 v231, v198, 5, v197
    s_mul_i32 s72, s36, 147456
    s_sub_u32 s85, s44, s72
    s_mov_b32 s96, 200000
    s_mov_b32 s91, 8192
    s_mov_b32 s90, 20480
    s_waitcnt vmcnt(10)
    s_barrier
    v_add_u32 v192, 0, v226
    v_add_u32 v193, 0, v227
    v_add_u32 v194, 0, v228
    v_add_u32 v195, 0, v229
    ds_read_b64_tr_b16 v[160:161], v213 offset:16384
    ds_read_b64_tr_b16 v[162:163], v213 offset:16896
    ds_read_b64_tr_b16 v[164:165], v213 offset:24576
    ds_read_b64_tr_b16 v[166:167], v213 offset:25088
    ds_read_b64_tr_b16 v[168:169], v213 offset:18432
    ds_read_b64_tr_b16 v[170:171], v213 offset:18944
    ds_read_b64_tr_b16 v[172:173], v213 offset:26624
    ds_read_b64_tr_b16 v[174:175], v213 offset:27136
    ds_read_b64_tr_b16 v[176:177], v216 offset:16384
    ds_read_b64_tr_b16 v[178:179], v216 offset:16896
    ds_read_b64_tr_b16 v[180:181], v216 offset:24576
    ds_read_b64_tr_b16 v[182:183], v216 offset:25088
    ds_read_b64_tr_b16 v[184:185], v216 offset:18432
    ds_read_b64_tr_b16 v[186:187], v216 offset:18944
    ds_read_b64_tr_b16 v[188:189], v216 offset:26624
    ds_read_b64_tr_b16 v[190:191], v216 offset:27136
    ds_read_b128 a[0:3], v192 offset:0
    ds_read_b128 a[16:19], v194 offset:0
    ds_read_b128 a[4:7], v192 offset:2048
    ds_read_b128 a[20:23], v194 offset:2048
    ds_read_b128 a[8:11], v193 offset:0
    ds_read_b128 a[24:27], v195 offset:0
    ds_read_b128 a[12:15], v193 offset:2048
    ds_read_b128 a[28:31], v195 offset:2048
    s_waitcnt lgkmcnt(7)
    v_mfma_f32_16x16x32_bf16 v[0:3], v[160:163], a[0:3], 0
    s_add_u32 m0, s40, 81920
    s_add_u32 s70, s43, 256
    s_mov_b32 s20, s88
    s_waitcnt lgkmcnt(6)
    v_mfma_f32_16x16x32_bf16 v[0:3], v[164:167], a[16:19], v[0:3]
    s_waitcnt lgkmcnt(5)
    buffer_load_dwordx4 v222, s[4:7], s70 offen lds
    v_mfma_f32_16x16x32_bf16 v[4:7], v[160:163], a[4:7], 0
    s_mov_b32 s21, s89
    s_mov_b32 s22, 18874368
    s_mov_b32 s23, 0x20000
    s_waitcnt lgkmcnt(4)
    v_mfma_f32_16x16x32_bf16 v[4:7], v[164:167], a[20:23], v[4:7]
    s_waitcnt lgkmcnt(3)
    v_add_u32 v196, 32768, v230
    v_add_u32 v197, 32768, v231
    v_mfma_f32_16x16x32_bf16 v[8:11], v[160:163], a[8:11], 0
    s_add_u32 s24, s88, 20971520
    s_addc_u32 s25, s89, 0
    s_mov_b32 s26, 10485760
    s_waitcnt lgkmcnt(2)
    v_mfma_f32_16x16x32_bf16 v[8:11], v[164:167], a[24:27], v[8:11]
    s_waitcnt lgkmcnt(1)
    buffer_load_dwordx4 v223, s[4:7], s70 offen offset:1024 lds
    v_mfma_f32_16x16x32_bf16 v[12:15], v[160:163], a[12:15], 0
    s_mov_b32 s27, 0x20000
    s_lshl_b32 s80, s37, 3
    s_lshl_b32 s84, s76, 2
    s_waitcnt lgkmcnt(0)
    v_mfma_f32_16x16x32_bf16 v[12:15], v[164:167], a[28:31], v[12:15]
    s_add_u32 s80, s80, s84
    ds_read_b64_tr_b16 v[160:161], v196 offset:0
    ds_read_b64_tr_b16 v[162:163], v196 offset:256
    v_mfma_f32_16x16x32_bf16 v[16:19], v[168:171], a[0:3], 0
    s_mul_i32 s81, s78, 9
    ds_read_b64_tr_b16 v[164:165], v196 offset:4096
    ds_read_b64_tr_b16 v[166:167], v196 offset:4352
    v_mfma_f32_16x16x32_bf16 v[16:19], v[172:175], a[16:19], v[16:19]
    buffer_load_dwordx4 v224, s[4:7], s70 offen offset:2048 lds
    v_mfma_f32_16x16x32_bf16 v[20:23], v[168:171], a[4:7], 0
    s_lshl_b32 s84, s77, 1
    s_xor_b32 s84, s84, 0
    s_add_u32 s84, s84, s80
    v_mfma_f32_16x16x32_bf16 v[20:23], v[172:175], a[20:23], v[20:23]
    s_mul_i32 s84, s84, 144
    s_add_u32 s84, s84, s81
    s_add_u32 s46, s84, s79
    v_mfma_f32_16x16x32_bf16 v[24:27], v[168:171], a[8:11], 0
    s_add_u32 s46, s46, s77
    s_lshl_b32 s46, s46, 10
    s_lshl_b32 s82, s79, 3
    v_mfma_f32_16x16x32_bf16 v[24:27], v[172:175], a[24:27], v[24:27]
    buffer_load_dwordx4 v225, s[4:7], s70 offen offset:3072 lds
    v_mfma_f32_16x16x32_bf16 v[28:31], v[168:171], a[12:15], 0
    s_add_u32 m0, s40, 98304
    s_add_u32 s71, s44, 1179648
    s_add_u32 s50, s84, 8
    v_mfma_f32_16x16x32_bf16 v[28:31], v[172:175], a[28:31], v[28:31]
    s_sub_u32 s50, s50, s82
    ds_read_b64_tr_b16 v[168:169], v196 offset:1024
    ds_read_b64_tr_b16 v[170:171], v196 offset:1280
    v_mfma_f32_16x16x32_bf16 v[32:35], v[176:179], a[0:3], 0
    s_lshl_b32 s50, s50, 10
    ds_read_b64_tr_b16 v[172:173], v196 offset:5120
    ds_read_b64_tr_b16 v[174:175], v196 offset:5376
    v_mfma_f32_16x16x32_bf16 v[32:35], v[180:183], a[16:19], v[32:35]
    buffer_load_dwordx4 v210, s[8:11], s71 offen lds
    v_mfma_f32_16x16x32_bf16 v[36:39], v[176:179], a[4:7], 0
    s_lshl_b32 s84, s77, 1
    s_xor_b32 s84, s84, 1
    s_add_u32 s84, s84, s80
    v_mfma_f32_16x16x32_bf16 v[36:39], v[180:183], a[20:23], v[36:39]
    s_mul_i32 s84, s84, 144
    s_add_u32 s84, s84, s81
    s_add_u32 s47, s84, s79
    v_mfma_f32_16x16x32_bf16 v[40:43], v[176:179], a[8:11], 0
    s_add_u32 s47, s47, s77
    s_lshl_b32 s47, s47, 10
    s_lshl_b32 s82, s79, 3
    v_mfma_f32_16x16x32_bf16 v[40:43], v[180:183], a[24:27], v[40:43]
    buffer_load_dwordx4 v211, s[8:11], s71 offen offset:1024 lds
    v_mfma_f32_16x16x32_bf16 v[44:47], v[176:179], a[12:15], 0
    s_add_u32 m0, s40, 100352
    s_add_u32 s51, s84, 8
    s_sub_u32 s51, s51, s82
    v_mfma_f32_16x16x32_bf16 v[44:47], v[180:183], a[28:31], v[44:47]
    s_lshl_b32 s51, s51, 10
    ds_read_b64_tr_b16 v[176:177], v197 offset:0
    ds_read_b64_tr_b16 v[178:179], v197 offset:256
    v_mfma_f32_16x16x32_bf16 v[48:51], v[184:187], a[0:3], 0
    s_lshl_b32 s84, s77, 1
    ds_read_b64_tr_b16 v[180:181], v197 offset:4096
    ds_read_b64_tr_b16 v[182:183], v197 offset:4352
    v_mfma_f32_16x16x32_bf16 v[48:51], v[188:191], a[16:19], v[48:51]
    buffer_load_dwordx4 v210, s[12:15], s71 offen lds
    v_mfma_f32_16x16x32_bf16 v[52:55], v[184:187], a[4:7], 0
    s_waitcnt vmcnt(7)
    s_xor_b32 s84, s84, 2
    s_add_u32 s84, s84, s80
    v_mfma_f32_16x16x32_bf16 v[52:55], v[188:191], a[20:23], v[52:55]
    s_barrier
    v_add_u32 v192, 40960, v226
    v_add_u32 v193, 40960, v227
    v_mfma_f32_16x16x32_bf16 v[56:59], v[184:187], a[8:11], 0
    s_mul_i32 s84, s84, 144
    v_add_u32 v194, 40960, v228
    v_add_u32 v195, 40960, v229
    v_mfma_f32_16x16x32_bf16 v[56:59], v[188:191], a[24:27], v[56:59]
    buffer_load_dwordx4 v211, s[12:15], s71 offen offset:1024 lds
    v_mfma_f32_16x16x32_bf16 v[60:63], v[184:187], a[12:15], 0
    s_add_u32 s84, s84, s81
    ds_read_b128 a[32:35], v192 offset:0
    ds_read_b128 a[48:51], v194 offset:0
    v_mfma_f32_16x16x32_bf16 v[60:63], v[188:191], a[28:31], v[60:63]
    s_add_u32 s48, s84, s79
    ds_read_b64_tr_b16 v[184:185], v197 offset:1024
    ds_read_b64_tr_b16 v[186:187], v197 offset:1280
    s_waitcnt lgkmcnt(14)
    v_mfma_f32_16x16x32_bf16 v[64:67], v[160:163], a[0:3], 0
    s_add_u32 s48, s48, s77
    ds_read_b64_tr_b16 v[188:189], v197 offset:5120
    ds_read_b64_tr_b16 v[190:191], v197 offset:5376
    s_waitcnt lgkmcnt(14)
    v_mfma_f32_16x16x32_bf16 v[64:67], v[164:167], a[16:19], v[64:67]
    s_lshl_b32 s48, s48, 10
    ds_read_b128 a[36:39], v192 offset:2048
    ds_read_b128 a[52:55], v194 offset:2048
    v_mfma_f32_16x16x32_bf16 v[68:71], v[160:163], a[4:7], 0
    s_lshl_b32 s84, s77, 1
    ds_read_b128 a[40:43], v193 offset:0
    ds_read_b128 a[56:59], v195 offset:0
    v_mfma_f32_16x16x32_bf16 v[68:71], v[164:167], a[20:23], v[68:71]
    s_add_u32 m0, s41, 114688
    s_add_u32 s70, s45, 1179648
    buffer_load_dwordx4 v212, s[8:11], s70 offen lds
    s_add_u32 m0, s41, 115712
    s_nop 0
    buffer_load_dwordx4 v212, s[12:15], s70 offen lds
    s_waitcnt lgkmcnt(15)
    v_mfma_f32_16x16x32_bf16 v[72:75], v[168:171], a[0:3], 0
    s_xor_b32 s84, s84, 3
    ds_read_b64_tr_b16 v[160:161], v213 offset:57344
    ds_read_b64_tr_b16 v[162:163], v213 offset:57856
    s_waitcnt lgkmcnt(15)
    v_mfma_f32_16x16x32_bf16 v[72:75], v[172:175], a[16:19], v[72:75]
    s_add_u32 s84, s84, s80
    ds_read_b64_tr_b16 v[164:165], v214 offset:0
    ds_read_b64_tr_b16 v[166:167], v214 offset:512
    v_mfma_f32_16x16x32_bf16 v[76:79], v[168:171], a[4:7], 0
    s_mul_i32 s84, s84, 144
    ds_read_b128 a[44:47], v193 offset:2048
    ds_read_b128 a[60:63], v195 offset:2048
    v_mfma_f32_16x16x32_bf16 v[76:79], v[172:175], a[20:23], v[76:79]
    s_add_u32 s84, s84, s81
    ds_read_b64_tr_b16 v[168:169], v213 offset:59392
    ds_read_b64_tr_b16 v[170:171], v213 offset:59904
    s_waitcnt lgkmcnt(15)
    v_mfma_f32_16x16x32_bf16 v[80:83], v[176:179], a[0:3], 0
    s_add_u32 s49, s84, s79
    ds_read_b64_tr_b16 v[172:173], v214 offset:2048
    ds_read_b64_tr_b16 v[174:175], v214 offset:2560
    s_waitcnt lgkmcnt(15)
    v_mfma_f32_16x16x32_bf16 v[80:83], v[180:183], a[16:19], v[80:83]
    s_add_u32 m0, s40, 122880
    s_add_u32 s71, s43, 384
    s_add_u32 s49, s49, s77
    v_mfma_f32_16x16x32_bf16 v[84:87], v[176:179], a[4:7], 0
    buffer_load_dwordx4 v222, s[4:7], s71 offen lds
    v_mfma_f32_16x16x32_bf16 v[84:87], v[180:183], a[20:23], v[84:87]
    s_lshl_b32 s49, s49, 10
    ds_read_b64_tr_b16 v[176:177], v216 offset:57344
    ds_read_b64_tr_b16 v[178:179], v216 offset:57856
    s_waitcnt lgkmcnt(15)
    v_mfma_f32_16x16x32_bf16 v[88:91], v[184:187], a[0:3], 0
    s_mul_i32 s83, s38, 36
    ds_read_b64_tr_b16 v[180:181], v217 offset:0
    ds_read_b64_tr_b16 v[182:183], v217 offset:512
    s_waitcnt lgkmcnt(15)
    v_mfma_f32_16x16x32_bf16 v[88:91], v[188:191], a[16:19], v[88:91]
    s_mul_i32 s84, s76, 10
    s_add_u32 s52, s83, s84
    s_add_u32 s52, s52, s77
    v_mfma_f32_16x16x32_bf16 v[92:95], v[184:187], a[4:7], 0
    buffer_load_dwordx4 v223, s[4:7], s71 offen offset:1024 lds
    v_mfma_f32_16x16x32_bf16 v[92:95], v[188:191], a[20:23], v[92:95]
    s_mul_i32 s84, s76, 18
    ds_read_b64_tr_b16 v[184:185], v216 offset:59392
    ds_read_b64_tr_b16 v[186:187], v216 offset:59904
    s_waitcnt lgkmcnt(14)
    v_mfma_f32_16x16x32_bf16 v[0:3], v[160:163], a[32:35], v[0:3]
    s_add_u32 s53, s83, s84
    ds_read_b64_tr_b16 v[188:189], v217 offset:2048
    ds_read_b64_tr_b16 v[190:191], v217 offset:2560
    s_waitcnt lgkmcnt(14)
    v_mfma_f32_16x16x32_bf16 v[0:3], v[164:167], a[48:51], v[0:3]
    s_add_u32 s53, s53, s77
    s_add_u32 s53, s53, 8
    s_mul_i32 s52, s52, 36864
    v_mfma_f32_16x16x32_bf16 v[4:7], v[160:163], a[36:39], v[4:7]
    buffer_load_dwordx4 v224, s[4:7], s71 offen offset:2048 lds
    v_mfma_f32_16x16x32_bf16 v[4:7], v[164:167], a[52:55], v[4:7]
    s_mul_i32 s53, s53, 36864
    v_add_u32 v196, 73728, v230
    v_add_u32 v197, 73728, v231
    v_mfma_f32_16x16x32_bf16 v[8:11], v[160:163], a[40:43], v[8:11]
    s_mul_i32 s84, s39, 288
    s_add_u32 s52, s52, s84
    s_add_u32 s53, s53, s84
    v_mfma_f32_16x16x32_bf16 v[8:11], v[164:167], a[56:59], v[8:11]
    s_lshl_b32 s54, s37, 3
    s_lshl_b32 s84, s36, 1
    s_add_u32 s54, s54, s84
    s_waitcnt lgkmcnt(13)
    v_mfma_f32_16x16x32_bf16 v[12:15], v[160:163], a[44:47], v[12:15]
    s_waitcnt lgkmcnt(12)
    buffer_load_dwordx4 v225, s[4:7], s71 offen offset:3072 lds
    v_mfma_f32_16x16x32_bf16 v[12:15], v[164:167], a[60:63], v[12:15]
    s_mul_i32 s54, s54, 144
    ds_read_b64_tr_b16 v[160:161], v196 offset:0
    ds_read_b64_tr_b16 v[162:163], v196 offset:256
    s_waitcnt lgkmcnt(12)
    v_mfma_f32_16x16x32_bf16 v[16:19], v[168:171], a[32:35], v[16:19]
    s_add_u32 s54, s54, s83
    ds_read_b64_tr_b16 v[164:165], v196 offset:4096
    ds_read_b64_tr_b16 v[166:167], v196 offset:4352
    s_waitcnt lgkmcnt(12)
    v_mfma_f32_16x16x32_bf16 v[16:19], v[172:175], a[48:51], v[16:19]
    s_add_u32 m0, s40, 139264
    s_add_u32 s70, s44, 1769472
    s_lshl_b32 s54, s54, 10
    v_mfma_f32_16x16x32_bf16 v[20:23], v[168:171], a[36:39], v[20:23]
    buffer_load_dwordx4 v210, s[8:11], s70 offen lds
    v_mfma_f32_16x16x32_bf16 v[20:23], v[172:175], a[52:55], v[20:23]
    s_lshl_b32 s80, s37, 2
    s_add_u32 s80, s80, s39
    s_lshl_b32 s80, s80, 2
    v_mfma_f32_16x16x32_bf16 v[24:27], v[168:171], a[40:43], v[24:27]
    s_add_u32 s81, s38, 1
    s_and_b32 s81, s81, 3
    s_add_u32 s56, s80, s81
    v_mfma_f32_16x16x32_bf16 v[24:27], v[172:175], a[56:59], v[24:27]
    s_lshl_b32 s56, s56, 2
    s_add_u32 s56, s56, s38
    s_lshl_b32 s56, s56, 2
    v_mfma_f32_16x16x32_bf16 v[28:31], v[168:171], a[44:47], v[28:31]
    buffer_load_dwordx4 v211, s[8:11], s70 offen offset:1024 lds
    v_mfma_f32_16x16x32_bf16 v[28:31], v[172:175], a[60:63], v[28:31]
    s_add_u32 m0, s40, 141312
    ds_read_b64_tr_b16 v[168:169], v196 offset:1024
    ds_read_b64_tr_b16 v[170:171], v196 offset:1280
    s_waitcnt lgkmcnt(12)
    v_mfma_f32_16x16x32_bf16 v[32:35], v[176:179], a[32:35], v[32:35]
    s_add_u32 s56, s56, s36
    ds_read_b64_tr_b16 v[172:173], v196 offset:5120
    ds_read_b64_tr_b16 v[174:175], v196 offset:5376
    s_waitcnt lgkmcnt(12)
    v_mfma_f32_16x16x32_bf16 v[32:35], v[180:183], a[48:51], v[32:35]
    s_mul_i32 s56, s56, 2560
    s_add_u32 s61, s80, s38
    s_lshl_b32 s61, s61, 2
    v_mfma_f32_16x16x32_bf16 v[36:39], v[176:179], a[36:39], v[36:39]
    buffer_load_dwordx4 v210, s[12:15], s70 offen lds
    v_mfma_f32_16x16x32_bf16 v[36:39], v[180:183], a[52:55], v[36:39]
    s_add_u32 s61, s61, s81
    s_lshl_b32 s61, s61, 2
    s_add_u32 s61, s61, s36
    v_mfma_f32_16x16x32_bf16 v[40:43], v[176:179], a[40:43], v[40:43]
    s_mul_i32 s61, s61, 2560
    s_add_u32 s64, s61, 2048
    v_mfma_f32_16x16x32_bf16 v[40:43], v[180:183], a[56:59], v[40:43]
    s_cmp_lt_u32 s38, 2
    s_cselect_b32 s64, s64, 0x80000000
    s_add_u32 s81, s38, 2
    v_mfma_f32_16x16x32_bf16 v[44:47], v[176:179], a[44:47], v[44:47]
    buffer_load_dwordx4 v211, s[12:15], s70 offen offset:1024 lds
    v_mfma_f32_16x16x32_bf16 v[44:47], v[180:183], a[60:63], v[44:47]
    s_and_b32 s81, s81, 3
    ds_read_b64_tr_b16 v[176:177], v197 offset:0
    ds_read_b64_tr_b16 v[178:179], v197 offset:256
    s_waitcnt lgkmcnt(12)
    v_mfma_f32_16x16x32_bf16 v[48:51], v[184:187], a[32:35], v[48:51]
    s_add_u32 s57, s80, s81
    ds_read_b64_tr_b16 v[180:181], v197 offset:4096
    ds_read_b64_tr_b16 v[182:183], v197 offset:4352
    s_waitcnt lgkmcnt(12)
    v_mfma_f32_16x16x32_bf16 v[48:51], v[188:191], a[48:51], v[48:51]
    s_add_u32 m0, s41, 155648
    s_add_u32 s71, s45, 1769472
    s_lshl_b32 s57, s57, 2
    v_mfma_f32_16x16x32_bf16 v[52:55], v[184:187], a[36:39], v[52:55]
    s_waitcnt vmcnt(8)
    s_add_u32 s57, s57, s38
    s_lshl_b32 s57, s57, 2
    v_mfma_f32_16x16x32_bf16 v[52:55], v[188:191], a[52:55], v[52:55]
    s_barrier
    v_add_u32 v192, 81920, v226
    v_add_u32 v193, 81920, v227
    v_mfma_f32_16x16x32_bf16 v[56:59], v[184:187], a[40:43], v[56:59]
    buffer_load_dwordx4 v212, s[8:11], s71 offen lds
    v_mfma_f32_16x16x32_bf16 v[56:59], v[188:191], a[56:59], v[56:59]
    s_add_u32 m0, s41, 156672
    v_add_u32 v194, 81920, v228
    v_add_u32 v195, 81920, v229
    v_mfma_f32_16x16x32_bf16 v[60:63], v[184:187], a[44:47], v[60:63]
    s_add_u32 s57, s57, s36
    v_readfirstlane_b32 s55, v244
    ds_read_b128 a[64:67], v192 offset:0
    v_mfma_f32_16x16x32_bf16 v[60:63], v[188:191], a[60:63], v[60:63]
    s_mul_i32 s57, s57, 2560
    ds_read_b64_tr_b16 v[184:185], v197 offset:1024
    ds_read_b64_tr_b16 v[186:187], v197 offset:1280
    s_waitcnt lgkmcnt(13)
    v_mfma_f32_16x16x32_bf16 v[64:67], v[160:163], a[32:35], v[64:67]
    s_waitcnt lgkmcnt(11)
    buffer_load_dwordx4 v212, s[12:15], s71 offen lds
    v_mfma_f32_16x16x32_bf16 v[64:67], v[164:167], a[48:51], v[64:67]
    s_add_u32 s62, s80, s38
    ds_read_b64_tr_b16 v[188:189], v197 offset:5120
    ds_read_b64_tr_b16 v[190:191], v197 offset:5376
    v_mfma_f32_16x16x32_bf16 v[68:71], v[160:163], a[36:39], v[68:71]
    s_lshl_b32 s62, s62, 2
    ds_read_b128 a[80:83], v194 offset:0
    ds_read_b128 a[68:71], v192 offset:2048
    v_mfma_f32_16x16x32_bf16 v[68:71], v[164:167], a[52:55], v[68:71]
    s_add_u32 s55, s55, 1
    ds_read_b64_tr_b16 v[160:161], v214 offset:32768
    ds_read_b64_tr_b16 v[162:163], v214 offset:33280
    s_waitcnt lgkmcnt(15)
    v_mfma_f32_16x16x32_bf16 v[72:75], v[168:171], a[32:35], v[72:75]
    s_getreg_b32 s101, hwreg(HW_REG_XCC_ID, 0, 4)
    ds_read_b64_tr_b16 v[164:165], v214 offset:40960
    ds_read_b64_tr_b16 v[166:167], v214 offset:41472
    s_waitcnt lgkmcnt(15)
    v_mfma_f32_16x16x32_bf16 v[72:75], v[172:175], a[48:51], v[72:75]
    s_lshl_b32 s69, s55, 4
    ds_read_b128 a[84:87], v194 offset:2048
    ds_read_b128 a[72:75], v193 offset:0
    v_mfma_f32_16x16x32_bf16 v[76:79], v[168:171], a[36:39], v[76:79]
    s_add_u32 s62, s62, s81
    ds_read_b128 a[88:91], v195 offset:0
    ds_read_b128 a[76:79], v193 offset:2048
    v_mfma_f32_16x16x32_bf16 v[76:79], v[172:175], a[52:55], v[76:79]
    s_lshl_b32 s62, s62, 2
    ds_read_b64_tr_b16 v[168:169], v214 offset:34816
    ds_read_b64_tr_b16 v[170:171], v214 offset:35328
    s_waitcnt lgkmcnt(15)
    v_mfma_f32_16x16x32_bf16 v[80:83], v[176:179], a[32:35], v[80:83]
    s_add_u32 s62, s62, s36
    ds_read_b64_tr_b16 v[172:173], v214 offset:43008
    ds_read_b64_tr_b16 v[174:175], v214 offset:43520
    s_waitcnt lgkmcnt(15)
    v_mfma_f32_16x16x32_bf16 v[80:83], v[180:183], a[48:51], v[80:83]
    ds_read_b128 a[92:95], v195 offset:2048
    s_or_b32 s101, s101, s69
    v_mov_b32 v242, s101
    v_mfma_f32_16x16x32_bf16 v[84:87], v[176:179], a[36:39], v[84:87]
    buffer_store_dword v242, v241, s[28:31], s91 offen
    v_mfma_f32_16x16x32_bf16 v[84:87], v[180:183], a[52:55], v[84:87]
    s_mul_i32 s62, s62, 2560
    ds_read_b64_tr_b16 v[176:177], v217 offset:32768
    ds_read_b64_tr_b16 v[178:179], v217 offset:33280
    s_waitcnt lgkmcnt(15)
    v_mfma_f32_16x16x32_bf16 v[88:91], v[184:187], a[32:35], v[88:91]
    s_add_u32 s65, s62, 2048
    ds_read_b64_tr_b16 v[180:181], v217 offset:40960
    ds_read_b64_tr_b16 v[182:183], v217 offset:41472
    s_waitcnt lgkmcnt(15)
    v_mfma_f32_16x16x32_bf16 v[88:91], v[188:191], a[48:51], v[88:91]
    s_add_u32 m0, s40, 0
    s_add_u32 s70, s43, 512
    v_mfma_f32_16x16x32_bf16 v[92:95], v[184:187], a[36:39], v[92:95]
    buffer_load_dwordx4 v222, s[4:7], s70 offen lds
    v_mfma_f32_16x16x32_bf16 v[92:95], v[188:191], a[52:55], v[92:95]
    s_waitcnt lgkmcnt(15)
    ds_read_b64_tr_b16 v[184:185], v217 offset:34816
    ds_read_b64_tr_b16 v[186:187], v217 offset:35328
    v_mfma_f32_16x16x32_bf16 v[0:3], v[160:163], a[64:67], v[0:3]
    s_waitcnt lgkmcnt(15)
    ds_read_b64_tr_b16 v[188:189], v217 offset:43008
    ds_read_b64_tr_b16 v[190:191], v217 offset:43520
    v_mfma_f32_16x16x32_bf16 v[0:3], v[164:167], a[80:83], v[0:3]
    s_cmp_lt_u32 s38, 2
    s_cselect_b32 s65, s65, 0x80000000
    s_add_u32 s81, s38, 3
    v_mfma_f32_16x16x32_bf16 v[4:7], v[160:163], a[68:71], v[4:7]
    s_waitcnt lgkmcnt(15)
    buffer_load_dwordx4 v223, s[4:7], s70 offen offset:1024 lds
    v_mfma_f32_16x16x32_bf16 v[4:7], v[164:167], a[84:87], v[4:7]
    s_and_b32 s81, s81, 3
    v_add_u32 v196, 114688, v230
    v_add_u32 v197, 114688, v231
    s_waitcnt lgkmcnt(15)
    v_mfma_f32_16x16x32_bf16 v[8:11], v[160:163], a[72:75], v[8:11]
    s_add_u32 s58, s80, s81
    s_lshl_b32 s58, s58, 2
    s_add_u32 s58, s58, s38
    s_waitcnt lgkmcnt(14)
    v_mfma_f32_16x16x32_bf16 v[8:11], v[164:167], a[88:91], v[8:11]
    s_lshl_b32 s58, s58, 2
    s_add_u32 s58, s58, s36
    s_mul_i32 s58, s58, 2560
    s_waitcnt lgkmcnt(13)
    v_mfma_f32_16x16x32_bf16 v[12:15], v[160:163], a[76:79], v[12:15]
    s_waitcnt lgkmcnt(8)
    buffer_load_dwordx4 v224, s[4:7], s70 offen offset:2048 lds
    v_mfma_f32_16x16x32_bf16 v[12:15], v[164:167], a[92:95], v[12:15]
    s_add_u32 s63, s80, s38
    ds_read_b64_tr_b16 v[160:161], v196 offset:0
    ds_read_b64_tr_b16 v[162:163], v196 offset:256
    v_mfma_f32_16x16x32_bf16 v[16:19], v[168:171], a[64:67], v[16:19]
    s_lshl_b32 s63, s63, 2
    ds_read_b64_tr_b16 v[164:165], v196 offset:4096
    ds_read_b64_tr_b16 v[166:167], v196 offset:4352
    v_mfma_f32_16x16x32_bf16 v[16:19], v[172:175], a[80:83], v[16:19]
    s_add_u32 s63, s63, s81
    s_lshl_b32 s63, s63, 2
    s_add_u32 s63, s63, s36
    v_mfma_f32_16x16x32_bf16 v[20:23], v[168:171], a[68:71], v[20:23]
    buffer_load_dwordx4 v225, s[4:7], s70 offen offset:3072 lds
    v_mfma_f32_16x16x32_bf16 v[20:23], v[172:175], a[84:87], v[20:23]
    s_add_u32 m0, s40, 16384
    s_add_u32 s71, s44, 2359296
    s_mul_i32 s63, s63, 2560
    v_mfma_f32_16x16x32_bf16 v[24:27], v[168:171], a[72:75], v[24:27]
    s_add_u32 s66, s63, 2048
    s_cmp_lt_u32 s38, 2
    s_cselect_b32 s66, s66, 0x80000000
    v_mfma_f32_16x16x32_bf16 v[24:27], v[172:175], a[88:91], v[24:27]
    s_mov_b32 s81, 0
    s_add_u32 s59, s80, s81
    s_lshl_b32 s59, s59, 2
    v_mfma_f32_16x16x32_bf16 v[28:31], v[168:171], a[76:79], v[28:31]
    buffer_load_dwordx4 v210, s[8:11], s71 offen lds
    v_mfma_f32_16x16x32_bf16 v[28:31], v[172:175], a[92:95], v[28:31]
    s_add_u32 s59, s59, s38
    ds_read_b64_tr_b16 v[168:169], v196 offset:1024
    ds_read_b64_tr_b16 v[170:171], v196 offset:1280
    s_waitcnt lgkmcnt(12)
    v_mfma_f32_16x16x32_bf16 v[32:35], v[176:179], a[64:67], v[32:35]
    s_lshl_b32 s59, s59, 2
    ds_read_b64_tr_b16 v[172:173], v196 offset:5120
    ds_read_b64_tr_b16 v[174:175], v196 offset:5376
    s_waitcnt lgkmcnt(12)
    v_mfma_f32_16x16x32_bf16 v[32:35], v[180:183], a[80:83], v[32:35]
    s_add_u32 s59, s59, s36
    s_mul_i32 s59, s59, 2560
    s_add_u32 s59, s59, 2048
    v_mfma_f32_16x16x32_bf16 v[36:39], v[176:179], a[68:71], v[36:39]
    buffer_load_dwordx4 v211, s[8:11], s71 offen offset:1024 lds
    v_mfma_f32_16x16x32_bf16 v[36:39], v[180:183], a[84:87], v[36:39]
    s_add_u32 m0, s40, 18432
    s_cmp_eq_u32 s38, 0
    s_cselect_b32 s59, 0x80000000, s59
    v_mfma_f32_16x16x32_bf16 v[40:43], v[176:179], a[72:75], v[40:43]
    s_mov_b32 s81, 1
    s_add_u32 s60, s80, s81
    s_lshl_b32 s60, s60, 2
    v_mfma_f32_16x16x32_bf16 v[40:43], v[180:183], a[88:91], v[40:43]
    s_add_u32 s60, s60, s38
    s_lshl_b32 s60, s60, 2
    s_add_u32 s60, s60, s36
    v_mfma_f32_16x16x32_bf16 v[44:47], v[176:179], a[76:79], v[44:47]
    buffer_load_dwordx4 v210, s[12:15], s71 offen lds
    v_mfma_f32_16x16x32_bf16 v[44:47], v[180:183], a[92:95], v[44:47]
    s_mul_i32 s60, s60, 2560
    ds_read_b64_tr_b16 v[176:177], v197 offset:0
    ds_read_b64_tr_b16 v[178:179], v197 offset:256
    s_waitcnt lgkmcnt(12)
    v_mfma_f32_16x16x32_bf16 v[48:51], v[184:187], a[64:67], v[48:51]
    s_add_u32 s60, s60, 2048
    ds_read_b64_tr_b16 v[180:181], v197 offset:4096
    ds_read_b64_tr_b16 v[182:183], v197 offset:4352
    s_waitcnt lgkmcnt(12)
    v_mfma_f32_16x16x32_bf16 v[48:51], v[188:191], a[80:83], v[48:51]
    s_cmp_eq_u32 s38, 1
    s_cselect_b32 s60, 0x80000000, s60
    s_lshl_b32 s67, s37, 7
    v_mfma_f32_16x16x32_bf16 v[52:55], v[184:187], a[68:71], v[52:55]
    s_waitcnt vmcnt(8)
    s_lshl_b32 s84, s36, 5
    s_add_u32 s67, s67, s84
    v_mfma_f32_16x16x32_bf16 v[52:55], v[188:191], a[84:87], v[52:55]
    s_barrier
    v_add_u32 v192, 122880, v226
    v_add_u32 v193, 122880, v227
    v_mfma_f32_16x16x32_bf16 v[56:59], v[184:187], a[72:75], v[56:59]
    buffer_load_dwordx4 v211, s[12:15], s71 offen offset:1024 lds
    v_mfma_f32_16x16x32_bf16 v[56:59], v[188:191], a[88:91], v[56:59]
    s_mul_i32 s67, s67, 1152
    v_add_u32 v194, 122880, v228
    v_add_u32 v195, 122880, v229
    v_mfma_f32_16x16x32_bf16 v[60:63], v[184:187], a[76:79], v[60:63]
    s_mul_i32 s84, s39, 288
    ds_read_b128 a[96:99], v192 offset:0
    ds_read_b128 a[112:115], v194 offset:0
    v_mfma_f32_16x16x32_bf16 v[60:63], v[188:191], a[92:95], v[60:63]
    s_add_u32 s67, s67, s84
    ds_read_b64_tr_b16 v[184:185], v197 offset:1024
    ds_read_b64_tr_b16 v[186:187], v197 offset:1280
    s_waitcnt lgkmcnt(14)
    v_mfma_f32_16x16x32_bf16 v[64:67], v[160:163], a[64:67], v[64:67]
    s_mul_i32 s84, s38, 18432
    ds_read_b64_tr_b16 v[188:189], v197 offset:5120
    ds_read_b64_tr_b16 v[190:191], v197 offset:5376
    s_waitcnt lgkmcnt(14)
    v_mfma_f32_16x16x32_bf16 v[64:67], v[164:167], a[80:83], v[64:67]
    s_add_u32 s68, s67, s84
    ds_read_b128 a[100:103], v192 offset:2048
    ds_read_b128 a[116:119], v194 offset:2048
    v_mfma_f32_16x16x32_bf16 v[68:71], v[160:163], a[68:71], v[68:71]
    s_add_u32 s68, s68, 256
    ds_read_b128 a[104:107], v193 offset:0
    ds_read_b128 a[120:123], v195 offset:0
    v_mfma_f32_16x16x32_bf16 v[68:71], v[164:167], a[84:87], v[68:71]
    s_add_u32 m0, s41, 32768
    s_add_u32 s70, s45, 2359296
    buffer_load_dwordx4 v212, s[8:11], s70 offen lds
    s_add_u32 m0, s41, 33792
    s_nop 0
    buffer_load_dwordx4 v212, s[12:15], s70 offen lds
    s_waitcnt lgkmcnt(15)
    v_mfma_f32_16x16x32_bf16 v[72:75], v[168:171], a[64:67], v[72:75]
    s_waitcnt lgkmcnt(14)
    ds_read_b64_tr_b16 v[160:161], v215 offset:8192
    ds_read_b64_tr_b16 v[162:163], v215 offset:8704
    v_mfma_f32_16x16x32_bf16 v[72:75], v[172:175], a[80:83], v[72:75]
    ds_read_b64_tr_b16 v[164:165], v215 offset:16384
    ds_read_b64_tr_b16 v[166:167], v215 offset:16896
    v_mfma_f32_16x16x32_bf16 v[76:79], v[168:171], a[68:71], v[76:79]
    ds_read_b128 a[108:111], v193 offset:2048
    ds_read_b128 a[124:127], v195 offset:2048
    v_mfma_f32_16x16x32_bf16 v[76:79], v[172:175], a[84:87], v[76:79]
    s_waitcnt lgkmcnt(15)
    ds_read_b64_tr_b16 v[168:169], v215 offset:10240
    ds_read_b64_tr_b16 v[170:171], v215 offset:10752
    v_mfma_f32_16x16x32_bf16 v[80:83], v[176:179], a[64:67], v[80:83]
    s_waitcnt lgkmcnt(15)
    ds_read_b64_tr_b16 v[172:173], v215 offset:18432
    ds_read_b64_tr_b16 v[174:175], v215 offset:18944
    v_mfma_f32_16x16x32_bf16 v[80:83], v[180:183], a[80:83], v[80:83]
    s_add_u32 m0, s40, 40960
    s_add_u32 s71, s43, 640
    v_mfma_f32_16x16x32_bf16 v[84:87], v[176:179], a[68:71], v[84:87]
    buffer_load_dwordx4 v222, s[4:7], s71 offen lds
    v_mfma_f32_16x16x32_bf16 v[84:87], v[180:183], a[84:87], v[84:87]
    s_waitcnt lgkmcnt(15)
    ds_read_b64_tr_b16 v[176:177], v218 offset:8192
    ds_read_b64_tr_b16 v[178:179], v218 offset:8704
    v_mfma_f32_16x16x32_bf16 v[88:91], v[184:187], a[64:67], v[88:91]
    s_waitcnt lgkmcnt(15)
    ds_read_b64_tr_b16 v[180:181], v218 offset:16384
    ds_read_b64_tr_b16 v[182:183], v218 offset:16896
    v_mfma_f32_16x16x32_bf16 v[88:91], v[188:191], a[80:83], v[88:91]
    s_cmp_lt_u32 s38, 2
    s_cselect_b32 s68, s68, 0x80000000
    s_lshl_b32 s84, s38, 6
    v_mfma_f32_16x16x32_bf16 v[92:95], v[184:187], a[68:71], v[92:95]
    buffer_load_dwordx4 v223, s[4:7], s71 offen offset:1024 lds
    v_mfma_f32_16x16x32_bf16 v[92:95], v[188:191], a[84:87], v[92:95]
    s_add_u32 s67, s67, s84
    ds_read_b64_tr_b16 v[184:185], v218 offset:10240
    ds_read_b64_tr_b16 v[186:187], v218 offset:10752
    s_waitcnt lgkmcnt(14)
    v_mfma_f32_16x16x32_bf16 v[0:3], v[160:163], a[96:99], v[0:3]
    s_and_b32 s84, s37, 7
    ds_read_b64_tr_b16 v[188:189], v218 offset:18432
    ds_read_b64_tr_b16 v[190:191], v218 offset:18944
    s_waitcnt lgkmcnt(14)
    v_mfma_f32_16x16x32_bf16 v[0:3], v[164:167], a[112:115], v[0:3]
    s_lshl_b32 s84, s84, 2
    s_add_u32 s84, s84, s39
    s_and_b32 s81, s84, 7
    v_mfma_f32_16x16x32_bf16 v[4:7], v[160:163], a[100:103], v[4:7]
    buffer_load_dwordx4 v224, s[4:7], s71 offen offset:2048 lds
    v_mfma_f32_16x16x32_bf16 v[4:7], v[164:167], a[116:119], v[4:7]
    s_lshl_b32 s81, s81, 2
    v_add_u32 v196, 155648, v230
    v_add_u32 v197, 155648, v231
    v_mfma_f32_16x16x32_bf16 v[8:11], v[160:163], a[104:107], v[8:11]
    s_add_u32 s81, s81, s36
    s_lshr_b32 s84, s84, 3
    s_lshr_b32 s82, s84, 1
    v_mfma_f32_16x16x32_bf16 v[8:11], v[164:167], a[120:123], v[8:11]
    s_and_b32 s84, s84, 1
    s_mul_i32 s83, s38, 36
    s_add_u32 s83, s83, s84
    s_waitcnt lgkmcnt(13)
    v_mfma_f32_16x16x32_bf16 v[12:15], v[160:163], a[108:111], v[12:15]
    s_waitcnt lgkmcnt(12)
    buffer_load_dwordx4 v225, s[4:7], s71 offen offset:3072 lds
    v_mfma_f32_16x16x32_bf16 v[12:15], v[164:167], a[124:127], v[12:15]
    s_mul_i32 s84, s82, 10
    ds_read_b64_tr_b16 v[160:161], v196 offset:0
    ds_read_b64_tr_b16 v[162:163], v196 offset:256
    s_waitcnt lgkmcnt(12)
    v_mfma_f32_16x16x32_bf16 v[16:19], v[168:171], a[96:99], v[16:19]
    s_add_u32 s78, s83, s84
    ds_read_b64_tr_b16 v[164:165], v196 offset:4096
    ds_read_b64_tr_b16 v[166:167], v196 offset:4352
    s_waitcnt lgkmcnt(12)
    v_mfma_f32_16x16x32_bf16 v[16:19], v[172:175], a[112:115], v[16:19]
    s_add_u32 m0, s40, 57344
    s_add_u32 s70, s44, 2949120
    s_mul_i32 s84, s82, 18
    v_mfma_f32_16x16x32_bf16 v[20:23], v[168:171], a[100:103], v[20:23]
    buffer_load_dwordx4 v210, s[8:11], s70 offen lds
    v_mfma_f32_16x16x32_bf16 v[20:23], v[172:175], a[116:119], v[20:23]
    s_add_u32 s80, s83, s84
    s_add_u32 s80, s80, 8
    s_lshl_b32 s78, s78, 5
    v_mfma_f32_16x16x32_bf16 v[24:27], v[168:171], a[104:107], v[24:27]
    s_add_u32 s78, s78, s81
    s_mul_i32 s78, s78, 1152
    s_lshl_b32 s80, s80, 5
    v_mfma_f32_16x16x32_bf16 v[24:27], v[172:175], a[120:123], v[24:27]
    s_add_u32 s80, s80, s81
    s_mul_i32 s77, s80, 1152
    v_mfma_f32_16x16x32_bf16 v[28:31], v[168:171], a[108:111], v[28:31]
    buffer_load_dwordx4 v211, s[8:11], s70 offen offset:1024 lds
    v_mfma_f32_16x16x32_bf16 v[28:31], v[172:175], a[124:127], v[28:31]
    s_add_u32 m0, s40, 59392
    ds_read_b64_tr_b16 v[168:169], v196 offset:1024
    ds_read_b64_tr_b16 v[170:171], v196 offset:1280
    s_waitcnt lgkmcnt(12)
    v_mfma_f32_16x16x32_bf16 v[32:35], v[176:179], a[96:99], v[32:35]
    s_waitcnt lgkmcnt(10)
    ds_read_b64_tr_b16 v[172:173], v196 offset:5120
    ds_read_b64_tr_b16 v[174:175], v196 offset:5376
    v_mfma_f32_16x16x32_bf16 v[32:35], v[180:183], a[112:115], v[32:35]
    v_mfma_f32_16x16x32_bf16 v[36:39], v[176:179], a[100:103], v[36:39]
    buffer_load_dwordx4 v210, s[12:15], s70 offen lds
    v_mfma_f32_16x16x32_bf16 v[36:39], v[180:183], a[116:119], v[36:39]
    v_mfma_f32_16x16x32_bf16 v[40:43], v[176:179], a[104:107], v[40:43]
    v_mfma_f32_16x16x32_bf16 v[40:43], v[180:183], a[120:123], v[40:43]
    v_mfma_f32_16x16x32_bf16 v[44:47], v[176:179], a[108:111], v[44:47]
    buffer_load_dwordx4 v211, s[12:15], s70 offen offset:1024 lds
    v_mfma_f32_16x16x32_bf16 v[44:47], v[180:183], a[124:127], v[44:47]
    s_waitcnt lgkmcnt(10)
    ds_read_b64_tr_b16 v[176:177], v197 offset:0
    ds_read_b64_tr_b16 v[178:179], v197 offset:256
    v_mfma_f32_16x16x32_bf16 v[48:51], v[184:187], a[96:99], v[48:51]
    s_waitcnt lgkmcnt(10)
    ds_read_b64_tr_b16 v[180:181], v197 offset:4096
    ds_read_b64_tr_b16 v[182:183], v197 offset:4352
    v_mfma_f32_16x16x32_bf16 v[48:51], v[188:191], a[112:115], v[48:51]
    s_add_u32 m0, s41, 73728
    s_add_u32 s71, s45, 2949120
    v_mfma_f32_16x16x32_bf16 v[52:55], v[184:187], a[100:103], v[52:55]
    s_waitcnt vmcnt(8)
    v_mfma_f32_16x16x32_bf16 v[52:55], v[188:191], a[116:119], v[52:55]
    s_barrier
    v_add_u32 v192, 0, v226
    v_add_u32 v193, 0, v227
    v_mfma_f32_16x16x32_bf16 v[56:59], v[184:187], a[104:107], v[56:59]
    buffer_load_dwordx4 v212, s[8:11], s71 offen lds
    v_mfma_f32_16x16x32_bf16 v[56:59], v[188:191], a[120:123], v[56:59]
    s_add_u32 m0, s41, 74752
    v_add_u32 v194, 0, v228
    v_add_u32 v195, 0, v229
    v_mfma_f32_16x16x32_bf16 v[60:63], v[184:187], a[108:111], v[60:63]
    ds_read_b128 a[128:131], v192 offset:0
    ds_read_b128 a[144:147], v194 offset:0
    v_mfma_f32_16x16x32_bf16 v[60:63], v[188:191], a[124:127], v[60:63]
    s_waitcnt lgkmcnt(12)
    ds_read_b64_tr_b16 v[184:185], v197 offset:1024
    ds_read_b64_tr_b16 v[186:187], v197 offset:1280
    v_mfma_f32_16x16x32_bf16 v[64:67], v[160:163], a[96:99], v[64:67]
    s_waitcnt lgkmcnt(12)
    buffer_load_dwordx4 v212, s[12:15], s71 offen lds
    v_mfma_f32_16x16x32_bf16 v[64:67], v[164:167], a[112:115], v[64:67]
    ds_read_b64_tr_b16 v[188:189], v197 offset:5120
    ds_read_b64_tr_b16 v[190:191], v197 offset:5376
    v_mfma_f32_16x16x32_bf16 v[68:71], v[160:163], a[100:103], v[68:71]
    ds_read_b128 a[132:135], v192 offset:2048
    ds_read_b128 a[148:151], v194 offset:2048
    v_mfma_f32_16x16x32_bf16 v[68:71], v[164:167], a[116:119], v[68:71]
    s_waitcnt lgkmcnt(14)
    ds_read_b64_tr_b16 v[160:161], v213 offset:16384
    ds_read_b64_tr_b16 v[162:163], v213 offset:16896
    v_mfma_f32_16x16x32_bf16 v[72:75], v[168:171], a[96:99], v[72:75]
    s_waitcnt lgkmcnt(14)
    ds_read_b64_tr_b16 v[164:165], v213 offset:24576
    ds_read_b64_tr_b16 v[166:167], v213 offset:25088
    v_mfma_f32_16x16x32_bf16 v[72:75], v[172:175], a[112:115], v[72:75]
    ds_read_b128 a[136:139], v193 offset:0
    ds_read_b128 a[152:155], v195 offset:0
    v_mfma_f32_16x16x32_bf16 v[76:79], v[168:171], a[100:103], v[76:79]
    ds_read_b128 a[140:143], v193 offset:2048
    ds_read_b128 a[156:159], v195 offset:2048
    v_mfma_f32_16x16x32_bf16 v[76:79], v[172:175], a[116:119], v[76:79]
    s_waitcnt lgkmcnt(15)
    ds_read_b64_tr_b16 v[168:169], v213 offset:18432
    ds_read_b64_tr_b16 v[170:171], v213 offset:18944
    v_mfma_f32_16x16x32_bf16 v[80:83], v[176:179], a[96:99], v[80:83]
    s_waitcnt lgkmcnt(15)
    ds_read_b64_tr_b16 v[172:173], v213 offset:26624
    ds_read_b64_tr_b16 v[174:175], v213 offset:27136
    v_mfma_f32_16x16x32_bf16 v[80:83], v[180:183], a[112:115], v[80:83]
    s_add_u32 m0, s40, 81920
    s_add_u32 s70, s43, 768
    v_mfma_f32_16x16x32_bf16 v[84:87], v[176:179], a[100:103], v[84:87]
    buffer_load_dwordx4 v222, s[4:7], s70 offen lds
    v_mfma_f32_16x16x32_bf16 v[84:87], v[180:183], a[116:119], v[84:87]
    s_waitcnt lgkmcnt(15)
    ds_read_b64_tr_b16 v[176:177], v216 offset:16384
    ds_read_b64_tr_b16 v[178:179], v216 offset:16896
    v_mfma_f32_16x16x32_bf16 v[88:91], v[184:187], a[96:99], v[88:91]
    s_waitcnt lgkmcnt(15)
    ds_read_b64_tr_b16 v[180:181], v216 offset:24576
    ds_read_b64_tr_b16 v[182:183], v216 offset:25088
    v_mfma_f32_16x16x32_bf16 v[88:91], v[188:191], a[112:115], v[88:91]
    v_mfma_f32_16x16x32_bf16 v[92:95], v[184:187], a[100:103], v[92:95]
    buffer_load_dwordx4 v223, s[4:7], s70 offen offset:1024 lds
    v_mfma_f32_16x16x32_bf16 v[92:95], v[188:191], a[116:119], v[92:95]
    s_waitcnt lgkmcnt(14)
    ds_read_b64_tr_b16 v[184:185], v216 offset:18432
    ds_read_b64_tr_b16 v[186:187], v216 offset:18944
    v_mfma_f32_16x16x32_bf16 v[0:3], v[160:163], a[128:131], v[0:3]
    s_waitcnt lgkmcnt(14)
    ds_read_b64_tr_b16 v[188:189], v216 offset:26624
    ds_read_b64_tr_b16 v[190:191], v216 offset:27136
    v_mfma_f32_16x16x32_bf16 v[0:3], v[164:167], a[144:147], v[0:3]
    v_mfma_f32_16x16x32_bf16 v[4:7], v[160:163], a[132:135], v[4:7]
    s_add_u32 s75, s85, 128
    buffer_load_dword v255, v254, s[8:11], s75 offen
    v_mfma_f32_16x16x32_bf16 v[4:7], v[164:167], a[148:151], v[4:7]
    s_waitcnt lgkmcnt(15)
    v_add_u32 v196, 32768, v230
    v_add_u32 v197, 32768, v231
    v_mfma_f32_16x16x32_bf16 v[8:11], v[160:163], a[136:139], v[8:11]
    s_waitcnt lgkmcnt(14)
    v_mfma_f32_16x16x32_bf16 v[8:11], v[164:167], a[152:155], v[8:11]
    s_waitcnt lgkmcnt(13)
    v_mfma_f32_16x16x32_bf16 v[12:15], v[160:163], a[140:143], v[12:15]
    s_add_u32 s72, s85, 128
    buffer_load_dword v255, v254, s[12:15], s72 offen
    s_waitcnt lgkmcnt(12)
    v_mfma_f32_16x16x32_bf16 v[12:15], v[164:167], a[156:159], v[12:15]
    s_waitcnt lgkmcnt(10)
    ds_read_b64_tr_b16 v[160:161], v196 offset:0
    ds_read_b64_tr_b16 v[162:163], v196 offset:256
    v_mfma_f32_16x16x32_bf16 v[16:19], v[168:171], a[128:131], v[16:19]
    s_waitcnt lgkmcnt(10)
    ds_read_b64_tr_b16 v[164:165], v196 offset:4096
    ds_read_b64_tr_b16 v[166:167], v196 offset:4352
    v_mfma_f32_16x16x32_bf16 v[16:19], v[172:175], a[144:147], v[16:19]
    v_mfma_f32_16x16x32_bf16 v[20:23], v[168:171], a[132:135], v[20:23]
    buffer_load_dwordx4 v224, s[4:7], s70 offen offset:2048 lds
    v_mfma_f32_16x16x32_bf16 v[20:23], v[172:175], a[148:151], v[20:23]
    v_mfma_f32_16x16x32_bf16 v[24:27], v[168:171], a[136:139], v[24:27]
    v_mfma_f32_16x16x32_bf16 v[24:27], v[172:175], a[152:155], v[24:27]
    v_mfma_f32_16x16x32_bf16 v[28:31], v[168:171], a[140:143], v[28:31]
    buffer_load_dwordx4 v225, s[4:7], s70 offen offset:3072 lds
    v_mfma_f32_16x16x32_bf16 v[28:31], v[172:175], a[156:159], v[28:31]
    s_waitcnt lgkmcnt(10)
    ds_read_b64_tr_b16 v[168:169], v196 offset:1024
    ds_read_b64_tr_b16 v[170:171], v196 offset:1280
    v_mfma_f32_16x16x32_bf16 v[32:35], v[176:179], a[128:131], v[32:35]
    s_waitcnt lgkmcnt(10)
    ds_read_b64_tr_b16 v[172:173], v196 offset:5120
    ds_read_b64_tr_b16 v[174:175], v196 offset:5376
    v_mfma_f32_16x16x32_bf16 v[32:35], v[180:183], a[144:147], v[32:35]
    s_add_u32 m0, s40, 98304
    s_add_u32 s71, s44, 3538944
    v_mfma_f32_16x16x32_bf16 v[36:39], v[176:179], a[132:135], v[36:39]
    buffer_load_dwordx4 v210, s[8:11], s71 offen lds
    v_mfma_f32_16x16x32_bf16 v[36:39], v[180:183], a[148:151], v[36:39]
    v_mfma_f32_16x16x32_bf16 v[40:43], v[176:179], a[136:139], v[40:43]
    v_mfma_f32_16x16x32_bf16 v[40:43], v[180:183], a[152:155], v[40:43]
    v_mfma_f32_16x16x32_bf16 v[44:47], v[176:179], a[140:143], v[44:47]
    buffer_load_dwordx4 v211, s[8:11], s71 offen offset:1024 lds
    v_mfma_f32_16x16x32_bf16 v[44:47], v[180:183], a[156:159], v[44:47]
    s_add_u32 m0, s40, 100352
    ds_read_b64_tr_b16 v[176:177], v197 offset:0
    ds_read_b64_tr_b16 v[178:179], v197 offset:256
    s_waitcnt lgkmcnt(12)
    v_mfma_f32_16x16x32_bf16 v[48:51], v[184:187], a[128:131], v[48:51]
    s_waitcnt lgkmcnt(10)
    ds_read_b64_tr_b16 v[180:181], v197 offset:4096
    ds_read_b64_tr_b16 v[182:183], v197 offset:4352
    v_mfma_f32_16x16x32_bf16 v[48:51], v[188:191], a[144:147], v[48:51]
    v_mfma_f32_16x16x32_bf16 v[52:55], v[184:187], a[132:135], v[52:55]
    s_waitcnt vmcnt(8)
    v_mfma_f32_16x16x32_bf16 v[52:55], v[188:191], a[148:151], v[52:55]
    s_barrier
    v_add_u32 v192, 40960, v226
    v_add_u32 v193, 40960, v227
    v_mfma_f32_16x16x32_bf16 v[56:59], v[184:187], a[136:139], v[56:59]
    buffer_load_dwordx4 v210, s[12:15], s71 offen lds
    v_mfma_f32_16x16x32_bf16 v[56:59], v[188:191], a[152:155], v[56:59]
    v_add_u32 v194, 40960, v228
    v_add_u32 v195, 40960, v229
    v_mfma_f32_16x16x32_bf16 v[60:63], v[184:187], a[140:143], v[60:63]
    ds_read_b128 a[160:163], v192 offset:0
    ds_read_b128 a[176:179], v194 offset:0
    v_mfma_f32_16x16x32_bf16 v[60:63], v[188:191], a[156:159], v[60:63]
    s_waitcnt lgkmcnt(12)
    ds_read_b64_tr_b16 v[184:185], v197 offset:1024
    ds_read_b64_tr_b16 v[186:187], v197 offset:1280
    v_mfma_f32_16x16x32_bf16 v[64:67], v[160:163], a[128:131], v[64:67]
    s_waitcnt lgkmcnt(12)
    buffer_load_dwordx4 v211, s[12:15], s71 offen offset:1024 lds
    v_mfma_f32_16x16x32_bf16 v[64:67], v[164:167], a[144:147], v[64:67]
    ds_read_b64_tr_b16 v[188:189], v197 offset:5120
    ds_read_b64_tr_b16 v[190:191], v197 offset:5376
    v_mfma_f32_16x16x32_bf16 v[68:71], v[160:163], a[132:135], v[68:71]
    ds_read_b128 a[164:167], v192 offset:2048
    ds_read_b128 a[180:183], v194 offset:2048
    v_mfma_f32_16x16x32_bf16 v[68:71], v[164:167], a[148:151], v[68:71]
    s_add_u32 m0, s41, 114688
    s_add_u32 s70, s45, 3538944
    buffer_load_dwordx4 v212, s[8:11], s70 offen lds
    s_add_u32 m0, s41, 115712
    s_nop 0
    buffer_load_dwordx4 v212, s[12:15], s70 offen lds
    s_waitcnt lgkmcnt(14)
    v_mfma_f32_16x16x32_bf16 v[72:75], v[168:171], a[128:131], v[72:75]
    s_waitcnt lgkmcnt(12)
    ds_read_b64_tr_b16 v[160:161], v213 offset:57344
    ds_read_b64_tr_b16 v[162:163], v213 offset:57856
    v_mfma_f32_16x16x32_bf16 v[72:75], v[172:175], a[144:147], v[72:75]
    ds_read_b64_tr_b16 v[164:165], v214 offset:0
    ds_read_b64_tr_b16 v[166:167], v214 offset:512
    v_mfma_f32_16x16x32_bf16 v[76:79], v[168:171], a[132:135], v[76:79]
    ds_read_b128 a[168:171], v193 offset:0
    ds_read_b128 a[184:187], v195 offset:0
    v_mfma_f32_16x16x32_bf16 v[76:79], v[172:175], a[148:151], v[76:79]
    s_waitcnt lgkmcnt(15)
    ds_read_b64_tr_b16 v[168:169], v213 offset:59392
    ds_read_b64_tr_b16 v[170:171], v213 offset:59904
    v_mfma_f32_16x16x32_bf16 v[80:83], v[176:179], a[128:131], v[80:83]
    s_waitcnt lgkmcnt(15)
    ds_read_b64_tr_b16 v[172:173], v214 offset:2048
    ds_read_b64_tr_b16 v[174:175], v214 offset:2560
    v_mfma_f32_16x16x32_bf16 v[80:83], v[180:183], a[144:147], v[80:83]
    ds_read_b128 a[172:175], v193 offset:2048
    ds_read_b128 a[188:191], v195 offset:2048
    v_mfma_f32_16x16x32_bf16 v[84:87], v[176:179], a[132:135], v[84:87]
    s_add_u32 m0, s40, 122880
    s_add_u32 s71, s43, 896
    v_mfma_f32_16x16x32_bf16 v[84:87], v[180:183], a[148:151], v[84:87]
    s_waitcnt lgkmcnt(15)
    buffer_load_dwordx4 v222, s[4:7], s71 offen lds
    v_mfma_f32_16x16x32_bf16 v[88:91], v[184:187], a[128:131], v[88:91]
    s_waitcnt lgkmcnt(14)
    ds_read_b64_tr_b16 v[176:177], v216 offset:57344
    ds_read_b64_tr_b16 v[178:179], v216 offset:57856
    v_mfma_f32_16x16x32_bf16 v[88:91], v[188:191], a[144:147], v[88:91]
    ds_read_b64_tr_b16 v[180:181], v217 offset:0
    ds_read_b64_tr_b16 v[182:183], v217 offset:512
    v_mfma_f32_16x16x32_bf16 v[92:95], v[184:187], a[132:135], v[92:95]
    v_mfma_f32_16x16x32_bf16 v[92:95], v[188:191], a[148:151], v[92:95]
    s_waitcnt lgkmcnt(14)
    buffer_load_dwordx4 v223, s[4:7], s71 offen offset:1024 lds
    v_mfma_f32_16x16x32_bf16 v[0:3], v[160:163], a[160:163], v[0:3]
    s_waitcnt lgkmcnt(12)
    ds_read_b64_tr_b16 v[184:185], v216 offset:59392
    ds_read_b64_tr_b16 v[186:187], v216 offset:59904
    v_mfma_f32_16x16x32_bf16 v[0:3], v[164:167], a[176:179], v[0:3]
    ds_read_b64_tr_b16 v[188:189], v217 offset:2048
    ds_read_b64_tr_b16 v[190:191], v217 offset:2560
    v_mfma_f32_16x16x32_bf16 v[4:7], v[160:163], a[164:167], v[4:7]
    v_mfma_f32_16x16x32_bf16 v[4:7], v[164:167], a[180:183], v[4:7]
    s_waitcnt lgkmcnt(15)
    buffer_load_dwordx4 v224, s[4:7], s71 offen offset:2048 lds
    v_mfma_f32_16x16x32_bf16 v[8:11], v[160:163], a[168:171], v[8:11]
    s_waitcnt lgkmcnt(14)
    v_add_u32 v196, 73728, v230
    v_add_u32 v197, 73728, v231
    v_mfma_f32_16x16x32_bf16 v[8:11], v[164:167], a[184:187], v[8:11]
    s_waitcnt lgkmcnt(9)
    v_mfma_f32_16x16x32_bf16 v[12:15], v[160:163], a[172:175], v[12:15]
    s_waitcnt lgkmcnt(8)
    v_mfma_f32_16x16x32_bf16 v[12:15], v[164:167], a[188:191], v[12:15]
    buffer_load_dwordx4 v225, s[4:7], s71 offen offset:3072 lds
    v_mfma_f32_16x16x32_bf16 v[16:19], v[168:171], a[160:163], v[16:19]
    ds_read_b64_tr_b16 v[160:161], v196 offset:0
    ds_read_b64_tr_b16 v[162:163], v196 offset:256
    v_mfma_f32_16x16x32_bf16 v[16:19], v[172:175], a[176:179], v[16:19]
    ds_read_b64_tr_b16 v[164:165], v196 offset:4096
    ds_read_b64_tr_b16 v[166:167], v196 offset:4352
    v_mfma_f32_16x16x32_bf16 v[20:23], v[168:171], a[164:167], v[20:23]
    s_add_u32 m0, s40, 139264
    s_add_u32 s70, s44, 4128768
    v_mfma_f32_16x16x32_bf16 v[20:23], v[172:175], a[180:183], v[20:23]
    buffer_load_dwordx4 v210, s[8:11], s70 offen lds
    v_mfma_f32_16x16x32_bf16 v[24:27], v[168:171], a[168:171], v[24:27]
    v_mfma_f32_16x16x32_bf16 v[24:27], v[172:175], a[184:187], v[24:27]
    v_mfma_f32_16x16x32_bf16 v[28:31], v[168:171], a[172:175], v[28:31]
    v_mfma_f32_16x16x32_bf16 v[28:31], v[172:175], a[188:191], v[28:31]
    s_waitcnt lgkmcnt(10)
    buffer_load_dwordx4 v211, s[8:11], s70 offen offset:1024 lds
    v_mfma_f32_16x16x32_bf16 v[32:35], v[176:179], a[160:163], v[32:35]
    s_add_u32 m0, s40, 141312
    ds_read_b64_tr_b16 v[168:169], v196 offset:1024
    ds_read_b64_tr_b16 v[170:171], v196 offset:1280
    s_waitcnt lgkmcnt(10)
    v_mfma_f32_16x16x32_bf16 v[32:35], v[180:183], a[176:179], v[32:35]
    ds_read_b64_tr_b16 v[172:173], v196 offset:5120
    ds_read_b64_tr_b16 v[174:175], v196 offset:5376
    v_mfma_f32_16x16x32_bf16 v[36:39], v[176:179], a[164:167], v[36:39]
    v_mfma_f32_16x16x32_bf16 v[36:39], v[180:183], a[180:183], v[36:39]
    buffer_load_dwordx4 v210, s[12:15], s70 offen lds
    v_mfma_f32_16x16x32_bf16 v[40:43], v[176:179], a[168:171], v[40:43]
    v_mfma_f32_16x16x32_bf16 v[40:43], v[180:183], a[184:187], v[40:43]
    v_mfma_f32_16x16x32_bf16 v[44:47], v[176:179], a[172:175], v[44:47]
    v_mfma_f32_16x16x32_bf16 v[44:47], v[180:183], a[188:191], v[44:47]
    s_waitcnt lgkmcnt(10)
    buffer_load_dwordx4 v211, s[12:15], s70 offen offset:1024 lds
    v_mfma_f32_16x16x32_bf16 v[48:51], v[184:187], a[160:163], v[48:51]
    s_waitcnt lgkmcnt(8)
    ds_read_b64_tr_b16 v[176:177], v197 offset:0
    ds_read_b64_tr_b16 v[178:179], v197 offset:256
    v_mfma_f32_16x16x32_bf16 v[48:51], v[188:191], a[176:179], v[48:51]
    ds_read_b64_tr_b16 v[180:181], v197 offset:4096
    ds_read_b64_tr_b16 v[182:183], v197 offset:4352
    v_mfma_f32_16x16x32_bf16 v[52:55], v[184:187], a[164:167], v[52:55]
    s_waitcnt vmcnt(8)
    s_add_u32 m0, s41, 155648
    s_add_u32 s71, s45, 4128768
    v_mfma_f32_16x16x32_bf16 v[52:55], v[188:191], a[180:183], v[52:55]
    s_barrier
    v_add_u32 v192, 81920, v226
    v_add_u32 v193, 81920, v227
    v_mfma_f32_16x16x32_bf16 v[56:59], v[184:187], a[168:171], v[56:59]
    buffer_load_dwordx4 v212, s[8:11], s71 offen lds
    v_mfma_f32_16x16x32_bf16 v[56:59], v[188:191], a[184:187], v[56:59]
    s_add_u32 m0, s41, 156672
    v_add_u32 v194, 81920, v228
    v_add_u32 v195, 81920, v229
    v_mfma_f32_16x16x32_bf16 v[60:63], v[184:187], a[172:175], v[60:63]
    ds_read_b128 a[192:195], v192 offset:0
    ds_read_b128 a[208:211], v194 offset:0
    v_mfma_f32_16x16x32_bf16 v[60:63], v[188:191], a[188:191], v[60:63]
    s_waitcnt lgkmcnt(12)
    ds_read_b64_tr_b16 v[184:185], v197 offset:1024
    ds_read_b64_tr_b16 v[186:187], v197 offset:1280
    v_mfma_f32_16x16x32_bf16 v[64:67], v[160:163], a[160:163], v[64:67]
    s_waitcnt lgkmcnt(12)
    buffer_load_dwordx4 v212, s[12:15], s71 offen lds
    v_mfma_f32_16x16x32_bf16 v[64:67], v[164:167], a[176:179], v[64:67]
    ds_read_b64_tr_b16 v[188:189], v197 offset:5120
    ds_read_b64_tr_b16 v[190:191], v197 offset:5376
    v_mfma_f32_16x16x32_bf16 v[68:71], v[160:163], a[164:167], v[68:71]
    ds_read_b128 a[196:199], v192 offset:2048
    ds_read_b128 a[212:215], v194 offset:2048
    v_mfma_f32_16x16x32_bf16 v[68:71], v[164:167], a[180:183], v[68:71]
    s_waitcnt lgkmcnt(14)
    ds_read_b64_tr_b16 v[160:161], v214 offset:32768
    ds_read_b64_tr_b16 v[162:163], v214 offset:33280
    v_mfma_f32_16x16x32_bf16 v[72:75], v[168:171], a[160:163], v[72:75]
    s_waitcnt lgkmcnt(14)
    ds_read_b64_tr_b16 v[164:165], v214 offset:40960
    ds_read_b64_tr_b16 v[166:167], v214 offset:41472
    v_mfma_f32_16x16x32_bf16 v[72:75], v[172:175], a[176:179], v[72:75]
    ds_read_b128 a[200:203], v193 offset:0
    ds_read_b128 a[216:219], v195 offset:0
    v_mfma_f32_16x16x32_bf16 v[76:79], v[168:171], a[164:167], v[76:79]
    ds_read_b128 a[204:207], v193 offset:2048
    ds_read_b128 a[220:223], v195 offset:2048
    v_mfma_f32_16x16x32_bf16 v[76:79], v[172:175], a[180:183], v[76:79]
    s_waitcnt lgkmcnt(15)
    ds_read_b64_tr_b16 v[168:169], v214 offset:34816
    ds_read_b64_tr_b16 v[170:171], v214 offset:35328
    v_mfma_f32_16x16x32_bf16 v[80:83], v[176:179], a[160:163], v[80:83]
    s_waitcnt lgkmcnt(15)
    ds_read_b64_tr_b16 v[172:173], v214 offset:43008
    ds_read_b64_tr_b16 v[174:175], v214 offset:43520
    v_mfma_f32_16x16x32_bf16 v[80:83], v[180:183], a[176:179], v[80:83]
    s_add_u32 m0, s40, 0
    s_add_u32 s70, s43, 1024
    v_mfma_f32_16x16x32_bf16 v[84:87], v[176:179], a[164:167], v[84:87]
    buffer_load_dwordx4 v222, s[4:7], s70 offen lds
    v_mfma_f32_16x16x32_bf16 v[84:87], v[180:183], a[180:183], v[84:87]
    s_waitcnt lgkmcnt(15)
    ds_read_b64_tr_b16 v[176:177], v217 offset:32768
    ds_read_b64_tr_b16 v[178:179], v217 offset:33280
    v_mfma_f32_16x16x32_bf16 v[88:91], v[184:187], a[160:163], v[88:91]
    s_waitcnt lgkmcnt(15)
    ds_read_b64_tr_b16 v[180:181], v217 offset:40960
    ds_read_b64_tr_b16 v[182:183], v217 offset:41472
    v_mfma_f32_16x16x32_bf16 v[88:91], v[188:191], a[176:179], v[88:91]
    v_mfma_f32_16x16x32_bf16 v[92:95], v[184:187], a[164:167], v[92:95]
    buffer_load_dwordx4 v223, s[4:7], s70 offen offset:1024 lds
    v_mfma_f32_16x16x32_bf16 v[92:95], v[188:191], a[180:183], v[92:95]
    s_waitcnt lgkmcnt(14)
    ds_read_b64_tr_b16 v[184:185], v217 offset:34816
    ds_read_b64_tr_b16 v[186:187], v217 offset:35328
    v_mfma_f32_16x16x32_bf16 v[0:3], v[160:163], a[192:195], v[0:3]
    s_waitcnt lgkmcnt(14)
    ds_read_b64_tr_b16 v[188:189], v217 offset:43008
    ds_read_b64_tr_b16 v[190:191], v217 offset:43520
    v_mfma_f32_16x16x32_bf16 v[0:3], v[164:167], a[208:211], v[0:3]
    v_mfma_f32_16x16x32_bf16 v[4:7], v[160:163], a[196:199], v[4:7]
    buffer_load_dwordx4 v224, s[4:7], s70 offen offset:2048 lds
    v_mfma_f32_16x16x32_bf16 v[4:7], v[164:167], a[212:215], v[4:7]
    s_waitcnt lgkmcnt(15)
    v_add_u32 v196, 114688, v230
    v_add_u32 v197, 114688, v231
    v_mfma_f32_16x16x32_bf16 v[8:11], v[160:163], a[200:203], v[8:11]
    s_waitcnt lgkmcnt(14)
    v_mfma_f32_16x16x32_bf16 v[8:11], v[164:167], a[216:219], v[8:11]
    s_waitcnt lgkmcnt(13)
    v_mfma_f32_16x16x32_bf16 v[12:15], v[160:163], a[204:207], v[12:15]
    s_waitcnt lgkmcnt(12)
    buffer_load_dwordx4 v225, s[4:7], s70 offen offset:3072 lds
    v_mfma_f32_16x16x32_bf16 v[12:15], v[164:167], a[220:223], v[12:15]
    s_waitcnt lgkmcnt(10)
    ds_read_b64_tr_b16 v[160:161], v196 offset:0
    ds_read_b64_tr_b16 v[162:163], v196 offset:256
    v_mfma_f32_16x16x32_bf16 v[16:19], v[168:171], a[192:195], v[16:19]
    s_waitcnt lgkmcnt(10)
    ds_read_b64_tr_b16 v[164:165], v196 offset:4096
    ds_read_b64_tr_b16 v[166:167], v196 offset:4352
    v_mfma_f32_16x16x32_bf16 v[16:19], v[172:175], a[208:211], v[16:19]
    s_add_u32 m0, s40, 16384
    s_add_u32 s71, s44, 4718592
    v_mfma_f32_16x16x32_bf16 v[20:23], v[168:171], a[196:199], v[20:23]
    buffer_load_dwordx4 v210, s[8:11], s71 offen lds
    v_mfma_f32_16x16x32_bf16 v[20:23], v[172:175], a[212:215], v[20:23]
    v_mfma_f32_16x16x32_bf16 v[24:27], v[168:171], a[200:203], v[24:27]
    v_mfma_f32_16x16x32_bf16 v[24:27], v[172:175], a[216:219], v[24:27]
    v_mfma_f32_16x16x32_bf16 v[28:31], v[168:171], a[204:207], v[28:31]
    buffer_load_dwordx4 v211, s[8:11], s71 offen offset:1024 lds
    v_mfma_f32_16x16x32_bf16 v[28:31], v[172:175], a[220:223], v[28:31]
    s_add_u32 m0, s40, 18432
    ds_read_b64_tr_b16 v[168:169], v196 offset:1024
    ds_read_b64_tr_b16 v[170:171], v196 offset:1280
    s_waitcnt lgkmcnt(12)
    v_mfma_f32_16x16x32_bf16 v[32:35], v[176:179], a[192:195], v[32:35]
    s_waitcnt lgkmcnt(10)
    ds_read_b64_tr_b16 v[172:173], v196 offset:5120
    ds_read_b64_tr_b16 v[174:175], v196 offset:5376
    v_mfma_f32_16x16x32_bf16 v[32:35], v[180:183], a[208:211], v[32:35]
    v_mfma_f32_16x16x32_bf16 v[36:39], v[176:179], a[196:199], v[36:39]
    buffer_load_dwordx4 v210, s[12:15], s71 offen lds
    v_mfma_f32_16x16x32_bf16 v[36:39], v[180:183], a[212:215], v[36:39]
    v_mfma_f32_16x16x32_bf16 v[40:43], v[176:179], a[200:203], v[40:43]
    v_mfma_f32_16x16x32_bf16 v[40:43], v[180:183], a[216:219], v[40:43]
    v_mfma_f32_16x16x32_bf16 v[44:47], v[176:179], a[204:207], v[44:47]
    buffer_load_dwordx4 v211, s[12:15], s71 offen offset:1024 lds
    v_mfma_f32_16x16x32_bf16 v[44:47], v[180:183], a[220:223], v[44:47]
    s_waitcnt lgkmcnt(10)
    ds_read_b64_tr_b16 v[176:177], v197 offset:0
    ds_read_b64_tr_b16 v[178:179], v197 offset:256
    v_mfma_f32_16x16x32_bf16 v[48:51], v[184:187], a[192:195], v[48:51]
    s_waitcnt lgkmcnt(10)
    ds_read_b64_tr_b16 v[180:181], v197 offset:4096
    ds_read_b64_tr_b16 v[182:183], v197 offset:4352
    v_mfma_f32_16x16x32_bf16 v[48:51], v[188:191], a[208:211], v[48:51]
    s_add_u32 m0, s41, 32768
    s_add_u32 s70, s45, 4718592
    v_mfma_f32_16x16x32_bf16 v[52:55], v[184:187], a[196:199], v[52:55]
    s_waitcnt vmcnt(8)
    v_mfma_f32_16x16x32_bf16 v[52:55], v[188:191], a[212:215], v[52:55]
    s_barrier
    v_add_u32 v192, 122880, v226
    v_add_u32 v193, 122880, v227
    v_mfma_f32_16x16x32_bf16 v[56:59], v[184:187], a[200:203], v[56:59]
    buffer_load_dwordx4 v212, s[8:11], s70 offen lds
    v_mfma_f32_16x16x32_bf16 v[56:59], v[188:191], a[216:219], v[56:59]
    s_add_u32 m0, s41, 33792
    v_add_u32 v194, 122880, v228
    v_add_u32 v195, 122880, v229
    v_mfma_f32_16x16x32_bf16 v[60:63], v[184:187], a[204:207], v[60:63]
    ds_read_b128 a[224:227], v192 offset:0
    ds_read_b128 a[240:243], v194 offset:0
    v_mfma_f32_16x16x32_bf16 v[60:63], v[188:191], a[220:223], v[60:63]
    s_waitcnt lgkmcnt(12)
    ds_read_b64_tr_b16 v[184:185], v197 offset:1024
    ds_read_b64_tr_b16 v[186:187], v197 offset:1280
    v_mfma_f32_16x16x32_bf16 v[64:67], v[160:163], a[192:195], v[64:67]
    s_waitcnt lgkmcnt(12)
    buffer_load_dwordx4 v212, s[12:15], s70 offen lds
    v_mfma_f32_16x16x32_bf16 v[64:67], v[164:167], a[208:211], v[64:67]
    ds_read_b64_tr_b16 v[188:189], v197 offset:5120
    ds_read_b64_tr_b16 v[190:191], v197 offset:5376
    v_mfma_f32_16x16x32_bf16 v[68:71], v[160:163], a[196:199], v[68:71]
    ds_read_b128 a[228:231], v192 offset:2048
    ds_read_b128 a[244:247], v194 offset:2048
    v_mfma_f32_16x16x32_bf16 v[68:71], v[164:167], a[212:215], v[68:71]
    s_waitcnt lgkmcnt(14)
    ds_read_b64_tr_b16 v[160:161], v215 offset:8192
    ds_read_b64_tr_b16 v[162:163], v215 offset:8704
    v_mfma_f32_16x16x32_bf16 v[72:75], v[168:171], a[192:195], v[72:75]
    s_waitcnt lgkmcnt(14)
    ds_read_b64_tr_b16 v[164:165], v215 offset:16384
    ds_read_b64_tr_b16 v[166:167], v215 offset:16896
    v_mfma_f32_16x16x32_bf16 v[72:75], v[172:175], a[208:211], v[72:75]
    ds_read_b128 a[232:235], v193 offset:0
    ds_read_b128 a[248:251], v195 offset:0
    v_mfma_f32_16x16x32_bf16 v[76:79], v[168:171], a[196:199], v[76:79]
    ds_read_b128 a[236:239], v193 offset:2048
    ds_read_b128 a[252:255], v195 offset:2048
    v_mfma_f32_16x16x32_bf16 v[76:79], v[172:175], a[212:215], v[76:79]
    s_waitcnt lgkmcnt(15)
    ds_read_b64_tr_b16 v[168:169], v215 offset:10240
    ds_read_b64_tr_b16 v[170:171], v215 offset:10752
    v_mfma_f32_16x16x32_bf16 v[80:83], v[176:179], a[192:195], v[80:83]
    s_waitcnt lgkmcnt(15)
    ds_read_b64_tr_b16 v[172:173], v215 offset:18432
    ds_read_b64_tr_b16 v[174:175], v215 offset:18944
    v_mfma_f32_16x16x32_bf16 v[80:83], v[180:183], a[208:211], v[80:83]
    s_add_u32 m0, s40, 40960
    s_add_u32 s71, s44, 128
    v_mfma_f32_16x16x32_bf16 v[84:87], v[176:179], a[196:199], v[84:87]
    buffer_load_dword v244, v243, s[28:31], s91 offen sc1
    v_mfma_f32_16x16x32_bf16 v[84:87], v[180:183], a[212:215], v[84:87]
    s_waitcnt lgkmcnt(15)
    ds_read_b64_tr_b16 v[176:177], v218 offset:8192
    ds_read_b64_tr_b16 v[178:179], v218 offset:8704
    v_mfma_f32_16x16x32_bf16 v[88:91], v[184:187], a[192:195], v[88:91]
    s_waitcnt lgkmcnt(15)
    ds_read_b64_tr_b16 v[180:181], v218 offset:16384
    ds_read_b64_tr_b16 v[182:183], v218 offset:16896
    v_mfma_f32_16x16x32_bf16 v[88:91], v[188:191], a[208:211], v[88:91]
    v_mfma_f32_16x16x32_bf16 v[92:95], v[184:187], a[196:199], v[92:95]
    buffer_load_dwordx4 v210, s[8:11], s71 offen lds
    v_mfma_f32_16x16x32_bf16 v[92:95], v[188:191], a[212:215], v[92:95]
    s_waitcnt lgkmcnt(14)
    ds_read_b64_tr_b16 v[184:185], v218 offset:10240
    ds_read_b64_tr_b16 v[186:187], v218 offset:10752
    v_mfma_f32_16x16x32_bf16 v[0:3], v[160:163], a[224:227], v[0:3]
    s_waitcnt lgkmcnt(14)
    ds_read_b64_tr_b16 v[188:189], v218 offset:18432
    ds_read_b64_tr_b16 v[190:191], v218 offset:18944
    v_mfma_f32_16x16x32_bf16 v[0:3], v[164:167], a[240:243], v[0:3]
    v_mfma_f32_16x16x32_bf16 v[4:7], v[160:163], a[228:231], v[4:7]
    buffer_load_dwordx4 v211, s[8:11], s71 offen offset:1024 lds
    v_mfma_f32_16x16x32_bf16 v[4:7], v[164:167], a[244:247], v[4:7]
    s_add_u32 m0, s40, 43008
    v_add_u32 v196, 155648, v230
    v_add_u32 v197, 155648, v231
    s_waitcnt lgkmcnt(15)
    v_mfma_f32_16x16x32_bf16 v[8:11], v[160:163], a[232:235], v[8:11]
    s_waitcnt lgkmcnt(14)
    v_mfma_f32_16x16x32_bf16 v[8:11], v[164:167], a[248:251], v[8:11]
    s_waitcnt lgkmcnt(13)
    v_mfma_f32_16x16x32_bf16 v[12:15], v[160:163], a[236:239], v[12:15]
    s_waitcnt lgkmcnt(12)
    buffer_load_dwordx4 v210, s[12:15], s71 offen lds
    v_mfma_f32_16x16x32_bf16 v[12:15], v[164:167], a[252:255], v[12:15]
    s_waitcnt lgkmcnt(10)
    ds_read_b64_tr_b16 v[160:161], v196 offset:0
    ds_read_b64_tr_b16 v[162:163], v196 offset:256
    v_mfma_f32_16x16x32_bf16 v[16:19], v[168:171], a[224:227], v[16:19]
    s_waitcnt lgkmcnt(10)
    ds_read_b64_tr_b16 v[164:165], v196 offset:4096
    ds_read_b64_tr_b16 v[166:167], v196 offset:4352
    v_mfma_f32_16x16x32_bf16 v[16:19], v[172:175], a[240:243], v[16:19]
    v_mfma_f32_16x16x32_bf16 v[20:23], v[168:171], a[228:231], v[20:23]
    buffer_load_dwordx4 v211, s[12:15], s71 offen offset:1024 lds
    v_mfma_f32_16x16x32_bf16 v[20:23], v[172:175], a[244:247], v[20:23]
    s_add_u32 m0, s40, 57344
    s_add_u32 s70, s44, 589952
    v_mfma_f32_16x16x32_bf16 v[24:27], v[168:171], a[232:235], v[24:27]
    v_mfma_f32_16x16x32_bf16 v[24:27], v[172:175], a[248:251], v[24:27]
    v_mfma_f32_16x16x32_bf16 v[28:31], v[168:171], a[236:239], v[28:31]
    buffer_load_dwordx4 v210, s[8:11], s70 offen lds
    v_mfma_f32_16x16x32_bf16 v[28:31], v[172:175], a[252:255], v[28:31]
    s_waitcnt lgkmcnt(10)
    ds_read_b64_tr_b16 v[168:169], v196 offset:1024
    ds_read_b64_tr_b16 v[170:171], v196 offset:1280
    v_mfma_f32_16x16x32_bf16 v[32:35], v[176:179], a[224:227], v[32:35]
    s_waitcnt lgkmcnt(10)
    ds_read_b64_tr_b16 v[172:173], v196 offset:5120
    ds_read_b64_tr_b16 v[174:175], v196 offset:5376
    v_mfma_f32_16x16x32_bf16 v[32:35], v[180:183], a[240:243], v[32:35]
    v_mfma_f32_16x16x32_bf16 v[36:39], v[176:179], a[228:231], v[36:39]
    buffer_load_dwordx4 v211, s[8:11], s70 offen offset:1024 lds
    v_mfma_f32_16x16x32_bf16 v[36:39], v[180:183], a[244:247], v[36:39]
    s_add_u32 m0, s40, 59392
    v_mfma_f32_16x16x32_bf16 v[40:43], v[176:179], a[232:235], v[40:43]
    v_mfma_f32_16x16x32_bf16 v[40:43], v[180:183], a[248:251], v[40:43]
    v_mfma_f32_16x16x32_bf16 v[44:47], v[176:179], a[236:239], v[44:47]
    buffer_load_dwordx4 v210, s[12:15], s70 offen lds
    v_mfma_f32_16x16x32_bf16 v[44:47], v[180:183], a[252:255], v[44:47]
    s_waitcnt lgkmcnt(10)
    ds_read_b64_tr_b16 v[176:177], v197 offset:0
    ds_read_b64_tr_b16 v[178:179], v197 offset:256
    v_mfma_f32_16x16x32_bf16 v[48:51], v[184:187], a[224:227], v[48:51]
    s_waitcnt lgkmcnt(10)
    ds_read_b64_tr_b16 v[180:181], v197 offset:4096
    ds_read_b64_tr_b16 v[182:183], v197 offset:4352
    v_mfma_f32_16x16x32_bf16 v[48:51], v[188:191], a[240:243], v[48:51]
    v_mfma_f32_16x16x32_bf16 v[52:55], v[184:187], a[228:231], v[52:55]
    s_waitcnt vmcnt(8)
    v_mfma_f32_16x16x32_bf16 v[52:55], v[188:191], a[244:247], v[52:55]
    s_barrier
    v_add_u32 v192, 0, v226
    v_add_u32 v193, 0, v227
    v_mfma_f32_16x16x32_bf16 v[56:59], v[184:187], a[232:235], v[56:59]
    buffer_load_dwordx4 v211, s[12:15], s70 offen offset:1024 lds
    v_mfma_f32_16x16x32_bf16 v[56:59], v[188:191], a[248:251], v[56:59]
    v_add_u32 v194, 0, v228
    v_add_u32 v195, 0, v229
    v_mfma_f32_16x16x32_bf16 v[60:63], v[184:187], a[236:239], v[60:63]
    ds_read_b128 v[128:131], v192 offset:0
    ds_read_b128 v[144:147], v194 offset:0
    v_mfma_f32_16x16x32_bf16 v[60:63], v[188:191], a[252:255], v[60:63]
    s_waitcnt lgkmcnt(12)
    ds_read_b64_tr_b16 v[184:185], v197 offset:1024
    ds_read_b64_tr_b16 v[186:187], v197 offset:1280
    v_mfma_f32_16x16x32_bf16 v[64:67], v[160:163], a[224:227], v[64:67]
    s_waitcnt lgkmcnt(12)
    ds_read_b64_tr_b16 v[188:189], v197 offset:5120
    ds_read_b64_tr_b16 v[190:191], v197 offset:5376
    v_mfma_f32_16x16x32_bf16 v[64:67], v[164:167], a[240:243], v[64:67]
    v_add_u32 v196, 32768, v230
    v_add_u32 v197, 32768, v231
    v_mfma_f32_16x16x32_bf16 v[68:71], v[160:163], a[228:231], v[68:71]
    ds_read_b128 v[132:135], v192 offset:2048
    ds_read_b128 v[148:151], v194 offset:2048
    v_mfma_f32_16x16x32_bf16 v[68:71], v[164:167], a[244:247], v[68:71]
    s_waitcnt lgkmcnt(14)
    ds_read_b64_tr_b16 v[160:161], v196 offset:0
    ds_read_b64_tr_b16 v[162:163], v196 offset:256
    v_mfma_f32_16x16x32_bf16 v[72:75], v[168:171], a[224:227], v[72:75]
    s_waitcnt lgkmcnt(14)
    ds_read_b64_tr_b16 v[164:165], v196 offset:4096
    ds_read_b64_tr_b16 v[166:167], v196 offset:4352
    v_mfma_f32_16x16x32_bf16 v[72:75], v[172:175], a[240:243], v[72:75]
    ds_read_b128 v[136:139], v193 offset:0
    ds_read_b128 v[152:155], v195 offset:0
    v_mfma_f32_16x16x32_bf16 v[76:79], v[168:171], a[228:231], v[76:79]
    ds_read_b128 v[140:143], v193 offset:2048
    ds_read_b128 v[156:159], v195 offset:2048
    v_mfma_f32_16x16x32_bf16 v[76:79], v[172:175], a[244:247], v[76:79]
    s_waitcnt lgkmcnt(15)
    ds_read_b64_tr_b16 v[168:169], v196 offset:1024
    ds_read_b64_tr_b16 v[170:171], v196 offset:1280
    v_mfma_f32_16x16x32_bf16 v[80:83], v[176:179], a[224:227], v[80:83]
    s_waitcnt lgkmcnt(15)
    ds_read_b64_tr_b16 v[172:173], v196 offset:5120
    ds_read_b64_tr_b16 v[174:175], v196 offset:5376
    v_mfma_f32_16x16x32_bf16 v[80:83], v[180:183], a[240:243], v[80:83]
    s_add_u32 m0, s40, 81920
    s_add_u32 s71, s44, 1179776
    v_mfma_f32_16x16x32_bf16 v[84:87], v[176:179], a[228:231], v[84:87]
    buffer_load_dwordx4 v210, s[8:11], s71 offen lds
    v_mfma_f32_16x16x32_bf16 v[84:87], v[180:183], a[244:247], v[84:87]
    s_waitcnt lgkmcnt(15)
    ds_read_b64_tr_b16 v[176:177], v197 offset:0
    ds_read_b64_tr_b16 v[178:179], v197 offset:256
    v_mfma_f32_16x16x32_bf16 v[88:91], v[184:187], a[224:227], v[88:91]
    s_waitcnt lgkmcnt(15)
    ds_read_b64_tr_b16 v[180:181], v197 offset:4096
    ds_read_b64_tr_b16 v[182:183], v197 offset:4352
    v_mfma_f32_16x16x32_bf16 v[88:91], v[188:191], a[240:243], v[88:91]
    v_mfma_f32_16x16x32_bf16 v[92:95], v[184:187], a[228:231], v[92:95]
    buffer_load_dwordx4 v211, s[8:11], s71 offen offset:1024 lds
    v_mfma_f32_16x16x32_bf16 v[92:95], v[188:191], a[244:247], v[92:95]
    s_add_u32 m0, s40, 83968
    ds_read_b64_tr_b16 v[184:185], v197 offset:1024
    ds_read_b64_tr_b16 v[186:187], v197 offset:1280
    s_waitcnt lgkmcnt(15)
    v_mfma_f32_16x16x32_bf16 v[64:67], v[160:163], v[128:131], v[64:67]
    s_waitcnt lgkmcnt(14)
    ds_read_b64_tr_b16 v[188:189], v197 offset:5120
    ds_read_b64_tr_b16 v[190:191], v197 offset:5376
    v_mfma_f32_16x16x32_bf16 v[64:67], v[164:167], v[144:147], v[64:67]
    v_mfma_f32_16x16x32_bf16 v[68:71], v[160:163], v[132:135], v[68:71]
    buffer_load_dwordx4 v210, s[12:15], s71 offen lds
    v_mfma_f32_16x16x32_bf16 v[68:71], v[164:167], v[148:151], v[68:71]
    s_mov_b32 s84, 0xc0135761
    ds_read_b64_tr_b16 v[160:161], v213 offset:16384
    ds_read_b64_tr_b16 v[162:163], v213 offset:16896
    s_waitcnt lgkmcnt(12)
    v_mfma_f32_16x16x32_bf16 v[72:75], v[168:171], v[128:131], v[72:75]
    s_waitcnt lgkmcnt(10)
    ds_read_b64_tr_b16 v[164:165], v213 offset:24576
    ds_read_b64_tr_b16 v[166:167], v213 offset:25088
    v_mfma_f32_16x16x32_bf16 v[72:75], v[172:175], v[144:147], v[72:75]
    v_mfma_f32_16x16x32_bf16 v[76:79], v[168:171], v[132:135], v[76:79]
    s_waitcnt vmcnt(11)
    v_cmp_ne_u32 vcc, s101, v244
    s_nop 1
    s_cbranch_vccnz L_slow
    v_mfma_f32_16x16x32_bf16 v[76:79], v[172:175], v[148:151], v[76:79]
    s_waitcnt lgkmcnt(10)
    buffer_load_dwordx4 v211, s[12:15], s71 offen offset:1024 lds
    v_mfma_f32_16x16x32_bf16 v[80:83], v[176:179], v[128:131], v[80:83]
    s_waitcnt lgkmcnt(8)
    ds_read_b64_tr_b16 v[168:169], v213 offset:18432
    ds_read_b64_tr_b16 v[170:171], v213 offset:18944
    v_mfma_f32_16x16x32_bf16 v[80:83], v[180:183], v[144:147], v[80:83]
    ds_read_b64_tr_b16 v[172:173], v213 offset:26624
    ds_read_b64_tr_b16 v[174:175], v213 offset:27136
    v_mfma_f32_16x16x32_bf16 v[84:87], v[176:179], v[132:135], v[84:87]
    v_lshlrev_b32 v244, 3, v209
    v_cmp_gt_u32 vcc, 9, v247
    v_mfma_f32_16x16x32_bf16 v[84:87], v[180:183], v[148:151], v[84:87]
    s_waitcnt lgkmcnt(10)
    ds_read_b64_tr_b16 v[176:177], v216 offset:16384
    ds_read_b64_tr_b16 v[178:179], v216 offset:16896
    v_mfma_f32_16x16x32_bf16 v[88:91], v[184:187], v[128:131], v[88:91]
    s_waitcnt lgkmcnt(10)
    ds_read_b64_tr_b16 v[180:181], v216 offset:24576
    ds_read_b64_tr_b16 v[182:183], v216 offset:25088
    v_mfma_f32_16x16x32_bf16 v[88:91], v[188:191], v[144:147], v[88:91]
    s_add_u32 m0, s40, 98304
    s_add_u32 s70, s44, 1769600
    v_mfma_f32_16x16x32_bf16 v[92:95], v[184:187], v[132:135], v[92:95]
    buffer_load_dwordx4 v210, s[8:11], s70 offen lds
    v_mfma_f32_16x16x32_bf16 v[92:95], v[188:191], v[148:151], v[92:95]
    s_waitcnt lgkmcnt(10)
    ds_read_b64_tr_b16 v[184:185], v216 offset:18432
    ds_read_b64_tr_b16 v[186:187], v216 offset:18944
    v_mfma_f32_16x16x32_bf16 v[0:3], v[160:163], v[128:131], v[0:3]
    s_waitcnt lgkmcnt(10)
    ds_read_b64_tr_b16 v[188:189], v216 offset:26624
    ds_read_b64_tr_b16 v[190:191], v216 offset:27136
    v_mfma_f32_16x16x32_bf16 v[0:3], v[164:167], v[144:147], v[0:3]
    v_cndmask_b32 v244, v248, v244, vcc
    v_mfma_f32_16x16x32_bf16 v[4:7], v[160:163], v[132:135], v[4:7]
    buffer_load_dwordx4 v211, s[8:11], s70 offen offset:1024 lds
    v_mfma_f32_16x16x32_bf16 v[4:7], v[164:167], v[148:151], v[4:7]
    s_add_u32 m0, s40, 100352
    v_mul_f32 v192, v64, v64
    v_fmaak_f32 v192, v192, v208, 0xc0135761
    v_mul_f32 v192, v192, v64
    v_exp_f32 v192, v192
    v_mfma_f32_16x16x32_bf16 v[8:11], v[160:163], v[136:139], v[8:11]
    v_mul_f32 v196, v64, v72
    v_add_f32 v192, 1.0, v192
    v_rcp_f32 v192, v192
    v_mul_f32 v193, v65, v65
    v_mfma_f32_16x16x32_bf16 v[8:11], v[164:167], v[152:155], v[8:11]
    v_mul_f32 v196, v196, v192
    v_fmaak_f32 v193, v193, v208, 0xc0135761
    v_mul_f32 v193, v193, v65
    v_mul_f32 v197, v65, v73
    v_mfma_f32_16x16x32_bf16 v[12:15], v[160:163], v[140:143], v[12:15]
    buffer_load_dwordx4 v210, s[12:15], s70 offen lds
    v_exp_f32 v193, v193
    v_mul_f32 v194, v66, v66
    v_mfma_f32_16x16x32_bf16 v[12:15], v[164:167], v[156:159], v[12:15]
    s_waitcnt lgkmcnt(10)
    v_add_f32 v193, 1.0, v193
    v_rcp_f32 v193, v193
    v_fmaak_f32 v194, v194, v208, 0xc0135761
    v_mul_f32 v194, v194, v66
    v_mfma_f32_16x16x32_bf16 v[16:19], v[168:171], v[128:131], v[16:19]
    s_waitcnt lgkmcnt(8)
    v_exp_f32 v194, v194
    v_mul_f32 v197, v197, v193
    v_mul_f32 v198, v66, v74
    v_mul_f32 v195, v67, v67
    v_mfma_f32_16x16x32_bf16 v[16:19], v[172:175], v[144:147], v[16:19]
    v_add_f32 v194, 1.0, v194
    v_rcp_f32 v194, v194
    v_fmaak_f32 v195, v195, v208, 0xc0135761
    v_mfma_f32_16x16x32_bf16 v[20:23], v[168:171], v[132:135], v[20:23]
    s_waitcnt vmcnt(11)
    v_mul_f32 v198, v198, v194
    v_mul_f32 v195, v195, v67
    v_exp_f32 v195, v195
    v_mul_f32 v199, v67, v75
    v_mfma_f32_16x16x32_bf16 v[20:23], v[172:175], v[148:151], v[20:23]
    s_barrier
    v_add_f32 v195, 1.0, v195
    v_rcp_f32 v195, v195
    v_cvt_pk_bf16_f32 v200, v196, v197
    v_mfma_f32_16x16x32_bf16 v[24:27], v[168:171], v[136:139], v[24:27]
    buffer_load_dwordx4 v211, s[12:15], s70 offen offset:1024 lds
    v_mul_f32 v199, v199, v195
    v_cvt_pk_bf16_f32 v201, v198, v199
    v_mul_f32 v222, v80, v80
    v_mfma_f32_16x16x32_bf16 v[24:27], v[172:175], v[152:155], v[24:27]
    ds_read_b64_tr_b16 v[160:161], v216 offset:40960
    ds_read_b64_tr_b16 v[162:163], v216 offset:41472
    v_fmaak_f32 v222, v222, v208, 0xc0135761
    v_mul_f32 v222, v222, v80
    v_mul_f32 v226, v80, v88
    v_mfma_f32_16x16x32_bf16 v[28:31], v[168:171], v[140:143], v[28:31]
    ds_read_b64_tr_b16 v[164:165], v216 offset:49152
    ds_read_b64_tr_b16 v[166:167], v216 offset:49664
    v_exp_f32 v222, v222
    v_mfma_f32_16x16x32_bf16 v[28:31], v[172:175], v[156:159], v[28:31]
    s_waitcnt lgkmcnt(10)
    ds_read_b64_tr_b16 v[168:169], v216 offset:43008
    ds_read_b64_tr_b16 v[170:171], v216 offset:43520
    v_add_f32 v222, 1.0, v222
    v_rcp_f32 v222, v222
    v_mfma_f32_16x16x32_bf16 v[32:35], v[176:179], v[128:131], v[32:35]
    s_waitcnt lgkmcnt(10)
    ds_read_b64_tr_b16 v[172:173], v216 offset:51200
    ds_read_b64_tr_b16 v[174:175], v216 offset:51712
    v_mul_f32 v226, v226, v222
    v_mul_f32 v223, v81, v81
    v_fmaak_f32 v223, v223, v208, 0xc0135761
    v_mfma_f32_16x16x32_bf16 v[32:35], v[180:183], v[144:147], v[32:35]
    s_add_u32 m0, s40, 122880
    s_add_u32 s71, s44, 2359424
    v_mul_f32 v223, v223, v81
    v_exp_f32 v223, v223
    v_mul_f32 v227, v81, v89
    v_mfma_f32_16x16x32_bf16 v[36:39], v[176:179], v[132:135], v[36:39]
    buffer_load_dwordx4 v210, s[8:11], s71 offen lds
    v_add_f32 v223, 1.0, v223
    v_mul_f32 v224, v82, v82
    v_mfma_f32_16x16x32_bf16 v[36:39], v[180:183], v[148:151], v[36:39]
    v_rcp_f32 v223, v223
    v_fmaak_f32 v224, v224, v208, 0xc0135761
    v_mul_f32 v224, v224, v82
    v_mul_f32 v228, v82, v90
    v_mfma_f32_16x16x32_bf16 v[40:43], v[176:179], v[136:139], v[40:43]
    v_exp_f32 v224, v224
    v_mul_f32 v227, v227, v223
    v_mul_f32 v225, v83, v83
    v_fmaak_f32 v225, v225, v208, 0xc0135761
    v_mfma_f32_16x16x32_bf16 v[40:43], v[180:183], v[152:155], v[40:43]
    v_add_f32 v224, 1.0, v224
    v_rcp_f32 v224, v224
    v_mul_f32 v225, v225, v83
    v_mul_f32 v229, v83, v91
    v_mfma_f32_16x16x32_bf16 v[44:47], v[176:179], v[140:143], v[44:47]
    buffer_load_dwordx4 v211, s[8:11], s71 offen offset:1024 lds
    v_exp_f32 v225, v225
    v_mul_f32 v228, v228, v224
    v_mfma_f32_16x16x32_bf16 v[44:47], v[180:183], v[156:159], v[44:47]
    s_add_u32 m0, s40, 124928
    ds_read_b64_tr_b16 v[176:177], v213 offset:40960
    ds_read_b64_tr_b16 v[178:179], v213 offset:41472
    v_add_f32 v225, 1.0, v225
    v_cvt_pk_bf16_f32 v202, v226, v227
    s_waitcnt lgkmcnt(12)
    v_mfma_f32_16x16x32_bf16 v[48:51], v[184:187], v[128:131], v[48:51]
    s_waitcnt lgkmcnt(10)
    ds_read_b64_tr_b16 v[180:181], v213 offset:49152
    ds_read_b64_tr_b16 v[182:183], v213 offset:49664
    v_rcp_f32 v225, v225
    v_mul_f32 v192, v68, v68
    v_mfma_f32_16x16x32_bf16 v[48:51], v[188:191], v[144:147], v[48:51]
    v_mul_f32 v229, v229, v225
    v_cvt_pk_bf16_f32 v203, v228, v229
    v_fmaak_f32 v192, v192, v208, 0xc0135761
    v_mul_f32 v192, v192, v68
    v_mul_f32 v196, v68, v76
    v_mfma_f32_16x16x32_bf16 v[52:55], v[184:187], v[132:135], v[52:55]
    buffer_store_dwordx4 v[200:203], v209, s[20:23], s50 offen sc1
    v_exp_f32 v192, v192
    v_mul_f32 v193, v69, v69
    v_mfma_f32_16x16x32_bf16 v[52:55], v[188:191], v[148:151], v[52:55]
    v_add_f32 v192, 1.0, v192
    v_rcp_f32 v192, v192
    v_fmaak_f32 v193, v193, v208, 0xc0135761
    v_mul_f32 v193, v193, v69
    v_mfma_f32_16x16x32_bf16 v[56:59], v[184:187], v[136:139], v[56:59]
    v_exp_f32 v193, v193
    v_mul_f32 v196, v196, v192
    v_mul_f32 v197, v69, v77
    v_mfma_f32_16x16x32_bf16 v[56:59], v[188:191], v[152:155], v[56:59]
    v_add_f32 v193, 1.0, v193
    v_rcp_f32 v193, v193
    v_mul_f32 v194, v70, v70
    v_fmaak_f32 v194, v194, v208, 0xc0135761
    v_mfma_f32_16x16x32_bf16 v[60:63], v[184:187], v[140:143], v[60:63]
    buffer_load_dwordx4 v210, s[12:15], s71 offen lds
    v_mul_f32 v197, v197, v193
    v_mul_f32 v194, v194, v70
    v_mul_f32 v198, v70, v78
    v_mfma_f32_16x16x32_bf16 v[60:63], v[188:191], v[156:159], v[60:63]
    s_waitcnt lgkmcnt(10)
    ds_read_b64_tr_b16 v[184:185], v213 offset:43008
    ds_read_b64_tr_b16 v[186:187], v213 offset:43520
    v_exp_f32 v194, v194
    v_mul_f32 v195, v71, v71
    v_mfma_f32_16x16x32_bf16 v[96:99], v[160:163], a[0:3], 0
    s_waitcnt lgkmcnt(10)
    ds_read_b64_tr_b16 v[188:189], v213 offset:51200
    ds_read_b64_tr_b16 v[190:191], v213 offset:51712
    v_add_f32 v194, 1.0, v194
    v_fmaak_f32 v195, v195, v208, 0xc0135761
    v_mfma_f32_16x16x32_bf16 v[96:99], v[164:167], a[16:19], v[96:99]
    v_rcp_f32 v194, v194
    v_mul_f32 v195, v195, v71
    v_exp_f32 v195, v195
    v_mfma_f32_16x16x32_bf16 v[100:103], v[160:163], a[4:7], 0
    v_mul_f32 v198, v198, v194
    v_mul_f32 v199, v71, v79
    v_add_f32 v195, 1.0, v195
    v_rcp_f32 v195, v195
    v_mfma_f32_16x16x32_bf16 v[100:103], v[164:167], a[20:23], v[100:103]
    s_add_u32 s73, s77, 0
    buffer_load_dword v255, v244, s[16:19], s73 offen
    v_mul_f32 v199, v199, v195
    v_cvt_pk_bf16_f32 v204, v196, v197
    v_cvt_pk_bf16_f32 v205, v198, v199
    v_mfma_f32_16x16x32_bf16 v[104:107], v[160:163], a[8:11], 0
    v_mul_f32 v222, v84, v84
    v_fmaak_f32 v222, v222, v208, 0xc0135761
    v_mul_f32 v222, v222, v84
    v_exp_f32 v222, v222
    v_mfma_f32_16x16x32_bf16 v[104:107], v[164:167], a[24:27], v[104:107]
    v_mul_f32 v226, v84, v92
    v_add_f32 v222, 1.0, v222
    v_rcp_f32 v222, v222
    v_mfma_f32_16x16x32_bf16 v[108:111], v[160:163], a[12:15], 0
    v_mul_f32 v226, v226, v222
    v_mul_f32 v223, v85, v85
    v_fmaak_f32 v223, v223, v208, 0xc0135761
    v_mul_f32 v223, v223, v85
    v_mul_f32 v227, v85, v93
    v_mfma_f32_16x16x32_bf16 v[108:111], v[164:167], a[28:31], v[108:111]
    s_waitcnt lgkmcnt(10)
    v_exp_f32 v223, v223
    v_mul_f32 v224, v86, v86
    v_fmaak_f32 v224, v224, v208, 0xc0135761
    v_mul_f32 v224, v224, v86
    v_mfma_f32_16x16x32_bf16 v[112:115], v[168:171], a[0:3], 0
    s_add_u32 s74, s85, 256
    buffer_load_dword v255, v254, s[8:11], s74 offen
    v_exp_f32 v224, v224
    s_waitcnt lgkmcnt(8)
    v_mfma_f32_16x16x32_bf16 v[112:115], v[172:175], a[16:19], v[112:115]
    v_add_f32 v223, 1.0, v223
    v_rcp_f32 v223, v223
    v_mul_f32 v228, v86, v94
    v_add_f32 v224, 1.0, v224
    v_mfma_f32_16x16x32_bf16 v[116:119], v[168:171], a[4:7], 0
    s_waitcnt vmcnt(14)
    v_rcp_f32 v224, v224
    v_mul_f32 v227, v227, v223
    v_mul_f32 v225, v87, v87
    v_mfma_f32_16x16x32_bf16 v[116:119], v[172:175], a[20:23], v[116:119]
    s_barrier
    v_mul_f32 v228, v228, v224
    v_fmaak_f32 v225, v225, v208, 0xc0135761
    v_mul_f32 v225, v225, v87
    v_exp_f32 v225, v225
    v_mfma_f32_16x16x32_bf16 v[120:123], v[168:171], a[8:11], 0
    ds_read_b64_tr_b16 v[160:161], v213 offset:57344
    ds_read_b64_tr_b16 v[162:163], v213 offset:57856
    v_mul_f32 v229, v87, v95
    v_add_f32 v225, 1.0, v225
    v_mfma_f32_16x16x32_bf16 v[120:123], v[172:175], a[24:27], v[120:123]
    s_add_u32 s75, s85, 256
    buffer_load_dword v255, v254, s[12:15], s75 offen
    v_mfma_f32_16x16x32_bf16 v[124:127], v[168:171], a[12:15], 0
    ds_read_b64_tr_b16 v[164:165], v214 offset:0
    ds_read_b64_tr_b16 v[166:167], v214 offset:512
    v_mfma_f32_16x16x32_bf16 v[124:127], v[172:175], a[28:31], v[124:127]
    s_waitcnt lgkmcnt(10)
    ds_read_b64_tr_b16 v[168:169], v213 offset:59392
    ds_read_b64_tr_b16 v[170:171], v213 offset:59904
    v_mfma_f32_16x16x32_bf16 v[64:67], v[176:179], a[0:3], 0
    s_add_u32 s97, s46, 0
    ds_read_b64_tr_b16 v[172:173], v214 offset:2048
    ds_read_b64_tr_b16 v[174:175], v214 offset:2560
    s_waitcnt lgkmcnt(12)
    v_mfma_f32_16x16x32_bf16 v[64:67], v[180:183], a[16:19], v[64:67]
    v_rcp_f32 v225, v225
    v_mfma_f32_16x16x32_bf16 v[68:71], v[176:179], a[4:7], 0
    buffer_load_dwordx4 v211, s[12:15], s71 offen offset:1024 lds
    v_mfma_f32_16x16x32_bf16 v[68:71], v[180:183], a[20:23], v[68:71]
    s_add_u32 m0, s40, 139264
    s_add_u32 s70, s44, 2949248
    v_mul_f32 v229, v229, v225
    v_mfma_f32_16x16x32_bf16 v[72:75], v[176:179], a[8:11], 0
    v_cvt_pk_bf16_f32 v206, v226, v227
    v_cvt_pk_bf16_f32 v207, v228, v229
    v_mfma_f32_16x16x32_bf16 v[72:75], v[180:183], a[24:27], v[72:75]
    v_mul_f32 v192, v0, v0
    v_fmaak_f32 v192, v192, v208, 0xc0135761
    v_mfma_f32_16x16x32_bf16 v[76:79], v[176:179], a[12:15], 0
    v_mul_f32 v192, v192, v0
    v_mul_f32 v196, v0, v16
    v_mfma_f32_16x16x32_bf16 v[76:79], v[180:183], a[28:31], v[76:79]
    s_waitcnt lgkmcnt(10)
    buffer_store_dwordx4 v[204:207], v209, s[20:23], s51 offen sc1
    v_mfma_f32_16x16x32_bf16 v[80:83], v[184:187], a[0:3], 0
    s_waitcnt lgkmcnt(8)
    ds_read_b64_tr_b16 v[176:177], v216 offset:57344
    ds_read_b64_tr_b16 v[178:179], v216 offset:57856
    v_mfma_f32_16x16x32_bf16 v[80:83], v[188:191], a[16:19], v[80:83]
    ds_read_b64_tr_b16 v[180:181], v217 offset:0
    ds_read_b64_tr_b16 v[182:183], v217 offset:512
    v_mfma_f32_16x16x32_bf16 v[84:87], v[184:187], a[4:7], 0
    v_exp_f32 v192, v192
    v_mfma_f32_16x16x32_bf16 v[84:87], v[188:191], a[20:23], v[84:87]
    v_add_f32 v192, 1.0, v192
    v_mul_f32 v193, v1, v1
    v_mfma_f32_16x16x32_bf16 v[88:91], v[184:187], a[8:11], 0
    buffer_load_dwordx4 v210, s[8:11], s70 offen lds
    v_mfma_f32_16x16x32_bf16 v[88:91], v[188:191], a[24:27], v[88:91]
    v_rcp_f32 v192, v192
    v_fmaak_f32 v193, v193, v208, 0xc0135761
    v_mfma_f32_16x16x32_bf16 v[92:95], v[184:187], a[12:15], 0
    v_mul_f32 v196, v196, v192
    v_mul_f32 v193, v193, v1
    v_mfma_f32_16x16x32_bf16 v[92:95], v[188:191], a[28:31], v[92:95]
    s_waitcnt lgkmcnt(10)
    ds_read_b64_tr_b16 v[184:185], v216 offset:59392
    ds_read_b64_tr_b16 v[186:187], v216 offset:59904
    v_mfma_f32_16x16x32_bf16 v[64:67], v[160:163], a[32:35], v[64:67]
    s_waitcnt lgkmcnt(10)
    ds_read_b64_tr_b16 v[188:189], v217 offset:2048
    ds_read_b64_tr_b16 v[190:191], v217 offset:2560
    v_mfma_f32_16x16x32_bf16 v[64:67], v[164:167], a[48:51], v[64:67]
    s_add_u32 s72, s78, 0
    buffer_load_dword v255, v244, s[16:19], s72 offen
    v_mfma_f32_16x16x32_bf16 v[68:71], v[160:163], a[36:39], v[68:71]
    v_exp_f32 v193, v193
    v_mfma_f32_16x16x32_bf16 v[68:71], v[164:167], a[52:55], v[68:71]
    v_mul_f32 v197, v1, v17
    v_add_f32 v193, 1.0, v193
    v_mfma_f32_16x16x32_bf16 v[72:75], v[160:163], a[40:43], v[72:75]
    v_rcp_f32 v193, v193
    v_mul_f32 v194, v2, v2
    v_mfma_f32_16x16x32_bf16 v[72:75], v[164:167], a[56:59], v[72:75]
    s_add_u32 s98, s47, 0
    v_mul_f32 v197, v197, v193
    v_fmaak_f32 v194, v194, v208, 0xc0135761
    v_mfma_f32_16x16x32_bf16 v[76:79], v[160:163], a[44:47], v[76:79]
    buffer_load_dwordx4 v211, s[8:11], s70 offen offset:1024 lds
    v_mfma_f32_16x16x32_bf16 v[76:79], v[164:167], a[60:63], v[76:79]
    s_add_u32 m0, s40, 141312
    v_mul_f32 v194, v194, v2
    v_mul_f32 v198, v2, v18
    s_waitcnt lgkmcnt(10)
    v_mfma_f32_16x16x32_bf16 v[80:83], v[168:171], a[32:35], v[80:83]
    s_waitcnt lgkmcnt(8)
    v_exp_f32 v194, v194
    v_mfma_f32_16x16x32_bf16 v[80:83], v[172:175], a[48:51], v[80:83]
    v_add_f32 v194, 1.0, v194
    v_mul_f32 v195, v3, v3
    v_mfma_f32_16x16x32_bf16 v[84:87], v[168:171], a[36:39], v[84:87]
    s_waitcnt vmcnt(16)
    v_rcp_f32 v194, v194
    v_fmaak_f32 v195, v195, v208, 0xc0135761
    v_mfma_f32_16x16x32_bf16 v[84:87], v[172:175], a[52:55], v[84:87]
    s_barrier
    v_mul_f32 v198, v198, v194
    v_mul_f32 v195, v195, v3
    v_mfma_f32_16x16x32_bf16 v[88:91], v[168:171], a[40:43], v[88:91]
    buffer_load_dwordx4 v210, s[12:15], s70 offen lds
    v_mfma_f32_16x16x32_bf16 v[88:91], v[172:175], a[56:59], v[88:91]
    ds_read_b64_tr_b16 v[160:161], v214 offset:16384
    ds_read_b64_tr_b16 v[162:163], v214 offset:16896
    v_mfma_f32_16x16x32_bf16 v[92:95], v[168:171], a[44:47], v[92:95]
    ds_read_b64_tr_b16 v[164:165], v214 offset:24576
    ds_read_b64_tr_b16 v[166:167], v214 offset:25088
    v_mfma_f32_16x16x32_bf16 v[92:95], v[172:175], a[60:63], v[92:95]
    s_waitcnt lgkmcnt(10)
    ds_read_b64_tr_b16 v[168:169], v214 offset:18432
    ds_read_b64_tr_b16 v[170:171], v214 offset:18944
    v_mfma_f32_16x16x32_bf16 v[96:99], v[176:179], a[32:35], v[96:99]
    s_waitcnt lgkmcnt(10)
    ds_read_b64_tr_b16 v[172:173], v214 offset:26624
    ds_read_b64_tr_b16 v[174:175], v214 offset:27136
    v_mfma_f32_16x16x32_bf16 v[96:99], v[180:183], a[48:51], v[96:99]
    buffer_load_dwordx4 v211, s[12:15], s70 offen offset:1024 lds
    v_mul_f32 v199, v3, v19
    v_mfma_f32_16x16x32_bf16 v[100:103], v[176:179], a[36:39], v[100:103]
    s_add_u32 m0, s40, 0
    s_add_u32 s71, s44, 3539072
    v_cvt_pk_bf16_f32 v200, v196, v197
    v_mfma_f32_16x16x32_bf16 v[100:103], v[180:183], a[52:55], v[100:103]
    v_exp_f32 v195, v195
    v_mfma_f32_16x16x32_bf16 v[104:107], v[176:179], a[40:43], v[104:107]
    v_add_f32 v195, 1.0, v195
    v_mul_f32 v222, v32, v32
    v_mfma_f32_16x16x32_bf16 v[104:107], v[180:183], a[56:59], v[104:107]
    v_rcp_f32 v195, v195
    v_mfma_f32_16x16x32_bf16 v[108:111], v[176:179], a[44:47], v[108:111]
    buffer_load_dwordx4 v210, s[8:11], s71 offen lds
    v_mfma_f32_16x16x32_bf16 v[108:111], v[180:183], a[60:63], v[108:111]
    s_waitcnt lgkmcnt(10)
    ds_read_b64_tr_b16 v[176:177], v217 offset:16384
    ds_read_b64_tr_b16 v[178:179], v217 offset:16896
    v_mfma_f32_16x16x32_bf16 v[112:115], v[184:187], a[32:35], v[112:115]
    s_waitcnt lgkmcnt(10)
    ds_read_b64_tr_b16 v[180:181], v217 offset:24576
    ds_read_b64_tr_b16 v[182:183], v217 offset:25088
    v_mul_f32 v199, v199, v195
    v_mfma_f32_16x16x32_bf16 v[112:115], v[188:191], a[48:51], v[112:115]
    v_cvt_pk_bf16_f32 v201, v198, v199
    v_fmaak_f32 v222, v222, v208, 0xc0135761
    v_mfma_f32_16x16x32_bf16 v[116:119], v[184:187], a[36:39], v[116:119]
    v_mul_f32 v222, v222, v32
    v_mul_f32 v226, v32, v48
    v_mfma_f32_16x16x32_bf16 v[116:119], v[188:191], a[52:55], v[116:119]
    buffer_load_dwordx4 v211, s[8:11], s71 offen offset:1024 lds
    v_mfma_f32_16x16x32_bf16 v[120:123], v[184:187], a[40:43], v[120:123]
    s_add_u32 m0, s40, 2048
    v_exp_f32 v222, v222
    v_mfma_f32_16x16x32_bf16 v[120:123], v[188:191], a[56:59], v[120:123]
    v_add_f32 v222, 1.0, v222
    v_mul_f32 v223, v33, v33
    v_mfma_f32_16x16x32_bf16 v[124:127], v[184:187], a[44:47], v[124:127]
    v_rcp_f32 v222, v222
    v_fmaak_f32 v223, v223, v208, 0xc0135761
    v_mfma_f32_16x16x32_bf16 v[124:127], v[188:191], a[60:63], v[124:127]
    s_waitcnt lgkmcnt(10)
    ds_read_b64_tr_b16 v[184:185], v217 offset:18432
    ds_read_b64_tr_b16 v[186:187], v217 offset:18944
    v_mfma_f32_16x16x32_bf16 v[64:67], v[160:163], a[64:67], v[64:67]
    s_waitcnt lgkmcnt(10)
    buffer_load_dwordx4 v210, s[12:15], s71 offen lds
    v_mfma_f32_16x16x32_bf16 v[64:67], v[164:167], a[80:83], v[64:67]
    ds_read_b64_tr_b16 v[188:189], v217 offset:26624
    ds_read_b64_tr_b16 v[190:191], v217 offset:27136
    v_mfma_f32_16x16x32_bf16 v[68:71], v[160:163], a[68:71], v[68:71]
    v_mul_f32 v226, v226, v222
    v_mul_f32 v223, v223, v33
    v_mfma_f32_16x16x32_bf16 v[68:71], v[164:167], a[84:87], v[68:71]
    v_exp_f32 v223, v223
    v_mfma_f32_16x16x32_bf16 v[72:75], v[160:163], a[72:75], v[72:75]
    v_mul_f32 v227, v33, v49
    v_add_f32 v223, 1.0, v223
    v_mul_f32 v224, v34, v34
    v_mfma_f32_16x16x32_bf16 v[72:75], v[164:167], a[88:91], v[72:75]
    buffer_load_dwordx4 v211, s[12:15], s71 offen offset:1024 lds
    v_mfma_f32_16x16x32_bf16 v[76:79], v[160:163], a[76:79], v[76:79]
    s_add_u32 m0, s40, 16384
    s_add_u32 s70, s44, 4128896
    v_fmaak_f32 v224, v224, v208, 0xc0135761
    v_mfma_f32_16x16x32_bf16 v[76:79], v[164:167], a[92:95], v[76:79]
    s_waitcnt lgkmcnt(10)
    v_rcp_f32 v223, v223
    v_mfma_f32_16x16x32_bf16 v[80:83], v[168:171], a[64:67], v[80:83]
    s_waitcnt lgkmcnt(8)
    v_mul_f32 v227, v227, v223
    v_mul_f32 v224, v224, v34
    v_mfma_f32_16x16x32_bf16 v[80:83], v[172:175], a[80:83], v[80:83]
    v_exp_f32 v224, v224
    v_mfma_f32_16x16x32_bf16 v[84:87], v[168:171], a[68:71], v[84:87]
    s_waitcnt vmcnt(18)
    v_mul_f32 v228, v34, v50
    v_add_f32 v224, 1.0, v224
    v_mfma_f32_16x16x32_bf16 v[84:87], v[172:175], a[84:87], v[84:87]
    s_barrier
    v_rcp_f32 v224, v224
    v_mul_f32 v225, v35, v35
    v_mfma_f32_16x16x32_bf16 v[88:91], v[168:171], a[72:75], v[88:91]
    buffer_load_dwordx4 v210, s[8:11], s70 offen lds
    v_mfma_f32_16x16x32_bf16 v[88:91], v[172:175], a[88:91], v[88:91]
    ds_read_b64_tr_b16 v[160:161], v214 offset:32768
    ds_read_b64_tr_b16 v[162:163], v214 offset:33280
    v_mfma_f32_16x16x32_bf16 v[92:95], v[168:171], a[76:79], v[92:95]
    ds_read_b64_tr_b16 v[164:165], v214 offset:40960
    ds_read_b64_tr_b16 v[166:167], v214 offset:41472
    v_mfma_f32_16x16x32_bf16 v[92:95], v[172:175], a[92:95], v[92:95]
    s_waitcnt lgkmcnt(10)
    ds_read_b64_tr_b16 v[168:169], v214 offset:34816
    ds_read_b64_tr_b16 v[170:171], v214 offset:35328
    v_mfma_f32_16x16x32_bf16 v[96:99], v[176:179], a[64:67], v[96:99]
    s_waitcnt lgkmcnt(10)
    ds_read_b64_tr_b16 v[172:173], v214 offset:43008
    ds_read_b64_tr_b16 v[174:175], v214 offset:43520
    v_mfma_f32_16x16x32_bf16 v[96:99], v[180:183], a[80:83], v[96:99]
    buffer_load_dwordx4 v211, s[8:11], s70 offen offset:1024 lds
    v_mul_f32 v228, v228, v224
    v_mfma_f32_16x16x32_bf16 v[100:103], v[176:179], a[68:71], v[100:103]
    s_add_u32 m0, s40, 18432
    v_fmaak_f32 v225, v225, v208, 0xc0135761
    v_mul_f32 v225, v225, v35
    v_mfma_f32_16x16x32_bf16 v[100:103], v[180:183], a[84:87], v[100:103]
    v_exp_f32 v225, v225
    v_mfma_f32_16x16x32_bf16 v[104:107], v[176:179], a[72:75], v[104:107]
    v_mul_f32 v229, v35, v51
    v_add_f32 v225, 1.0, v225
    v_mfma_f32_16x16x32_bf16 v[104:107], v[180:183], a[88:91], v[104:107]
    v_rcp_f32 v225, v225
    v_mfma_f32_16x16x32_bf16 v[108:111], v[176:179], a[76:79], v[108:111]
    buffer_load_dwordx4 v210, s[12:15], s70 offen lds
    v_mfma_f32_16x16x32_bf16 v[108:111], v[180:183], a[92:95], v[108:111]
    s_waitcnt lgkmcnt(10)
    ds_read_b64_tr_b16 v[176:177], v217 offset:32768
    ds_read_b64_tr_b16 v[178:179], v217 offset:33280
    v_mul_f32 v229, v229, v225
    v_mfma_f32_16x16x32_bf16 v[112:115], v[184:187], a[64:67], v[112:115]
    s_waitcnt lgkmcnt(10)
    ds_read_b64_tr_b16 v[180:181], v217 offset:40960
    ds_read_b64_tr_b16 v[182:183], v217 offset:41472
    v_mfma_f32_16x16x32_bf16 v[112:115], v[188:191], a[80:83], v[112:115]
    v_cvt_pk_bf16_f32 v202, v226, v227
    v_cvt_pk_bf16_f32 v203, v228, v229
    v_mfma_f32_16x16x32_bf16 v[116:119], v[184:187], a[68:71], v[116:119]
    v_mul_f32 v192, v4, v4
    v_fmaak_f32 v192, v192, v208, 0xc0135761
    v_mfma_f32_16x16x32_bf16 v[116:119], v[188:191], a[84:87], v[116:119]
    buffer_load_dwordx4 v211, s[12:15], s70 offen offset:1024 lds
    v_mfma_f32_16x16x32_bf16 v[120:123], v[184:187], a[72:75], v[120:123]
    v_mul_f32 v192, v192, v4
    v_mul_f32 v196, v4, v20
    v_mfma_f32_16x16x32_bf16 v[120:123], v[188:191], a[88:91], v[120:123]
    v_exp_f32 v192, v192
    v_mul_f32 v193, v5, v5
    v_mfma_f32_16x16x32_bf16 v[124:127], v[184:187], a[76:79], v[124:127]
    v_add_f32 v192, 1.0, v192
    v_fmaak_f32 v193, v193, v208, 0xc0135761
    v_mfma_f32_16x16x32_bf16 v[124:127], v[188:191], a[92:95], v[124:127]
    s_waitcnt lgkmcnt(10)
    ds_read_b64_tr_b16 v[184:185], v217 offset:34816
    ds_read_b64_tr_b16 v[186:187], v217 offset:35328
    v_mfma_f32_16x16x32_bf16 v[64:67], v[160:163], a[96:99], v[64:67]
    s_add_u32 s73, s78, 663552
    buffer_load_dword v255, v244, s[16:19], s73 offen
    s_waitcnt lgkmcnt(10)
    v_mfma_f32_16x16x32_bf16 v[64:67], v[164:167], a[112:115], v[64:67]
    ds_read_b64_tr_b16 v[188:189], v217 offset:43008
    ds_read_b64_tr_b16 v[190:191], v217 offset:43520
    v_mfma_f32_16x16x32_bf16 v[68:71], v[160:163], a[100:103], v[68:71]
    v_rcp_f32 v192, v192
    v_mfma_f32_16x16x32_bf16 v[68:71], v[164:167], a[116:119], v[68:71]
    v_mul_f32 v196, v196, v192
    v_mul_f32 v193, v193, v5
    v_mul_f32 v197, v5, v21
    v_mfma_f32_16x16x32_bf16 v[72:75], v[160:163], a[104:107], v[72:75]
    v_exp_f32 v193, v193
    v_mfma_f32_16x16x32_bf16 v[72:75], v[164:167], a[120:123], v[72:75]
    buffer_store_dwordx4 v[200:203], v209, s[20:23], s97 offen sc1
    v_mfma_f32_16x16x32_bf16 v[76:79], v[160:163], a[108:111], v[76:79]
    v_add_f32 v193, 1.0, v193
    v_mul_f32 v194, v6, v6
    v_mfma_f32_16x16x32_bf16 v[76:79], v[164:167], a[124:127], v[76:79]
    s_waitcnt lgkmcnt(10)
    v_rcp_f32 v193, v193
    v_mfma_f32_16x16x32_bf16 v[80:83], v[168:171], a[96:99], v[80:83]
    s_add_u32 s97, s48, 0
    v_mul_f32 v197, v197, v193
    v_fmaak_f32 v194, v194, v208, 0xc0135761
    s_waitcnt lgkmcnt(8)
    v_mfma_f32_16x16x32_bf16 v[80:83], v[172:175], a[112:115], v[80:83]
    v_mul_f32 v194, v194, v6
    v_mul_f32 v198, v6, v22
    v_mfma_f32_16x16x32_bf16 v[84:87], v[168:171], a[100:103], v[84:87]
    s_waitcnt vmcnt(16)
    v_exp_f32 v194, v194
    v_mul_f32 v195, v7, v7
    v_mfma_f32_16x16x32_bf16 v[84:87], v[172:175], a[116:119], v[84:87]
    s_barrier
    v_add_f32 v194, 1.0, v194
    v_fmaak_f32 v195, v195, v208, 0xc0135761
    v_mfma_f32_16x16x32_bf16 v[88:91], v[168:171], a[104:107], v[88:91]
    ds_read_b64_tr_b16 v[160:161], v214 offset:57344
    ds_read_b64_tr_b16 v[162:163], v214 offset:57856
    v_mfma_f32_16x16x32_bf16 v[88:91], v[172:175], a[120:123], v[88:91]
    ds_read_b64_tr_b16 v[164:165], v215 offset:0
    ds_read_b64_tr_b16 v[166:167], v215 offset:512
    v_mfma_f32_16x16x32_bf16 v[92:95], v[168:171], a[108:111], v[92:95]
    s_add_u32 m0, s40, 81920
    s_add_u32 s71, s44, 4718720
    v_mul_f32 v195, v195, v7
    v_mfma_f32_16x16x32_bf16 v[92:95], v[172:175], a[124:127], v[92:95]
    s_waitcnt lgkmcnt(10)
    buffer_load_dwordx4 v210, s[8:11], s71 offen lds
    v_mfma_f32_16x16x32_bf16 v[96:99], v[176:179], a[96:99], v[96:99]
    s_waitcnt lgkmcnt(8)
    ds_read_b64_tr_b16 v[168:169], v214 offset:59392
    ds_read_b64_tr_b16 v[170:171], v214 offset:59904
    v_mfma_f32_16x16x32_bf16 v[96:99], v[180:183], a[112:115], v[96:99]
    ds_read_b64_tr_b16 v[172:173], v215 offset:2048
    ds_read_b64_tr_b16 v[174:175], v215 offset:2560
    v_mul_f32 v199, v7, v23
    v_mfma_f32_16x16x32_bf16 v[100:103], v[176:179], a[100:103], v[100:103]
    v_rcp_f32 v194, v194
    v_mfma_f32_16x16x32_bf16 v[100:103], v[180:183], a[116:119], v[100:103]
    v_exp_f32 v195, v195
    v_mfma_f32_16x16x32_bf16 v[104:107], v[176:179], a[104:107], v[104:107]
    buffer_load_dwordx4 v211, s[8:11], s71 offen offset:1024 lds
    v_mfma_f32_16x16x32_bf16 v[104:107], v[180:183], a[120:123], v[104:107]
    s_add_u32 m0, s40, 83968
    v_mul_f32 v198, v198, v194
    v_add_f32 v195, 1.0, v195
    v_mfma_f32_16x16x32_bf16 v[108:111], v[176:179], a[108:111], v[108:111]
    v_rcp_f32 v195, v195
    v_mfma_f32_16x16x32_bf16 v[108:111], v[180:183], a[124:127], v[108:111]
    s_waitcnt lgkmcnt(10)
    ds_read_b64_tr_b16 v[176:177], v217 offset:57344
    ds_read_b64_tr_b16 v[178:179], v217 offset:57856
    v_mul_f32 v199, v199, v195
    v_mfma_f32_16x16x32_bf16 v[112:115], v[184:187], a[96:99], v[112:115]
    s_waitcnt lgkmcnt(10)
    ds_read_b64_tr_b16 v[180:181], v218 offset:0
    ds_read_b64_tr_b16 v[182:183], v218 offset:512
    v_mfma_f32_16x16x32_bf16 v[112:115], v[188:191], a[112:115], v[112:115]
    buffer_load_dwordx4 v210, s[12:15], s71 offen lds
    v_mfma_f32_16x16x32_bf16 v[116:119], v[184:187], a[100:103], v[116:119]
    v_cvt_pk_bf16_f32 v204, v196, v197
    v_cvt_pk_bf16_f32 v205, v198, v199
    v_mfma_f32_16x16x32_bf16 v[116:119], v[188:191], a[116:119], v[116:119]
    v_mul_f32 v222, v36, v36
    v_fmaak_f32 v222, v222, v208, 0xc0135761
    v_mfma_f32_16x16x32_bf16 v[120:123], v[184:187], a[104:107], v[120:123]
    v_mul_f32 v222, v222, v36
    v_mul_f32 v226, v36, v52
    v_mfma_f32_16x16x32_bf16 v[120:123], v[188:191], a[120:123], v[120:123]
    v_exp_f32 v222, v222
    v_mul_f32 v223, v37, v37
    v_mfma_f32_16x16x32_bf16 v[124:127], v[184:187], a[108:111], v[124:127]
    buffer_load_dwordx4 v211, s[12:15], s71 offen offset:1024 lds
    v_mfma_f32_16x16x32_bf16 v[124:127], v[188:191], a[124:127], v[124:127]
    s_waitcnt lgkmcnt(10)
    ds_read_b64_tr_b16 v[184:185], v217 offset:59392
    ds_read_b64_tr_b16 v[186:187], v217 offset:59904
    v_mfma_f32_16x16x32_bf16 v[64:67], v[160:163], a[128:131], v[64:67]
    s_waitcnt lgkmcnt(10)
    ds_read_b64_tr_b16 v[188:189], v218 offset:2048
    ds_read_b64_tr_b16 v[190:191], v218 offset:2560
    v_mfma_f32_16x16x32_bf16 v[64:67], v[164:167], a[144:147], v[64:67]
    s_add_u32 m0, s40, 32768
    s_add_u32 s70, s44, 256
    v_add_f32 v222, 1.0, v222
    v_mfma_f32_16x16x32_bf16 v[68:71], v[160:163], a[132:135], v[68:71]
    v_rcp_f32 v222, v222
    v_mfma_f32_16x16x32_bf16 v[68:71], v[164:167], a[148:151], v[68:71]
    buffer_load_dwordx4 v210, s[8:11], s70 offen lds
    v_mul_f32 v226, v226, v222
    v_mfma_f32_16x16x32_bf16 v[72:75], v[160:163], a[136:139], v[72:75]
    v_fmaak_f32 v223, v223, v208, 0xc0135761
    v_mul_f32 v223, v223, v37
    v_mfma_f32_16x16x32_bf16 v[72:75], v[164:167], a[152:155], v[72:75]
    v_exp_f32 v223, v223
    v_mfma_f32_16x16x32_bf16 v[76:79], v[160:163], a[140:143], v[76:79]
    v_mul_f32 v227, v37, v53
    v_add_f32 v223, 1.0, v223
    v_mfma_f32_16x16x32_bf16 v[76:79], v[164:167], a[156:159], v[76:79]
    s_waitcnt lgkmcnt(10)
    v_rcp_f32 v223, v223
    v_mfma_f32_16x16x32_bf16 v[80:83], v[168:171], a[128:131], v[80:83]
    s_waitcnt lgkmcnt(8)
    buffer_load_dwordx4 v211, s[8:11], s70 offen offset:1024 lds
    v_mfma_f32_16x16x32_bf16 v[80:83], v[172:175], a[144:147], v[80:83]
    s_add_u32 m0, s40, 34816
    v_mul_f32 v227, v227, v223
    v_mul_f32 v224, v38, v38
    v_fmaak_f32 v224, v224, v208, 0xc0135761
    v_mfma_f32_16x16x32_bf16 v[84:87], v[168:171], a[132:135], v[84:87]
    s_waitcnt vmcnt(16)
    v_mul_f32 v224, v224, v38
    v_mul_f32 v228, v38, v54
    v_mfma_f32_16x16x32_bf16 v[84:87], v[172:175], a[148:151], v[84:87]
    s_barrier
    v_exp_f32 v224, v224
    v_mfma_f32_16x16x32_bf16 v[88:91], v[168:171], a[136:139], v[88:91]
    ds_read_b64_tr_b16 v[160:161], v215 offset:8192
    ds_read_b64_tr_b16 v[162:163], v215 offset:8704
    v_mfma_f32_16x16x32_bf16 v[88:91], v[172:175], a[152:155], v[88:91]
    buffer_load_dwordx4 v210, s[12:15], s70 offen lds
    v_mfma_f32_16x16x32_bf16 v[92:95], v[168:171], a[140:143], v[92:95]
    ds_read_b64_tr_b16 v[164:165], v215 offset:16384
    ds_read_b64_tr_b16 v[166:167], v215 offset:16896
    v_mfma_f32_16x16x32_bf16 v[92:95], v[172:175], a[156:159], v[92:95]
    s_waitcnt lgkmcnt(10)
    ds_read_b64_tr_b16 v[168:169], v215 offset:10240
    ds_read_b64_tr_b16 v[170:171], v215 offset:10752
    v_mfma_f32_16x16x32_bf16 v[96:99], v[176:179], a[128:131], v[96:99]
    s_waitcnt lgkmcnt(10)
    ds_read_b64_tr_b16 v[172:173], v215 offset:18432
    ds_read_b64_tr_b16 v[174:175], v215 offset:18944
    v_add_f32 v224, 1.0, v224
    v_mfma_f32_16x16x32_bf16 v[96:99], v[180:183], a[144:147], v[96:99]
    v_rcp_f32 v224, v224
    v_mfma_f32_16x16x32_bf16 v[100:103], v[176:179], a[132:135], v[100:103]
    buffer_load_dwordx4 v211, s[12:15], s70 offen offset:1024 lds
    v_mfma_f32_16x16x32_bf16 v[100:103], v[180:183], a[148:151], v[100:103]
    s_add_u32 m0, s40, 49152
    s_add_u32 s71, s44, 590080
    v_mul_f32 v228, v228, v224
    v_mfma_f32_16x16x32_bf16 v[104:107], v[176:179], a[136:139], v[104:107]
    v_mul_f32 v225, v39, v39
    v_fmaak_f32 v225, v225, v208, 0xc0135761
    v_mfma_f32_16x16x32_bf16 v[104:107], v[180:183], a[152:155], v[104:107]
    v_mul_f32 v225, v225, v39
    v_exp_f32 v225, v225
    v_mfma_f32_16x16x32_bf16 v[108:111], v[176:179], a[140:143], v[108:111]
    v_mul_f32 v229, v39, v55
    v_add_f32 v225, 1.0, v225
    v_mfma_f32_16x16x32_bf16 v[108:111], v[180:183], a[156:159], v[108:111]
    s_waitcnt lgkmcnt(10)
    buffer_load_dwordx4 v210, s[8:11], s71 offen lds
    v_mfma_f32_16x16x32_bf16 v[112:115], v[184:187], a[128:131], v[112:115]
    s_waitcnt lgkmcnt(8)
    ds_read_b64_tr_b16 v[176:177], v218 offset:8192
    ds_read_b64_tr_b16 v[178:179], v218 offset:8704
    v_mfma_f32_16x16x32_bf16 v[112:115], v[188:191], a[144:147], v[112:115]
    ds_read_b64_tr_b16 v[180:181], v218 offset:16384
    ds_read_b64_tr_b16 v[182:183], v218 offset:16896
    v_mfma_f32_16x16x32_bf16 v[116:119], v[184:187], a[132:135], v[116:119]
    v_rcp_f32 v225, v225
    v_mfma_f32_16x16x32_bf16 v[116:119], v[188:191], a[148:151], v[116:119]
    v_mul_f32 v229, v229, v225
    v_cvt_pk_bf16_f32 v206, v226, v227
    v_cvt_pk_bf16_f32 v207, v228, v229
    v_mfma_f32_16x16x32_bf16 v[120:123], v[184:187], a[136:139], v[120:123]
    buffer_load_dwordx4 v211, s[8:11], s71 offen offset:1024 lds
    v_mfma_f32_16x16x32_bf16 v[120:123], v[188:191], a[152:155], v[120:123]
    s_add_u32 m0, s40, 51200
    v_mul_f32 v192, v8, v8
    v_fmaak_f32 v192, v192, v208, 0xc0135761
    v_mfma_f32_16x16x32_bf16 v[124:127], v[184:187], a[140:143], v[124:127]
    v_mul_f32 v192, v192, v8
    v_mul_f32 v196, v8, v24
    v_mfma_f32_16x16x32_bf16 v[124:127], v[188:191], a[156:159], v[124:127]
    s_waitcnt lgkmcnt(10)
    ds_read_b64_tr_b16 v[184:185], v218 offset:10240
    ds_read_b64_tr_b16 v[186:187], v218 offset:10752
    v_mfma_f32_16x16x32_bf16 v[64:67], v[160:163], a[160:163], v[64:67]
    s_waitcnt lgkmcnt(10)
    ds_read_b64_tr_b16 v[188:189], v218 offset:18432
    ds_read_b64_tr_b16 v[190:191], v218 offset:18944
    v_mul_f32 v193, v9, v9
    v_mfma_f32_16x16x32_bf16 v[64:67], v[164:167], a[176:179], v[64:67]
    s_add_u32 s74, s78, 73728
    buffer_load_dword v255, v244, s[16:19], s74 offen
    v_mfma_f32_16x16x32_bf16 v[68:71], v[160:163], a[164:167], v[68:71]
    v_exp_f32 v192, v192
    v_mfma_f32_16x16x32_bf16 v[68:71], v[164:167], a[180:183], v[68:71]
    v_add_f32 v192, 1.0, v192
    v_fmaak_f32 v193, v193, v208, 0xc0135761
    v_mfma_f32_16x16x32_bf16 v[72:75], v[160:163], a[168:171], v[72:75]
    v_rcp_f32 v192, v192
    v_mfma_f32_16x16x32_bf16 v[72:75], v[164:167], a[184:187], v[72:75]
    v_mul_f32 v196, v196, v192
    v_mul_f32 v193, v193, v9
    v_mfma_f32_16x16x32_bf16 v[76:79], v[160:163], a[172:175], v[76:79]
    s_add_u32 s75, s85, 384
    buffer_load_dword v255, v254, s[8:11], s75 offen
    v_mul_f32 v197, v9, v25
    v_mfma_f32_16x16x32_bf16 v[76:79], v[164:167], a[188:191], v[76:79]
    s_waitcnt lgkmcnt(10)
    v_exp_f32 v193, v193
    v_mfma_f32_16x16x32_bf16 v[80:83], v[168:171], a[160:163], v[80:83]
    s_waitcnt lgkmcnt(8)
    v_add_f32 v193, 1.0, v193
    v_mul_f32 v194, v10, v10
    v_mfma_f32_16x16x32_bf16 v[80:83], v[172:175], a[176:179], v[80:83]
    v_rcp_f32 v193, v193
    v_mfma_f32_16x16x32_bf16 v[84:87], v[168:171], a[164:167], v[84:87]
    s_waitcnt vmcnt(18)
    v_mul_f32 v197, v197, v193
    v_fmaak_f32 v194, v194, v208, 0xc0135761
    v_mfma_f32_16x16x32_bf16 v[84:87], v[172:175], a[180:183], v[84:87]
    s_barrier
    buffer_store_dwordx4 v[204:207], v209, s[20:23], s98 offen sc1
    v_mul_f32 v194, v194, v10
    v_mfma_f32_16x16x32_bf16 v[88:91], v[168:171], a[168:171], v[88:91]
    s_add_u32 s98, s49, 0
    ds_read_b64_tr_b16 v[160:161], v213 offset:0
    ds_read_b64_tr_b16 v[162:163], v213 offset:512
    v_mfma_f32_16x16x32_bf16 v[88:91], v[172:175], a[184:187], v[88:91]
    ds_read_b64_tr_b16 v[164:165], v213 offset:8192
    ds_read_b64_tr_b16 v[166:167], v213 offset:8704
    v_mfma_f32_16x16x32_bf16 v[92:95], v[168:171], a[172:175], v[92:95]
    v_exp_f32 v194, v194
    v_mfma_f32_16x16x32_bf16 v[92:95], v[172:175], a[188:191], v[92:95]
    s_add_u32 s72, s85, 384
    buffer_load_dword v255, v254, s[12:15], s72 offen
    s_waitcnt lgkmcnt(10)
    v_mfma_f32_16x16x32_bf16 v[96:99], v[176:179], a[160:163], v[96:99]
    s_waitcnt lgkmcnt(8)
    ds_read_b64_tr_b16 v[168:169], v213 offset:2048
    ds_read_b64_tr_b16 v[170:171], v213 offset:2560
    v_mfma_f32_16x16x32_bf16 v[96:99], v[180:183], a[176:179], v[96:99]
    ds_read_b64_tr_b16 v[172:173], v213 offset:10240
    ds_read_b64_tr_b16 v[174:175], v213 offset:10752
    v_mul_f32 v198, v10, v26
    v_mfma_f32_16x16x32_bf16 v[100:103], v[176:179], a[164:167], v[100:103]
    v_add_f32 v194, 1.0, v194
    v_mul_f32 v195, v11, v11
    v_mfma_f32_16x16x32_bf16 v[100:103], v[180:183], a[180:183], v[100:103]
    v_rcp_f32 v194, v194
    v_mfma_f32_16x16x32_bf16 v[104:107], v[176:179], a[168:171], v[104:107]
    buffer_load_dwordx4 v210, s[12:15], s71 offen lds
    v_mfma_f32_16x16x32_bf16 v[104:107], v[180:183], a[184:187], v[104:107]
    v_mul_f32 v198, v198, v194
    v_fmaak_f32 v195, v195, v208, 0xc0135761
    v_mfma_f32_16x16x32_bf16 v[108:111], v[176:179], a[172:175], v[108:111]
    v_mul_f32 v195, v195, v11
    v_mul_f32 v199, v11, v27
    v_mfma_f32_16x16x32_bf16 v[108:111], v[180:183], a[188:191], v[108:111]
    s_waitcnt lgkmcnt(10)
    ds_read_b64_tr_b16 v[176:177], v216 offset:0
    ds_read_b64_tr_b16 v[178:179], v216 offset:512
    v_cvt_pk_bf16_f32 v200, v196, v197
    v_mfma_f32_16x16x32_bf16 v[112:115], v[184:187], a[160:163], v[112:115]
    s_waitcnt lgkmcnt(10)
    ds_read_b64_tr_b16 v[180:181], v216 offset:8192
    ds_read_b64_tr_b16 v[182:183], v216 offset:8704
    v_mfma_f32_16x16x32_bf16 v[112:115], v[188:191], a[176:179], v[112:115]
    buffer_load_dwordx4 v211, s[12:15], s71 offen offset:1024 lds
    v_mfma_f32_16x16x32_bf16 v[116:119], v[184:187], a[164:167], v[116:119]
    s_add_u32 m0, s40, 65536
    s_add_u32 s70, s44, 1179904
    v_mul_f32 v222, v40, v40
    v_mfma_f32_16x16x32_bf16 v[116:119], v[188:191], a[180:183], v[116:119]
    v_exp_f32 v195, v195
    v_mfma_f32_16x16x32_bf16 v[120:123], v[184:187], a[168:171], v[120:123]
    v_add_f32 v195, 1.0, v195
    v_rcp_f32 v195, v195
    v_mfma_f32_16x16x32_bf16 v[120:123], v[188:191], a[184:187], v[120:123]
    v_mul_f32 v199, v199, v195
    v_cvt_pk_bf16_f32 v201, v198, v199
    v_mfma_f32_16x16x32_bf16 v[124:127], v[184:187], a[172:175], v[124:127]
    buffer_load_dwordx4 v210, s[8:11], s70 offen lds
    v_mfma_f32_16x16x32_bf16 v[124:127], v[188:191], a[188:191], v[124:127]
    s_waitcnt lgkmcnt(10)
    ds_read_b64_tr_b16 v[184:185], v216 offset:2048
    ds_read_b64_tr_b16 v[186:187], v216 offset:2560
    v_mfma_f32_16x16x32_bf16 v[64:67], v[160:163], a[192:195], v[64:67]
    s_waitcnt lgkmcnt(10)
    ds_read_b64_tr_b16 v[188:189], v216 offset:10240
    ds_read_b64_tr_b16 v[190:191], v216 offset:10752
    v_mfma_f32_16x16x32_bf16 v[64:67], v[164:167], a[208:211], v[64:67]
    v_fmaak_f32 v222, v222, v208, 0xc0135761
    v_mul_f32 v222, v222, v40
    v_mul_f32 v226, v40, v56
    v_mfma_f32_16x16x32_bf16 v[68:71], v[160:163], a[196:199], v[68:71]
    v_exp_f32 v222, v222
    v_mfma_f32_16x16x32_bf16 v[68:71], v[164:167], a[212:215], v[68:71]
    buffer_load_dwordx4 v211, s[8:11], s70 offen offset:1024 lds
    v_mfma_f32_16x16x32_bf16 v[72:75], v[160:163], a[200:203], v[72:75]
    s_add_u32 m0, s40, 67584
    v_add_f32 v222, 1.0, v222
    v_mul_f32 v223, v41, v41
    v_mfma_f32_16x16x32_bf16 v[72:75], v[164:167], a[216:219], v[72:75]
    v_rcp_f32 v222, v222
    v_mfma_f32_16x16x32_bf16 v[76:79], v[160:163], a[204:207], v[76:79]
    v_mul_f32 v226, v226, v222
    v_fmaak_f32 v223, v223, v208, 0xc0135761
    v_mul_f32 v223, v223, v41
    v_mfma_f32_16x16x32_bf16 v[76:79], v[164:167], a[220:223], v[76:79]
    s_waitcnt lgkmcnt(10)
    v_exp_f32 v223, v223
    v_mfma_f32_16x16x32_bf16 v[80:83], v[168:171], a[192:195], v[80:83]
    s_waitcnt lgkmcnt(8)
    buffer_load_dwordx4 v210, s[12:15], s70 offen lds
    v_mfma_f32_16x16x32_bf16 v[80:83], v[172:175], a[208:211], v[80:83]
    v_mul_f32 v227, v41, v57
    v_add_f32 v223, 1.0, v223
    v_mfma_f32_16x16x32_bf16 v[84:87], v[168:171], a[196:199], v[84:87]
    s_waitcnt vmcnt(21)
    v_rcp_f32 v223, v223
    v_mfma_f32_16x16x32_bf16 v[84:87], v[172:175], a[212:215], v[84:87]
    s_barrier
    v_mul_f32 v227, v227, v223
    v_mul_f32 v224, v42, v42
    v_fmaak_f32 v224, v224, v208, 0xc0135761
    v_mfma_f32_16x16x32_bf16 v[88:91], v[168:171], a[200:203], v[88:91]
    ds_read_b64_tr_b16 v[160:161], v213 offset:16384
    ds_read_b64_tr_b16 v[162:163], v213 offset:16896
    v_mfma_f32_16x16x32_bf16 v[88:91], v[172:175], a[216:219], v[88:91]
    buffer_load_dwordx4 v211, s[12:15], s70 offen offset:1024 lds
    v_mfma_f32_16x16x32_bf16 v[92:95], v[168:171], a[204:207], v[92:95]
    ds_read_b64_tr_b16 v[164:165], v213 offset:24576
    ds_read_b64_tr_b16 v[166:167], v213 offset:25088
    v_mfma_f32_16x16x32_bf16 v[92:95], v[172:175], a[220:223], v[92:95]
    s_waitcnt lgkmcnt(10)
    ds_read_b64_tr_b16 v[168:169], v213 offset:18432
    ds_read_b64_tr_b16 v[170:171], v213 offset:18944
    v_mfma_f32_16x16x32_bf16 v[96:99], v[176:179], a[192:195], v[96:99]
    s_waitcnt lgkmcnt(10)
    ds_read_b64_tr_b16 v[172:173], v213 offset:26624
    ds_read_b64_tr_b16 v[174:175], v213 offset:27136
    v_mfma_f32_16x16x32_bf16 v[96:99], v[180:183], a[208:211], v[96:99]
    v_mul_f32 v224, v224, v42
    v_exp_f32 v224, v224
    v_mfma_f32_16x16x32_bf16 v[100:103], v[176:179], a[196:199], v[100:103]
    v_mul_f32 v228, v42, v58
    v_add_f32 v224, 1.0, v224
    v_mfma_f32_16x16x32_bf16 v[100:103], v[180:183], a[212:215], v[100:103]
    v_rcp_f32 v224, v224
    v_mfma_f32_16x16x32_bf16 v[104:107], v[176:179], a[200:203], v[104:107]
    v_mul_f32 v228, v228, v224
    v_mul_f32 v225, v43, v43
    v_mfma_f32_16x16x32_bf16 v[104:107], v[180:183], a[216:219], v[104:107]
    v_fmaak_f32 v225, v225, v208, 0xc0135761
    v_mul_f32 v225, v225, v43
    v_mfma_f32_16x16x32_bf16 v[108:111], v[176:179], a[204:207], v[108:111]
    v_exp_f32 v225, v225
    v_mul_f32 v229, v43, v59
    v_mfma_f32_16x16x32_bf16 v[108:111], v[180:183], a[220:223], v[108:111]
    s_waitcnt lgkmcnt(10)
    ds_read_b64_tr_b16 v[176:177], v216 offset:16384
    ds_read_b64_tr_b16 v[178:179], v216 offset:16896
    v_mfma_f32_16x16x32_bf16 v[112:115], v[184:187], a[192:195], v[112:115]
    s_waitcnt lgkmcnt(10)
    ds_read_b64_tr_b16 v[180:181], v216 offset:24576
    ds_read_b64_tr_b16 v[182:183], v216 offset:25088
    v_mfma_f32_16x16x32_bf16 v[112:115], v[188:191], a[208:211], v[112:115]
    v_add_f32 v225, 1.0, v225
    v_cvt_pk_bf16_f32 v202, v226, v227
    v_mfma_f32_16x16x32_bf16 v[116:119], v[184:187], a[196:199], v[116:119]
    v_rcp_f32 v225, v225
    v_mfma_f32_16x16x32_bf16 v[116:119], v[188:191], a[212:215], v[116:119]
    v_mul_f32 v229, v229, v225
    v_cvt_pk_bf16_f32 v203, v228, v229
    v_mul_f32 v192, v12, v12
    v_mfma_f32_16x16x32_bf16 v[120:123], v[184:187], a[200:203], v[120:123]
    buffer_store_dwordx4 v[200:203], v209, s[20:23], s97 offen sc1
    v_mfma_f32_16x16x32_bf16 v[120:123], v[188:191], a[216:219], v[120:123]
    v_fmaak_f32 v192, v192, v208, 0xc0135761
    v_mul_f32 v192, v192, v12
    v_mfma_f32_16x16x32_bf16 v[124:127], v[184:187], a[204:207], v[124:127]
    v_exp_f32 v192, v192
    v_mfma_f32_16x16x32_bf16 v[124:127], v[188:191], a[220:223], v[124:127]
    s_waitcnt lgkmcnt(10)
    ds_read_b64_tr_b16 v[184:185], v216 offset:18432
    ds_read_b64_tr_b16 v[186:187], v216 offset:18944
    v_mfma_f32_16x16x32_bf16 v[64:67], v[160:163], a[224:227], v[64:67]
    s_waitcnt lgkmcnt(10)
    ds_read_b64_tr_b16 v[188:189], v216 offset:26624
    ds_read_b64_tr_b16 v[190:191], v216 offset:27136
    v_mfma_f32_16x16x32_bf16 v[64:67], v[164:167], a[240:243], v[64:67]
    s_add_u32 s73, s78, 737280
    buffer_load_dword v255, v244, s[16:19], s73 offen
    v_mfma_f32_16x16x32_bf16 v[68:71], v[160:163], a[228:231], v[68:71]
    v_mul_f32 v196, v12, v28
    v_add_f32 v192, 1.0, v192
    v_mul_f32 v193, v13, v13
    v_mfma_f32_16x16x32_bf16 v[68:71], v[164:167], a[244:247], v[68:71]
    v_rcp_f32 v192, v192
    v_mfma_f32_16x16x32_bf16 v[72:75], v[160:163], a[232:235], v[72:75]
    v_mul_f32 v196, v196, v192
    v_fmaak_f32 v193, v193, v208, 0xc0135761
    v_mfma_f32_16x16x32_bf16 v[72:75], v[164:167], a[248:251], v[72:75]
    v_mul_f32 v193, v193, v13
    v_mul_f32 v197, v13, v29
    v_mfma_f32_16x16x32_bf16 v[76:79], v[160:163], a[236:239], v[76:79]
    v_exp_f32 v193, v193
    v_mfma_f32_16x16x32_bf16 v[76:79], v[164:167], a[252:255], v[76:79]
    s_waitcnt lgkmcnt(10)
    v_add_f32 v193, 1.0, v193
    v_mul_f32 v194, v14, v14
    v_mfma_f32_16x16x32_bf16 v[80:83], v[168:171], a[224:227], v[80:83]
    s_waitcnt lgkmcnt(8)
    v_rcp_f32 v193, v193
    v_mfma_f32_16x16x32_bf16 v[80:83], v[172:175], a[240:243], v[80:83]
    v_mul_f32 v197, v197, v193
    v_fmaak_f32 v194, v194, v208, 0xc0135761
    v_mfma_f32_16x16x32_bf16 v[84:87], v[168:171], a[228:231], v[84:87]
    s_waitcnt vmcnt(18)
    v_mul_f32 v194, v194, v14
    v_mul_f32 v198, v14, v30
    v_mfma_f32_16x16x32_bf16 v[84:87], v[172:175], a[244:247], v[84:87]
    s_barrier
    v_exp_f32 v194, v194
    v_mfma_f32_16x16x32_bf16 v[88:91], v[168:171], a[232:235], v[88:91]
    ds_read_b64_tr_b16 v[160:161], v214 offset:16384
    ds_read_b64_tr_b16 v[162:163], v214 offset:16896
    v_mfma_f32_16x16x32_bf16 v[88:91], v[172:175], a[248:251], v[88:91]
    ds_read_b64_tr_b16 v[164:165], v214 offset:24576
    ds_read_b64_tr_b16 v[166:167], v214 offset:25088
    v_mfma_f32_16x16x32_bf16 v[92:95], v[168:171], a[236:239], v[92:95]
    s_add_u32 m0, s40, 0
    s_add_u32 s71, s44, 1769728
    v_add_f32 v194, 1.0, v194
    v_mul_f32 v195, v15, v15
    v_mfma_f32_16x16x32_bf16 v[92:95], v[172:175], a[252:255], v[92:95]
    s_waitcnt lgkmcnt(10)
    buffer_load_dwordx4 v210, s[8:11], s71 offen lds
    v_mfma_f32_16x16x32_bf16 v[96:99], v[176:179], a[224:227], v[96:99]
    s_waitcnt lgkmcnt(8)
    ds_read_b64_tr_b16 v[168:169], v214 offset:18432
    ds_read_b64_tr_b16 v[170:171], v214 offset:18944
    v_mfma_f32_16x16x32_bf16 v[96:99], v[180:183], a[240:243], v[96:99]
    ds_read_b64_tr_b16 v[172:173], v214 offset:26624
    ds_read_b64_tr_b16 v[174:175], v214 offset:27136
    v_mfma_f32_16x16x32_bf16 v[100:103], v[176:179], a[228:231], v[100:103]
    v_rcp_f32 v194, v194
    v_mfma_f32_16x16x32_bf16 v[100:103], v[180:183], a[244:247], v[100:103]
    v_mul_f32 v198, v198, v194
    v_fmaak_f32 v195, v195, v208, 0xc0135761
    v_mfma_f32_16x16x32_bf16 v[104:107], v[176:179], a[232:235], v[104:107]
    buffer_load_dwordx4 v211, s[8:11], s71 offen offset:1024 lds
    v_mfma_f32_16x16x32_bf16 v[104:107], v[180:183], a[248:251], v[104:107]
    s_add_u32 m0, s40, 2048
    v_mul_f32 v195, v195, v15
    v_mul_f32 v199, v15, v31
    v_mfma_f32_16x16x32_bf16 v[108:111], v[176:179], a[236:239], v[108:111]
    v_exp_f32 v195, v195
    v_mfma_f32_16x16x32_bf16 v[108:111], v[180:183], a[252:255], v[108:111]
    s_waitcnt lgkmcnt(10)
    ds_read_b64_tr_b16 v[176:177], v217 offset:16384
    ds_read_b64_tr_b16 v[178:179], v217 offset:16896
    v_add_f32 v195, 1.0, v195
    v_mfma_f32_16x16x32_bf16 v[112:115], v[184:187], a[224:227], v[112:115]
    s_waitcnt lgkmcnt(10)
    ds_read_b64_tr_b16 v[180:181], v217 offset:24576
    ds_read_b64_tr_b16 v[182:183], v217 offset:25088
    v_mfma_f32_16x16x32_bf16 v[112:115], v[188:191], a[240:243], v[112:115]
    buffer_load_dwordx4 v210, s[12:15], s71 offen lds
    v_mfma_f32_16x16x32_bf16 v[116:119], v[184:187], a[228:231], v[116:119]
    v_rcp_f32 v195, v195
    v_mfma_f32_16x16x32_bf16 v[116:119], v[188:191], a[244:247], v[116:119]
    v_mul_f32 v199, v199, v195
    v_cvt_pk_bf16_f32 v204, v196, v197
    v_mfma_f32_16x16x32_bf16 v[120:123], v[184:187], a[232:235], v[120:123]
    v_cvt_pk_bf16_f32 v205, v198, v199
    v_mul_f32 v222, v44, v44
    v_mfma_f32_16x16x32_bf16 v[120:123], v[188:191], a[248:251], v[120:123]
    v_fmaak_f32 v222, v222, v208, 0xc0135761
    v_mul_f32 v222, v222, v44
    v_mfma_f32_16x16x32_bf16 v[124:127], v[184:187], a[236:239], v[124:127]
    buffer_load_dwordx4 v211, s[12:15], s71 offen offset:1024 lds
    v_mfma_f32_16x16x32_bf16 v[124:127], v[188:191], a[252:255], v[124:127]
    s_waitcnt lgkmcnt(10)
    ds_read_b64_tr_b16 v[184:185], v217 offset:18432
    ds_read_b64_tr_b16 v[186:187], v217 offset:18944
    v_mul_f32 v226, v44, v60
    v_mfma_f32_16x16x32_bf16 v[64:67], v[160:163], v[128:131], v[64:67]
    s_waitcnt lgkmcnt(10)
    ds_read_b64_tr_b16 v[188:189], v217 offset:26624
    ds_read_b64_tr_b16 v[190:191], v217 offset:27136
    v_mfma_f32_16x16x32_bf16 v[64:67], v[164:167], v[144:147], v[64:67]
    s_add_u32 s92, s53, 0
    s_add_u32 m0, s42, 118784
    v_mul_f32 v223, v45, v45
    v_mfma_f32_16x16x32_bf16 v[68:71], v[160:163], v[132:135], v[68:71]
    v_exp_f32 v222, v222
    v_mfma_f32_16x16x32_bf16 v[68:71], v[164:167], v[148:151], v[68:71]
    buffer_load_dwordx4 v232, s[16:19], s92 offen lds
    v_mfma_f32_16x16x32_bf16 v[72:75], v[160:163], v[136:139], v[72:75]
    v_add_f32 v222, 1.0, v222
    v_fmaak_f32 v223, v223, v208, 0xc0135761
    v_mfma_f32_16x16x32_bf16 v[72:75], v[164:167], v[152:155], v[72:75]
    s_add_u32 m0, s42, 118784
    v_rcp_f32 v222, v222
    v_mul_f32 v223, v223, v45
    v_mfma_f32_16x16x32_bf16 v[76:79], v[160:163], v[140:143], v[76:79]
    v_exp_f32 v223, v223
    v_mfma_f32_16x16x32_bf16 v[76:79], v[164:167], v[156:159], v[76:79]
    s_waitcnt lgkmcnt(10)
    v_mul_f32 v226, v226, v222
    v_mul_f32 v227, v45, v61
    v_mfma_f32_16x16x32_bf16 v[80:83], v[168:171], v[128:131], v[80:83]
    s_waitcnt lgkmcnt(8)
    buffer_load_dwordx4 v233, s[16:19], s92 offen offset:1024 lds
    v_mfma_f32_16x16x32_bf16 v[80:83], v[172:175], v[144:147], v[80:83]
    v_add_f32 v223, 1.0, v223
    v_mul_f32 v224, v46, v46
    v_mfma_f32_16x16x32_bf16 v[84:87], v[168:171], v[132:135], v[84:87]
    s_waitcnt vmcnt(20)
    v_rcp_f32 v223, v223
    v_mfma_f32_16x16x32_bf16 v[84:87], v[172:175], v[148:151], v[84:87]
    s_barrier
    v_mul_f32 v227, v227, v223
    v_fmaak_f32 v224, v224, v208, 0xc0135761
    v_mfma_f32_16x16x32_bf16 v[88:91], v[168:171], v[136:139], v[88:91]
    ds_read_b64_tr_b16 v[160:161], v213 offset:32768
    ds_read_b64_tr_b16 v[162:163], v213 offset:33280
    v_mfma_f32_16x16x32_bf16 v[88:91], v[172:175], v[152:155], v[88:91]
    ds_read_b64_tr_b16 v[164:165], v213 offset:40960
    ds_read_b64_tr_b16 v[166:167], v213 offset:41472
    v_mfma_f32_16x16x32_bf16 v[92:95], v[168:171], v[140:143], v[92:95]
    s_add_u32 m0, s40, 16384
    s_add_u32 s70, s44, 2359552
    v_mul_f32 v224, v224, v46
    v_mfma_f32_16x16x32_bf16 v[92:95], v[172:175], v[156:159], v[92:95]
    s_waitcnt lgkmcnt(10)
    buffer_load_dwordx4 v210, s[8:11], s70 offen lds
    v_mul_f32 v228, v46, v62
    v_mfma_f32_16x16x32_bf16 v[96:99], v[176:179], v[128:131], v[96:99]
    s_waitcnt lgkmcnt(8)
    ds_read_b64_tr_b16 v[168:169], v213 offset:34816
    ds_read_b64_tr_b16 v[170:171], v213 offset:35328
    v_mfma_f32_16x16x32_bf16 v[96:99], v[180:183], v[144:147], v[96:99]
    ds_read_b64_tr_b16 v[172:173], v213 offset:43008
    ds_read_b64_tr_b16 v[174:175], v213 offset:43520
    v_mfma_f32_16x16x32_bf16 v[100:103], v[176:179], v[132:135], v[100:103]
    v_exp_f32 v224, v224
    v_mfma_f32_16x16x32_bf16 v[100:103], v[180:183], v[148:151], v[100:103]
    v_add_f32 v224, 1.0, v224
    v_rcp_f32 v224, v224
    v_mfma_f32_16x16x32_bf16 v[104:107], v[176:179], v[136:139], v[104:107]
    buffer_load_dwordx4 v211, s[8:11], s70 offen offset:1024 lds
    v_mfma_f32_16x16x32_bf16 v[104:107], v[180:183], v[152:155], v[104:107]
    s_add_u32 m0, s40, 18432
    v_mul_f32 v228, v228, v224
    v_mul_f32 v225, v47, v47
    v_mfma_f32_16x16x32_bf16 v[108:111], v[176:179], v[140:143], v[108:111]
    v_fmaak_f32 v225, v225, v208, 0xc0135761
    v_mul_f32 v225, v225, v47
    v_mul_f32 v229, v47, v63
    v_mfma_f32_16x16x32_bf16 v[108:111], v[180:183], v[156:159], v[108:111]
    s_waitcnt lgkmcnt(10)
    ds_read_b64_tr_b16 v[176:177], v216 offset:32768
    ds_read_b64_tr_b16 v[178:179], v216 offset:33280
    v_mfma_f32_16x16x32_bf16 v[112:115], v[184:187], v[128:131], v[112:115]
    s_waitcnt lgkmcnt(10)
    ds_read_b64_tr_b16 v[180:181], v216 offset:40960
    ds_read_b64_tr_b16 v[182:183], v216 offset:41472
    v_mfma_f32_16x16x32_bf16 v[112:115], v[188:191], v[144:147], v[112:115]
    buffer_load_dwordx4 v210, s[12:15], s70 offen lds
    v_cvt_pk_bf16_f32 v206, v226, v227
    v_mfma_f32_16x16x32_bf16 v[116:119], v[184:187], v[132:135], v[116:119]
    v_exp_f32 v225, v225
    v_mfma_f32_16x16x32_bf16 v[116:119], v[188:191], v[148:151], v[116:119]
    v_add_f32 v225, 1.0, v225
    v_rcp_f32 v225, v225
    v_mfma_f32_16x16x32_bf16 v[120:123], v[184:187], v[136:139], v[120:123]
    v_mul_f32 v229, v229, v225
    v_cvt_pk_bf16_f32 v207, v228, v229
    v_mfma_f32_16x16x32_bf16 v[120:123], v[188:191], v[152:155], v[120:123]
    v_mfma_f32_16x16x32_bf16 v[124:127], v[184:187], v[140:143], v[124:127]
    buffer_store_dwordx4 v[204:207], v209, s[20:23], s98 offen sc1
    v_mfma_f32_16x16x32_bf16 v[124:127], v[188:191], v[156:159], v[124:127]
    s_waitcnt lgkmcnt(10)
    ds_read_b64_tr_b16 v[184:185], v216 offset:34816
    ds_read_b64_tr_b16 v[186:187], v216 offset:35328
    v_mfma_f32_16x16x32_bf16 v[0:3], v[160:163], a[0:3], 0
    s_waitcnt lgkmcnt(10)
    ds_read_b64_tr_b16 v[188:189], v216 offset:43008
    ds_read_b64_tr_b16 v[190:191], v216 offset:43520
    v_mfma_f32_16x16x32_bf16 v[0:3], v[164:167], a[16:19], v[0:3]
    v_mfma_f32_16x16x32_bf16 v[4:7], v[160:163], a[4:7], 0
    v_mfma_f32_16x16x32_bf16 v[4:7], v[164:167], a[20:23], v[4:7]
    s_add_u32 s74, s78, 147456
    buffer_load_dword v255, v244, s[16:19], s74 offen
    v_mfma_f32_16x16x32_bf16 v[8:11], v[160:163], a[8:11], 0
    s_add_u32 s97, s46, 2048
    v_mul_f32 v192, v64, v64
    v_fmaak_f32 v192, v192, v208, 0xc0135761
    v_mfma_f32_16x16x32_bf16 v[8:11], v[164:167], a[24:27], v[8:11]
    v_mul_f32 v192, v192, v64
    v_mul_f32 v196, v64, v80
    v_mfma_f32_16x16x32_bf16 v[12:15], v[160:163], a[12:15], 0
    v_exp_f32 v192, v192
    v_mfma_f32_16x16x32_bf16 v[12:15], v[164:167], a[28:31], v[12:15]
    s_waitcnt lgkmcnt(10)
    v_add_f32 v192, 1.0, v192
    v_rcp_f32 v192, v192
    v_mfma_f32_16x16x32_bf16 v[16:19], v[168:171], a[0:3], 0
    s_waitcnt lgkmcnt(8)
    buffer_load_dwordx4 v211, s[12:15], s70 offen offset:1024 lds
    v_mfma_f32_16x16x32_bf16 v[16:19], v[172:175], a[16:19], v[16:19]
    s_add_u32 m0, s42, 118784
    v_mul_f32 v196, v196, v192
    v_mul_f32 v193, v65, v65
    v_mfma_f32_16x16x32_bf16 v[20:23], v[168:171], a[4:7], 0
    s_waitcnt vmcnt(18)
    v_fmaak_f32 v193, v193, v208, 0xc0135761
    v_mul_f32 v193, v193, v65
    v_mfma_f32_16x16x32_bf16 v[20:23], v[172:175], a[20:23], v[20:23]
    s_barrier
    v_exp_f32 v193, v193
    v_mfma_f32_16x16x32_bf16 v[24:27], v[168:171], a[8:11], 0
    ds_read_b64_tr_b16 v[160:161], v213 offset:49152
    ds_read_b64_tr_b16 v[162:163], v213 offset:49664
    v_mfma_f32_16x16x32_bf16 v[24:27], v[172:175], a[24:27], v[24:27]
    buffer_load_dwordx4 v234, s[16:19], s92 offen offset:2048 lds
    v_mfma_f32_16x16x32_bf16 v[28:31], v[168:171], a[12:15], 0
    s_add_u32 m0, s42, 118784
    ds_read_b64_tr_b16 v[164:165], v213 offset:57344
    ds_read_b64_tr_b16 v[166:167], v213 offset:57856
    v_mfma_f32_16x16x32_bf16 v[28:31], v[172:175], a[28:31], v[28:31]
    s_waitcnt lgkmcnt(10)
    ds_read_b64_tr_b16 v[168:169], v213 offset:51200
    ds_read_b64_tr_b16 v[170:171], v213 offset:51712
    v_mfma_f32_16x16x32_bf16 v[32:35], v[176:179], a[0:3], 0
    s_waitcnt lgkmcnt(10)
    ds_read_b64_tr_b16 v[172:173], v213 offset:59392
    ds_read_b64_tr_b16 v[174:175], v213 offset:59904
    v_mfma_f32_16x16x32_bf16 v[32:35], v[180:183], a[16:19], v[32:35]
    buffer_load_dwordx4 v235, s[16:19], s92 offen offset:3072 lds
    v_mfma_f32_16x16x32_bf16 v[36:39], v[176:179], a[4:7], 0
    v_mul_f32 v197, v65, v81
    v_add_f32 v193, 1.0, v193
    v_mfma_f32_16x16x32_bf16 v[36:39], v[180:183], a[20:23], v[36:39]
    v_rcp_f32 v193, v193
    v_mfma_f32_16x16x32_bf16 v[40:43], v[176:179], a[8:11], 0
    v_mul_f32 v197, v197, v193
    v_mul_f32 v194, v66, v66
    v_mfma_f32_16x16x32_bf16 v[40:43], v[180:183], a[24:27], v[40:43]
    v_fmaak_f32 v194, v194, v208, 0xc0135761
    s_add_u32 s98, s47, 2048
    v_mul_f32 v194, v194, v66
    v_mfma_f32_16x16x32_bf16 v[44:47], v[176:179], a[12:15], 0
    v_exp_f32 v194, v194
    v_mfma_f32_16x16x32_bf16 v[44:47], v[180:183], a[28:31], v[44:47]
    s_waitcnt lgkmcnt(10)
    ds_read_b64_tr_b16 v[176:177], v216 offset:49152
    ds_read_b64_tr_b16 v[178:179], v216 offset:49664
    v_mfma_f32_16x16x32_bf16 v[48:51], v[184:187], a[0:3], 0
    s_waitcnt lgkmcnt(10)
    ds_read_b64_tr_b16 v[180:181], v216 offset:57344
    ds_read_b64_tr_b16 v[182:183], v216 offset:57856
    v_mul_f32 v198, v66, v82
    v_mfma_f32_16x16x32_bf16 v[48:51], v[188:191], a[16:19], v[48:51]
    v_add_f32 v194, 1.0, v194
    v_mul_f32 v195, v67, v67
    v_mfma_f32_16x16x32_bf16 v[52:55], v[184:187], a[4:7], 0
    v_rcp_f32 v194, v194
    v_mfma_f32_16x16x32_bf16 v[52:55], v[188:191], a[20:23], v[52:55]
    v_mul_f32 v198, v198, v194
    v_fmaak_f32 v195, v195, v208, 0xc0135761
    v_mfma_f32_16x16x32_bf16 v[56:59], v[184:187], a[8:11], 0
    v_mul_f32 v195, v195, v67
    v_mul_f32 v199, v67, v83
    v_mfma_f32_16x16x32_bf16 v[56:59], v[188:191], a[24:27], v[56:59]
    v_exp_f32 v195, v195
    v_mfma_f32_16x16x32_bf16 v[60:63], v[184:187], a[12:15], 0
    v_add_f32 v195, 1.0, v195
    v_cvt_pk_bf16_f32 v200, v196, v197
    v_mfma_f32_16x16x32_bf16 v[60:63], v[188:191], a[28:31], v[60:63]
    s_waitcnt lgkmcnt(10)
    ds_read_b64_tr_b16 v[184:185], v216 offset:51200
    ds_read_b64_tr_b16 v[186:187], v216 offset:51712
    v_mfma_f32_16x16x32_bf16 v[0:3], v[160:163], a[32:35], v[0:3]
    s_waitcnt lgkmcnt(10)
    ds_read_b64_tr_b16 v[188:189], v216 offset:59392
    ds_read_b64_tr_b16 v[190:191], v216 offset:59904
    v_mfma_f32_16x16x32_bf16 v[0:3], v[164:167], a[48:51], v[0:3]
    s_add_u32 m0, s42, 122880
    v_rcp_f32 v195, v195
    v_mfma_f32_16x16x32_bf16 v[4:7], v[160:163], a[36:39], v[4:7]
    buffer_load_dwordx4 v236, s[16:19], s92 offen lds
    v_mfma_f32_16x16x32_bf16 v[4:7], v[164:167], a[52:55], v[4:7]
    v_mul_f32 v199, v199, v195
    v_cvt_pk_bf16_f32 v201, v198, v199
    v_mfma_f32_16x16x32_bf16 v[8:11], v[160:163], a[40:43], v[8:11]
    v_mul_f32 v222, v96, v96
    v_fmaak_f32 v222, v222, v208, 0xc0135761
    v_mfma_f32_16x16x32_bf16 v[8:11], v[164:167], a[56:59], v[8:11]
    s_add_u32 m0, s42, 122880
    v_mul_f32 v222, v222, v96
    v_mul_f32 v226, v96, v112
    v_mfma_f32_16x16x32_bf16 v[12:15], v[160:163], a[44:47], v[12:15]
    v_exp_f32 v222, v222
    v_mfma_f32_16x16x32_bf16 v[12:15], v[164:167], a[60:63], v[12:15]
    s_waitcnt lgkmcnt(10)
    buffer_load_dwordx4 v237, s[16:19], s92 offen offset:1024 lds
    v_mfma_f32_16x16x32_bf16 v[16:19], v[168:171], a[32:35], v[16:19]
    s_waitcnt lgkmcnt(8)
    v_add_f32 v222, 1.0, v222
    v_mul_f32 v223, v97, v97
    v_mfma_f32_16x16x32_bf16 v[16:19], v[172:175], a[48:51], v[16:19]
    v_rcp_f32 v222, v222
    v_mfma_f32_16x16x32_bf16 v[20:23], v[168:171], a[36:39], v[20:23]
    s_waitcnt vmcnt(6)
    v_mul_f32 v226, v226, v222
    v_fmaak_f32 v223, v223, v208, 0xc0135761
    v_mfma_f32_16x16x32_bf16 v[20:23], v[172:175], a[52:55], v[20:23]
    s_barrier
    v_mul_f32 v223, v223, v97
    v_exp_f32 v223, v223
    v_mfma_f32_16x16x32_bf16 v[24:27], v[168:171], a[40:43], v[24:27]
    ds_read_b64_tr_b16 v[160:161], v214 offset:0
    ds_read_b64_tr_b16 v[162:163], v214 offset:512
    v_mfma_f32_16x16x32_bf16 v[24:27], v[172:175], a[56:59], v[24:27]
    ds_read_b64_tr_b16 v[164:165], v214 offset:8192
    ds_read_b64_tr_b16 v[166:167], v214 offset:8704
    v_mfma_f32_16x16x32_bf16 v[28:31], v[168:171], a[44:47], v[28:31]
    s_add_u32 s72, s55, 1
    v_mov_b32 v242, s72
    v_mul_f32 v227, v97, v113
    v_mfma_f32_16x16x32_bf16 v[28:31], v[172:175], a[60:63], v[28:31]
    s_waitcnt lgkmcnt(10)
    buffer_store_dword v242, v241, s[28:31], 0 offen
    v_mfma_f32_16x16x32_bf16 v[32:35], v[176:179], a[32:35], v[32:35]
    s_waitcnt lgkmcnt(8)
    ds_read_b64_tr_b16 v[168:169], v214 offset:2048
    ds_read_b64_tr_b16 v[170:171], v214 offset:2560
    v_mfma_f32_16x16x32_bf16 v[32:35], v[180:183], a[48:51], v[32:35]
    ds_read_b64_tr_b16 v[172:173], v214 offset:10240
    ds_read_b64_tr_b16 v[174:175], v214 offset:10752
    v_mfma_f32_16x16x32_bf16 v[36:39], v[176:179], a[36:39], v[36:39]
    s_add_u32 m0, s40, 32768
    s_add_u32 s71, s44, 2949376
    v_add_f32 v223, 1.0, v223
    v_mfma_f32_16x16x32_bf16 v[36:39], v[180:183], a[52:55], v[36:39]
    v_rcp_f32 v223, v223
    v_mfma_f32_16x16x32_bf16 v[40:43], v[176:179], a[40:43], v[40:43]
    buffer_load_dwordx4 v210, s[8:11], s71 offen lds
    v_mfma_f32_16x16x32_bf16 v[40:43], v[180:183], a[56:59], v[40:43]
    v_mul_f32 v227, v227, v223
    v_mul_f32 v224, v98, v98
    v_mfma_f32_16x16x32_bf16 v[44:47], v[176:179], a[44:47], v[44:47]
    v_fmaak_f32 v224, v224, v208, 0xc0135761
    v_mul_f32 v224, v224, v98
    v_mfma_f32_16x16x32_bf16 v[44:47], v[180:183], a[60:63], v[44:47]
    s_waitcnt lgkmcnt(10)
    ds_read_b64_tr_b16 v[176:177], v217 offset:0
    ds_read_b64_tr_b16 v[178:179], v217 offset:512
    v_mfma_f32_16x16x32_bf16 v[48:51], v[184:187], a[32:35], v[48:51]
    s_waitcnt lgkmcnt(10)
    ds_read_b64_tr_b16 v[180:181], v217 offset:8192
    ds_read_b64_tr_b16 v[182:183], v217 offset:8704
    v_mfma_f32_16x16x32_bf16 v[48:51], v[188:191], a[48:51], v[48:51]
    buffer_load_dwordx4 v211, s[8:11], s71 offen offset:1024 lds
    v_mfma_f32_16x16x32_bf16 v[52:55], v[184:187], a[36:39], v[52:55]
    s_add_u32 m0, s40, 34816
    v_exp_f32 v224, v224
    v_mfma_f32_16x16x32_bf16 v[52:55], v[188:191], a[52:55], v[52:55]
    v_mul_f32 v228, v98, v114
    v_add_f32 v224, 1.0, v224
    v_mfma_f32_16x16x32_bf16 v[56:59], v[184:187], a[40:43], v[56:59]
    v_rcp_f32 v224, v224
    v_mfma_f32_16x16x32_bf16 v[56:59], v[188:191], a[56:59], v[56:59]
    v_mul_f32 v228, v228, v224
    v_mul_f32 v225, v99, v99
    v_mfma_f32_16x16x32_bf16 v[60:63], v[184:187], a[44:47], v[60:63]
    buffer_load_dwordx4 v210, s[12:15], s71 offen lds
    v_fmaak_f32 v225, v225, v208, 0xc0135761
    v_mfma_f32_16x16x32_bf16 v[60:63], v[188:191], a[60:63], v[60:63]
    s_waitcnt lgkmcnt(10)
    ds_read_b64_tr_b16 v[184:185], v217 offset:2048
    ds_read_b64_tr_b16 v[186:187], v217 offset:2560
    v_mfma_f32_16x16x32_bf16 v[0:3], v[160:163], a[64:67], v[0:3]
    s_waitcnt lgkmcnt(10)
    ds_read_b64_tr_b16 v[188:189], v217 offset:10240
    ds_read_b64_tr_b16 v[190:191], v217 offset:10752
    v_mfma_f32_16x16x32_bf16 v[0:3], v[164:167], a[80:83], v[0:3]
    v_mul_f32 v225, v225, v99
    v_mul_f32 v229, v99, v115
    v_mfma_f32_16x16x32_bf16 v[4:7], v[160:163], a[68:71], v[4:7]
    v_exp_f32 v225, v225
    v_mfma_f32_16x16x32_bf16 v[4:7], v[164:167], a[84:87], v[4:7]
    s_add_u32 s75, s78, 811008
    buffer_load_dword v255, v244, s[16:19], s75 offen
    v_mfma_f32_16x16x32_bf16 v[8:11], v[160:163], a[72:75], v[8:11]
    v_add_f32 v225, 1.0, v225
    v_cvt_pk_bf16_f32 v202, v226, v227
    v_mfma_f32_16x16x32_bf16 v[8:11], v[164:167], a[88:91], v[8:11]
    v_rcp_f32 v225, v225
    v_mfma_f32_16x16x32_bf16 v[12:15], v[160:163], a[76:79], v[12:15]
    v_mul_f32 v229, v229, v225
    v_cvt_pk_bf16_f32 v203, v228, v229
    v_mfma_f32_16x16x32_bf16 v[12:15], v[164:167], a[92:95], v[12:15]
    s_waitcnt lgkmcnt(10)
    v_mul_f32 v192, v68, v68
    v_fmaak_f32 v192, v192, v208, 0xc0135761
    v_mfma_f32_16x16x32_bf16 v[16:19], v[168:171], a[64:67], v[16:19]
    s_waitcnt lgkmcnt(8)
    buffer_load_dwordx4 v211, s[12:15], s71 offen offset:1024 lds
    v_mfma_f32_16x16x32_bf16 v[16:19], v[172:175], a[80:83], v[16:19]
    s_add_u32 m0, s42, 122880
    v_mul_f32 v192, v192, v68
    v_mul_f32 v196, v68, v84
    v_mfma_f32_16x16x32_bf16 v[20:23], v[168:171], a[68:71], v[20:23]
    v_exp_f32 v192, v192
    v_mfma_f32_16x16x32_bf16 v[20:23], v[172:175], a[84:87], v[20:23]
    s_barrier
    v_add_f32 v192, 1.0, v192
    v_mul_f32 v193, v69, v69
    v_mfma_f32_16x16x32_bf16 v[24:27], v[168:171], a[72:75], v[24:27]
    ds_read_b64_tr_b16 v[160:161], v213 offset:0
    ds_read_b64_tr_b16 v[162:163], v213 offset:512
    v_mfma_f32_16x16x32_bf16 v[24:27], v[172:175], a[88:91], v[24:27]
    buffer_load_dwordx4 v238, s[16:19], s92 offen offset:2048 lds
    v_mfma_f32_16x16x32_bf16 v[28:31], v[168:171], a[76:79], v[28:31]
    s_add_u32 m0, s42, 122880
    ds_read_b64_tr_b16 v[164:165], v213 offset:8192
    ds_read_b64_tr_b16 v[166:167], v213 offset:8704
    v_mfma_f32_16x16x32_bf16 v[28:31], v[172:175], a[92:95], v[28:31]
    s_waitcnt lgkmcnt(10)
    ds_read_b64_tr_b16 v[168:169], v213 offset:2048
    ds_read_b64_tr_b16 v[170:171], v213 offset:2560
    v_mfma_f32_16x16x32_bf16 v[32:35], v[176:179], a[64:67], v[32:35]
    s_waitcnt lgkmcnt(10)
    ds_read_b64_tr_b16 v[172:173], v213 offset:10240
    ds_read_b64_tr_b16 v[174:175], v213 offset:10752
    v_fmaak_f32 v193, v193, v208, 0xc0135761
    v_mfma_f32_16x16x32_bf16 v[32:35], v[180:183], a[80:83], v[32:35]
    buffer_load_dwordx4 v239, s[16:19], s92 offen offset:3072 lds
    v_mfma_f32_16x16x32_bf16 v[36:39], v[176:179], a[68:71], v[36:39]
    s_add_u32 m0, s40, 49152
    s_add_u32 s70, s44, 3539200
    v_mul_f32 v193, v193, v69
    v_mfma_f32_16x16x32_bf16 v[36:39], v[180:183], a[84:87], v[36:39]
    v_rcp_f32 v192, v192
    v_mfma_f32_16x16x32_bf16 v[40:43], v[176:179], a[72:75], v[40:43]
    v_exp_f32 v193, v193
    v_mfma_f32_16x16x32_bf16 v[40:43], v[180:183], a[88:91], v[40:43]
    v_mul_f32 v196, v196, v192
    v_mul_f32 v197, v69, v85
    v_mfma_f32_16x16x32_bf16 v[44:47], v[176:179], a[76:79], v[44:47]
    buffer_load_dwordx4 v210, s[8:11], s70 offen lds
    v_mfma_f32_16x16x32_bf16 v[44:47], v[180:183], a[92:95], v[44:47]
    s_waitcnt lgkmcnt(10)
    ds_read_b64_tr_b16 v[176:177], v216 offset:0
    ds_read_b64_tr_b16 v[178:179], v216 offset:512
    v_mfma_f32_16x16x32_bf16 v[48:51], v[184:187], a[64:67], v[48:51]
    s_waitcnt lgkmcnt(10)
    ds_read_b64_tr_b16 v[180:181], v216 offset:8192
    ds_read_b64_tr_b16 v[182:183], v216 offset:8704
    v_mfma_f32_16x16x32_bf16 v[48:51], v[188:191], a[80:83], v[48:51]
    v_add_f32 v193, 1.0, v193
    v_mul_f32 v194, v70, v70
    v_mfma_f32_16x16x32_bf16 v[52:55], v[184:187], a[68:71], v[52:55]
    v_rcp_f32 v193, v193
    v_mfma_f32_16x16x32_bf16 v[52:55], v[188:191], a[84:87], v[52:55]
    buffer_load_dwordx4 v211, s[8:11], s70 offen offset:1024 lds
    v_mfma_f32_16x16x32_bf16 v[56:59], v[184:187], a[72:75], v[56:59]
    s_add_u32 m0, s40, 51200
    v_mul_f32 v197, v197, v193
    v_fmaak_f32 v194, v194, v208, 0xc0135761
    v_mfma_f32_16x16x32_bf16 v[56:59], v[188:191], a[88:91], v[56:59]
    v_mul_f32 v194, v194, v70
    v_exp_f32 v194, v194
    v_mfma_f32_16x16x32_bf16 v[60:63], v[184:187], a[76:79], v[60:63]
    v_mul_f32 v198, v70, v86
    v_add_f32 v194, 1.0, v194
    v_mfma_f32_16x16x32_bf16 v[60:63], v[188:191], a[92:95], v[60:63]
    s_waitcnt lgkmcnt(10)
    ds_read_b64_tr_b16 v[184:185], v216 offset:2048
    ds_read_b64_tr_b16 v[186:187], v216 offset:2560
    v_mfma_f32_16x16x32_bf16 v[0:3], v[160:163], a[96:99], v[0:3]
    s_waitcnt lgkmcnt(10)
    buffer_load_dwordx4 v210, s[12:15], s70 offen lds
    v_mfma_f32_16x16x32_bf16 v[0:3], v[164:167], a[112:115], v[0:3]
    ds_read_b64_tr_b16 v[188:189], v216 offset:10240
    ds_read_b64_tr_b16 v[190:191], v216 offset:10752
    v_mfma_f32_16x16x32_bf16 v[4:7], v[160:163], a[100:103], v[4:7]
    v_rcp_f32 v194, v194
    v_mfma_f32_16x16x32_bf16 v[4:7], v[164:167], a[116:119], v[4:7]
    v_mul_f32 v198, v198, v194
    v_mul_f32 v195, v71, v71
    v_mfma_f32_16x16x32_bf16 v[8:11], v[160:163], a[104:107], v[8:11]
    v_fmaak_f32 v195, v195, v208, 0xc0135761
    v_mul_f32 v195, v195, v71
    v_mfma_f32_16x16x32_bf16 v[8:11], v[164:167], a[120:123], v[8:11]
    buffer_load_dwordx4 v211, s[12:15], s70 offen offset:1024 lds
    v_mfma_f32_16x16x32_bf16 v[12:15], v[160:163], a[108:111], v[12:15]
    s_add_u32 m0, s42, 126976
    v_exp_f32 v195, v195
    v_mfma_f32_16x16x32_bf16 v[12:15], v[164:167], a[124:127], v[12:15]
    s_waitcnt lgkmcnt(10)
    v_mul_f32 v199, v71, v87
    v_add_f32 v195, 1.0, v195
    v_mfma_f32_16x16x32_bf16 v[16:19], v[168:171], a[96:99], v[16:19]
    s_waitcnt lgkmcnt(8)
    v_rcp_f32 v195, v195
    v_mfma_f32_16x16x32_bf16 v[16:19], v[172:175], a[112:115], v[16:19]
    v_mul_f32 v199, v199, v195
    v_cvt_pk_bf16_f32 v204, v196, v197
    v_mfma_f32_16x16x32_bf16 v[20:23], v[168:171], a[100:103], v[20:23]
    s_waitcnt vmcnt(16)
    buffer_store_dwordx4 v[200:203], v209, s[20:23], s97 offen sc1
    v_mfma_f32_16x16x32_bf16 v[20:23], v[172:175], a[116:119], v[20:23]
    s_barrier
    v_cvt_pk_bf16_f32 v205, v198, v199
    v_mul_f32 v222, v100, v100
    v_fmaak_f32 v222, v222, v208, 0xc0135761
    v_mfma_f32_16x16x32_bf16 v[24:27], v[168:171], a[104:107], v[24:27]
    s_add_u32 s97, s48, 2048
    ds_read_b64_tr_b16 v[160:161], v213 offset:16384
    ds_read_b64_tr_b16 v[162:163], v213 offset:16896
    v_mfma_f32_16x16x32_bf16 v[24:27], v[172:175], a[120:123], v[24:27]
    buffer_load_dwordx4 v240, s[16:19], s92 offen lds
    v_mfma_f32_16x16x32_bf16 v[28:31], v[168:171], a[108:111], v[28:31]
    ds_read_b64_tr_b16 v[164:165], v213 offset:24576
    ds_read_b64_tr_b16 v[166:167], v213 offset:25088
    v_mfma_f32_16x16x32_bf16 v[28:31], v[172:175], a[124:127], v[28:31]
    s_waitcnt lgkmcnt(10)
    ds_read_b64_tr_b16 v[168:169], v213 offset:18432
    ds_read_b64_tr_b16 v[170:171], v213 offset:18944
    v_mfma_f32_16x16x32_bf16 v[32:35], v[176:179], a[96:99], v[32:35]
    s_waitcnt lgkmcnt(10)
    ds_read_b64_tr_b16 v[172:173], v213 offset:26624
    ds_read_b64_tr_b16 v[174:175], v213 offset:27136
    v_mfma_f32_16x16x32_bf16 v[32:35], v[180:183], a[112:115], v[32:35]
    s_add_u32 m0, s40, 65536
    s_add_u32 s71, s44, 4129024
    v_mul_f32 v222, v222, v100
    v_mfma_f32_16x16x32_bf16 v[36:39], v[176:179], a[100:103], v[36:39]
    buffer_load_dwordx4 v210, s[8:11], s71 offen lds
    v_mfma_f32_16x16x32_bf16 v[36:39], v[180:183], a[116:119], v[36:39]
    v_exp_f32 v222, v222
    v_mfma_f32_16x16x32_bf16 v[40:43], v[176:179], a[104:107], v[40:43]
    v_mul_f32 v226, v100, v116
    v_add_f32 v222, 1.0, v222
    v_mfma_f32_16x16x32_bf16 v[40:43], v[180:183], a[120:123], v[40:43]
    v_rcp_f32 v222, v222
    v_mfma_f32_16x16x32_bf16 v[44:47], v[176:179], a[108:111], v[44:47]
    v_mul_f32 v226, v226, v222
    v_mul_f32 v223, v101, v101
    v_mfma_f32_16x16x32_bf16 v[44:47], v[180:183], a[124:127], v[44:47]
    s_waitcnt lgkmcnt(10)
    buffer_load_dwordx4 v211, s[8:11], s71 offen offset:1024 lds
    v_mfma_f32_16x16x32_bf16 v[48:51], v[184:187], a[96:99], v[48:51]
    s_add_u32 m0, s40, 67584
    ds_read_b64_tr_b16 v[176:177], v216 offset:16384
    ds_read_b64_tr_b16 v[178:179], v216 offset:16896
    s_waitcnt lgkmcnt(10)
    v_mfma_f32_16x16x32_bf16 v[48:51], v[188:191], a[112:115], v[48:51]
    ds_read_b64_tr_b16 v[180:181], v216 offset:24576
    ds_read_b64_tr_b16 v[182:183], v216 offset:25088
    v_fmaak_f32 v223, v223, v208, 0xc0135761
    v_mfma_f32_16x16x32_bf16 v[52:55], v[184:187], a[100:103], v[52:55]
    v_mul_f32 v223, v223, v101
    v_mul_f32 v227, v101, v117
    v_mfma_f32_16x16x32_bf16 v[52:55], v[188:191], a[116:119], v[52:55]
    v_exp_f32 v223, v223
    v_mfma_f32_16x16x32_bf16 v[56:59], v[184:187], a[104:107], v[56:59]
    buffer_load_dwordx4 v210, s[12:15], s71 offen lds
    v_mfma_f32_16x16x32_bf16 v[56:59], v[188:191], a[120:123], v[56:59]
    v_add_f32 v223, 1.0, v223
    v_mul_f32 v224, v102, v102
    v_mfma_f32_16x16x32_bf16 v[60:63], v[184:187], a[108:111], v[60:63]
    v_rcp_f32 v223, v223
    v_mfma_f32_16x16x32_bf16 v[60:63], v[188:191], a[124:127], v[60:63]
    s_waitcnt lgkmcnt(10)
    ds_read_b64_tr_b16 v[184:185], v216 offset:18432
    ds_read_b64_tr_b16 v[186:187], v216 offset:18944
    v_mfma_f32_16x16x32_bf16 v[0:3], v[160:163], a[128:131], v[0:3]
    s_waitcnt lgkmcnt(10)
    ds_read_b64_tr_b16 v[188:189], v216 offset:26624
    ds_read_b64_tr_b16 v[190:191], v216 offset:27136
    v_mfma_f32_16x16x32_bf16 v[0:3], v[164:167], a[144:147], v[0:3]
    s_add_u32 s72, s78, 221184
    buffer_load_dword v255, v244, s[16:19], s72 offen
    v_mfma_f32_16x16x32_bf16 v[4:7], v[160:163], a[132:135], v[4:7]
    s_add_u32 s93, s52, 0
    v_mul_f32 v227, v227, v223
    v_fmaak_f32 v224, v224, v208, 0xc0135761
    v_mfma_f32_16x16x32_bf16 v[4:7], v[164:167], a[148:151], v[4:7]
    v_mul_f32 v224, v224, v102
    v_mul_f32 v228, v102, v118
    v_mfma_f32_16x16x32_bf16 v[8:11], v[160:163], a[136:139], v[8:11]
    v_exp_f32 v224, v224
    v_mfma_f32_16x16x32_bf16 v[8:11], v[164:167], a[152:155], v[8:11]
    v_add_f32 v224, 1.0, v224
    v_rcp_f32 v224, v224
    v_mfma_f32_16x16x32_bf16 v[12:15], v[160:163], a[140:143], v[12:15]
    buffer_load_dwordx4 v211, s[12:15], s71 offen offset:1024 lds
    v_mfma_f32_16x16x32_bf16 v[12:15], v[164:167], a[156:159], v[12:15]
    s_add_u32 m0, s42, 81920
    v_mul_f32 v228, v228, v224
    v_mul_f32 v225, v103, v103
    s_waitcnt lgkmcnt(10)
    v_mfma_f32_16x16x32_bf16 v[16:19], v[168:171], a[128:131], v[16:19]
    s_waitcnt lgkmcnt(8)
    v_fmaak_f32 v225, v225, v208, 0xc0135761
    v_mul_f32 v225, v225, v103
    v_mfma_f32_16x16x32_bf16 v[16:19], v[172:175], a[144:147], v[16:19]
    v_exp_f32 v225, v225
    v_mfma_f32_16x16x32_bf16 v[20:23], v[168:171], a[132:135], v[20:23]
    s_waitcnt vmcnt(13)
    v_mul_f32 v229, v103, v119
    v_add_f32 v225, 1.0, v225
    v_mfma_f32_16x16x32_bf16 v[20:23], v[172:175], a[148:151], v[20:23]
    s_barrier
    v_rcp_f32 v225, v225
    v_mfma_f32_16x16x32_bf16 v[24:27], v[168:171], a[136:139], v[24:27]
    buffer_load_dwordx4 v232, s[16:19], s93 offen lds
    v_mfma_f32_16x16x32_bf16 v[24:27], v[172:175], a[152:155], v[24:27]
    s_add_u32 m0, s42, 81920
    ds_read_b64_tr_b16 v[160:161], v213 offset:32768
    ds_read_b64_tr_b16 v[162:163], v213 offset:33280
    v_mfma_f32_16x16x32_bf16 v[28:31], v[168:171], a[140:143], v[28:31]
    ds_read_b64_tr_b16 v[164:165], v213 offset:40960
    ds_read_b64_tr_b16 v[166:167], v213 offset:41472
    v_mfma_f32_16x16x32_bf16 v[28:31], v[172:175], a[156:159], v[28:31]
    s_waitcnt lgkmcnt(10)
    ds_read_b64_tr_b16 v[168:169], v213 offset:34816
    ds_read_b64_tr_b16 v[170:171], v213 offset:35328
    v_mfma_f32_16x16x32_bf16 v[32:35], v[176:179], a[128:131], v[32:35]
    s_waitcnt lgkmcnt(10)
    ds_read_b64_tr_b16 v[172:173], v213 offset:43008
    ds_read_b64_tr_b16 v[174:175], v213 offset:43520
    v_mfma_f32_16x16x32_bf16 v[32:35], v[180:183], a[144:147], v[32:35]
    buffer_load_dwordx4 v233, s[16:19], s93 offen offset:1024 lds
    v_mfma_f32_16x16x32_bf16 v[36:39], v[176:179], a[132:135], v[36:39]
    s_add_u32 m0, s40, 0
    s_add_u32 s70, s44, 4718848
    v_mul_f32 v229, v229, v225
    v_cvt_pk_bf16_f32 v206, v226, v227
    v_mfma_f32_16x16x32_bf16 v[36:39], v[180:183], a[148:151], v[36:39]
    v_cvt_pk_bf16_f32 v207, v228, v229
    v_mul_f32 v192, v72, v72
    v_mfma_f32_16x16x32_bf16 v[40:43], v[176:179], a[136:139], v[40:43]
    v_fmaak_f32 v192, v192, v208, 0xc0135761
    v_mul_f32 v192, v192, v72
    v_mfma_f32_16x16x32_bf16 v[40:43], v[180:183], a[152:155], v[40:43]
    v_exp_f32 v192, v192
    v_mfma_f32_16x16x32_bf16 v[44:47], v[176:179], a[140:143], v[44:47]
    buffer_load_dwordx4 v210, s[8:11], s70 offen lds
    v_mfma_f32_16x16x32_bf16 v[44:47], v[180:183], a[156:159], v[44:47]
    s_waitcnt lgkmcnt(10)
    ds_read_b64_tr_b16 v[176:177], v216 offset:32768
    ds_read_b64_tr_b16 v[178:179], v216 offset:33280
    v_mfma_f32_16x16x32_bf16 v[48:51], v[184:187], a[128:131], v[48:51]
    s_waitcnt lgkmcnt(10)
    ds_read_b64_tr_b16 v[180:181], v216 offset:40960
    ds_read_b64_tr_b16 v[182:183], v216 offset:41472
    v_mfma_f32_16x16x32_bf16 v[48:51], v[188:191], a[144:147], v[48:51]
    v_mul_f32 v196, v72, v88
    v_add_f32 v192, 1.0, v192
    v_mfma_f32_16x16x32_bf16 v[52:55], v[184:187], a[132:135], v[52:55]
    v_rcp_f32 v192, v192
    v_mfma_f32_16x16x32_bf16 v[52:55], v[188:191], a[148:151], v[52:55]
    buffer_load_dwordx4 v211, s[8:11], s70 offen offset:1024 lds
    v_mfma_f32_16x16x32_bf16 v[56:59], v[184:187], a[136:139], v[56:59]
    s_add_u32 m0, s40, 2048
    v_mul_f32 v196, v196, v192
    v_mul_f32 v193, v73, v73
    v_fmaak_f32 v193, v193, v208, 0xc0135761
    v_mfma_f32_16x16x32_bf16 v[56:59], v[188:191], a[152:155], v[56:59]
    v_mul_f32 v193, v193, v73
    v_mul_f32 v197, v73, v89
    v_mfma_f32_16x16x32_bf16 v[60:63], v[184:187], a[140:143], v[60:63]
    v_exp_f32 v193, v193
    v_mfma_f32_16x16x32_bf16 v[60:63], v[188:191], a[156:159], v[60:63]
    s_waitcnt lgkmcnt(10)
    ds_read_b64_tr_b16 v[184:185], v216 offset:34816
    ds_read_b64_tr_b16 v[186:187], v216 offset:35328
    v_mfma_f32_16x16x32_bf16 v[0:3], v[160:163], a[160:163], v[0:3]
    s_waitcnt lgkmcnt(10)
    buffer_load_dwordx4 v210, s[12:15], s70 offen lds
    v_mfma_f32_16x16x32_bf16 v[0:3], v[164:167], a[176:179], v[0:3]
    ds_read_b64_tr_b16 v[188:189], v216 offset:43008
    ds_read_b64_tr_b16 v[190:191], v216 offset:43520
    v_mfma_f32_16x16x32_bf16 v[4:7], v[160:163], a[164:167], v[4:7]
    v_add_f32 v193, 1.0, v193
    v_mul_f32 v194, v74, v74
    v_mfma_f32_16x16x32_bf16 v[4:7], v[164:167], a[180:183], v[4:7]
    v_rcp_f32 v193, v193
    v_mfma_f32_16x16x32_bf16 v[8:11], v[160:163], a[168:171], v[8:11]
    v_mul_f32 v197, v197, v193
    v_fmaak_f32 v194, v194, v208, 0xc0135761
    v_mfma_f32_16x16x32_bf16 v[8:11], v[164:167], a[184:187], v[8:11]
    buffer_load_dwordx4 v211, s[12:15], s70 offen offset:1024 lds
    v_mfma_f32_16x16x32_bf16 v[12:15], v[160:163], a[172:175], v[12:15]
    s_add_u32 m0, s42, 81920
    v_mul_f32 v194, v194, v74
    v_exp_f32 v194, v194
    v_mfma_f32_16x16x32_bf16 v[12:15], v[164:167], a[188:191], v[12:15]
    s_waitcnt lgkmcnt(10)
    v_mul_f32 v198, v74, v90
    v_add_f32 v194, 1.0, v194
    v_mfma_f32_16x16x32_bf16 v[16:19], v[168:171], a[160:163], v[16:19]
    s_waitcnt lgkmcnt(8)
    v_rcp_f32 v194, v194
    v_mfma_f32_16x16x32_bf16 v[16:19], v[172:175], a[176:179], v[16:19]
    v_mul_f32 v198, v198, v194
    v_mul_f32 v195, v75, v75
    v_mfma_f32_16x16x32_bf16 v[20:23], v[168:171], a[164:167], v[20:23]
    s_waitcnt vmcnt(13)
    buffer_store_dwordx4 v[204:207], v209, s[20:23], s98 offen sc1
    v_mfma_f32_16x16x32_bf16 v[20:23], v[172:175], a[180:183], v[20:23]
    s_barrier
    v_fmaak_f32 v195, v195, v208, 0xc0135761
    v_mul_f32 v195, v195, v75
    v_mfma_f32_16x16x32_bf16 v[24:27], v[168:171], a[168:171], v[24:27]
    s_add_u32 s98, s49, 2048
    ds_read_b64_tr_b16 v[160:161], v213 offset:49152
    ds_read_b64_tr_b16 v[162:163], v213 offset:49664
    v_mfma_f32_16x16x32_bf16 v[24:27], v[172:175], a[184:187], v[24:27]
    buffer_load_dwordx4 v234, s[16:19], s93 offen offset:2048 lds
    v_mfma_f32_16x16x32_bf16 v[28:31], v[168:171], a[172:175], v[28:31]
    s_add_u32 m0, s42, 81920
    ds_read_b64_tr_b16 v[164:165], v213 offset:57344
    ds_read_b64_tr_b16 v[166:167], v213 offset:57856
    v_mfma_f32_16x16x32_bf16 v[28:31], v[172:175], a[188:191], v[28:31]
    s_waitcnt lgkmcnt(10)
    ds_read_b64_tr_b16 v[168:169], v213 offset:51200
    ds_read_b64_tr_b16 v[170:171], v213 offset:51712
    v_mfma_f32_16x16x32_bf16 v[32:35], v[176:179], a[160:163], v[32:35]
    s_waitcnt lgkmcnt(10)
    ds_read_b64_tr_b16 v[172:173], v213 offset:59392
    ds_read_b64_tr_b16 v[174:175], v213 offset:59904
    v_mfma_f32_16x16x32_bf16 v[32:35], v[180:183], a[176:179], v[32:35]
    buffer_load_dwordx4 v235, s[16:19], s93 offen offset:3072 lds
    v_mfma_f32_16x16x32_bf16 v[36:39], v[176:179], a[164:167], v[36:39]
    s_add_u32 m0, s40, 16384
    s_add_u32 s71, s44, 384
    v_exp_f32 v195, v195
    v_mfma_f32_16x16x32_bf16 v[36:39], v[180:183], a[180:183], v[36:39]
    v_mul_f32 v199, v75, v91
    v_add_f32 v195, 1.0, v195
    v_mfma_f32_16x16x32_bf16 v[40:43], v[176:179], a[168:171], v[40:43]
    v_rcp_f32 v195, v195
    v_mfma_f32_16x16x32_bf16 v[40:43], v[180:183], a[184:187], v[40:43]
    v_mul_f32 v199, v199, v195
    v_cvt_pk_bf16_f32 v200, v196, v197
    v_mfma_f32_16x16x32_bf16 v[44:47], v[176:179], a[172:175], v[44:47]
    buffer_load_dwordx4 v210, s[8:11], s71 offen lds
    v_mfma_f32_16x16x32_bf16 v[44:47], v[180:183], a[188:191], v[44:47]
    s_waitcnt lgkmcnt(10)
    ds_read_b64_tr_b16 v[176:177], v216 offset:49152
    ds_read_b64_tr_b16 v[178:179], v216 offset:49664
    v_mfma_f32_16x16x32_bf16 v[48:51], v[184:187], a[160:163], v[48:51]
    s_waitcnt lgkmcnt(10)
    ds_read_b64_tr_b16 v[180:181], v216 offset:57344
    ds_read_b64_tr_b16 v[182:183], v216 offset:57856
    v_mfma_f32_16x16x32_bf16 v[48:51], v[188:191], a[176:179], v[48:51]
    v_cvt_pk_bf16_f32 v201, v198, v199
    v_mul_f32 v222, v104, v104
    v_mfma_f32_16x16x32_bf16 v[52:55], v[184:187], a[164:167], v[52:55]
    v_fmaak_f32 v222, v222, v208, 0xc0135761
    v_mul_f32 v222, v222, v104
    v_mfma_f32_16x16x32_bf16 v[52:55], v[188:191], a[180:183], v[52:55]
    buffer_load_dwordx4 v211, s[8:11], s71 offen offset:1024 lds
    v_mul_f32 v226, v104, v120
    v_mfma_f32_16x16x32_bf16 v[56:59], v[184:187], a[168:171], v[56:59]
    s_add_u32 m0, s40, 18432
    v_exp_f32 v222, v222
    v_mfma_f32_16x16x32_bf16 v[56:59], v[188:191], a[184:187], v[56:59]
    v_add_f32 v222, 1.0, v222
    v_mul_f32 v223, v105, v105
    v_mfma_f32_16x16x32_bf16 v[60:63], v[184:187], a[172:175], v[60:63]
    v_rcp_f32 v222, v222
    v_mfma_f32_16x16x32_bf16 v[60:63], v[188:191], a[188:191], v[60:63]
    s_waitcnt lgkmcnt(10)
    ds_read_b64_tr_b16 v[184:185], v216 offset:51200
    ds_read_b64_tr_b16 v[186:187], v216 offset:51712
    v_mfma_f32_16x16x32_bf16 v[0:3], v[160:163], a[192:195], v[0:3]
    s_add_u32 s73, s78, 884736
    buffer_load_dword v255, v244, s[16:19], s73 offen
    s_waitcnt lgkmcnt(10)
    v_mfma_f32_16x16x32_bf16 v[0:3], v[164:167], a[208:211], v[0:3]
    ds_read_b64_tr_b16 v[188:189], v216 offset:59392
    ds_read_b64_tr_b16 v[190:191], v216 offset:59904
    v_mfma_f32_16x16x32_bf16 v[4:7], v[160:163], a[196:199], v[4:7]
    v_mul_f32 v226, v226, v222
    v_fmaak_f32 v223, v223, v208, 0xc0135761
    v_mfma_f32_16x16x32_bf16 v[4:7], v[164:167], a[212:215], v[4:7]
    v_mul_f32 v223, v223, v105
    v_exp_f32 v223, v223
    v_mfma_f32_16x16x32_bf16 v[8:11], v[160:163], a[200:203], v[8:11]
    v_mul_f32 v227, v105, v121
    v_add_f32 v223, 1.0, v223
    v_mfma_f32_16x16x32_bf16 v[8:11], v[164:167], a[216:219], v[8:11]
    buffer_load_dwordx4 v210, s[12:15], s71 offen lds
    v_mfma_f32_16x16x32_bf16 v[12:15], v[160:163], a[204:207], v[12:15]
    v_rcp_f32 v223, v223
    v_mfma_f32_16x16x32_bf16 v[12:15], v[164:167], a[220:223], v[12:15]
    s_waitcnt lgkmcnt(10)
    v_mul_f32 v227, v227, v223
    v_mul_f32 v224, v106, v106
    v_mfma_f32_16x16x32_bf16 v[16:19], v[168:171], a[192:195], v[16:19]
    s_waitcnt lgkmcnt(8)
    v_fmaak_f32 v224, v224, v208, 0xc0135761
    v_mul_f32 v224, v224, v106
    v_mfma_f32_16x16x32_bf16 v[16:19], v[172:175], a[208:211], v[16:19]
    v_exp_f32 v224, v224
    v_mfma_f32_16x16x32_bf16 v[20:23], v[168:171], a[196:199], v[20:23]
    s_waitcnt vmcnt(13)
    v_mul_f32 v228, v106, v122
    v_add_f32 v224, 1.0, v224
    v_mfma_f32_16x16x32_bf16 v[20:23], v[172:175], a[212:215], v[20:23]
    s_barrier
    v_rcp_f32 v224, v224
    v_mfma_f32_16x16x32_bf16 v[24:27], v[168:171], a[200:203], v[24:27]
    buffer_load_dwordx4 v211, s[12:15], s71 offen offset:1024 lds
    v_mfma_f32_16x16x32_bf16 v[24:27], v[172:175], a[216:219], v[24:27]
    s_add_u32 m0, s42, 86016
    s_nop 0
    buffer_load_dwordx4 v236, s[16:19], s93 offen lds
    v_mfma_f32_16x16x32_bf16 v[28:31], v[168:171], a[204:207], v[28:31]
    s_add_u32 m0, s42, 86016
    ds_read_b64_tr_b16 v[160:161], v214 offset:0
    ds_read_b64_tr_b16 v[162:163], v214 offset:512
    v_mul_f32 v228, v228, v224
    v_mfma_f32_16x16x32_bf16 v[28:31], v[172:175], a[220:223], v[28:31]
    s_waitcnt lgkmcnt(8)
    ds_read_b64_tr_b16 v[164:165], v214 offset:8192
    ds_read_b64_tr_b16 v[166:167], v214 offset:8704
    v_mfma_f32_16x16x32_bf16 v[32:35], v[176:179], a[192:195], v[32:35]
    s_waitcnt lgkmcnt(8)
    ds_read_b64_tr_b16 v[168:169], v214 offset:2048
    ds_read_b64_tr_b16 v[170:171], v214 offset:2560
    v_mfma_f32_16x16x32_bf16 v[32:35], v[180:183], a[208:211], v[32:35]
    buffer_load_dwordx4 v237, s[16:19], s93 offen offset:1024 lds
    v_mfma_f32_16x16x32_bf16 v[36:39], v[176:179], a[196:199], v[36:39]
    ds_read_b64_tr_b16 v[172:173], v214 offset:10240
    ds_read_b64_tr_b16 v[174:175], v214 offset:10752
    v_mfma_f32_16x16x32_bf16 v[36:39], v[180:183], a[212:215], v[36:39]
    s_add_u32 m0, s40, 32768
    s_add_u32 s70, s44, 590208
    v_mul_f32 v225, v107, v107
    v_mfma_f32_16x16x32_bf16 v[40:43], v[176:179], a[200:203], v[40:43]
    v_fmaak_f32 v225, v225, v208, 0xc0135761
    v_mul_f32 v225, v225, v107
    v_mfma_f32_16x16x32_bf16 v[40:43], v[180:183], a[216:219], v[40:43]
    v_exp_f32 v225, v225
    v_mul_f32 v229, v107, v123
    v_mfma_f32_16x16x32_bf16 v[44:47], v[176:179], a[204:207], v[44:47]
    buffer_load_dwordx4 v210, s[8:11], s70 offen lds
    v_mfma_f32_16x16x32_bf16 v[44:47], v[180:183], a[220:223], v[44:47]
    s_waitcnt lgkmcnt(10)
    ds_read_b64_tr_b16 v[176:177], v217 offset:0
    ds_read_b64_tr_b16 v[178:179], v217 offset:512
    v_mfma_f32_16x16x32_bf16 v[48:51], v[184:187], a[192:195], v[48:51]
    s_waitcnt lgkmcnt(10)
    ds_read_b64_tr_b16 v[180:181], v217 offset:8192
    ds_read_b64_tr_b16 v[182:183], v217 offset:8704
    v_mfma_f32_16x16x32_bf16 v[48:51], v[188:191], a[208:211], v[48:51]
    v_add_f32 v225, 1.0, v225
    v_cvt_pk_bf16_f32 v202, v226, v227
    v_mfma_f32_16x16x32_bf16 v[52:55], v[184:187], a[196:199], v[52:55]
    v_rcp_f32 v225, v225
    v_mfma_f32_16x16x32_bf16 v[52:55], v[188:191], a[212:215], v[52:55]
    buffer_load_dwordx4 v211, s[8:11], s70 offen offset:1024 lds
    v_mul_f32 v229, v229, v225
    v_mfma_f32_16x16x32_bf16 v[56:59], v[184:187], a[200:203], v[56:59]
    s_add_u32 m0, s40, 34816
    v_cvt_pk_bf16_f32 v203, v228, v229
    v_mul_f32 v192, v76, v76
    v_mfma_f32_16x16x32_bf16 v[56:59], v[188:191], a[216:219], v[56:59]
    v_fmaak_f32 v192, v192, v208, 0xc0135761
    v_mul_f32 v192, v192, v76
    v_mfma_f32_16x16x32_bf16 v[60:63], v[184:187], a[204:207], v[60:63]
    v_exp_f32 v192, v192
    v_mfma_f32_16x16x32_bf16 v[60:63], v[188:191], a[220:223], v[60:63]
    s_waitcnt lgkmcnt(10)
    ds_read_b64_tr_b16 v[184:185], v217 offset:2048
    ds_read_b64_tr_b16 v[186:187], v217 offset:2560
    v_mfma_f32_16x16x32_bf16 v[0:3], v[160:163], a[224:227], v[0:3]
    s_waitcnt lgkmcnt(10)
    buffer_load_dwordx4 v210, s[12:15], s70 offen lds
    v_mfma_f32_16x16x32_bf16 v[0:3], v[164:167], a[240:243], v[0:3]
    ds_read_b64_tr_b16 v[188:189], v217 offset:10240
    ds_read_b64_tr_b16 v[190:191], v217 offset:10752
    v_mul_f32 v196, v76, v92
    v_mfma_f32_16x16x32_bf16 v[4:7], v[160:163], a[228:231], v[4:7]
    v_add_f32 v192, 1.0, v192
    v_mul_f32 v193, v77, v77
    v_mfma_f32_16x16x32_bf16 v[4:7], v[164:167], a[244:247], v[4:7]
    v_rcp_f32 v192, v192
    v_mfma_f32_16x16x32_bf16 v[8:11], v[160:163], a[232:235], v[8:11]
    v_mul_f32 v196, v196, v192
    v_fmaak_f32 v193, v193, v208, 0xc0135761
    v_mfma_f32_16x16x32_bf16 v[8:11], v[164:167], a[248:251], v[8:11]
    buffer_load_dwordx4 v211, s[12:15], s70 offen offset:1024 lds
    v_mfma_f32_16x16x32_bf16 v[12:15], v[160:163], a[236:239], v[12:15]
    s_add_u32 m0, s42, 86016
    v_mul_f32 v193, v193, v77
    v_exp_f32 v193, v193
    v_mfma_f32_16x16x32_bf16 v[12:15], v[164:167], a[252:255], v[12:15]
    s_waitcnt lgkmcnt(10)
    v_mul_f32 v197, v77, v93
    v_add_f32 v193, 1.0, v193
    v_mfma_f32_16x16x32_bf16 v[16:19], v[168:171], a[224:227], v[16:19]
    s_waitcnt lgkmcnt(8)
    v_rcp_f32 v193, v193
    v_mfma_f32_16x16x32_bf16 v[16:19], v[172:175], a[240:243], v[16:19]
    v_mul_f32 v197, v197, v193
    v_mul_f32 v194, v78, v78
    v_mfma_f32_16x16x32_bf16 v[20:23], v[168:171], a[228:231], v[20:23]
    s_waitcnt vmcnt(14)
    buffer_store_dwordx4 v[200:203], v209, s[20:23], s97 offen sc1
    v_mfma_f32_16x16x32_bf16 v[20:23], v[172:175], a[244:247], v[20:23]
    s_barrier
    v_fmaak_f32 v194, v194, v208, 0xc0135761
    v_mul_f32 v194, v194, v78
    v_mfma_f32_16x16x32_bf16 v[24:27], v[168:171], a[232:235], v[24:27]
    ds_read_b64_tr_b16 v[160:161], v213 offset:0
    ds_read_b64_tr_b16 v[162:163], v213 offset:512
    v_mfma_f32_16x16x32_bf16 v[24:27], v[172:175], a[248:251], v[24:27]
    buffer_load_dwordx4 v238, s[16:19], s93 offen offset:2048 lds
    v_mfma_f32_16x16x32_bf16 v[28:31], v[168:171], a[236:239], v[28:31]
    s_add_u32 m0, s42, 86016
    ds_read_b64_tr_b16 v[164:165], v213 offset:8192
    ds_read_b64_tr_b16 v[166:167], v213 offset:8704
    v_mfma_f32_16x16x32_bf16 v[28:31], v[172:175], a[252:255], v[28:31]
    s_waitcnt lgkmcnt(10)
    ds_read_b64_tr_b16 v[168:169], v213 offset:2048
    ds_read_b64_tr_b16 v[170:171], v213 offset:2560
    v_mul_f32 v198, v78, v94
    v_mfma_f32_16x16x32_bf16 v[32:35], v[176:179], a[224:227], v[32:35]
    s_waitcnt lgkmcnt(10)
    ds_read_b64_tr_b16 v[172:173], v213 offset:10240
    ds_read_b64_tr_b16 v[174:175], v213 offset:10752
    v_mfma_f32_16x16x32_bf16 v[32:35], v[180:183], a[240:243], v[32:35]
    buffer_load_dwordx4 v239, s[16:19], s93 offen offset:3072 lds
    v_mfma_f32_16x16x32_bf16 v[36:39], v[176:179], a[228:231], v[36:39]
    s_add_u32 m0, s40, 49152
    s_add_u32 s71, s44, 1180032
    v_mul_f32 v195, v79, v79
    v_mfma_f32_16x16x32_bf16 v[36:39], v[180:183], a[244:247], v[36:39]
    v_exp_f32 v194, v194
    v_mfma_f32_16x16x32_bf16 v[40:43], v[176:179], a[232:235], v[40:43]
    v_add_f32 v194, 1.0, v194
    v_rcp_f32 v194, v194
    v_mfma_f32_16x16x32_bf16 v[40:43], v[180:183], a[248:251], v[40:43]
    v_mul_f32 v198, v198, v194
    v_fmaak_f32 v195, v195, v208, 0xc0135761
    v_mfma_f32_16x16x32_bf16 v[44:47], v[176:179], a[236:239], v[44:47]
    buffer_load_dwordx4 v210, s[8:11], s71 offen lds
    v_mfma_f32_16x16x32_bf16 v[44:47], v[180:183], a[252:255], v[44:47]
    s_waitcnt lgkmcnt(10)
    ds_read_b64_tr_b16 v[176:177], v216 offset:0
    ds_read_b64_tr_b16 v[178:179], v216 offset:512
    v_mfma_f32_16x16x32_bf16 v[48:51], v[184:187], a[224:227], v[48:51]
    s_waitcnt lgkmcnt(10)
    ds_read_b64_tr_b16 v[180:181], v216 offset:8192
    ds_read_b64_tr_b16 v[182:183], v216 offset:8704
    v_mfma_f32_16x16x32_bf16 v[48:51], v[188:191], a[240:243], v[48:51]
    v_mul_f32 v195, v195, v79
    v_exp_f32 v195, v195
    v_mfma_f32_16x16x32_bf16 v[52:55], v[184:187], a[228:231], v[52:55]
    v_mul_f32 v199, v79, v95
    v_add_f32 v195, 1.0, v195
    v_mfma_f32_16x16x32_bf16 v[52:55], v[188:191], a[244:247], v[52:55]
    buffer_load_dwordx4 v211, s[8:11], s71 offen offset:1024 lds
    v_mfma_f32_16x16x32_bf16 v[56:59], v[184:187], a[232:235], v[56:59]
    s_add_u32 m0, s40, 51200
    v_rcp_f32 v195, v195
    v_mfma_f32_16x16x32_bf16 v[56:59], v[188:191], a[248:251], v[56:59]
    v_mul_f32 v199, v199, v195
    v_cvt_pk_bf16_f32 v204, v196, v197
    v_cvt_pk_bf16_f32 v205, v198, v199
    v_mfma_f32_16x16x32_bf16 v[60:63], v[184:187], a[236:239], v[60:63]
    v_mul_f32 v222, v108, v108
    v_fmaak_f32 v222, v222, v208, 0xc0135761
    v_mfma_f32_16x16x32_bf16 v[60:63], v[188:191], a[252:255], v[60:63]
    s_waitcnt lgkmcnt(10)
    ds_read_b64_tr_b16 v[184:185], v216 offset:2048
    ds_read_b64_tr_b16 v[186:187], v216 offset:2560
    v_mfma_f32_16x16x32_bf16 v[0:3], v[160:163], v[128:131], v[0:3]
    s_waitcnt lgkmcnt(10)
    buffer_load_dwordx4 v210, s[12:15], s71 offen lds
    v_mfma_f32_16x16x32_bf16 v[0:3], v[164:167], v[144:147], v[0:3]
    ds_read_b64_tr_b16 v[188:189], v216 offset:10240
    ds_read_b64_tr_b16 v[190:191], v216 offset:10752
    v_mfma_f32_16x16x32_bf16 v[4:7], v[160:163], v[132:135], v[4:7]
    v_mul_f32 v222, v222, v108
    v_exp_f32 v222, v222
    v_mfma_f32_16x16x32_bf16 v[4:7], v[164:167], v[148:151], v[4:7]
    v_mul_f32 v226, v108, v124
    v_add_f32 v222, 1.0, v222
    v_mfma_f32_16x16x32_bf16 v[8:11], v[160:163], v[136:139], v[8:11]
    v_rcp_f32 v222, v222
    v_mfma_f32_16x16x32_bf16 v[8:11], v[164:167], v[152:155], v[8:11]
    buffer_load_dwordx4 v211, s[12:15], s71 offen offset:1024 lds
    v_mfma_f32_16x16x32_bf16 v[12:15], v[160:163], v[140:143], v[12:15]
    s_add_u32 m0, s42, 90112
    v_mul_f32 v226, v226, v222
    v_mul_f32 v223, v109, v109
    v_fmaak_f32 v223, v223, v208, 0xc0135761
    v_mfma_f32_16x16x32_bf16 v[12:15], v[164:167], v[156:159], v[12:15]
    s_waitcnt lgkmcnt(10)
    v_mul_f32 v223, v223, v109
    v_mul_f32 v227, v109, v125
    v_mfma_f32_16x16x32_bf16 v[16:19], v[168:171], v[128:131], v[16:19]
    s_waitcnt lgkmcnt(8)
    v_exp_f32 v223, v223
    v_mfma_f32_16x16x32_bf16 v[16:19], v[172:175], v[144:147], v[16:19]
    v_add_f32 v223, 1.0, v223
    v_mul_f32 v224, v110, v110
    v_mfma_f32_16x16x32_bf16 v[20:23], v[168:171], v[132:135], v[20:23]
    s_waitcnt vmcnt(13)
    v_rcp_f32 v223, v223
    v_mfma_f32_16x16x32_bf16 v[20:23], v[172:175], v[148:151], v[20:23]
    s_barrier
    v_mul_f32 v227, v227, v223
    v_fmaak_f32 v224, v224, v208, 0xc0135761
    v_mfma_f32_16x16x32_bf16 v[24:27], v[168:171], v[136:139], v[24:27]
    buffer_load_dwordx4 v240, s[16:19], s93 offen lds
    v_mfma_f32_16x16x32_bf16 v[24:27], v[172:175], v[152:155], v[24:27]
    ds_read_b64_tr_b16 v[160:161], v213 offset:16384
    ds_read_b64_tr_b16 v[162:163], v213 offset:16896
    v_mfma_f32_16x16x32_bf16 v[28:31], v[168:171], v[140:143], v[28:31]
    ds_read_b64_tr_b16 v[164:165], v213 offset:24576
    ds_read_b64_tr_b16 v[166:167], v213 offset:25088
    v_mfma_f32_16x16x32_bf16 v[28:31], v[172:175], v[156:159], v[28:31]
    s_waitcnt lgkmcnt(10)
    ds_read_b64_tr_b16 v[168:169], v213 offset:18432
    ds_read_b64_tr_b16 v[170:171], v213 offset:18944
    v_mul_f32 v224, v224, v110
    v_mfma_f32_16x16x32_bf16 v[32:35], v[176:179], v[128:131], v[32:35]
    s_waitcnt lgkmcnt(10)
    ds_read_b64_tr_b16 v[172:173], v213 offset:26624
    ds_read_b64_tr_b16 v[174:175], v213 offset:27136
    v_mfma_f32_16x16x32_bf16 v[32:35], v[180:183], v[144:147], v[32:35]
    s_add_u32 m0, s40, 65536
    s_add_u32 s70, s44, 1769856
    v_mul_f32 v228, v110, v126
    v_mfma_f32_16x16x32_bf16 v[36:39], v[176:179], v[132:135], v[36:39]
    buffer_load_dwordx4 v210, s[8:11], s70 offen lds
    v_mul_f32 v225, v111, v111
    v_mfma_f32_16x16x32_bf16 v[36:39], v[180:183], v[148:151], v[36:39]
    v_exp_f32 v224, v224
    v_mfma_f32_16x16x32_bf16 v[40:43], v[176:179], v[136:139], v[40:43]
    v_add_f32 v224, 1.0, v224
    v_rcp_f32 v224, v224
    v_mfma_f32_16x16x32_bf16 v[40:43], v[180:183], v[152:155], v[40:43]
    v_mul_f32 v228, v228, v224
    v_fmaak_f32 v225, v225, v208, 0xc0135761
    v_mfma_f32_16x16x32_bf16 v[44:47], v[176:179], v[140:143], v[44:47]
    v_mul_f32 v225, v225, v111
    v_mul_f32 v229, v111, v127
    v_mfma_f32_16x16x32_bf16 v[44:47], v[180:183], v[156:159], v[44:47]
    s_waitcnt lgkmcnt(10)
    buffer_load_dword v244, v243, s[28:31], 0 offen sc1
    v_mfma_f32_16x16x32_bf16 v[48:51], v[184:187], v[128:131], v[48:51]
    s_waitcnt lgkmcnt(8)
    ds_read_b64_tr_b16 v[176:177], v216 offset:16384
    ds_read_b64_tr_b16 v[178:179], v216 offset:16896
    v_mfma_f32_16x16x32_bf16 v[48:51], v[188:191], v[144:147], v[48:51]
    ds_read_b64_tr_b16 v[180:181], v216 offset:24576
    ds_read_b64_tr_b16 v[182:183], v216 offset:25088
    v_cvt_pk_bf16_f32 v206, v226, v227
    v_mfma_f32_16x16x32_bf16 v[52:55], v[184:187], v[132:135], v[52:55]
    v_exp_f32 v225, v225
    v_mfma_f32_16x16x32_bf16 v[52:55], v[188:191], v[148:151], v[52:55]
    v_add_f32 v225, 1.0, v225
    v_mfma_f32_16x16x32_bf16 v[56:59], v[184:187], v[136:139], v[56:59]
    buffer_load_dwordx4 v211, s[8:11], s70 offen offset:1024 lds
    v_mfma_f32_16x16x32_bf16 v[56:59], v[188:191], v[152:155], v[56:59]
    s_add_u32 m0, s40, 67584
    v_rcp_f32 v225, v225
    v_mfma_f32_16x16x32_bf16 v[60:63], v[184:187], v[140:143], v[60:63]
    v_mul_f32 v229, v229, v225
    v_cvt_pk_bf16_f32 v207, v228, v229
    v_mfma_f32_16x16x32_bf16 v[60:63], v[188:191], v[156:159], v[60:63]
    s_waitcnt lgkmcnt(10)
    buffer_store_dwordx4 v[204:207], v209, s[20:23], s98 offen sc1
    ds_read_b64_tr_b16 v[184:185], v216 offset:18432
    ds_read_b64_tr_b16 v[186:187], v216 offset:18944
    v_mfma_f32_16x16x32_bf16 v[64:67], v[160:163], a[0:3], 0
    s_waitcnt lgkmcnt(10)
    ds_read_b64_tr_b16 v[188:189], v216 offset:26624
    ds_read_b64_tr_b16 v[190:191], v216 offset:27136
    v_mfma_f32_16x16x32_bf16 v[64:67], v[164:167], a[16:19], v[64:67]
    v_mfma_f32_16x16x32_bf16 v[68:71], v[160:163], a[4:7], 0
    v_mfma_f32_16x16x32_bf16 v[68:71], v[164:167], a[20:23], v[68:71]
    s_add_u32 s97, s46, 4096
    v_mul_f32 v192, v0, v0
    v_fmaak_f32 v192, v192, v208, 0xc0135761
    v_mfma_f32_16x16x32_bf16 v[72:75], v[160:163], a[8:11], 0
    buffer_load_dwordx4 v210, s[12:15], s70 offen lds
    v_mfma_f32_16x16x32_bf16 v[72:75], v[164:167], a[24:27], v[72:75]
    v_mul_f32 v192, v192, v0
    v_mul_f32 v196, v0, v16
    v_mfma_f32_16x16x32_bf16 v[76:79], v[160:163], a[12:15], 0
    v_exp_f32 v192, v192
    v_mfma_f32_16x16x32_bf16 v[76:79], v[164:167], a[28:31], v[76:79]
    s_waitcnt lgkmcnt(10)
    v_add_f32 v192, 1.0, v192
    v_mul_f32 v193, v1, v1
    v_mfma_f32_16x16x32_bf16 v[80:83], v[168:171], a[0:3], 0
    s_waitcnt lgkmcnt(8)
    v_rcp_f32 v192, v192
    v_mfma_f32_16x16x32_bf16 v[80:83], v[172:175], a[16:19], v[80:83]
    buffer_load_dwordx4 v211, s[12:15], s70 offen offset:1024 lds
    v_mfma_f32_16x16x32_bf16 v[84:87], v[168:171], a[4:7], 0
    s_waitcnt vmcnt(14)
    v_mul_f32 v196, v196, v192
    v_fmaak_f32 v193, v193, v208, 0xc0135761
    v_mfma_f32_16x16x32_bf16 v[84:87], v[172:175], a[20:23], v[84:87]
    s_barrier
    v_mul_f32 v193, v193, v1
    v_mul_f32 v197, v1, v17
    v_mfma_f32_16x16x32_bf16 v[88:91], v[168:171], a[8:11], 0
    ds_read_b64_tr_b16 v[160:161], v213 offset:32768
    ds_read_b64_tr_b16 v[162:163], v213 offset:33280
    v_mfma_f32_16x16x32_bf16 v[88:91], v[172:175], a[24:27], v[88:91]
    ds_read_b64_tr_b16 v[164:165], v213 offset:40960
    ds_read_b64_tr_b16 v[166:167], v213 offset:41472
    v_mfma_f32_16x16x32_bf16 v[92:95], v[168:171], a[12:15], 0
    s_add_u32 m0, s40, 0
    s_add_u32 s71, s44, 2359680
    v_mul_f32 v194, v2, v2
    v_mfma_f32_16x16x32_bf16 v[92:95], v[172:175], a[28:31], v[92:95]
    s_waitcnt lgkmcnt(10)
    buffer_load_dwordx4 v210, s[8:11], s71 offen lds
    v_mfma_f32_16x16x32_bf16 v[96:99], v[176:179], a[0:3], 0
    s_waitcnt lgkmcnt(8)
    ds_read_b64_tr_b16 v[168:169], v213 offset:34816
    ds_read_b64_tr_b16 v[170:171], v213 offset:35328
    v_mfma_f32_16x16x32_bf16 v[96:99], v[180:183], a[16:19], v[96:99]
    ds_read_b64_tr_b16 v[172:173], v213 offset:43008
    ds_read_b64_tr_b16 v[174:175], v213 offset:43520
    v_mfma_f32_16x16x32_bf16 v[100:103], v[176:179], a[4:7], 0
    v_exp_f32 v193, v193
    v_mfma_f32_16x16x32_bf16 v[100:103], v[180:183], a[20:23], v[100:103]
    v_add_f32 v193, 1.0, v193
    v_fmaak_f32 v194, v194, v208, 0xc0135761
    v_mfma_f32_16x16x32_bf16 v[104:107], v[176:179], a[8:11], 0
    buffer_load_dwordx4 v211, s[8:11], s71 offen offset:1024 lds
    v_mfma_f32_16x16x32_bf16 v[104:107], v[180:183], a[24:27], v[104:107]
    s_add_u32 m0, s40, 2048
    v_rcp_f32 v193, v193
    v_mfma_f32_16x16x32_bf16 v[108:111], v[176:179], a[12:15], 0
    s_add_u32 s98, s47, 4096
    v_mul_f32 v197, v197, v193
    v_mul_f32 v194, v194, v2
    v_mfma_f32_16x16x32_bf16 v[108:111], v[180:183], a[28:31], v[108:111]
    s_waitcnt lgkmcnt(10)
    ds_read_b64_tr_b16 v[176:177], v216 offset:32768
    ds_read_b64_tr_b16 v[178:179], v216 offset:33280
    v_mfma_f32_16x16x32_bf16 v[112:115], v[184:187], a[0:3], 0
    s_waitcnt lgkmcnt(10)
    ds_read_b64_tr_b16 v[180:181], v216 offset:40960
    ds_read_b64_tr_b16 v[182:183], v216 offset:41472
    v_mfma_f32_16x16x32_bf16 v[112:115], v[188:191], a[16:19], v[112:115]
    buffer_load_dwordx4 v210, s[12:15], s71 offen lds
    v_mfma_f32_16x16x32_bf16 v[116:119], v[184:187], a[4:7], 0
    v_lshlrev_b32 v254, 3, v247
    v_mul_f32 v198, v2, v18
    v_mfma_f32_16x16x32_bf16 v[116:119], v[188:191], a[20:23], v[116:119]
    v_exp_f32 v194, v194
    v_mfma_f32_16x16x32_bf16 v[120:123], v[184:187], a[8:11], 0
    v_add_f32 v194, 1.0, v194
    v_mul_f32 v195, v3, v3
    v_mfma_f32_16x16x32_bf16 v[120:123], v[188:191], a[24:27], v[120:123]
    v_rcp_f32 v194, v194
    v_mfma_f32_16x16x32_bf16 v[124:127], v[184:187], a[12:15], 0
    buffer_load_dwordx4 v211, s[12:15], s71 offen offset:1024 lds
    v_mfma_f32_16x16x32_bf16 v[124:127], v[188:191], a[28:31], v[124:127]
    s_waitcnt lgkmcnt(10)
    ds_read_b64_tr_b16 v[184:185], v216 offset:34816
    ds_read_b64_tr_b16 v[186:187], v216 offset:35328
    v_mfma_f32_16x16x32_bf16 v[64:67], v[160:163], a[32:35], v[64:67]
    s_waitcnt lgkmcnt(10)
    ds_read_b64_tr_b16 v[188:189], v216 offset:43008
    ds_read_b64_tr_b16 v[190:191], v216 offset:43520
    v_mfma_f32_16x16x32_bf16 v[64:67], v[164:167], a[48:51], v[64:67]
    v_mul_f32 v198, v198, v194
    v_fmaak_f32 v195, v195, v208, 0xc0135761
    v_mfma_f32_16x16x32_bf16 v[68:71], v[160:163], a[36:39], v[68:71]
    v_mul_f32 v195, v195, v3
    v_mul_f32 v199, v3, v19
    v_mfma_f32_16x16x32_bf16 v[68:71], v[164:167], a[52:55], v[68:71]
    buffer_store_dwordx4 v[248:251], v209, s[24:27], s61 offen sc1
    v_mfma_f32_16x16x32_bf16 v[72:75], v[160:163], a[40:43], v[72:75]
    v_exp_f32 v195, v195
    v_mfma_f32_16x16x32_bf16 v[72:75], v[164:167], a[56:59], v[72:75]
    v_add_f32 v195, 1.0, v195
    v_cvt_pk_bf16_f32 v200, v196, v197
    v_mfma_f32_16x16x32_bf16 v[76:79], v[160:163], a[44:47], v[76:79]
    v_rcp_f32 v195, v195
    v_mfma_f32_16x16x32_bf16 v[76:79], v[164:167], a[60:63], v[76:79]
    s_waitcnt lgkmcnt(10)
    v_mul_f32 v199, v199, v195
    v_cvt_pk_bf16_f32 v201, v198, v199
    v_mfma_f32_16x16x32_bf16 v[80:83], v[168:171], a[32:35], v[80:83]
    s_waitcnt lgkmcnt(8)
    v_mul_f32 v222, v32, v32
    v_fmaak_f32 v222, v222, v208, 0xc0135761
    v_mfma_f32_16x16x32_bf16 v[80:83], v[172:175], a[48:51], v[80:83]
    v_mul_f32 v222, v222, v32
    v_mul_f32 v226, v32, v48
    v_mfma_f32_16x16x32_bf16 v[84:87], v[168:171], a[36:39], v[84:87]
    s_waitcnt vmcnt(7)
    v_exp_f32 v222, v222
    v_mfma_f32_16x16x32_bf16 v[84:87], v[172:175], a[52:55], v[84:87]
    s_barrier
    v_add_f32 v222, 1.0, v222
    v_mul_f32 v223, v33, v33
    v_mfma_f32_16x16x32_bf16 v[88:91], v[168:171], a[40:43], v[88:91]
    ds_read_b64_tr_b16 v[160:161], v213 offset:49152
    ds_read_b64_tr_b16 v[162:163], v213 offset:49664
    v_mfma_f32_16x16x32_bf16 v[88:91], v[172:175], a[56:59], v[88:91]
    ds_read_b64_tr_b16 v[164:165], v213 offset:57344
    ds_read_b64_tr_b16 v[166:167], v213 offset:57856
    v_mfma_f32_16x16x32_bf16 v[92:95], v[168:171], a[44:47], v[92:95]
    s_add_u32 s73, s55, 2
    v_mov_b32 v242, s73
    v_fmaak_f32 v223, v223, v208, 0xc0135761
    v_mfma_f32_16x16x32_bf16 v[92:95], v[172:175], a[60:63], v[92:95]
    s_waitcnt lgkmcnt(10)
    buffer_store_dword v242, v241, s[28:31], 0 offen
    v_mfma_f32_16x16x32_bf16 v[96:99], v[176:179], a[32:35], v[96:99]
    s_waitcnt lgkmcnt(8)
    ds_read_b64_tr_b16 v[168:169], v213 offset:51200
    ds_read_b64_tr_b16 v[170:171], v213 offset:51712
    v_mfma_f32_16x16x32_bf16 v[96:99], v[180:183], a[48:51], v[96:99]
    ds_read_b64_tr_b16 v[172:173], v213 offset:59392
    ds_read_b64_tr_b16 v[174:175], v213 offset:59904
    v_mfma_f32_16x16x32_bf16 v[100:103], v[176:179], a[36:39], v[100:103]
    s_add_u32 m0, s40, 16384
    s_add_u32 s70, s44, 2949504
    v_mul_f32 v223, v223, v33
    v_mfma_f32_16x16x32_bf16 v[100:103], v[180:183], a[52:55], v[100:103]
    v_rcp_f32 v222, v222
    v_mfma_f32_16x16x32_bf16 v[104:107], v[176:179], a[40:43], v[104:107]
    buffer_load_dwordx4 v210, s[8:11], s70 offen lds
    v_mfma_f32_16x16x32_bf16 v[104:107], v[180:183], a[56:59], v[104:107]
    v_exp_f32 v223, v223
    v_mfma_f32_16x16x32_bf16 v[108:111], v[176:179], a[44:47], v[108:111]
    v_mul_f32 v226, v226, v222
    v_mul_f32 v227, v33, v49
    v_mfma_f32_16x16x32_bf16 v[108:111], v[180:183], a[60:63], v[108:111]
    s_waitcnt lgkmcnt(10)
    ds_read_b64_tr_b16 v[176:177], v216 offset:49152
    ds_read_b64_tr_b16 v[178:179], v216 offset:49664
    v_mfma_f32_16x16x32_bf16 v[112:115], v[184:187], a[32:35], v[112:115]
    s_add_u32 s69, s55, 1
    v_subrev_u32 v245, s69, v244
    v_cmp_le_u32 vcc, 8, v245
    s_nop 1
    s_cbranch_vccnz L_spin0
L_back0:
    s_waitcnt lgkmcnt(10)
    v_mfma_f32_16x16x32_bf16 v[112:115], v[188:191], a[48:51], v[112:115]
    buffer_load_dwordx4 v211, s[8:11], s70 offen offset:1024 lds
    v_mfma_f32_16x16x32_bf16 v[116:119], v[184:187], a[36:39], v[116:119]
    s_add_u32 m0, s40, 18432
    ds_read_b64_tr_b16 v[180:181], v216 offset:57344
    ds_read_b64_tr_b16 v[182:183], v216 offset:57856
    v_mfma_f32_16x16x32_bf16 v[116:119], v[188:191], a[52:55], v[116:119]
    v_add_f32 v223, 1.0, v223
    v_mul_f32 v224, v34, v34
    v_mfma_f32_16x16x32_bf16 v[120:123], v[184:187], a[40:43], v[120:123]
    s_add_u32 s99, s54, 8192
    v_rcp_f32 v223, v223
    v_mfma_f32_16x16x32_bf16 v[120:123], v[188:191], a[56:59], v[120:123]
    v_mul_f32 v227, v227, v223
    v_fmaak_f32 v224, v224, v208, 0xc0135761
    v_mfma_f32_16x16x32_bf16 v[124:127], v[184:187], a[44:47], v[124:127]
    buffer_load_dwordx4 v210, s[12:15], s70 offen lds
    v_mfma_f32_16x16x32_bf16 v[124:127], v[188:191], a[60:63], v[124:127]
    s_waitcnt lgkmcnt(10)
    ds_read_b64_tr_b16 v[184:185], v216 offset:51200
    ds_read_b64_tr_b16 v[186:187], v216 offset:51712
    v_mfma_f32_16x16x32_bf16 v[64:67], v[160:163], a[64:67], v[64:67]
    s_waitcnt lgkmcnt(10)
    ds_read_b64_tr_b16 v[188:189], v216 offset:59392
    ds_read_b64_tr_b16 v[190:191], v216 offset:59904
    v_mfma_f32_16x16x32_bf16 v[64:67], v[164:167], a[80:83], v[64:67]
    v_mul_f32 v224, v224, v34
    v_mul_f32 v228, v34, v50
    v_mfma_f32_16x16x32_bf16 v[68:71], v[160:163], a[68:71], v[68:71]
    v_exp_f32 v224, v224
    v_mfma_f32_16x16x32_bf16 v[68:71], v[164:167], a[84:87], v[68:71]
    buffer_store_dwordx4 v[248:251], v209, s[24:27], s61 offen offset:1024 sc1
    v_mfma_f32_16x16x32_bf16 v[72:75], v[160:163], a[72:75], v[72:75]
    v_add_f32 v224, 1.0, v224
    v_mul_f32 v225, v35, v35
    v_mfma_f32_16x16x32_bf16 v[72:75], v[164:167], a[88:91], v[72:75]
    v_rcp_f32 v224, v224
    v_mfma_f32_16x16x32_bf16 v[76:79], v[160:163], a[76:79], v[76:79]
    v_mul_f32 v228, v228, v224
    v_fmaak_f32 v225, v225, v208, 0xc0135761
    v_mfma_f32_16x16x32_bf16 v[76:79], v[164:167], a[92:95], v[76:79]
    s_waitcnt lgkmcnt(10)
    v_mul_f32 v225, v225, v35
    v_mul_f32 v229, v35, v51
    v_mfma_f32_16x16x32_bf16 v[80:83], v[168:171], a[64:67], v[80:83]
    s_waitcnt lgkmcnt(8)
    buffer_load_dwordx4 v211, s[12:15], s70 offen offset:1024 lds
    v_mfma_f32_16x16x32_bf16 v[80:83], v[172:175], a[80:83], v[80:83]
    v_exp_f32 v225, v225
    v_mfma_f32_16x16x32_bf16 v[84:87], v[168:171], a[68:71], v[84:87]
    s_waitcnt vmcnt(11)
    v_add_f32 v225, 1.0, v225
    v_cvt_pk_bf16_f32 v202, v226, v227
    v_mfma_f32_16x16x32_bf16 v[84:87], v[172:175], a[84:87], v[84:87]
    s_barrier
    v_rcp_f32 v225, v225
    v_mfma_f32_16x16x32_bf16 v[88:91], v[168:171], a[72:75], v[88:91]
    ds_read_b64_tr_b16 v[160:161], v214 offset:0
    ds_read_b64_tr_b16 v[162:163], v214 offset:512
    v_mfma_f32_16x16x32_bf16 v[88:91], v[172:175], a[88:91], v[88:91]
    buffer_load_dwordx4 a[0:3], v209, s[20:23], s99 offen sc1
    v_mfma_f32_16x16x32_bf16 v[92:95], v[168:171], a[76:79], v[92:95]
    s_add_u32 s100, s54, 155648
    ds_read_b64_tr_b16 v[164:165], v214 offset:8192
    ds_read_b64_tr_b16 v[166:167], v214 offset:8704
    v_mfma_f32_16x16x32_bf16 v[92:95], v[172:175], a[92:95], v[92:95]
    s_waitcnt lgkmcnt(10)
    ds_read_b64_tr_b16 v[168:169], v214 offset:2048
    ds_read_b64_tr_b16 v[170:171], v214 offset:2560
    v_mfma_f32_16x16x32_bf16 v[96:99], v[176:179], a[64:67], v[96:99]
    s_waitcnt lgkmcnt(10)
    ds_read_b64_tr_b16 v[172:173], v214 offset:10240
    ds_read_b64_tr_b16 v[174:175], v214 offset:10752
    v_mfma_f32_16x16x32_bf16 v[96:99], v[180:183], a[80:83], v[96:99]
    s_add_u32 m0, s40, 32768
    s_add_u32 s71, s44, 3539328
    v_mul_f32 v229, v229, v225
    v_mfma_f32_16x16x32_bf16 v[100:103], v[176:179], a[68:71], v[100:103]
    buffer_load_dwordx4 v210, s[8:11], s71 offen lds
    v_mfma_f32_16x16x32_bf16 v[100:103], v[180:183], a[84:87], v[100:103]
    v_cvt_pk_bf16_f32 v203, v228, v229
    v_mul_f32 v192, v4, v4
    v_mfma_f32_16x16x32_bf16 v[104:107], v[176:179], a[72:75], v[104:107]
    v_fmaak_f32 v192, v192, v208, 0xc0135761
    v_mul_f32 v192, v192, v4
    v_mfma_f32_16x16x32_bf16 v[104:107], v[180:183], a[88:91], v[104:107]
    v_exp_f32 v192, v192
    v_mfma_f32_16x16x32_bf16 v[108:111], v[176:179], a[76:79], v[108:111]
    v_mul_f32 v196, v4, v20
    v_add_f32 v192, 1.0, v192
    v_mfma_f32_16x16x32_bf16 v[108:111], v[180:183], a[92:95], v[108:111]
    s_waitcnt lgkmcnt(10)
    buffer_load_dwordx4 v211, s[8:11], s71 offen offset:1024 lds
    v_mfma_f32_16x16x32_bf16 v[112:115], v[184:187], a[64:67], v[112:115]
    s_add_u32 m0, s40, 34816
    ds_read_b64_tr_b16 v[176:177], v217 offset:0
    ds_read_b64_tr_b16 v[178:179], v217 offset:512
    s_waitcnt lgkmcnt(10)
    v_mfma_f32_16x16x32_bf16 v[112:115], v[188:191], a[80:83], v[112:115]
    ds_read_b64_tr_b16 v[180:181], v217 offset:8192
    ds_read_b64_tr_b16 v[182:183], v217 offset:8704
    v_mfma_f32_16x16x32_bf16 v[116:119], v[184:187], a[68:71], v[116:119]
    v_rcp_f32 v192, v192
    v_mfma_f32_16x16x32_bf16 v[116:119], v[188:191], a[84:87], v[116:119]
    v_mul_f32 v196, v196, v192
    v_mul_f32 v193, v5, v5
    v_mfma_f32_16x16x32_bf16 v[120:123], v[184:187], a[72:75], v[120:123]
    buffer_load_dwordx4 v210, s[12:15], s71 offen lds
    v_mfma_f32_16x16x32_bf16 v[120:123], v[188:191], a[88:91], v[120:123]
    v_fmaak_f32 v193, v193, v208, 0xc0135761
    v_mul_f32 v193, v193, v5
    v_mfma_f32_16x16x32_bf16 v[124:127], v[184:187], a[76:79], v[124:127]
    v_exp_f32 v193, v193
    v_mfma_f32_16x16x32_bf16 v[124:127], v[188:191], a[92:95], v[124:127]
    s_waitcnt lgkmcnt(10)
    ds_read_b64_tr_b16 v[184:185], v217 offset:2048
    ds_read_b64_tr_b16 v[186:187], v217 offset:2560
    v_mfma_f32_16x16x32_bf16 v[64:67], v[160:163], a[96:99], v[64:67]
    s_waitcnt lgkmcnt(10)
    ds_read_b64_tr_b16 v[188:189], v217 offset:10240
    ds_read_b64_tr_b16 v[190:191], v217 offset:10752
    v_mfma_f32_16x16x32_bf16 v[64:67], v[164:167], a[112:115], v[64:67]
    buffer_load_dwordx4 v211, s[12:15], s71 offen offset:1024 lds
    v_mfma_f32_16x16x32_bf16 v[68:71], v[160:163], a[100:103], v[68:71]
    v_mul_f32 v197, v5, v21
    v_add_f32 v193, 1.0, v193
    v_mfma_f32_16x16x32_bf16 v[68:71], v[164:167], a[116:119], v[68:71]
    v_rcp_f32 v193, v193
    v_mfma_f32_16x16x32_bf16 v[72:75], v[160:163], a[104:107], v[72:75]
    v_mul_f32 v197, v197, v193
    v_mul_f32 v194, v6, v6
    v_mfma_f32_16x16x32_bf16 v[72:75], v[164:167], a[120:123], v[72:75]
    v_fmaak_f32 v194, v194, v208, 0xc0135761
    v_mul_f32 v194, v194, v6
    v_mfma_f32_16x16x32_bf16 v[76:79], v[160:163], a[108:111], v[76:79]
    buffer_store_dwordx2 v[248:249], v254, s[24:27], s61 offen offset:2048 sc1
    v_mfma_f32_16x16x32_bf16 v[76:79], v[164:167], a[124:127], v[76:79]
    s_waitcnt lgkmcnt(10)
    v_exp_f32 v194, v194
    v_mfma_f32_16x16x32_bf16 v[80:83], v[168:171], a[96:99], v[80:83]
    s_waitcnt lgkmcnt(8)
    v_mul_f32 v198, v6, v22
    v_add_f32 v194, 1.0, v194
    v_mfma_f32_16x16x32_bf16 v[80:83], v[172:175], a[112:115], v[80:83]
    v_rcp_f32 v194, v194
    v_mfma_f32_16x16x32_bf16 v[84:87], v[168:171], a[100:103], v[84:87]
    s_waitcnt vmcnt(13)
    v_mul_f32 v198, v198, v194
    v_mul_f32 v195, v7, v7
    v_mfma_f32_16x16x32_bf16 v[84:87], v[172:175], a[116:119], v[84:87]
    s_barrier
    buffer_store_dwordx4 v[200:203], v209, s[20:23], s97 offen sc1
    v_mfma_f32_16x16x32_bf16 v[88:91], v[168:171], a[104:107], v[88:91]
    s_add_u32 s97, s48, 4096
    ds_read_b64_tr_b16 v[160:161], v213 offset:0
    ds_read_b64_tr_b16 v[162:163], v213 offset:512
    v_mfma_f32_16x16x32_bf16 v[88:91], v[172:175], a[120:123], v[88:91]
    ds_read_b64_tr_b16 v[164:165], v213 offset:8192
    ds_read_b64_tr_b16 v[166:167], v213 offset:8704
    v_mfma_f32_16x16x32_bf16 v[92:95], v[168:171], a[108:111], v[92:95]
    s_add_u32 m0, s40, 49152
    s_add_u32 s70, s44, 4129152
    v_fmaak_f32 v195, v195, v208, 0xc0135761
    v_mfma_f32_16x16x32_bf16 v[92:95], v[172:175], a[124:127], v[92:95]
    s_waitcnt lgkmcnt(10)
    ds_read_b64_tr_b16 v[168:169], v213 offset:2048
    ds_read_b64_tr_b16 v[170:171], v213 offset:2560
    v_mfma_f32_16x16x32_bf16 v[96:99], v[176:179], a[96:99], v[96:99]
    s_waitcnt lgkmcnt(10)
    buffer_load_dwordx4 v210, s[8:11], s70 offen lds
    v_mfma_f32_16x16x32_bf16 v[96:99], v[180:183], a[112:115], v[96:99]
    ds_read_b64_tr_b16 v[172:173], v213 offset:10240
    ds_read_b64_tr_b16 v[174:175], v213 offset:10752
    v_mfma_f32_16x16x32_bf16 v[100:103], v[176:179], a[100:103], v[100:103]
    v_mul_f32 v195, v195, v7
    v_mul_f32 v199, v7, v23
    v_mfma_f32_16x16x32_bf16 v[100:103], v[180:183], a[116:119], v[100:103]
    v_exp_f32 v195, v195
    v_mfma_f32_16x16x32_bf16 v[104:107], v[176:179], a[104:107], v[104:107]
    v_add_f32 v195, 1.0, v195
    v_cvt_pk_bf16_f32 v204, v196, v197
    v_mfma_f32_16x16x32_bf16 v[104:107], v[180:183], a[120:123], v[104:107]
    buffer_load_dwordx4 v211, s[8:11], s70 offen offset:1024 lds
    v_mfma_f32_16x16x32_bf16 v[108:111], v[176:179], a[108:111], v[108:111]
    s_add_u32 m0, s40, 51200
    v_rcp_f32 v195, v195
    v_mfma_f32_16x16x32_bf16 v[108:111], v[180:183], a[124:127], v[108:111]
    s_waitcnt lgkmcnt(10)
    ds_read_b64_tr_b16 v[176:177], v216 offset:0
    ds_read_b64_tr_b16 v[178:179], v216 offset:512
    v_mfma_f32_16x16x32_bf16 v[112:115], v[184:187], a[96:99], v[112:115]
    s_waitcnt lgkmcnt(10)
    ds_read_b64_tr_b16 v[180:181], v216 offset:8192
    ds_read_b64_tr_b16 v[182:183], v216 offset:8704
    v_mfma_f32_16x16x32_bf16 v[112:115], v[188:191], a[112:115], v[112:115]
    v_mul_f32 v199, v199, v195
    v_cvt_pk_bf16_f32 v205, v198, v199
    v_mfma_f32_16x16x32_bf16 v[116:119], v[184:187], a[100:103], v[116:119]
    buffer_load_dwordx4 v210, s[12:15], s70 offen lds
    v_mfma_f32_16x16x32_bf16 v[116:119], v[188:191], a[116:119], v[116:119]
    v_mul_f32 v222, v36, v36
    v_fmaak_f32 v222, v222, v208, 0xc0135761
    v_mfma_f32_16x16x32_bf16 v[120:123], v[184:187], a[104:107], v[120:123]
    v_mul_f32 v222, v222, v36
    v_mul_f32 v226, v36, v52
    v_mfma_f32_16x16x32_bf16 v[120:123], v[188:191], a[120:123], v[120:123]
    v_exp_f32 v222, v222
    v_mfma_f32_16x16x32_bf16 v[124:127], v[184:187], a[108:111], v[124:127]
    v_add_f32 v222, 1.0, v222
    v_mul_f32 v223, v37, v37
    v_mfma_f32_16x16x32_bf16 v[124:127], v[188:191], a[124:127], v[124:127]
    s_waitcnt lgkmcnt(10)
    buffer_load_dwordx4 v211, s[12:15], s70 offen offset:1024 lds
    v_mfma_f32_16x16x32_bf16 v[64:67], v[160:163], a[128:131], v[64:67]
    s_waitcnt lgkmcnt(8)
    ds_read_b64_tr_b16 v[184:185], v216 offset:2048
    ds_read_b64_tr_b16 v[186:187], v216 offset:2560
    v_mfma_f32_16x16x32_bf16 v[64:67], v[164:167], a[144:147], v[64:67]
    ds_read_b64_tr_b16 v[188:189], v216 offset:10240
    ds_read_b64_tr_b16 v[190:191], v216 offset:10752
    v_mfma_f32_16x16x32_bf16 v[68:71], v[160:163], a[132:135], v[68:71]
    v_rcp_f32 v222, v222
    v_mfma_f32_16x16x32_bf16 v[68:71], v[164:167], a[148:151], v[68:71]
    v_mul_f32 v226, v226, v222
    v_fmaak_f32 v223, v223, v208, 0xc0135761
    v_mfma_f32_16x16x32_bf16 v[72:75], v[160:163], a[136:139], v[72:75]
    buffer_load_dword v244, v243, s[28:31], 0 offen sc1
    v_mfma_f32_16x16x32_bf16 v[72:75], v[164:167], a[152:155], v[72:75]
    v_mul_f32 v223, v223, v37
    v_mul_f32 v227, v37, v53
    v_mfma_f32_16x16x32_bf16 v[76:79], v[160:163], a[140:143], v[76:79]
    v_exp_f32 v223, v223
    v_mfma_f32_16x16x32_bf16 v[76:79], v[164:167], a[156:159], v[76:79]
    s_waitcnt lgkmcnt(10)
    v_add_f32 v223, 1.0, v223
    v_mul_f32 v224, v38, v38
    v_mfma_f32_16x16x32_bf16 v[80:83], v[168:171], a[128:131], v[80:83]
    s_waitcnt lgkmcnt(8)
    v_rcp_f32 v223, v223
    v_mfma_f32_16x16x32_bf16 v[80:83], v[172:175], a[144:147], v[80:83]
    buffer_store_dwordx4 v[248:251], v209, s[24:27], s62 offen sc1
    v_mfma_f32_16x16x32_bf16 v[84:87], v[168:171], a[132:135], v[84:87]
    s_waitcnt vmcnt(13)
    v_mul_f32 v227, v227, v223
    v_fmaak_f32 v224, v224, v208, 0xc0135761
    v_mfma_f32_16x16x32_bf16 v[84:87], v[172:175], a[148:151], v[84:87]
    s_barrier
    v_mul_f32 v224, v224, v38
    v_mul_f32 v228, v38, v54
    v_mfma_f32_16x16x32_bf16 v[88:91], v[168:171], a[136:139], v[88:91]
    ds_read_b64_tr_b16 v[160:161], v213 offset:16384
    ds_read_b64_tr_b16 v[162:163], v213 offset:16896
    v_mfma_f32_16x16x32_bf16 v[88:91], v[172:175], a[152:155], v[88:91]
    ds_read_b64_tr_b16 v[164:165], v213 offset:24576
    ds_read_b64_tr_b16 v[166:167], v213 offset:25088
    v_mfma_f32_16x16x32_bf16 v[92:95], v[168:171], a[140:143], v[92:95]
    buffer_load_dwordx4 a[4:7], v209, s[20:23], s100 offen sc1
    v_mfma_f32_16x16x32_bf16 v[92:95], v[172:175], a[156:159], v[92:95]
    s_add_u32 s99, s54, 9216
    ds_read_b64_tr_b16 v[168:169], v213 offset:18432
    ds_read_b64_tr_b16 v[170:171], v213 offset:18944
    s_waitcnt lgkmcnt(12)
    v_mfma_f32_16x16x32_bf16 v[96:99], v[176:179], a[128:131], v[96:99]
    s_waitcnt lgkmcnt(10)
    ds_read_b64_tr_b16 v[172:173], v213 offset:26624
    ds_read_b64_tr_b16 v[174:175], v213 offset:27136
    v_mfma_f32_16x16x32_bf16 v[96:99], v[180:183], a[144:147], v[96:99]
    s_add_u32 m0, s40, 65536
    s_add_u32 s71, s44, 4718976
    v_mul_f32 v225, v39, v39
    v_mfma_f32_16x16x32_bf16 v[100:103], v[176:179], a[132:135], v[100:103]
    v_exp_f32 v224, v224
    v_mfma_f32_16x16x32_bf16 v[100:103], v[180:183], a[148:151], v[100:103]
    buffer_load_dwordx4 v210, s[8:11], s71 offen lds
    v_mfma_f32_16x16x32_bf16 v[104:107], v[176:179], a[136:139], v[104:107]
    v_add_f32 v224, 1.0, v224
    v_fmaak_f32 v225, v225, v208, 0xc0135761
    v_mfma_f32_16x16x32_bf16 v[104:107], v[180:183], a[152:155], v[104:107]
    v_rcp_f32 v224, v224
    v_mfma_f32_16x16x32_bf16 v[108:111], v[176:179], a[140:143], v[108:111]
    v_mul_f32 v228, v228, v224
    v_mul_f32 v225, v225, v39
    v_mfma_f32_16x16x32_bf16 v[108:111], v[180:183], a[156:159], v[108:111]
    s_waitcnt lgkmcnt(10)
    ds_read_b64_tr_b16 v[176:177], v216 offset:16384
    ds_read_b64_tr_b16 v[178:179], v216 offset:16896
    v_mfma_f32_16x16x32_bf16 v[112:115], v[184:187], a[128:131], v[112:115]
    s_waitcnt lgkmcnt(10)
    buffer_load_dwordx4 v211, s[8:11], s71 offen offset:1024 lds
    v_mfma_f32_16x16x32_bf16 v[112:115], v[188:191], a[144:147], v[112:115]
    s_add_u32 m0, s40, 67584
    ds_read_b64_tr_b16 v[180:181], v216 offset:24576
    ds_read_b64_tr_b16 v[182:183], v216 offset:25088
    v_mfma_f32_16x16x32_bf16 v[116:119], v[184:187], a[132:135], v[116:119]
    v_exp_f32 v225, v225
    v_mfma_f32_16x16x32_bf16 v[116:119], v[188:191], a[148:151], v[116:119]
    v_mul_f32 v229, v39, v55
    v_add_f32 v225, 1.0, v225
    v_mfma_f32_16x16x32_bf16 v[120:123], v[184:187], a[136:139], v[120:123]
    v_rcp_f32 v225, v225
    v_mfma_f32_16x16x32_bf16 v[120:123], v[188:191], a[152:155], v[120:123]
    buffer_load_dwordx4 v210, s[12:15], s71 offen lds
    v_mfma_f32_16x16x32_bf16 v[124:127], v[184:187], a[140:143], v[124:127]
    v_mul_f32 v229, v229, v225
    v_cvt_pk_bf16_f32 v206, v226, v227
    v_mfma_f32_16x16x32_bf16 v[124:127], v[188:191], a[156:159], v[124:127]
    s_waitcnt lgkmcnt(10)
    ds_read_b64_tr_b16 v[184:185], v216 offset:18432
    ds_read_b64_tr_b16 v[186:187], v216 offset:18944
    v_mfma_f32_16x16x32_bf16 v[64:67], v[160:163], a[160:163], v[64:67]
    s_waitcnt lgkmcnt(10)
    ds_read_b64_tr_b16 v[188:189], v216 offset:26624
    ds_read_b64_tr_b16 v[190:191], v216 offset:27136
    v_mfma_f32_16x16x32_bf16 v[64:67], v[164:167], a[176:179], v[64:67]
    v_cvt_pk_bf16_f32 v207, v228, v229
    v_mul_f32 v192, v8, v8
    v_mfma_f32_16x16x32_bf16 v[68:71], v[160:163], a[164:167], v[68:71]
    buffer_load_dwordx4 v211, s[12:15], s71 offen offset:1024 lds
    v_mfma_f32_16x16x32_bf16 v[68:71], v[164:167], a[180:183], v[68:71]
    v_fmaak_f32 v192, v192, v208, 0xc0135761
    v_mul_f32 v192, v192, v8
    v_mfma_f32_16x16x32_bf16 v[72:75], v[160:163], a[168:171], v[72:75]
    v_exp_f32 v192, v192
    v_mfma_f32_16x16x32_bf16 v[72:75], v[164:167], a[184:187], v[72:75]
    v_mul_f32 v196, v8, v24
    v_add_f32 v192, 1.0, v192
    v_mfma_f32_16x16x32_bf16 v[76:79], v[160:163], a[172:175], v[76:79]
    v_rcp_f32 v192, v192
    v_mfma_f32_16x16x32_bf16 v[76:79], v[164:167], a[188:191], v[76:79]
    s_waitcnt lgkmcnt(10)
    buffer_store_dwordx4 v[248:251], v209, s[24:27], s62 offen offset:1024 sc1
    v_mfma_f32_16x16x32_bf16 v[80:83], v[168:171], a[160:163], v[80:83]
    s_waitcnt lgkmcnt(8)
    v_mul_f32 v196, v196, v192
    v_mul_f32 v193, v9, v9
    v_mfma_f32_16x16x32_bf16 v[80:83], v[172:175], a[176:179], v[80:83]
    v_fmaak_f32 v193, v193, v208, 0xc0135761
    v_mul_f32 v193, v193, v9
    v_mfma_f32_16x16x32_bf16 v[84:87], v[168:171], a[164:167], v[84:87]
    s_waitcnt vmcnt(14)
    v_exp_f32 v193, v193
    v_mfma_f32_16x16x32_bf16 v[84:87], v[172:175], a[180:183], v[84:87]
    s_barrier
    v_mul_f32 v197, v9, v25
    v_add_f32 v193, 1.0, v193
    v_mfma_f32_16x16x32_bf16 v[88:91], v[168:171], a[168:171], v[88:91]
    buffer_load_dwordx4 a[8:11], v209, s[20:23], s99 offen sc1
    v_mfma_f32_16x16x32_bf16 v[88:91], v[172:175], a[184:187], v[88:91]
    s_add_u32 s100, s54, 156672
    ds_read_b64_tr_b16 v[160:161], v213 offset:32768
    ds_read_b64_tr_b16 v[162:163], v213 offset:33280
    v_mfma_f32_16x16x32_bf16 v[92:95], v[168:171], a[172:175], v[92:95]
    ds_read_b64_tr_b16 v[164:165], v213 offset:40960
    ds_read_b64_tr_b16 v[166:167], v213 offset:41472
    v_mfma_f32_16x16x32_bf16 v[92:95], v[172:175], a[188:191], v[92:95]
    s_waitcnt lgkmcnt(10)
    ds_read_b64_tr_b16 v[168:169], v213 offset:34816
    ds_read_b64_tr_b16 v[170:171], v213 offset:35328
    v_mfma_f32_16x16x32_bf16 v[96:99], v[176:179], a[160:163], v[96:99]
    s_waitcnt lgkmcnt(10)
    ds_read_b64_tr_b16 v[172:173], v213 offset:43008
    ds_read_b64_tr_b16 v[174:175], v213 offset:43520
    v_mfma_f32_16x16x32_bf16 v[96:99], v[180:183], a[176:179], v[96:99]
    buffer_load_dwordx4 a[12:15], v209, s[20:23], s100 offen sc1
    v_mfma_f32_16x16x32_bf16 v[100:103], v[176:179], a[164:167], v[100:103]
    s_add_u32 s99, s54, 26624
    v_rcp_f32 v193, v193
    v_mfma_f32_16x16x32_bf16 v[100:103], v[180:183], a[180:183], v[100:103]
    v_mul_f32 v197, v197, v193
    v_mul_f32 v194, v10, v10
    v_mfma_f32_16x16x32_bf16 v[104:107], v[176:179], a[168:171], v[104:107]
    v_fmaak_f32 v194, v194, v208, 0xc0135761
    v_mul_f32 v194, v194, v10
    v_mfma_f32_16x16x32_bf16 v[104:107], v[180:183], a[184:187], v[104:107]
    v_exp_f32 v194, v194
    v_mfma_f32_16x16x32_bf16 v[108:111], v[176:179], a[172:175], v[108:111]
    buffer_store_dwordx4 v[204:207], v209, s[20:23], s98 offen sc1
    v_mfma_f32_16x16x32_bf16 v[108:111], v[180:183], a[188:191], v[108:111]
    s_waitcnt lgkmcnt(10)
    ds_read_b64_tr_b16 v[176:177], v216 offset:32768
    ds_read_b64_tr_b16 v[178:179], v216 offset:33280
    v_mfma_f32_16x16x32_bf16 v[112:115], v[184:187], a[160:163], v[112:115]
    s_waitcnt lgkmcnt(10)
    ds_read_b64_tr_b16 v[180:181], v216 offset:40960
    ds_read_b64_tr_b16 v[182:183], v216 offset:41472
    v_mfma_f32_16x16x32_bf16 v[112:115], v[188:191], a[176:179], v[112:115]
    v_mul_f32 v198, v10, v26
    v_add_f32 v194, 1.0, v194
    v_mfma_f32_16x16x32_bf16 v[116:119], v[184:187], a[164:167], v[116:119]
    v_rcp_f32 v194, v194
    v_mfma_f32_16x16x32_bf16 v[116:119], v[188:191], a[180:183], v[116:119]
    buffer_load_dwordx4 a[16:19], v209, s[20:23], s99 offen sc1
    v_mfma_f32_16x16x32_bf16 v[120:123], v[184:187], a[168:171], v[120:123]
    s_add_u32 s69, s55, 2
    s_waitcnt vmcnt(11)
    v_subrev_u32 v245, s69, v244
    v_cmp_le_u32 vcc, 8, v245
    s_nop 1
    s_cbranch_vccnz L_spin1
L_back1:
    v_mfma_f32_16x16x32_bf16 v[120:123], v[188:191], a[184:187], v[120:123]
    s_add_u32 s100, s54, 174080
    v_mul_f32 v198, v198, v194
    v_mul_f32 v195, v11, v11
    v_mfma_f32_16x16x32_bf16 v[124:127], v[184:187], a[172:175], v[124:127]
    v_fmaak_f32 v195, v195, v208, 0xc0135761
    v_mul_f32 v195, v195, v11
    v_mfma_f32_16x16x32_bf16 v[124:127], v[188:191], a[188:191], v[124:127]
    s_waitcnt lgkmcnt(10)
    ds_read_b64_tr_b16 v[184:185], v216 offset:34816
    ds_read_b64_tr_b16 v[186:187], v216 offset:35328
    v_mfma_f32_16x16x32_bf16 v[64:67], v[160:163], a[192:195], v[64:67]
    s_waitcnt lgkmcnt(10)
    buffer_load_dwordx4 a[20:23], v209, s[20:23], s100 offen sc1
    v_mfma_f32_16x16x32_bf16 v[64:67], v[164:167], a[208:211], v[64:67]
    s_add_u32 s99, s54, 27648
    ds_read_b64_tr_b16 v[188:189], v216 offset:43008
    ds_read_b64_tr_b16 v[190:191], v216 offset:43520
    v_mfma_f32_16x16x32_bf16 v[68:71], v[160:163], a[196:199], v[68:71]
    v_exp_f32 v195, v195
    v_mfma_f32_16x16x32_bf16 v[68:71], v[164:167], a[212:215], v[68:71]
    v_mul_f32 v199, v11, v27
    v_add_f32 v195, 1.0, v195
    v_mfma_f32_16x16x32_bf16 v[72:75], v[160:163], a[200:203], v[72:75]
    v_rcp_f32 v195, v195
    v_mfma_f32_16x16x32_bf16 v[72:75], v[164:167], a[216:219], v[72:75]
    buffer_store_dwordx2 v[248:249], v254, s[24:27], s62 offen offset:2048 sc1
    v_mfma_f32_16x16x32_bf16 v[76:79], v[160:163], a[204:207], v[76:79]
    v_mul_f32 v199, v199, v195
    v_cvt_pk_bf16_f32 v200, v196, v197
    v_mfma_f32_16x16x32_bf16 v[76:79], v[164:167], a[220:223], v[76:79]
    s_waitcnt lgkmcnt(10)
    v_cvt_pk_bf16_f32 v201, v198, v199
    v_mul_f32 v222, v40, v40
    v_mfma_f32_16x16x32_bf16 v[80:83], v[168:171], a[192:195], v[80:83]
    s_waitcnt lgkmcnt(8)
    v_fmaak_f32 v222, v222, v208, 0xc0135761
    v_mul_f32 v222, v222, v40
    v_mfma_f32_16x16x32_bf16 v[80:83], v[172:175], a[208:211], v[80:83]
    v_exp_f32 v222, v222
    v_mfma_f32_16x16x32_bf16 v[84:87], v[168:171], a[196:199], v[84:87]
    v_mul_f32 v226, v40, v56
    v_add_f32 v222, 1.0, v222
    v_mfma_f32_16x16x32_bf16 v[84:87], v[172:175], a[212:215], v[84:87]
    s_barrier
    v_rcp_f32 v222, v222
    v_mfma_f32_16x16x32_bf16 v[88:91], v[168:171], a[200:203], v[88:91]
    buffer_load_dwordx4 a[24:27], v209, s[20:23], s99 offen sc1
    v_mfma_f32_16x16x32_bf16 v[88:91], v[172:175], a[216:219], v[88:91]
    s_add_u32 s100, s54, 175104
    ds_read_b64_tr_b16 v[160:161], v213 offset:49152
    ds_read_b64_tr_b16 v[162:163], v213 offset:49664
    v_mfma_f32_16x16x32_bf16 v[92:95], v[168:171], a[204:207], v[92:95]
    ds_read_b64_tr_b16 v[164:165], v213 offset:57344
    ds_read_b64_tr_b16 v[166:167], v213 offset:57856
    v_mfma_f32_16x16x32_bf16 v[92:95], v[172:175], a[220:223], v[92:95]
    s_waitcnt lgkmcnt(10)
    ds_read_b64_tr_b16 v[168:169], v213 offset:51200
    ds_read_b64_tr_b16 v[170:171], v213 offset:51712
    v_mfma_f32_16x16x32_bf16 v[96:99], v[176:179], a[192:195], v[96:99]
    s_waitcnt lgkmcnt(10)
    ds_read_b64_tr_b16 v[172:173], v213 offset:59392
    ds_read_b64_tr_b16 v[174:175], v213 offset:59904
    v_mfma_f32_16x16x32_bf16 v[96:99], v[180:183], a[208:211], v[96:99]
    buffer_load_dwordx4 a[28:31], v209, s[20:23], s100 offen sc1
    v_mfma_f32_16x16x32_bf16 v[100:103], v[176:179], a[196:199], v[100:103]
    s_add_u32 s99, s54, 0
    v_mul_f32 v226, v226, v222
    v_mul_f32 v223, v41, v41
    v_mfma_f32_16x16x32_bf16 v[100:103], v[180:183], a[212:215], v[100:103]
    v_fmaak_f32 v223, v223, v208, 0xc0135761
    v_mul_f32 v223, v223, v41
    v_mfma_f32_16x16x32_bf16 v[104:107], v[176:179], a[200:203], v[104:107]
    v_exp_f32 v223, v223
    v_mfma_f32_16x16x32_bf16 v[104:107], v[180:183], a[216:219], v[104:107]
    v_mul_f32 v227, v41, v57
    v_add_f32 v223, 1.0, v223
    v_mfma_f32_16x16x32_bf16 v[108:111], v[176:179], a[204:207], v[108:111]
    buffer_load_dwordx4 a[32:35], v209, s[20:23], s99 offen sc1
    v_mfma_f32_16x16x32_bf16 v[108:111], v[180:183], a[220:223], v[108:111]
    s_add_u32 s100, s54, 147456
    ds_read_b64_tr_b16 v[176:177], v216 offset:49152
    ds_read_b64_tr_b16 v[178:179], v216 offset:49664
    s_waitcnt lgkmcnt(12)
    v_mfma_f32_16x16x32_bf16 v[112:115], v[184:187], a[192:195], v[112:115]
    s_waitcnt lgkmcnt(10)
    ds_read_b64_tr_b16 v[180:181], v216 offset:57344
    ds_read_b64_tr_b16 v[182:183], v216 offset:57856
    v_mfma_f32_16x16x32_bf16 v[112:115], v[188:191], a[208:211], v[112:115]
    v_rcp_f32 v223, v223
    v_mfma_f32_16x16x32_bf16 v[116:119], v[184:187], a[196:199], v[116:119]
    v_mul_f32 v227, v227, v223
    v_mul_f32 v224, v42, v42
    v_mfma_f32_16x16x32_bf16 v[116:119], v[188:191], a[212:215], v[116:119]
    buffer_load_dwordx4 a[36:39], v209, s[20:23], s100 offen sc1
    v_mfma_f32_16x16x32_bf16 v[120:123], v[184:187], a[200:203], v[120:123]
    s_add_u32 s99, s54, 1024
    v_fmaak_f32 v224, v224, v208, 0xc0135761
    v_mul_f32 v224, v224, v42
    v_mfma_f32_16x16x32_bf16 v[120:123], v[188:191], a[216:219], v[120:123]
    v_exp_f32 v224, v224
    v_mfma_f32_16x16x32_bf16 v[124:127], v[184:187], a[204:207], v[124:127]
    v_mul_f32 v228, v42, v58
    v_add_f32 v224, 1.0, v224
    v_mfma_f32_16x16x32_bf16 v[124:127], v[188:191], a[220:223], v[124:127]
    s_waitcnt lgkmcnt(10)
    ds_read_b64_tr_b16 v[184:185], v216 offset:51200
    ds_read_b64_tr_b16 v[186:187], v216 offset:51712
    v_mfma_f32_16x16x32_bf16 v[64:67], v[160:163], a[224:227], v[64:67]
    s_waitcnt lgkmcnt(10)
    buffer_load_dwordx4 a[40:43], v209, s[20:23], s99 offen sc1
    v_mfma_f32_16x16x32_bf16 v[64:67], v[164:167], a[240:243], v[64:67]
    s_add_u32 s100, s54, 148480
    ds_read_b64_tr_b16 v[188:189], v216 offset:59392
    ds_read_b64_tr_b16 v[190:191], v216 offset:59904
    v_mfma_f32_16x16x32_bf16 v[68:71], v[160:163], a[228:231], v[68:71]
    v_rcp_f32 v224, v224
    v_mfma_f32_16x16x32_bf16 v[68:71], v[164:167], a[244:247], v[68:71]
    v_mul_f32 v228, v228, v224
    v_mul_f32 v225, v43, v43
    v_mfma_f32_16x16x32_bf16 v[72:75], v[160:163], a[232:235], v[72:75]
    v_fmaak_f32 v225, v225, v208, 0xc0135761
    v_mul_f32 v225, v225, v43
    v_mfma_f32_16x16x32_bf16 v[72:75], v[164:167], a[248:251], v[72:75]
    buffer_store_dwordx4 v[248:251], v209, s[24:27], s63 offen sc1
    v_mfma_f32_16x16x32_bf16 v[76:79], v[160:163], a[236:239], v[76:79]
    v_exp_f32 v225, v225
    v_mfma_f32_16x16x32_bf16 v[76:79], v[164:167], a[252:255], v[76:79]
    s_waitcnt lgkmcnt(10)
    v_mul_f32 v229, v43, v59
    v_add_f32 v225, 1.0, v225
    v_mfma_f32_16x16x32_bf16 v[80:83], v[168:171], a[224:227], v[80:83]
    s_waitcnt lgkmcnt(8)
    v_rcp_f32 v225, v225
    v_mfma_f32_16x16x32_bf16 v[80:83], v[172:175], a[240:243], v[80:83]
    v_mul_f32 v229, v229, v225
    v_cvt_pk_bf16_f32 v202, v226, v227
    v_mfma_f32_16x16x32_bf16 v[84:87], v[168:171], a[228:231], v[84:87]
    s_waitcnt vmcnt(13)
    v_cvt_pk_bf16_f32 v203, v228, v229
    v_mfma_f32_16x16x32_bf16 v[84:87], v[172:175], a[244:247], v[84:87]
    s_barrier
    buffer_store_dwordx4 v[200:203], v209, s[20:23], s97 offen sc1
    v_mfma_f32_16x16x32_bf16 v[88:91], v[168:171], a[232:235], v[88:91]
    ds_read_b64_tr_b16 v[160:161], v214 offset:0
    ds_read_b64_tr_b16 v[162:163], v214 offset:512
    v_mfma_f32_16x16x32_bf16 v[88:91], v[172:175], a[248:251], v[88:91]
    ds_read_b64_tr_b16 v[164:165], v214 offset:8192
    ds_read_b64_tr_b16 v[166:167], v214 offset:8704
    v_mfma_f32_16x16x32_bf16 v[92:95], v[168:171], a[236:239], v[92:95]
    s_add_u32 m0, s42, 0
    s_add_u32 s92, s52, 663552
    v_mfma_f32_16x16x32_bf16 v[92:95], v[172:175], a[252:255], v[92:95]
    s_waitcnt lgkmcnt(10)
    ds_read_b64_tr_b16 v[168:169], v214 offset:2048
    ds_read_b64_tr_b16 v[170:171], v214 offset:2560
    v_mfma_f32_16x16x32_bf16 v[96:99], v[176:179], a[224:227], v[96:99]
    s_waitcnt lgkmcnt(10)
    buffer_load_dwordx4 a[44:47], v209, s[20:23], s100 offen sc1
    v_mfma_f32_16x16x32_bf16 v[96:99], v[180:183], a[240:243], v[96:99]
    s_add_u32 s99, s54, 10240
    ds_read_b64_tr_b16 v[172:173], v214 offset:10240
    ds_read_b64_tr_b16 v[174:175], v214 offset:10752
    v_mfma_f32_16x16x32_bf16 v[100:103], v[176:179], a[228:231], v[100:103]
    v_mfma_f32_16x16x32_bf16 v[100:103], v[180:183], a[244:247], v[100:103]
    v_mfma_f32_16x16x32_bf16 v[104:107], v[176:179], a[232:235], v[104:107]
    v_mfma_f32_16x16x32_bf16 v[104:107], v[180:183], a[248:251], v[104:107]
    buffer_load_dwordx4 a[48:51], v209, s[20:23], s99 offen sc1
    v_mfma_f32_16x16x32_bf16 v[108:111], v[176:179], a[236:239], v[108:111]
    s_add_u32 s100, s54, 157696
    v_mfma_f32_16x16x32_bf16 v[108:111], v[180:183], a[252:255], v[108:111]
    s_waitcnt lgkmcnt(10)
    ds_read_b64_tr_b16 v[176:177], v217 offset:0
    ds_read_b64_tr_b16 v[178:179], v217 offset:512
    v_mfma_f32_16x16x32_bf16 v[112:115], v[184:187], a[224:227], v[112:115]
    s_waitcnt lgkmcnt(10)
    ds_read_b64_tr_b16 v[180:181], v217 offset:8192
    ds_read_b64_tr_b16 v[182:183], v217 offset:8704
    v_mfma_f32_16x16x32_bf16 v[112:115], v[188:191], a[240:243], v[112:115]
    v_mfma_f32_16x16x32_bf16 v[116:119], v[184:187], a[228:231], v[116:119]
    buffer_load_dwordx4 a[52:55], v209, s[20:23], s100 offen sc1
    v_mfma_f32_16x16x32_bf16 v[116:119], v[188:191], a[244:247], v[116:119]
    s_add_u32 s99, s54, 11264
    v_mfma_f32_16x16x32_bf16 v[120:123], v[184:187], a[232:235], v[120:123]
    v_mfma_f32_16x16x32_bf16 v[120:123], v[188:191], a[248:251], v[120:123]
    v_mfma_f32_16x16x32_bf16 v[124:127], v[184:187], a[236:239], v[124:127]
    v_mfma_f32_16x16x32_bf16 v[124:127], v[188:191], a[252:255], v[124:127]
    s_waitcnt lgkmcnt(10)
    buffer_load_dwordx4 a[56:59], v209, s[20:23], s99 offen sc1
    v_mfma_f32_16x16x32_bf16 v[64:67], v[160:163], v[128:131], v[64:67]
    s_add_u32 s100, s54, 158720
    ds_read_b64_tr_b16 v[184:185], v217 offset:2048
    ds_read_b64_tr_b16 v[186:187], v217 offset:2560
    s_waitcnt lgkmcnt(10)
    v_mfma_f32_16x16x32_bf16 v[64:67], v[164:167], v[144:147], v[64:67]
    ds_read_b64_tr_b16 v[188:189], v217 offset:10240
    ds_read_b64_tr_b16 v[190:191], v217 offset:10752
    v_mfma_f32_16x16x32_bf16 v[68:71], v[160:163], v[132:135], v[68:71]
    v_mfma_f32_16x16x32_bf16 v[68:71], v[164:167], v[148:151], v[68:71]
    v_mfma_f32_16x16x32_bf16 v[72:75], v[160:163], v[136:139], v[72:75]
    buffer_store_dwordx4 v[248:251], v209, s[24:27], s63 offen offset:1024 sc1
    v_mfma_f32_16x16x32_bf16 v[72:75], v[164:167], v[152:155], v[72:75]
    v_mfma_f32_16x16x32_bf16 v[76:79], v[160:163], v[140:143], v[76:79]
    v_mfma_f32_16x16x32_bf16 v[76:79], v[164:167], v[156:159], v[76:79]
    s_waitcnt lgkmcnt(10)
    v_mfma_f32_16x16x32_bf16 v[80:83], v[168:171], v[128:131], v[80:83]
    s_waitcnt lgkmcnt(8)
    v_mfma_f32_16x16x32_bf16 v[80:83], v[172:175], v[144:147], v[80:83]
    buffer_store_dwordx2 v[248:249], v254, s[24:27], s63 offen offset:2048 sc1
    v_mfma_f32_16x16x32_bf16 v[84:87], v[168:171], v[132:135], v[84:87]
    v_mfma_f32_16x16x32_bf16 v[84:87], v[172:175], v[148:151], v[84:87]
    s_barrier
    v_mfma_f32_16x16x32_bf16 v[88:91], v[168:171], v[136:139], v[88:91]
    ds_read_b64_tr_b16 v[160:161], v220 offset:53248
    ds_read_b64_tr_b16 v[162:163], v220 offset:57856
    v_mfma_f32_16x16x32_bf16 v[88:91], v[172:175], v[152:155], v[88:91]
    ds_read_b64_tr_b16 v[164:165], v220 offset:62464
    ds_read_b64_tr_b16 v[166:167], v221 offset:1536
    v_mfma_f32_16x16x32_bf16 v[92:95], v[168:171], v[140:143], v[92:95]
    buffer_load_dwordx4 a[60:63], v209, s[20:23], s100 offen sc1
    v_mfma_f32_16x16x32_bf16 v[92:95], v[172:175], v[156:159], v[92:95]
    s_add_u32 s99, s54, 18432
    ds_read_b64_tr_b16 v[168:169], v220 offset:53280
    ds_read_b64_tr_b16 v[170:171], v220 offset:57888
    s_waitcnt lgkmcnt(12)
    v_mfma_f32_16x16x32_bf16 v[96:99], v[176:179], v[128:131], v[96:99]
    s_waitcnt lgkmcnt(10)
    ds_read_b64_tr_b16 v[172:173], v220 offset:62496
    ds_read_b64_tr_b16 v[174:175], v221 offset:1568
    v_mfma_f32_16x16x32_bf16 v[96:99], v[180:183], v[144:147], v[96:99]
    v_mfma_f32_16x16x32_bf16 v[100:103], v[176:179], v[132:135], v[100:103]
    v_mfma_f32_16x16x32_bf16 v[100:103], v[180:183], v[148:151], v[100:103]
    buffer_load_dwordx4 v232, s[16:19], s92 offen lds
    v_mfma_f32_16x16x32_bf16 v[104:107], v[176:179], v[136:139], v[104:107]
    v_mfma_f32_16x16x32_bf16 v[104:107], v[180:183], v[152:155], v[104:107]
    v_mfma_f32_16x16x32_bf16 v[108:111], v[176:179], v[140:143], v[108:111]
    v_mfma_f32_16x16x32_bf16 v[108:111], v[180:183], v[156:159], v[108:111]
    s_waitcnt lgkmcnt(10)
    ds_read_b64_tr_b16 v[176:177], v220 offset:53312
    ds_read_b64_tr_b16 v[178:179], v220 offset:57920
    v_mfma_f32_16x16x32_bf16 v[112:115], v[184:187], v[128:131], v[112:115]
    s_waitcnt lgkmcnt(10)
    buffer_load_dwordx4 v233, s[16:19], s92 offen offset:1024 lds
    v_mfma_f32_16x16x32_bf16 v[112:115], v[188:191], v[144:147], v[112:115]
    ds_read_b64_tr_b16 v[180:181], v220 offset:62528
    ds_read_b64_tr_b16 v[182:183], v221 offset:1600
    v_mfma_f32_16x16x32_bf16 v[116:119], v[184:187], v[132:135], v[116:119]
    v_mfma_f32_16x16x32_bf16 v[116:119], v[188:191], v[148:151], v[116:119]
    v_mfma_f32_16x16x32_bf16 v[120:123], v[184:187], v[136:139], v[120:123]
    v_mfma_f32_16x16x32_bf16 v[120:123], v[188:191], v[152:155], v[120:123]
    buffer_load_dwordx4 v234, s[16:19], s92 offen offset:2048 lds
    v_mfma_f32_16x16x32_bf16 v[124:127], v[184:187], v[140:143], v[124:127]
    v_mfma_f32_16x16x32_bf16 v[124:127], v[188:191], v[156:159], v[124:127]
    s_waitcnt lgkmcnt(10)
    ds_read_b64_tr_b16 v[184:185], v220 offset:53344
    ds_read_b64_tr_b16 v[186:187], v220 offset:57952
    v_pk_mul_f32 v[192:193], v[64:65], v[64:65]
    v_pk_mul_f32 v[194:195], v[66:67], v[66:67]
    v_pk_mul_f32 v[222:223], v[96:97], v[96:97]
    v_pk_mul_f32 v[224:225], v[98:99], v[98:99]
    v_pk_fma_f32 v[192:193], v[192:193], v[208:209], s[84:85] op_sel_hi:[1,0,0]
    v_pk_fma_f32 v[194:195], v[194:195], v[208:209], s[84:85] op_sel_hi:[1,0,0]
    v_pk_fma_f32 v[222:223], v[222:223], v[208:209], s[84:85] op_sel_hi:[1,0,0]
    v_pk_fma_f32 v[224:225], v[224:225], v[208:209], s[84:85] op_sel_hi:[1,0,0]
    v_pk_mul_f32 v[192:193], v[192:193], v[64:65]
    v_pk_mul_f32 v[194:195], v[194:195], v[66:67]
    v_pk_mul_f32 v[222:223], v[222:223], v[96:97]
    v_pk_mul_f32 v[224:225], v[224:225], v[98:99]
    v_exp_f32 v192, v192
    v_exp_f32 v193, v193
    v_exp_f32 v194, v194
    v_exp_f32 v195, v195
    v_exp_f32 v222, v222
    v_exp_f32 v223, v223
    v_exp_f32 v224, v224
    v_exp_f32 v225, v225
    v_pk_mul_f32 v[196:197], v[64:65], v[80:81]
    v_pk_mul_f32 v[198:199], v[66:67], v[82:83]
    v_pk_mul_f32 v[226:227], v[96:97], v[112:113]
    v_pk_mul_f32 v[228:229], v[98:99], v[114:115]
    v_pk_add_f32 v[192:193], v[192:193], 1.0 op_sel_hi:[1,0]
    v_pk_add_f32 v[194:195], v[194:195], 1.0 op_sel_hi:[1,0]
    v_pk_add_f32 v[222:223], v[222:223], 1.0 op_sel_hi:[1,0]
    v_pk_add_f32 v[224:225], v[224:225], 1.0 op_sel_hi:[1,0]
    v_rcp_f32 v192, v192
    v_rcp_f32 v193, v193
    v_rcp_f32 v194, v194
    v_rcp_f32 v195, v195
    v_rcp_f32 v222, v222
    v_rcp_f32 v223, v223
    v_rcp_f32 v224, v224
    v_rcp_f32 v225, v225
    v_pk_mul_f32 v[196:197], v[196:197], v[192:193]
    v_pk_mul_f32 v[198:199], v[198:199], v[194:195]
    v_pk_mul_f32 v[226:227], v[226:227], v[222:223]
    v_pk_mul_f32 v[228:229], v[228:229], v[224:225]
    v_cvt_pk_bf16_f32 v200, v196, v197
    v_cvt_pk_bf16_f32 v201, v198, v199
    v_cvt_pk_bf16_f32 v202, v226, v227
    v_cvt_pk_bf16_f32 v203, v228, v229
    s_add_u32 s97, s46, 6144
    buffer_store_dwordx4 v[200:203], v209, s[20:23], s97 offen
    v_pk_mul_f32 v[192:193], v[68:69], v[68:69]
    v_pk_mul_f32 v[194:195], v[70:71], v[70:71]
    v_pk_mul_f32 v[222:223], v[100:101], v[100:101]
    v_pk_mul_f32 v[224:225], v[102:103], v[102:103]
    v_pk_fma_f32 v[192:193], v[192:193], v[208:209], s[84:85] op_sel_hi:[1,0,0]
    v_pk_fma_f32 v[194:195], v[194:195], v[208:209], s[84:85] op_sel_hi:[1,0,0]
    v_pk_fma_f32 v[222:223], v[222:223], v[208:209], s[84:85] op_sel_hi:[1,0,0]
    v_pk_fma_f32 v[224:225], v[224:225], v[208:209], s[84:85] op_sel_hi:[1,0,0]
    v_pk_mul_f32 v[192:193], v[192:193], v[68:69]
    v_pk_mul_f32 v[194:195], v[194:195], v[70:71]
    v_pk_mul_f32 v[222:223], v[222:223], v[100:101]
    v_pk_mul_f32 v[224:225], v[224:225], v[102:103]
    v_exp_f32 v192, v192
    v_exp_f32 v193, v193
    v_exp_f32 v194, v194
    v_exp_f32 v195, v195
    v_exp_f32 v222, v222
    v_exp_f32 v223, v223
    v_exp_f32 v224, v224
    v_exp_f32 v225, v225
    v_pk_mul_f32 v[196:197], v[68:69], v[84:85]
    v_pk_mul_f32 v[198:199], v[70:71], v[86:87]
    v_pk_mul_f32 v[226:227], v[100:101], v[116:117]
    v_pk_mul_f32 v[228:229], v[102:103], v[118:119]
    v_pk_add_f32 v[192:193], v[192:193], 1.0 op_sel_hi:[1,0]
    v_pk_add_f32 v[194:195], v[194:195], 1.0 op_sel_hi:[1,0]
    v_pk_add_f32 v[222:223], v[222:223], 1.0 op_sel_hi:[1,0]
    v_pk_add_f32 v[224:225], v[224:225], 1.0 op_sel_hi:[1,0]
    v_rcp_f32 v192, v192
    v_rcp_f32 v193, v193
    v_rcp_f32 v194, v194
    v_rcp_f32 v195, v195
    v_rcp_f32 v222, v222
    v_rcp_f32 v223, v223
    v_rcp_f32 v224, v224
    v_rcp_f32 v225, v225
    v_pk_mul_f32 v[196:197], v[196:197], v[192:193]
    v_pk_mul_f32 v[198:199], v[198:199], v[194:195]
    v_pk_mul_f32 v[226:227], v[226:227], v[222:223]
    v_pk_mul_f32 v[228:229], v[228:229], v[224:225]
    v_cvt_pk_bf16_f32 v204, v196, v197
    v_cvt_pk_bf16_f32 v205, v198, v199
    v_cvt_pk_bf16_f32 v206, v226, v227
    v_cvt_pk_bf16_f32 v207, v228, v229
    s_add_u32 s98, s47, 6144
    buffer_store_dwordx4 v[204:207], v209, s[20:23], s98 offen
    v_pk_mul_f32 v[192:193], v[72:73], v[72:73]
    v_pk_mul_f32 v[194:195], v[74:75], v[74:75]
    v_pk_mul_f32 v[222:223], v[104:105], v[104:105]
    v_pk_mul_f32 v[224:225], v[106:107], v[106:107]
    v_pk_fma_f32 v[192:193], v[192:193], v[208:209], s[84:85] op_sel_hi:[1,0,0]
    v_pk_fma_f32 v[194:195], v[194:195], v[208:209], s[84:85] op_sel_hi:[1,0,0]
    v_pk_fma_f32 v[222:223], v[222:223], v[208:209], s[84:85] op_sel_hi:[1,0,0]
    v_pk_fma_f32 v[224:225], v[224:225], v[208:209], s[84:85] op_sel_hi:[1,0,0]
    v_pk_mul_f32 v[192:193], v[192:193], v[72:73]
    v_pk_mul_f32 v[194:195], v[194:195], v[74:75]
    v_pk_mul_f32 v[222:223], v[222:223], v[104:105]
    v_pk_mul_f32 v[224:225], v[224:225], v[106:107]
    v_exp_f32 v192, v192
    v_exp_f32 v193, v193
    v_exp_f32 v194, v194
    v_exp_f32 v195, v195
    v_exp_f32 v222, v222
    v_exp_f32 v223, v223
    v_exp_f32 v224, v224
    v_exp_f32 v225, v225
    v_pk_mul_f32 v[196:197], v[72:73], v[88:89]
    v_pk_mul_f32 v[198:199], v[74:75], v[90:91]
    v_pk_mul_f32 v[226:227], v[104:105], v[120:121]
    v_pk_mul_f32 v[228:229], v[106:107], v[122:123]
    v_pk_add_f32 v[192:193], v[192:193], 1.0 op_sel_hi:[1,0]
    v_pk_add_f32 v[194:195], v[194:195], 1.0 op_sel_hi:[1,0]
    v_pk_add_f32 v[222:223], v[222:223], 1.0 op_sel_hi:[1,0]
    v_pk_add_f32 v[224:225], v[224:225], 1.0 op_sel_hi:[1,0]
    v_rcp_f32 v192, v192
    v_rcp_f32 v193, v193
    v_rcp_f32 v194, v194
    v_rcp_f32 v195, v195
    v_rcp_f32 v222, v222
    v_rcp_f32 v223, v223
    v_rcp_f32 v224, v224
    v_rcp_f32 v225, v225
    v_pk_mul_f32 v[196:197], v[196:197], v[192:193]
    v_pk_mul_f32 v[198:199], v[198:199], v[194:195]
    v_pk_mul_f32 v[226:227], v[226:227], v[222:223]
    v_pk_mul_f32 v[228:229], v[228:229], v[224:225]
    v_cvt_pk_bf16_f32 v200, v196, v197
    v_cvt_pk_bf16_f32 v201, v198, v199
    v_cvt_pk_bf16_f32 v202, v226, v227
    v_cvt_pk_bf16_f32 v203, v228, v229
    s_add_u32 s97, s48, 6144
    buffer_store_dwordx4 v[200:203], v209, s[20:23], s97 offen
    v_pk_mul_f32 v[192:193], v[76:77], v[76:77]
    v_pk_mul_f32 v[194:195], v[78:79], v[78:79]
    v_pk_mul_f32 v[222:223], v[108:109], v[108:109]
    v_pk_mul_f32 v[224:225], v[110:111], v[110:111]
    v_pk_fma_f32 v[192:193], v[192:193], v[208:209], s[84:85] op_sel_hi:[1,0,0]
    v_pk_fma_f32 v[194:195], v[194:195], v[208:209], s[84:85] op_sel_hi:[1,0,0]
    v_pk_fma_f32 v[222:223], v[222:223], v[208:209], s[84:85] op_sel_hi:[1,0,0]
    v_pk_fma_f32 v[224:225], v[224:225], v[208:209], s[84:85] op_sel_hi:[1,0,0]
    v_pk_mul_f32 v[192:193], v[192:193], v[76:77]
    v_pk_mul_f32 v[194:195], v[194:195], v[78:79]
    v_pk_mul_f32 v[222:223], v[222:223], v[108:109]
    v_pk_mul_f32 v[224:225], v[224:225], v[110:111]
    v_exp_f32 v192, v192
    v_exp_f32 v193, v193
    v_exp_f32 v194, v194
    v_exp_f32 v195, v195
    v_exp_f32 v222, v222
    v_exp_f32 v223, v223
    v_exp_f32 v224, v224
    v_exp_f32 v225, v225
    v_pk_mul_f32 v[196:197], v[76:77], v[92:93]
    v_pk_mul_f32 v[198:199], v[78:79], v[94:95]
    v_pk_mul_f32 v[226:227], v[108:109], v[124:125]
    v_pk_mul_f32 v[228:229], v[110:111], v[126:127]
    v_pk_add_f32 v[192:193], v[192:193], 1.0 op_sel_hi:[1,0]
    v_pk_add_f32 v[194:195], v[194:195], 1.0 op_sel_hi:[1,0]
    v_pk_add_f32 v[222:223], v[222:223], 1.0 op_sel_hi:[1,0]
    v_pk_add_f32 v[224:225], v[224:225], 1.0 op_sel_hi:[1,0]
    v_rcp_f32 v192, v192
    v_rcp_f32 v193, v193
    v_rcp_f32 v194, v194
    v_rcp_f32 v195, v195
    v_rcp_f32 v222, v222
    v_rcp_f32 v223, v223
    v_rcp_f32 v224, v224
    v_rcp_f32 v225, v225
    v_pk_mul_f32 v[196:197], v[196:197], v[192:193]
    v_pk_mul_f32 v[198:199], v[198:199], v[194:195]
    v_pk_mul_f32 v[226:227], v[226:227], v[222:223]
    v_pk_mul_f32 v[228:229], v[228:229], v[224:225]
    v_cvt_pk_bf16_f32 v204, v196, v197
    v_cvt_pk_bf16_f32 v205, v198, v199
    v_cvt_pk_bf16_f32 v206, v226, v227
    v_cvt_pk_bf16_f32 v207, v228, v229
    s_add_u32 s98, s49, 6144
    v_mfma_f32_16x16x32_bf16 v[64:67], v[160:163], a[0:3], 0
    s_waitcnt vmcnt(25) lgkmcnt(10)
    ds_read_b64_tr_b16 v[188:189], v220 offset:62560
    ds_read_b64_tr_b16 v[190:191], v221 offset:1632
    v_mfma_f32_16x16x32_bf16 v[64:67], v[164:167], a[8:11], v[64:67]
    v_mul_f32 v192, v12, v12
    v_fmaak_f32 v192, v192, v208, 0xc0135761
    v_mfma_f32_16x16x32_bf16 v[68:71], v[160:163], a[4:7], 0
    s_waitcnt vmcnt(24)
    v_mul_f32 v192, v192, v12
    v_mul_f32 v196, v12, v28
    v_mfma_f32_16x16x32_bf16 v[68:71], v[164:167], a[12:15], v[68:71]
    s_waitcnt lgkmcnt(10)
    buffer_store_dwordx4 v[204:207], v209, s[20:23], s98 offen
    v_mfma_f32_16x16x32_bf16 v[72:75], v[168:171], a[0:3], 0
    s_add_u32 s98, s49, 4096
    ds_read_b64_tr_b16 v[160:161], v220 offset:53376
    ds_read_b64_tr_b16 v[162:163], v220 offset:57984
    s_waitcnt lgkmcnt(10)
    v_mfma_f32_16x16x32_bf16 v[72:75], v[172:175], a[8:11], v[72:75]
    ds_read_b64_tr_b16 v[164:165], v220 offset:62592
    ds_read_b64_tr_b16 v[166:167], v221 offset:1664
    v_mul_f32 v193, v13, v13
    v_mfma_f32_16x16x32_bf16 v[76:79], v[168:171], a[4:7], 0
    v_exp_f32 v192, v192
    v_mfma_f32_16x16x32_bf16 v[76:79], v[172:175], a[12:15], v[76:79]
    s_waitcnt lgkmcnt(10)
    buffer_load_dwordx4 v235, s[16:19], s92 offen offset:3072 lds
    v_mfma_f32_16x16x32_bf16 v[80:83], v[176:179], a[0:3], 0
    s_add_u32 m0, s42, 4096
    ds_read_b64_tr_b16 v[168:169], v220 offset:53408
    ds_read_b64_tr_b16 v[170:171], v220 offset:58016
    v_add_f32 v192, 1.0, v192
    s_waitcnt lgkmcnt(10)
    v_mfma_f32_16x16x32_bf16 v[80:83], v[180:183], a[8:11], v[80:83]
    ds_read_b64_tr_b16 v[172:173], v220 offset:62624
    ds_read_b64_tr_b16 v[174:175], v221 offset:1696
    v_mfma_f32_16x16x32_bf16 v[84:87], v[176:179], a[4:7], 0
    v_rcp_f32 v192, v192
    v_mfma_f32_16x16x32_bf16 v[84:87], v[180:183], a[12:15], v[84:87]
    s_waitcnt lgkmcnt(10)
    buffer_load_dwordx4 v236, s[16:19], s92 offen lds
    v_mul_f32 v196, v196, v192
    v_mfma_f32_16x16x32_bf16 v[88:91], v[184:187], a[0:3], 0
    s_waitcnt lgkmcnt(8)
    ds_read_b64_tr_b16 v[176:177], v220 offset:53440
    ds_read_b64_tr_b16 v[178:179], v220 offset:58048
    v_mfma_f32_16x16x32_bf16 v[88:91], v[188:191], a[8:11], v[88:91]
    ds_read_b64_tr_b16 v[180:181], v220 offset:62656
    ds_read_b64_tr_b16 v[182:183], v221 offset:1728
    v_mfma_f32_16x16x32_bf16 v[92:95], v[184:187], a[4:7], 0
    v_fmaak_f32 v193, v193, v208, 0xc0135761
    v_mul_f32 v193, v193, v13
    v_mul_f32 v197, v13, v29
    v_mfma_f32_16x16x32_bf16 v[92:95], v[188:191], a[12:15], v[92:95]
    s_waitcnt lgkmcnt(10)
    buffer_load_dwordx4 v237, s[16:19], s92 offen offset:1024 lds
    v_mfma_f32_16x16x32_bf16 v[96:99], v[160:163], a[0:3], 0
    s_waitcnt lgkmcnt(8)
    ds_read_b64_tr_b16 v[184:185], v220 offset:53472
    ds_read_b64_tr_b16 v[186:187], v220 offset:58080
    v_mfma_f32_16x16x32_bf16 v[96:99], v[164:167], a[8:11], v[96:99]
    ds_read_b64_tr_b16 v[188:189], v220 offset:62688
    ds_read_b64_tr_b16 v[190:191], v221 offset:1760
    v_mul_f32 v194, v14, v14
    v_mfma_f32_16x16x32_bf16 v[100:103], v[160:163], a[4:7], 0
    v_exp_f32 v193, v193
    v_mfma_f32_16x16x32_bf16 v[100:103], v[164:167], a[12:15], v[100:103]
    s_waitcnt lgkmcnt(10)
    buffer_load_dwordx4 v238, s[16:19], s92 offen offset:2048 lds
    v_mfma_f32_16x16x32_bf16 v[104:107], v[168:171], a[0:3], 0
    s_waitcnt lgkmcnt(8)
    ds_read_b64_tr_b16 v[160:161], v220 offset:53504
    ds_read_b64_tr_b16 v[162:163], v220 offset:58112
    v_add_f32 v193, 1.0, v193
    v_mfma_f32_16x16x32_bf16 v[104:107], v[172:175], a[8:11], v[104:107]
    ds_read_b64_tr_b16 v[164:165], v220 offset:62720
    ds_read_b64_tr_b16 v[166:167], v221 offset:1792
    v_mfma_f32_16x16x32_bf16 v[108:111], v[168:171], a[4:7], 0
    v_rcp_f32 v193, v193
    v_mfma_f32_16x16x32_bf16 v[108:111], v[172:175], a[12:15], v[108:111]
    s_waitcnt lgkmcnt(10)
    buffer_load_dwordx4 v239, s[16:19], s92 offen offset:3072 lds
    v_mfma_f32_16x16x32_bf16 v[112:115], v[176:179], a[0:3], 0
    s_add_u32 m0, s42, 8192
    ds_read_b64_tr_b16 v[168:169], v221 offset:6144
    ds_read_b64_tr_b16 v[170:171], v221 offset:10752
    v_mul_f32 v197, v197, v193
    s_waitcnt lgkmcnt(10)
    v_mfma_f32_16x16x32_bf16 v[112:115], v[180:183], a[8:11], v[112:115]
    ds_read_b64_tr_b16 v[172:173], v221 offset:15360
    ds_read_b64_tr_b16 v[174:175], v221 offset:19968
    v_mfma_f32_16x16x32_bf16 v[116:119], v[176:179], a[4:7], 0
    v_fmaak_f32 v194, v194, v208, 0xc0135761
    v_mul_f32 v194, v194, v14
    v_mfma_f32_16x16x32_bf16 v[116:119], v[180:183], a[12:15], v[116:119]
    s_waitcnt lgkmcnt(10)
    buffer_load_dwordx4 v240, s[16:19], s92 offen lds
    v_mul_f32 v198, v14, v30
    v_mfma_f32_16x16x32_bf16 v[120:123], v[184:187], a[0:3], 0
    s_waitcnt lgkmcnt(8)
    ds_read_b64_tr_b16 v[176:177], v221 offset:6176
    ds_read_b64_tr_b16 v[178:179], v221 offset:10784
    v_mfma_f32_16x16x32_bf16 v[120:123], v[188:191], a[8:11], v[120:123]
    ds_read_b64_tr_b16 v[180:181], v221 offset:15392
    ds_read_b64_tr_b16 v[182:183], v221 offset:20000
    v_mfma_f32_16x16x32_bf16 v[124:127], v[184:187], a[4:7], 0
    v_exp_f32 v194, v194
    v_mul_f32 v195, v15, v15
    v_mfma_f32_16x16x32_bf16 v[124:127], v[188:191], a[12:15], v[124:127]
    s_waitcnt lgkmcnt(10)
    buffer_load_dwordx4 a[64:67], v209, s[20:23], s99 offen sc1
    v_mfma_f32_16x16x32_bf16 v[128:131], v[160:163], a[0:3], 0
    s_add_u32 s100, s54, 165888
    ds_read_b64_tr_b16 v[184:185], v221 offset:6208
    ds_read_b64_tr_b16 v[186:187], v221 offset:10816
    s_waitcnt lgkmcnt(10)
    v_mfma_f32_16x16x32_bf16 v[128:131], v[164:167], a[8:11], v[128:131]
    ds_read_b64_tr_b16 v[188:189], v221 offset:15424
    ds_read_b64_tr_b16 v[190:191], v221 offset:20032
    v_add_f32 v194, 1.0, v194
    v_mfma_f32_16x16x32_bf16 v[132:135], v[160:163], a[4:7], 0
    v_rcp_f32 v194, v194
    v_mfma_f32_16x16x32_bf16 v[132:135], v[164:167], a[12:15], v[132:135]
    s_waitcnt vmcnt(30) lgkmcnt(10)
    buffer_load_dwordx4 a[68:71], v209, s[20:23], s100 offen sc1
    v_mfma_f32_16x16x32_bf16 v[64:67], v[168:171], a[16:19], v[64:67]
    s_add_u32 s99, s54, 19456
    ds_read_b64_tr_b16 v[160:161], v221 offset:6240
    ds_read_b64_tr_b16 v[162:163], v221 offset:10848
    v_mul_f32 v198, v198, v194
    s_waitcnt vmcnt(28) lgkmcnt(10)
    v_mfma_f32_16x16x32_bf16 v[64:67], v[172:175], a[24:27], v[64:67]
    ds_read_b64_tr_b16 v[164:165], v221 offset:15456
    ds_read_b64_tr_b16 v[166:167], v221 offset:20064
    v_mfma_f32_16x16x32_bf16 v[68:71], v[168:171], a[20:23], v[68:71]
    s_waitcnt vmcnt(27)
    v_fmaak_f32 v195, v195, v208, 0xc0135761
    v_mul_f32 v195, v195, v15
    v_mul_f32 v199, v15, v31
    v_mfma_f32_16x16x32_bf16 v[68:71], v[172:175], a[28:31], v[68:71]
    s_waitcnt lgkmcnt(10)
    buffer_load_dwordx4 a[72:75], v209, s[20:23], s99 offen sc1
    v_mfma_f32_16x16x32_bf16 v[72:75], v[176:179], a[16:19], v[72:75]
    s_add_u32 s100, s54, 166912
    ds_read_b64_tr_b16 v[168:169], v221 offset:6272
    ds_read_b64_tr_b16 v[170:171], v221 offset:10880
    s_waitcnt lgkmcnt(10)
    v_mfma_f32_16x16x32_bf16 v[72:75], v[180:183], a[24:27], v[72:75]
    ds_read_b64_tr_b16 v[172:173], v221 offset:15488
    ds_read_b64_tr_b16 v[174:175], v221 offset:20096
    v_mfma_f32_16x16x32_bf16 v[76:79], v[176:179], a[20:23], v[76:79]
    v_exp_f32 v195, v195
    v_cvt_pk_bf16_f32 v204, v196, v197
    v_mfma_f32_16x16x32_bf16 v[76:79], v[180:183], a[28:31], v[76:79]
    s_waitcnt lgkmcnt(10)
    buffer_load_dwordx4 a[76:79], v209, s[20:23], s100 offen sc1
    v_mfma_f32_16x16x32_bf16 v[80:83], v[184:187], a[16:19], v[80:83]
    s_add_u32 s99, s54, 28672
    ds_read_b64_tr_b16 v[176:177], v221 offset:6304
    ds_read_b64_tr_b16 v[178:179], v221 offset:10912
    v_add_f32 v195, 1.0, v195
    s_waitcnt lgkmcnt(10)
    v_mfma_f32_16x16x32_bf16 v[80:83], v[188:191], a[24:27], v[80:83]
    ds_read_b64_tr_b16 v[180:181], v221 offset:15520
    ds_read_b64_tr_b16 v[182:183], v221 offset:20128
    v_mfma_f32_16x16x32_bf16 v[84:87], v[184:187], a[20:23], v[84:87]
    v_rcp_f32 v195, v195
    v_mfma_f32_16x16x32_bf16 v[84:87], v[188:191], a[28:31], v[84:87]
    s_waitcnt lgkmcnt(10)
    buffer_load_dwordx4 a[80:83], v209, s[20:23], s99 offen sc1
    v_mul_f32 v199, v199, v195
    v_mfma_f32_16x16x32_bf16 v[88:91], v[160:163], a[16:19], v[88:91]
    s_add_u32 s100, s54, 176128
    ds_read_b64_tr_b16 v[184:185], v221 offset:6336
    ds_read_b64_tr_b16 v[186:187], v221 offset:10944
    s_waitcnt lgkmcnt(10)
    v_mfma_f32_16x16x32_bf16 v[88:91], v[164:167], a[24:27], v[88:91]
    ds_read_b64_tr_b16 v[188:189], v221 offset:15552
    ds_read_b64_tr_b16 v[190:191], v221 offset:20160
    v_mfma_f32_16x16x32_bf16 v[92:95], v[160:163], a[20:23], v[92:95]
    v_cvt_pk_bf16_f32 v205, v198, v199
    v_mul_f32 v222, v44, v44
    v_fmaak_f32 v222, v222, v208, 0xc0135761
    v_mfma_f32_16x16x32_bf16 v[92:95], v[164:167], a[28:31], v[92:95]
    s_waitcnt lgkmcnt(10)
    buffer_load_dwordx4 a[84:87], v209, s[20:23], s100 offen sc1
    v_mfma_f32_16x16x32_bf16 v[96:99], v[168:171], a[16:19], v[96:99]
    s_add_u32 s99, s54, 29696
    ds_read_b64_tr_b16 v[160:161], v221 offset:6368
    ds_read_b64_tr_b16 v[162:163], v221 offset:10976
    s_waitcnt lgkmcnt(10)
    v_mfma_f32_16x16x32_bf16 v[96:99], v[172:175], a[24:27], v[96:99]
    ds_read_b64_tr_b16 v[164:165], v221 offset:15584
    ds_read_b64_tr_b16 v[166:167], v221 offset:20192
    v_mul_f32 v222, v222, v44
    v_mfma_f32_16x16x32_bf16 v[100:103], v[168:171], a[20:23], v[100:103]
    v_exp_f32 v222, v222
    v_mfma_f32_16x16x32_bf16 v[100:103], v[172:175], a[28:31], v[100:103]
    s_waitcnt lgkmcnt(10)
    buffer_load_dwordx4 a[88:91], v209, s[20:23], s99 offen sc1
    v_mfma_f32_16x16x32_bf16 v[104:107], v[176:179], a[16:19], v[104:107]
    s_waitcnt lgkmcnt(8)
    ds_read_b64_tr_b16 v[168:169], v221 offset:6400
    ds_read_b64_tr_b16 v[170:171], v221 offset:11008
    v_mul_f32 v226, v44, v60
    v_mfma_f32_16x16x32_bf16 v[104:107], v[180:183], a[24:27], v[104:107]
    s_barrier
    ds_read_b64_tr_b16 v[172:173], v221 offset:15616
    ds_read_b64_tr_b16 v[174:175], v221 offset:20224
    v_mfma_f32_16x16x32_bf16 v[108:111], v[176:179], a[20:23], v[108:111]
    s_add_u32 s100, s54, 177152
    s_add_u32 m0, s42, 36864
    s_add_u32 s93, s52, 73728
    v_mfma_f32_16x16x32_bf16 v[108:111], v[180:183], a[28:31], v[108:111]
    s_waitcnt lgkmcnt(10)
    buffer_load_dwordx4 a[92:95], v209, s[20:23], s100 offen sc1
    v_add_f32 v222, 1.0, v222
    v_mfma_f32_16x16x32_bf16 v[112:115], v[184:187], a[16:19], v[112:115]
    s_add_u32 s99, s54, 2048
    ds_read_b64_tr_b16 v[176:177], v220 offset:16384
    ds_read_b64_tr_b16 v[178:179], v220 offset:20992
    s_waitcnt lgkmcnt(10)
    v_mfma_f32_16x16x32_bf16 v[112:115], v[188:191], a[24:27], v[112:115]
    ds_read_b64_tr_b16 v[180:181], v220 offset:25600
    ds_read_b64_tr_b16 v[182:183], v220 offset:30208
    v_mul_f32 v223, v45, v45
    v_mfma_f32_16x16x32_bf16 v[116:119], v[184:187], a[20:23], v[116:119]
    v_rcp_f32 v222, v222
    v_mfma_f32_16x16x32_bf16 v[116:119], v[188:191], a[28:31], v[116:119]
    s_waitcnt lgkmcnt(10)
    buffer_load_dwordx4 v232, s[16:19], s93 offen lds
    v_mfma_f32_16x16x32_bf16 v[120:123], v[160:163], a[16:19], v[120:123]
    s_waitcnt lgkmcnt(8)
    ds_read_b64_tr_b16 v[184:185], v220 offset:16416
    ds_read_b64_tr_b16 v[186:187], v220 offset:21024
    v_mul_f32 v226, v226, v222
    v_mfma_f32_16x16x32_bf16 v[120:123], v[164:167], a[24:27], v[120:123]
    ds_read_b64_tr_b16 v[188:189], v220 offset:25632
    ds_read_b64_tr_b16 v[190:191], v220 offset:30240
    v_mfma_f32_16x16x32_bf16 v[124:127], v[160:163], a[20:23], v[124:127]
    v_fmaak_f32 v223, v223, v208, 0xc0135761
    v_mul_f32 v223, v223, v45
    v_mul_f32 v227, v45, v61
    v_mfma_f32_16x16x32_bf16 v[124:127], v[164:167], a[28:31], v[124:127]
    s_waitcnt lgkmcnt(10)
    buffer_load_dwordx4 v233, s[16:19], s93 offen offset:1024 lds
    v_mfma_f32_16x16x32_bf16 v[128:131], v[168:171], a[16:19], v[128:131]
    s_waitcnt lgkmcnt(8)
    ds_read_b64_tr_b16 v[160:161], v220 offset:16448
    ds_read_b64_tr_b16 v[162:163], v220 offset:21056
    v_mul_f32 v224, v46, v46
    v_mfma_f32_16x16x32_bf16 v[128:131], v[172:175], a[24:27], v[128:131]
    ds_read_b64_tr_b16 v[164:165], v220 offset:25664
    ds_read_b64_tr_b16 v[166:167], v220 offset:30272
    v_mfma_f32_16x16x32_bf16 v[132:135], v[168:171], a[20:23], v[132:135]
    v_exp_f32 v223, v223
    v_mfma_f32_16x16x32_bf16 v[132:135], v[172:175], a[28:31], v[132:135]
    s_waitcnt vmcnt(34) lgkmcnt(10)
    buffer_load_dwordx4 v234, s[16:19], s93 offen offset:2048 lds
    v_add_f32 v223, 1.0, v223
    v_mfma_f32_16x16x32_bf16 v[64:67], v[176:179], a[32:35], v[64:67]
    s_waitcnt vmcnt(33) lgkmcnt(8)
    ds_read_b64_tr_b16 v[168:169], v220 offset:16480
    ds_read_b64_tr_b16 v[170:171], v220 offset:21088
    v_mfma_f32_16x16x32_bf16 v[64:67], v[180:183], a[40:43], v[64:67]
    ds_read_b64_tr_b16 v[172:173], v220 offset:25696
    ds_read_b64_tr_b16 v[174:175], v220 offset:30304
    v_fmaak_f32 v224, v224, v208, 0xc0135761
    v_mfma_f32_16x16x32_bf16 v[68:71], v[176:179], a[36:39], v[68:71]
    s_waitcnt vmcnt(30)
    v_rcp_f32 v223, v223
    v_mfma_f32_16x16x32_bf16 v[68:71], v[180:183], a[44:47], v[68:71]
    s_waitcnt lgkmcnt(10)
    buffer_load_dwordx4 v235, s[16:19], s93 offen offset:3072 lds
    v_mul_f32 v227, v227, v223
    v_mfma_f32_16x16x32_bf16 v[72:75], v[184:187], a[32:35], v[72:75]
    s_add_u32 m0, s42, 40960
    ds_read_b64_tr_b16 v[176:177], v220 offset:16512
    ds_read_b64_tr_b16 v[178:179], v220 offset:21120
    s_waitcnt lgkmcnt(10)
    v_mfma_f32_16x16x32_bf16 v[72:75], v[188:191], a[40:43], v[72:75]
    ds_read_b64_tr_b16 v[180:181], v220 offset:25728
    ds_read_b64_tr_b16 v[182:183], v220 offset:30336
    v_mfma_f32_16x16x32_bf16 v[76:79], v[184:187], a[36:39], v[76:79]
    v_mul_f32 v224, v224, v46
    v_exp_f32 v224, v224
    v_mfma_f32_16x16x32_bf16 v[76:79], v[188:191], a[44:47], v[76:79]
    s_waitcnt lgkmcnt(10)
    buffer_load_dwordx4 v236, s[16:19], s93 offen lds
    v_mfma_f32_16x16x32_bf16 v[80:83], v[160:163], a[32:35], v[80:83]
    s_waitcnt lgkmcnt(8)
    ds_read_b64_tr_b16 v[184:185], v220 offset:16544
    ds_read_b64_tr_b16 v[186:187], v220 offset:21152
    v_mul_f32 v228, v46, v62
    v_mfma_f32_16x16x32_bf16 v[80:83], v[164:167], a[40:43], v[80:83]
    ds_read_b64_tr_b16 v[188:189], v220 offset:25760
    ds_read_b64_tr_b16 v[190:191], v220 offset:30368
    v_mfma_f32_16x16x32_bf16 v[84:87], v[160:163], a[36:39], v[84:87]
    v_add_f32 v224, 1.0, v224
    v_rcp_f32 v224, v224
    v_mfma_f32_16x16x32_bf16 v[84:87], v[164:167], a[44:47], v[84:87]
    s_waitcnt lgkmcnt(10)
    buffer_load_dwordx4 v237, s[16:19], s93 offen offset:1024 lds
    v_mfma_f32_16x16x32_bf16 v[88:91], v[168:171], a[32:35], v[88:91]
    s_waitcnt lgkmcnt(8)
    ds_read_b64_tr_b16 v[160:161], v220 offset:16576
    ds_read_b64_tr_b16 v[162:163], v220 offset:21184
    v_mul_f32 v228, v228, v224
    v_mfma_f32_16x16x32_bf16 v[88:91], v[172:175], a[40:43], v[88:91]
    ds_read_b64_tr_b16 v[164:165], v220 offset:25792
    ds_read_b64_tr_b16 v[166:167], v220 offset:30400
    v_mfma_f32_16x16x32_bf16 v[92:95], v[168:171], a[36:39], v[92:95]
    v_mul_f32 v225, v47, v47
    v_fmaak_f32 v225, v225, v208, 0xc0135761
    v_mul_f32 v225, v225, v47
    v_mfma_f32_16x16x32_bf16 v[92:95], v[172:175], a[44:47], v[92:95]
    s_waitcnt lgkmcnt(10)
    buffer_load_dwordx4 v238, s[16:19], s93 offen offset:2048 lds
    v_mfma_f32_16x16x32_bf16 v[96:99], v[176:179], a[32:35], v[96:99]
    s_waitcnt lgkmcnt(8)
    ds_read_b64_tr_b16 v[168:169], v220 offset:16608
    ds_read_b64_tr_b16 v[170:171], v220 offset:21216
    v_mfma_f32_16x16x32_bf16 v[96:99], v[180:183], a[40:43], v[96:99]
    ds_read_b64_tr_b16 v[172:173], v220 offset:25824
    ds_read_b64_tr_b16 v[174:175], v220 offset:30432
    v_mul_f32 v229, v47, v63
    v_mfma_f32_16x16x32_bf16 v[100:103], v[176:179], a[36:39], v[100:103]
    v_exp_f32 v225, v225
    v_mfma_f32_16x16x32_bf16 v[100:103], v[180:183], a[44:47], v[100:103]
    s_waitcnt lgkmcnt(10)
    buffer_load_dwordx4 v239, s[16:19], s93 offen offset:3072 lds
    v_add_f32 v225, 1.0, v225
    v_mfma_f32_16x16x32_bf16 v[104:107], v[184:187], a[32:35], v[104:107]
    s_add_u32 m0, s42, 45056
    ds_read_b64_tr_b16 v[176:177], v220 offset:16640
    ds_read_b64_tr_b16 v[178:179], v220 offset:21248
    s_waitcnt lgkmcnt(10)
    v_mfma_f32_16x16x32_bf16 v[104:107], v[188:191], a[40:43], v[104:107]
    ds_read_b64_tr_b16 v[180:181], v220 offset:25856
    ds_read_b64_tr_b16 v[182:183], v220 offset:30464
    v_cvt_pk_bf16_f32 v206, v226, v227
    v_mfma_f32_16x16x32_bf16 v[108:111], v[184:187], a[36:39], v[108:111]
    v_rcp_f32 v225, v225
    v_mfma_f32_16x16x32_bf16 v[108:111], v[188:191], a[44:47], v[108:111]
    s_waitcnt lgkmcnt(10)
    buffer_load_dwordx4 v240, s[16:19], s93 offen lds
    v_mfma_f32_16x16x32_bf16 v[112:115], v[160:163], a[32:35], v[112:115]
    s_waitcnt lgkmcnt(8)
    ds_read_b64_tr_b16 v[184:185], v220 offset:34816
    ds_read_b64_tr_b16 v[186:187], v220 offset:39424
    v_mul_f32 v229, v229, v225
    v_mfma_f32_16x16x32_bf16 v[112:115], v[164:167], a[40:43], v[112:115]
    ds_read_b64_tr_b16 v[188:189], v220 offset:44032
    ds_read_b64_tr_b16 v[190:191], v220 offset:48640
    v_cvt_pk_bf16_f32 v207, v228, v229
    v_mfma_f32_16x16x32_bf16 v[116:119], v[160:163], a[36:39], v[116:119]
    v_mfma_f32_16x16x32_bf16 v[116:119], v[164:167], a[44:47], v[116:119]
    s_waitcnt lgkmcnt(10)
    buffer_store_dwordx4 v[204:207], v209, s[20:23], s98 offen sc1
    v_mfma_f32_16x16x32_bf16 v[120:123], v[168:171], a[32:35], v[120:123]
    s_waitcnt lgkmcnt(8)
    ds_read_b64_tr_b16 v[160:161], v220 offset:34848
    ds_read_b64_tr_b16 v[162:163], v220 offset:39456
    v_mfma_f32_16x16x32_bf16 v[120:123], v[172:175], a[40:43], v[120:123]
    ds_read_b64_tr_b16 v[164:165], v220 offset:44064
    ds_read_b64_tr_b16 v[166:167], v220 offset:48672
    v_mfma_f32_16x16x32_bf16 v[124:127], v[168:171], a[36:39], v[124:127]
    v_mfma_f32_16x16x32_bf16 v[124:127], v[172:175], a[44:47], v[124:127]
    s_waitcnt lgkmcnt(10)
    buffer_load_dwordx4 a[96:99], v209, s[20:23], s99 offen sc1
    v_mfma_f32_16x16x32_bf16 v[128:131], v[176:179], a[32:35], v[128:131]
    s_add_u32 s100, s54, 149504
    ds_read_b64_tr_b16 v[168:169], v220 offset:34880
    ds_read_b64_tr_b16 v[170:171], v220 offset:39488
    s_waitcnt lgkmcnt(10)
    v_mfma_f32_16x16x32_bf16 v[128:131], v[180:183], a[40:43], v[128:131]
    ds_read_b64_tr_b16 v[172:173], v220 offset:44096
    ds_read_b64_tr_b16 v[174:175], v220 offset:48704
    v_mfma_f32_16x16x32_bf16 v[132:135], v[176:179], a[36:39], v[132:135]
    v_mfma_f32_16x16x32_bf16 v[132:135], v[180:183], a[44:47], v[132:135]
    s_waitcnt vmcnt(37) lgkmcnt(10)
    buffer_load_dwordx4 a[100:103], v209, s[20:23], s100 offen sc1
    v_mfma_f32_16x16x32_bf16 v[64:67], v[184:187], a[48:51], v[64:67]
    s_add_u32 s99, s54, 3072
    ds_read_b64_tr_b16 v[176:177], v220 offset:34912
    ds_read_b64_tr_b16 v[178:179], v220 offset:39520
    s_waitcnt vmcnt(36) lgkmcnt(10)
    v_mfma_f32_16x16x32_bf16 v[64:67], v[188:191], a[56:59], v[64:67]
    ds_read_b64_tr_b16 v[180:181], v220 offset:44128
    ds_read_b64_tr_b16 v[182:183], v220 offset:48736
    v_mfma_f32_16x16x32_bf16 v[68:71], v[184:187], a[52:55], v[68:71]
    s_waitcnt vmcnt(33)
    v_mfma_f32_16x16x32_bf16 v[68:71], v[188:191], a[60:63], v[68:71]
    s_waitcnt lgkmcnt(10)
    buffer_load_dwordx4 a[104:107], v209, s[20:23], s99 offen sc1
    v_mfma_f32_16x16x32_bf16 v[72:75], v[160:163], a[48:51], v[72:75]
    s_add_u32 s100, s54, 150528
    ds_read_b64_tr_b16 v[184:185], v220 offset:34944
    ds_read_b64_tr_b16 v[186:187], v220 offset:39552
    s_waitcnt lgkmcnt(10)
    v_mfma_f32_16x16x32_bf16 v[72:75], v[164:167], a[56:59], v[72:75]
    ds_read_b64_tr_b16 v[188:189], v220 offset:44160
    ds_read_b64_tr_b16 v[190:191], v220 offset:48768
    v_mfma_f32_16x16x32_bf16 v[76:79], v[160:163], a[52:55], v[76:79]
    v_mfma_f32_16x16x32_bf16 v[76:79], v[164:167], a[60:63], v[76:79]
    s_waitcnt lgkmcnt(10)
    buffer_load_dwordx4 a[108:111], v209, s[20:23], s100 offen sc1
    v_mfma_f32_16x16x32_bf16 v[80:83], v[168:171], a[48:51], v[80:83]
    s_add_u32 s99, s54, 12288
    ds_read_b64_tr_b16 v[160:161], v220 offset:34976
    ds_read_b64_tr_b16 v[162:163], v220 offset:39584
    s_waitcnt lgkmcnt(10)
    v_mfma_f32_16x16x32_bf16 v[80:83], v[172:175], a[56:59], v[80:83]
    ds_read_b64_tr_b16 v[164:165], v220 offset:44192
    ds_read_b64_tr_b16 v[166:167], v220 offset:48800
    v_mfma_f32_16x16x32_bf16 v[84:87], v[168:171], a[52:55], v[84:87]
    v_mfma_f32_16x16x32_bf16 v[84:87], v[172:175], a[60:63], v[84:87]
    s_waitcnt lgkmcnt(10)
    buffer_load_dwordx4 a[112:115], v209, s[20:23], s99 offen sc1
    v_mfma_f32_16x16x32_bf16 v[88:91], v[176:179], a[48:51], v[88:91]
    s_add_u32 s100, s54, 159744
    ds_read_b64_tr_b16 v[168:169], v220 offset:35008
    ds_read_b64_tr_b16 v[170:171], v220 offset:39616
    s_waitcnt lgkmcnt(10)
    v_mfma_f32_16x16x32_bf16 v[88:91], v[180:183], a[56:59], v[88:91]
    ds_read_b64_tr_b16 v[172:173], v220 offset:44224
    ds_read_b64_tr_b16 v[174:175], v220 offset:48832
    v_mfma_f32_16x16x32_bf16 v[92:95], v[176:179], a[52:55], v[92:95]
    v_mfma_f32_16x16x32_bf16 v[92:95], v[180:183], a[60:63], v[92:95]
    s_waitcnt lgkmcnt(10)
    buffer_load_dwordx4 a[116:119], v209, s[20:23], s100 offen sc1
    v_mfma_f32_16x16x32_bf16 v[96:99], v[184:187], a[48:51], v[96:99]
    s_add_u32 s99, s54, 13312
    ds_read_b64_tr_b16 v[176:177], v220 offset:35040
    ds_read_b64_tr_b16 v[178:179], v220 offset:39648
    s_waitcnt lgkmcnt(10)
    v_mfma_f32_16x16x32_bf16 v[96:99], v[188:191], a[56:59], v[96:99]
    ds_read_b64_tr_b16 v[180:181], v220 offset:44256
    ds_read_b64_tr_b16 v[182:183], v220 offset:48864
    v_mfma_f32_16x16x32_bf16 v[100:103], v[184:187], a[52:55], v[100:103]
    v_mfma_f32_16x16x32_bf16 v[100:103], v[188:191], a[60:63], v[100:103]
    s_waitcnt lgkmcnt(10)
    buffer_load_dwordx4 a[120:123], v209, s[20:23], s99 offen sc1
    v_mfma_f32_16x16x32_bf16 v[104:107], v[160:163], a[48:51], v[104:107]
    s_waitcnt vmcnt(7)
    ds_read_b64_tr_b16 v[184:185], v220 offset:35072
    ds_read_b64_tr_b16 v[186:187], v220 offset:39680
    s_waitcnt lgkmcnt(10)
    v_mfma_f32_16x16x32_bf16 v[104:107], v[164:167], a[56:59], v[104:107]
    s_barrier
    ds_read_b64_tr_b16 v[188:189], v220 offset:44288
    ds_read_b64_tr_b16 v[190:191], v220 offset:48896
    v_mfma_f32_16x16x32_bf16 v[108:111], v[160:163], a[52:55], v[108:111]
    s_add_u32 s100, s54, 160768
    s_add_u32 s74, s55, 4
    v_mov_b32 v242, s74
    v_mfma_f32_16x16x32_bf16 v[108:111], v[164:167], a[60:63], v[108:111]
    s_waitcnt lgkmcnt(10)
    buffer_store_dword v242, v241, s[28:31], 0 offen
    v_mfma_f32_16x16x32_bf16 v[112:115], v[168:171], a[48:51], v[112:115]
    s_waitcnt lgkmcnt(8)
    ds_read_b64_tr_b16 v[160:161], v219 offset:0
    ds_read_b64_tr_b16 v[162:163], v219 offset:4608
    v_mfma_f32_16x16x32_bf16 v[112:115], v[172:175], a[56:59], v[112:115]
    ds_read_b64_tr_b16 v[164:165], v219 offset:9216
    ds_read_b64_tr_b16 v[166:167], v219 offset:13824
    v_mfma_f32_16x16x32_bf16 v[116:119], v[168:171], a[52:55], v[116:119]
    s_add_u32 m0, s42, 118784
    s_add_u32 s92, s52, 737280
    v_mfma_f32_16x16x32_bf16 v[116:119], v[172:175], a[60:63], v[116:119]
    s_waitcnt lgkmcnt(10)
    buffer_store_dword v242, v241, s[28:31], s90 offen sc1
    v_mfma_f32_16x16x32_bf16 v[120:123], v[176:179], a[48:51], v[120:123]
    s_waitcnt lgkmcnt(8)
    ds_read_b64_tr_b16 v[168:169], v219 offset:32
    ds_read_b64_tr_b16 v[170:171], v219 offset:4640
    v_mfma_f32_16x16x32_bf16 v[120:123], v[180:183], a[56:59], v[120:123]
    ds_read_b64_tr_b16 v[172:173], v219 offset:9248
    ds_read_b64_tr_b16 v[174:175], v219 offset:13856
    v_mfma_f32_16x16x32_bf16 v[124:127], v[176:179], a[52:55], v[124:127]
    v_mfma_f32_16x16x32_bf16 v[124:127], v[180:183], a[60:63], v[124:127]
    s_waitcnt lgkmcnt(10)
    buffer_load_dwordx4 a[124:127], v209, s[20:23], s100 offen sc1
    v_mfma_f32_16x16x32_bf16 v[128:131], v[184:187], a[48:51], v[128:131]
    s_add_u32 s99, s54, 20480
    ds_read_b64_tr_b16 v[176:177], v219 offset:64
    ds_read_b64_tr_b16 v[178:179], v219 offset:4672
    s_waitcnt lgkmcnt(10)
    v_mfma_f32_16x16x32_bf16 v[128:131], v[188:191], a[56:59], v[128:131]
    ds_read_b64_tr_b16 v[180:181], v219 offset:9280
    ds_read_b64_tr_b16 v[182:183], v219 offset:13888
    v_mfma_f32_16x16x32_bf16 v[132:135], v[184:187], a[52:55], v[132:135]
    v_mfma_f32_16x16x32_bf16 v[132:135], v[188:191], a[60:63], v[132:135]
    s_waitcnt lgkmcnt(10)
    buffer_load_dwordx4 v232, s[16:19], s92 offen lds
    v_mfma_f32_16x16x32_bf16 v[64:67], v[160:163], a[64:67], v[64:67]
    s_waitcnt lgkmcnt(8)
    ds_read_b64_tr_b16 v[184:185], v219 offset:96
    ds_read_b64_tr_b16 v[186:187], v219 offset:4704
    v_mfma_f32_16x16x32_bf16 v[64:67], v[164:167], a[72:75], v[64:67]
    s_barrier
    ds_read_b64_tr_b16 v[188:189], v219 offset:9312
    ds_read_b64_tr_b16 v[190:191], v219 offset:13920
    v_mfma_f32_16x16x32_bf16 v[68:71], v[160:163], a[68:71], v[68:71]
    v_mfma_f32_16x16x32_bf16 v[68:71], v[164:167], a[76:79], v[68:71]
    s_waitcnt lgkmcnt(10)
    buffer_load_dword v244, v243, s[28:31], 0 offen sc1
    v_mfma_f32_16x16x32_bf16 v[72:75], v[168:171], a[64:67], v[72:75]
    s_waitcnt lgkmcnt(8)
    ds_read_b64_tr_b16 v[160:161], v219 offset:128
    ds_read_b64_tr_b16 v[162:163], v219 offset:4736
    v_mfma_f32_16x16x32_bf16 v[72:75], v[172:175], a[72:75], v[72:75]
    ds_read_b64_tr_b16 v[164:165], v219 offset:9344
    ds_read_b64_tr_b16 v[166:167], v219 offset:13952
    v_mfma_f32_16x16x32_bf16 v[76:79], v[168:171], a[68:71], v[76:79]
    v_mfma_f32_16x16x32_bf16 v[76:79], v[172:175], a[76:79], v[76:79]
    s_waitcnt lgkmcnt(10)
    buffer_load_dwordx4 v233, s[16:19], s92 offen offset:1024 lds
    v_mfma_f32_16x16x32_bf16 v[80:83], v[176:179], a[64:67], v[80:83]
    s_waitcnt lgkmcnt(8)
    ds_read_b64_tr_b16 v[168:169], v219 offset:160
    ds_read_b64_tr_b16 v[170:171], v219 offset:4768
    v_mfma_f32_16x16x32_bf16 v[80:83], v[180:183], a[72:75], v[80:83]
    ds_read_b64_tr_b16 v[172:173], v219 offset:9376
    ds_read_b64_tr_b16 v[174:175], v219 offset:13984
    v_mfma_f32_16x16x32_bf16 v[84:87], v[176:179], a[68:71], v[84:87]
    v_mfma_f32_16x16x32_bf16 v[84:87], v[180:183], a[76:79], v[84:87]
    s_waitcnt lgkmcnt(10)
    buffer_load_dwordx4 v234, s[16:19], s92 offen offset:2048 lds
    v_mfma_f32_16x16x32_bf16 v[88:91], v[184:187], a[64:67], v[88:91]
    s_waitcnt lgkmcnt(8)
    ds_read_b64_tr_b16 v[176:177], v219 offset:192
    ds_read_b64_tr_b16 v[178:179], v219 offset:4800
    v_mfma_f32_16x16x32_bf16 v[88:91], v[188:191], a[72:75], v[88:91]
    ds_read_b64_tr_b16 v[180:181], v219 offset:9408
    ds_read_b64_tr_b16 v[182:183], v219 offset:14016
    v_mfma_f32_16x16x32_bf16 v[92:95], v[184:187], a[68:71], v[92:95]
    v_mfma_f32_16x16x32_bf16 v[92:95], v[188:191], a[76:79], v[92:95]
    s_waitcnt lgkmcnt(10)
    buffer_load_dwordx4 v235, s[16:19], s92 offen offset:3072 lds
    v_mfma_f32_16x16x32_bf16 v[96:99], v[160:163], a[64:67], v[96:99]
    s_add_u32 m0, s42, 122880
    ds_read_b64_tr_b16 v[184:185], v219 offset:224
    ds_read_b64_tr_b16 v[186:187], v219 offset:4832
    s_waitcnt lgkmcnt(10)
    v_mfma_f32_16x16x32_bf16 v[96:99], v[164:167], a[72:75], v[96:99]
    ds_read_b64_tr_b16 v[188:189], v219 offset:9440
    ds_read_b64_tr_b16 v[190:191], v219 offset:14048
    v_mfma_f32_16x16x32_bf16 v[100:103], v[160:163], a[68:71], v[100:103]
    v_mfma_f32_16x16x32_bf16 v[100:103], v[164:167], a[76:79], v[100:103]
    s_waitcnt lgkmcnt(10)
    buffer_load_dwordx4 v236, s[16:19], s92 offen lds
    v_mfma_f32_16x16x32_bf16 v[104:107], v[168:171], a[64:67], v[104:107]
    s_waitcnt lgkmcnt(8)
    ds_read_b64_tr_b16 v[160:161], v219 offset:256
    ds_read_b64_tr_b16 v[162:163], v219 offset:4864
    v_mfma_f32_16x16x32_bf16 v[104:107], v[172:175], a[72:75], v[104:107]
    ds_read_b64_tr_b16 v[164:165], v219 offset:9472
    ds_read_b64_tr_b16 v[166:167], v219 offset:14080
    v_mfma_f32_16x16x32_bf16 v[108:111], v[168:171], a[68:71], v[108:111]
    v_mfma_f32_16x16x32_bf16 v[108:111], v[172:175], a[76:79], v[108:111]
    s_waitcnt lgkmcnt(10)
    buffer_load_dwordx4 v237, s[16:19], s92 offen offset:1024 lds
    v_mfma_f32_16x16x32_bf16 v[112:115], v[176:179], a[64:67], v[112:115]
    s_waitcnt lgkmcnt(8)
    ds_read_b64_tr_b16 v[168:169], v219 offset:18432
    ds_read_b64_tr_b16 v[170:171], v219 offset:23040
    v_mfma_f32_16x16x32_bf16 v[112:115], v[180:183], a[72:75], v[112:115]
    ds_read_b64_tr_b16 v[172:173], v219 offset:27648
    ds_read_b64_tr_b16 v[174:175], v219 offset:32256
    v_mfma_f32_16x16x32_bf16 v[116:119], v[176:179], a[68:71], v[116:119]
    v_mfma_f32_16x16x32_bf16 v[116:119], v[180:183], a[76:79], v[116:119]
    s_waitcnt lgkmcnt(10)
    buffer_load_dwordx4 v238, s[16:19], s92 offen offset:2048 lds
    v_mfma_f32_16x16x32_bf16 v[120:123], v[184:187], a[64:67], v[120:123]
    s_waitcnt lgkmcnt(8)
    ds_read_b64_tr_b16 v[176:177], v219 offset:18464
    ds_read_b64_tr_b16 v[178:179], v219 offset:23072
    v_mfma_f32_16x16x32_bf16 v[120:123], v[188:191], a[72:75], v[120:123]
    ds_read_b64_tr_b16 v[180:181], v219 offset:27680
    ds_read_b64_tr_b16 v[182:183], v219 offset:32288
    v_mfma_f32_16x16x32_bf16 v[124:127], v[184:187], a[68:71], v[124:127]
    v_mfma_f32_16x16x32_bf16 v[124:127], v[188:191], a[76:79], v[124:127]
    s_waitcnt lgkmcnt(10)
    buffer_load_dwordx4 v239, s[16:19], s92 offen offset:3072 lds
    v_mfma_f32_16x16x32_bf16 v[128:131], v[160:163], a[64:67], v[128:131]
    s_add_u32 m0, s42, 126976
    ds_read_b64_tr_b16 v[184:185], v219 offset:18496
    ds_read_b64_tr_b16 v[186:187], v219 offset:23104
    s_waitcnt lgkmcnt(10)
    v_mfma_f32_16x16x32_bf16 v[128:131], v[164:167], a[72:75], v[128:131]
    ds_read_b64_tr_b16 v[188:189], v219 offset:27712
    ds_read_b64_tr_b16 v[190:191], v219 offset:32320
    v_mfma_f32_16x16x32_bf16 v[132:135], v[160:163], a[68:71], v[132:135]
    v_mfma_f32_16x16x32_bf16 v[132:135], v[164:167], a[76:79], v[132:135]
    s_waitcnt lgkmcnt(10)
    buffer_load_dwordx4 v240, s[16:19], s92 offen lds
    v_mfma_f32_16x16x32_bf16 v[64:67], v[168:171], a[80:83], v[64:67]
    s_and_b32 s74, s37, 7
    s_xor_b32 s74, s74, 0
    s_or_b32 s74, s74, s39
    s_xor_b32 s75, s36, 0
    s_or_b32 s74, s74, s75
    s_cmp_eq_u32 s74, 0
    s_cbranch_scc0 L_backwb0
    buffer_wbl2 sc1
L_backwb0:
    s_waitcnt lgkmcnt(8)
    v_mfma_f32_16x16x32_bf16 v[64:67], v[172:175], a[88:91], v[64:67]
    ds_read_b64_tr_b16 v[160:161], v219 offset:18528
    ds_read_b64_tr_b16 v[162:163], v219 offset:23136
    v_mfma_f32_16x16x32_bf16 v[68:71], v[168:171], a[84:87], v[68:71]
    ds_read_b64_tr_b16 v[164:165], v219 offset:27744
    ds_read_b64_tr_b16 v[166:167], v219 offset:32352
    v_mfma_f32_16x16x32_bf16 v[68:71], v[172:175], a[92:95], v[68:71]
    s_waitcnt lgkmcnt(10)
    buffer_load_dwordx4 a[128:131], v209, s[20:23], s99 offen sc1
    v_mfma_f32_16x16x32_bf16 v[72:75], v[176:179], a[80:83], v[72:75]
    s_add_u32 s100, s54, 167936
    ds_read_b64_tr_b16 v[168:169], v219 offset:18560
    ds_read_b64_tr_b16 v[170:171], v219 offset:23168
    s_waitcnt lgkmcnt(10)
    v_mfma_f32_16x16x32_bf16 v[72:75], v[180:183], a[88:91], v[72:75]
    s_add_u32 s69, s55, 4
    s_waitcnt vmcnt(9)
    v_subrev_u32 v245, s69, v244
    v_cmp_le_u32 vcc, 8, v245
    s_nop 1
    s_cbranch_vccnz L_spin2
L_back2:
    v_mfma_f32_16x16x32_bf16 v[76:79], v[176:179], a[84:87], v[76:79]
    ds_read_b64_tr_b16 v[172:173], v219 offset:27776
    ds_read_b64_tr_b16 v[174:175], v219 offset:32384
    v_mfma_f32_16x16x32_bf16 v[76:79], v[180:183], a[92:95], v[76:79]
    s_waitcnt lgkmcnt(10)
    buffer_load_dwordx4 a[132:135], v209, s[20:23], s100 offen sc1
    v_mfma_f32_16x16x32_bf16 v[80:83], v[184:187], a[80:83], v[80:83]
    s_add_u32 s99, s54, 21504
    ds_read_b64_tr_b16 v[176:177], v219 offset:18592
    ds_read_b64_tr_b16 v[178:179], v219 offset:23200
    s_waitcnt lgkmcnt(10)
    v_mfma_f32_16x16x32_bf16 v[80:83], v[188:191], a[88:91], v[80:83]
    ds_read_b64_tr_b16 v[180:181], v219 offset:27808
    ds_read_b64_tr_b16 v[182:183], v219 offset:32416
    v_mfma_f32_16x16x32_bf16 v[84:87], v[184:187], a[84:87], v[84:87]
    s_add_u32 m0, s42, 81920
    s_add_u32 s93, s52, 147456
    v_mfma_f32_16x16x32_bf16 v[84:87], v[188:191], a[92:95], v[84:87]
    s_waitcnt lgkmcnt(10)
    buffer_load_dwordx4 a[136:139], v209, s[20:23], s99 offen sc1
    v_mfma_f32_16x16x32_bf16 v[88:91], v[160:163], a[80:83], v[88:91]
    s_add_u32 s100, s54, 168960
    ds_read_b64_tr_b16 v[184:185], v219 offset:18624
    ds_read_b64_tr_b16 v[186:187], v219 offset:23232
    s_waitcnt lgkmcnt(10)
    v_mfma_f32_16x16x32_bf16 v[88:91], v[164:167], a[88:91], v[88:91]
    ds_read_b64_tr_b16 v[188:189], v219 offset:27840
    ds_read_b64_tr_b16 v[190:191], v219 offset:32448
    v_mfma_f32_16x16x32_bf16 v[92:95], v[160:163], a[84:87], v[92:95]
    v_mfma_f32_16x16x32_bf16 v[92:95], v[164:167], a[92:95], v[92:95]
    s_waitcnt lgkmcnt(10)
    buffer_load_dwordx4 a[140:143], v209, s[20:23], s100 offen sc1
    v_mfma_f32_16x16x32_bf16 v[96:99], v[168:171], a[80:83], v[96:99]
    s_add_u32 s99, s54, 30720
    ds_read_b64_tr_b16 v[160:161], v219 offset:18656
    ds_read_b64_tr_b16 v[162:163], v219 offset:23264
    s_waitcnt lgkmcnt(10)
    v_mfma_f32_16x16x32_bf16 v[96:99], v[172:175], a[88:91], v[96:99]
    ds_read_b64_tr_b16 v[164:165], v219 offset:27872
    ds_read_b64_tr_b16 v[166:167], v219 offset:32480
    v_mfma_f32_16x16x32_bf16 v[100:103], v[168:171], a[84:87], v[100:103]
    v_mfma_f32_16x16x32_bf16 v[100:103], v[172:175], a[92:95], v[100:103]
    s_waitcnt lgkmcnt(10)
    buffer_load_dwordx4 a[144:147], v209, s[20:23], s99 offen sc1
    v_mfma_f32_16x16x32_bf16 v[104:107], v[176:179], a[80:83], v[104:107]
    s_waitcnt lgkmcnt(8)
    ds_read_b64_tr_b16 v[168:169], v219 offset:18688
    ds_read_b64_tr_b16 v[170:171], v219 offset:23296
    v_mfma_f32_16x16x32_bf16 v[104:107], v[180:183], a[88:91], v[104:107]
    s_barrier
    ds_read_b64_tr_b16 v[172:173], v219 offset:27904
    ds_read_b64_tr_b16 v[174:175], v219 offset:32512
    v_mfma_f32_16x16x32_bf16 v[108:111], v[176:179], a[84:87], v[108:111]
    s_add_u32 s100, s54, 178176
    v_mfma_f32_16x16x32_bf16 v[108:111], v[180:183], a[92:95], v[108:111]
    s_waitcnt lgkmcnt(10)
    buffer_load_dwordx4 a[148:151], v209, s[20:23], s100 offen sc1
    v_mfma_f32_16x16x32_bf16 v[112:115], v[184:187], a[80:83], v[112:115]
    s_add_u32 s99, s54, 31744
    ds_read_b64_tr_b16 v[176:177], v219 offset:36864
    ds_read_b64_tr_b16 v[178:179], v219 offset:41472
    s_waitcnt lgkmcnt(10)
    v_mfma_f32_16x16x32_bf16 v[112:115], v[188:191], a[88:91], v[112:115]
    ds_read_b64_tr_b16 v[180:181], v219 offset:46080
    ds_read_b64_tr_b16 v[182:183], v219 offset:50688
    v_mfma_f32_16x16x32_bf16 v[116:119], v[184:187], a[84:87], v[116:119]
    v_mfma_f32_16x16x32_bf16 v[116:119], v[188:191], a[92:95], v[116:119]
    s_waitcnt lgkmcnt(10)
    buffer_load_dwordx4 a[152:155], v209, s[20:23], s99 offen sc1
    v_mfma_f32_16x16x32_bf16 v[120:123], v[160:163], a[80:83], v[120:123]
    s_add_u32 s100, s54, 179200
    ds_read_b64_tr_b16 v[184:185], v219 offset:36896
    ds_read_b64_tr_b16 v[186:187], v219 offset:41504
    s_waitcnt lgkmcnt(10)
    v_mfma_f32_16x16x32_bf16 v[120:123], v[164:167], a[88:91], v[120:123]
    ds_read_b64_tr_b16 v[188:189], v219 offset:46112
    ds_read_b64_tr_b16 v[190:191], v219 offset:50720
    v_mfma_f32_16x16x32_bf16 v[124:127], v[160:163], a[84:87], v[124:127]
    v_mfma_f32_16x16x32_bf16 v[124:127], v[164:167], a[92:95], v[124:127]
    s_waitcnt lgkmcnt(10)
    buffer_load_dwordx4 a[156:159], v209, s[20:23], s100 offen sc1
    v_mfma_f32_16x16x32_bf16 v[128:131], v[168:171], a[80:83], v[128:131]
    s_add_u32 s99, s54, 4096
    ds_read_b64_tr_b16 v[160:161], v219 offset:36928
    ds_read_b64_tr_b16 v[162:163], v219 offset:41536
    s_waitcnt lgkmcnt(10)
    v_mfma_f32_16x16x32_bf16 v[128:131], v[172:175], a[88:91], v[128:131]
    ds_read_b64_tr_b16 v[164:165], v219 offset:46144
    ds_read_b64_tr_b16 v[166:167], v219 offset:50752
    v_mfma_f32_16x16x32_bf16 v[132:135], v[168:171], a[84:87], v[132:135]
    v_mfma_f32_16x16x32_bf16 v[132:135], v[172:175], a[92:95], v[132:135]
    s_waitcnt lgkmcnt(10)
    buffer_load_dwordx4 v232, s[16:19], s93 offen lds
    v_mfma_f32_16x16x32_bf16 v[64:67], v[176:179], a[96:99], v[64:67]
    s_waitcnt lgkmcnt(8)
    ds_read_b64_tr_b16 v[168:169], v219 offset:36960
    ds_read_b64_tr_b16 v[170:171], v219 offset:41568
    v_mfma_f32_16x16x32_bf16 v[64:67], v[180:183], a[104:107], v[64:67]
    s_barrier
    ds_read_b64_tr_b16 v[172:173], v219 offset:46176
    ds_read_b64_tr_b16 v[174:175], v219 offset:50784
    v_mfma_f32_16x16x32_bf16 v[68:71], v[176:179], a[100:103], v[68:71]
    v_mfma_f32_16x16x32_bf16 v[68:71], v[180:183], a[108:111], v[68:71]
    s_waitcnt lgkmcnt(10)
    buffer_load_dwordx4 v233, s[16:19], s93 offen offset:1024 lds
    v_mfma_f32_16x16x32_bf16 v[72:75], v[184:187], a[96:99], v[72:75]
    s_waitcnt lgkmcnt(8)
    ds_read_b64_tr_b16 v[176:177], v219 offset:36992
    ds_read_b64_tr_b16 v[178:179], v219 offset:41600
    v_mfma_f32_16x16x32_bf16 v[72:75], v[188:191], a[104:107], v[72:75]
    ds_read_b64_tr_b16 v[180:181], v219 offset:46208
    ds_read_b64_tr_b16 v[182:183], v219 offset:50816
    v_mfma_f32_16x16x32_bf16 v[76:79], v[184:187], a[100:103], v[76:79]
    v_mfma_f32_16x16x32_bf16 v[76:79], v[188:191], a[108:111], v[76:79]
    s_waitcnt lgkmcnt(10)
    buffer_load_dwordx4 v234, s[16:19], s93 offen offset:2048 lds
    v_mfma_f32_16x16x32_bf16 v[80:83], v[160:163], a[96:99], v[80:83]
    s_waitcnt lgkmcnt(8)
    ds_read_b64_tr_b16 v[184:185], v219 offset:37024
    ds_read_b64_tr_b16 v[186:187], v219 offset:41632
    v_mfma_f32_16x16x32_bf16 v[80:83], v[164:167], a[104:107], v[80:83]
    ds_read_b64_tr_b16 v[188:189], v219 offset:46240
    ds_read_b64_tr_b16 v[190:191], v219 offset:50848
    v_mfma_f32_16x16x32_bf16 v[84:87], v[160:163], a[100:103], v[84:87]
    v_mfma_f32_16x16x32_bf16 v[84:87], v[164:167], a[108:111], v[84:87]
    s_waitcnt lgkmcnt(10)
    buffer_load_dwordx4 v235, s[16:19], s93 offen offset:3072 lds
    v_mfma_f32_16x16x32_bf16 v[88:91], v[168:171], a[96:99], v[88:91]
    s_add_u32 m0, s42, 86016
    ds_read_b64_tr_b16 v[160:161], v219 offset:37056
    ds_read_b64_tr_b16 v[162:163], v219 offset:41664
    s_waitcnt lgkmcnt(10)
    v_mfma_f32_16x16x32_bf16 v[88:91], v[172:175], a[104:107], v[88:91]
    ds_read_b64_tr_b16 v[164:165], v219 offset:46272
    ds_read_b64_tr_b16 v[166:167], v219 offset:50880
    v_mfma_f32_16x16x32_bf16 v[92:95], v[168:171], a[100:103], v[92:95]
    v_mfma_f32_16x16x32_bf16 v[92:95], v[172:175], a[108:111], v[92:95]
    s_waitcnt lgkmcnt(10)
    buffer_load_dwordx4 v236, s[16:19], s93 offen lds
    v_mfma_f32_16x16x32_bf16 v[96:99], v[176:179], a[96:99], v[96:99]
    s_waitcnt lgkmcnt(8)
    ds_read_b64_tr_b16 v[168:169], v219 offset:37088
    ds_read_b64_tr_b16 v[170:171], v219 offset:41696
    v_mfma_f32_16x16x32_bf16 v[96:99], v[180:183], a[104:107], v[96:99]
    ds_read_b64_tr_b16 v[172:173], v219 offset:46304
    ds_read_b64_tr_b16 v[174:175], v219 offset:50912
    v_mfma_f32_16x16x32_bf16 v[100:103], v[176:179], a[100:103], v[100:103]
    v_mfma_f32_16x16x32_bf16 v[100:103], v[180:183], a[108:111], v[100:103]
    s_waitcnt lgkmcnt(10)
    buffer_load_dwordx4 v237, s[16:19], s93 offen offset:1024 lds
    v_mfma_f32_16x16x32_bf16 v[104:107], v[184:187], a[96:99], v[104:107]
    s_waitcnt lgkmcnt(8)
    ds_read_b64_tr_b16 v[176:177], v219 offset:37120
    ds_read_b64_tr_b16 v[178:179], v219 offset:41728
    v_mfma_f32_16x16x32_bf16 v[104:107], v[188:191], a[104:107], v[104:107]
    ds_read_b64_tr_b16 v[180:181], v219 offset:46336
    ds_read_b64_tr_b16 v[182:183], v219 offset:50944
    v_mfma_f32_16x16x32_bf16 v[108:111], v[184:187], a[100:103], v[108:111]
    v_mfma_f32_16x16x32_bf16 v[108:111], v[188:191], a[108:111], v[108:111]
    s_waitcnt lgkmcnt(10)
    buffer_load_dwordx4 v238, s[16:19], s93 offen offset:2048 lds
    v_mfma_f32_16x16x32_bf16 v[112:115], v[160:163], a[96:99], v[112:115]
    s_waitcnt lgkmcnt(8)
    ds_read_b64_tr_b16 v[184:185], v219 offset:55296
    ds_read_b64_tr_b16 v[186:187], v219 offset:59904
    v_mfma_f32_16x16x32_bf16 v[112:115], v[164:167], a[104:107], v[112:115]
    ds_read_b64_tr_b16 v[188:189], v219 offset:64512
    ds_read_b64_tr_b16 v[190:191], v220 offset:3584
    v_mfma_f32_16x16x32_bf16 v[116:119], v[160:163], a[100:103], v[116:119]
    v_mfma_f32_16x16x32_bf16 v[116:119], v[164:167], a[108:111], v[116:119]
    s_waitcnt lgkmcnt(10)
    buffer_load_dwordx4 v239, s[16:19], s93 offen offset:3072 lds
    v_mfma_f32_16x16x32_bf16 v[120:123], v[168:171], a[96:99], v[120:123]
    s_add_u32 m0, s42, 90112
    ds_read_b64_tr_b16 v[160:161], v219 offset:55328
    ds_read_b64_tr_b16 v[162:163], v219 offset:59936
    s_waitcnt lgkmcnt(10)
    v_mfma_f32_16x16x32_bf16 v[120:123], v[172:175], a[104:107], v[120:123]
    ds_read_b64_tr_b16 v[164:165], v219 offset:64544
    ds_read_b64_tr_b16 v[166:167], v220 offset:3616
    v_mfma_f32_16x16x32_bf16 v[124:127], v[168:171], a[100:103], v[124:127]
    v_mfma_f32_16x16x32_bf16 v[124:127], v[172:175], a[108:111], v[124:127]
    s_waitcnt lgkmcnt(10)
    buffer_load_dwordx4 v240, s[16:19], s93 offen lds
    v_mfma_f32_16x16x32_bf16 v[128:131], v[176:179], a[96:99], v[128:131]
    s_waitcnt lgkmcnt(8)
    ds_read_b64_tr_b16 v[168:169], v219 offset:55360
    ds_read_b64_tr_b16 v[170:171], v219 offset:59968
    v_mfma_f32_16x16x32_bf16 v[128:131], v[180:183], a[104:107], v[128:131]
    ds_read_b64_tr_b16 v[172:173], v219 offset:64576
    ds_read_b64_tr_b16 v[174:175], v220 offset:3648
    v_mfma_f32_16x16x32_bf16 v[132:135], v[176:179], a[100:103], v[132:135]
    s_add_u32 m0, s42, 0
    s_add_u32 s92, s52, 811008
    v_mfma_f32_16x16x32_bf16 v[132:135], v[180:183], a[108:111], v[132:135]
    s_waitcnt lgkmcnt(10)
    buffer_load_dwordx4 a[160:163], v209, s[20:23], s99 offen sc1
    v_mfma_f32_16x16x32_bf16 v[64:67], v[184:187], a[112:115], v[64:67]
    s_add_u32 s100, s54, 151552
    ds_read_b64_tr_b16 v[176:177], v219 offset:55392
    ds_read_b64_tr_b16 v[178:179], v219 offset:60000
    s_waitcnt lgkmcnt(10)
    v_mfma_f32_16x16x32_bf16 v[64:67], v[188:191], a[120:123], v[64:67]
    ds_read_b64_tr_b16 v[180:181], v219 offset:64608
    ds_read_b64_tr_b16 v[182:183], v220 offset:3680
    v_mfma_f32_16x16x32_bf16 v[68:71], v[184:187], a[116:119], v[68:71]
    v_mfma_f32_16x16x32_bf16 v[68:71], v[188:191], a[124:127], v[68:71]
    s_waitcnt lgkmcnt(10)
    buffer_load_dwordx4 a[164:167], v209, s[20:23], s100 offen sc1
    v_mfma_f32_16x16x32_bf16 v[72:75], v[160:163], a[112:115], v[72:75]
    s_add_u32 s99, s54, 5120
    ds_read_b64_tr_b16 v[184:185], v219 offset:55424
    ds_read_b64_tr_b16 v[186:187], v219 offset:60032
    s_waitcnt lgkmcnt(10)
    v_mfma_f32_16x16x32_bf16 v[72:75], v[164:167], a[120:123], v[72:75]
    ds_read_b64_tr_b16 v[188:189], v219 offset:64640
    ds_read_b64_tr_b16 v[190:191], v220 offset:3712
    v_mfma_f32_16x16x32_bf16 v[76:79], v[160:163], a[116:119], v[76:79]
    v_mfma_f32_16x16x32_bf16 v[76:79], v[164:167], a[124:127], v[76:79]
    s_waitcnt lgkmcnt(10)
    buffer_load_dwordx4 a[168:171], v209, s[20:23], s99 offen sc1
    v_mfma_f32_16x16x32_bf16 v[80:83], v[168:171], a[112:115], v[80:83]
    s_add_u32 s100, s54, 152576
    ds_read_b64_tr_b16 v[160:161], v219 offset:55456
    ds_read_b64_tr_b16 v[162:163], v219 offset:60064
    s_waitcnt lgkmcnt(10)
    v_mfma_f32_16x16x32_bf16 v[80:83], v[172:175], a[120:123], v[80:83]
    ds_read_b64_tr_b16 v[164:165], v219 offset:64672
    ds_read_b64_tr_b16 v[166:167], v220 offset:3744
    v_mfma_f32_16x16x32_bf16 v[84:87], v[168:171], a[116:119], v[84:87]
    v_mfma_f32_16x16x32_bf16 v[84:87], v[172:175], a[124:127], v[84:87]
    s_waitcnt lgkmcnt(10)
    buffer_load_dwordx4 a[172:175], v209, s[20:23], s100 offen sc1
    v_mfma_f32_16x16x32_bf16 v[88:91], v[176:179], a[112:115], v[88:91]
    s_add_u32 s99, s54, 14336
    ds_read_b64_tr_b16 v[168:169], v219 offset:55488
    ds_read_b64_tr_b16 v[170:171], v219 offset:60096
    s_waitcnt lgkmcnt(10)
    v_mfma_f32_16x16x32_bf16 v[88:91], v[180:183], a[120:123], v[88:91]
    ds_read_b64_tr_b16 v[172:173], v219 offset:64704
    ds_read_b64_tr_b16 v[174:175], v220 offset:3776
    v_mfma_f32_16x16x32_bf16 v[92:95], v[176:179], a[116:119], v[92:95]
    v_mfma_f32_16x16x32_bf16 v[92:95], v[180:183], a[124:127], v[92:95]
    s_waitcnt lgkmcnt(10)
    buffer_load_dwordx4 a[176:179], v209, s[20:23], s99 offen sc1
    v_mfma_f32_16x16x32_bf16 v[96:99], v[184:187], a[112:115], v[96:99]
    s_add_u32 s100, s54, 161792
    ds_read_b64_tr_b16 v[176:177], v219 offset:55520
    ds_read_b64_tr_b16 v[178:179], v219 offset:60128
    s_waitcnt lgkmcnt(10)
    v_mfma_f32_16x16x32_bf16 v[96:99], v[188:191], a[120:123], v[96:99]
    ds_read_b64_tr_b16 v[180:181], v219 offset:64736
    ds_read_b64_tr_b16 v[182:183], v220 offset:3808
    v_mfma_f32_16x16x32_bf16 v[100:103], v[184:187], a[116:119], v[100:103]
    v_mfma_f32_16x16x32_bf16 v[100:103], v[188:191], a[124:127], v[100:103]
    s_waitcnt lgkmcnt(10)
    buffer_load_dwordx4 a[180:183], v209, s[20:23], s100 offen sc1
    v_mfma_f32_16x16x32_bf16 v[104:107], v[160:163], a[112:115], v[104:107]
    s_waitcnt vmcnt(23)
    ds_read_b64_tr_b16 v[184:185], v219 offset:55552
    ds_read_b64_tr_b16 v[186:187], v219 offset:60160
    s_waitcnt lgkmcnt(10)
    v_mfma_f32_16x16x32_bf16 v[104:107], v[164:167], a[120:123], v[104:107]
    s_barrier
    ds_read_b64_tr_b16 v[188:189], v219 offset:64768
    ds_read_b64_tr_b16 v[190:191], v220 offset:3840
    v_mfma_f32_16x16x32_bf16 v[108:111], v[160:163], a[116:119], v[108:111]
    s_add_u32 s99, s54, 15360
    v_mfma_f32_16x16x32_bf16 v[108:111], v[164:167], a[124:127], v[108:111]
    s_waitcnt lgkmcnt(10)
    buffer_load_dwordx4 a[184:187], v209, s[20:23], s99 offen sc1
    v_mfma_f32_16x16x32_bf16 v[112:115], v[168:171], a[112:115], v[112:115]
    s_add_u32 s100, s54, 162816
    ds_read_b64_tr_b16 v[160:161], v220 offset:53248
    ds_read_b64_tr_b16 v[162:163], v220 offset:57856
    s_waitcnt lgkmcnt(10)
    v_mfma_f32_16x16x32_bf16 v[112:115], v[172:175], a[120:123], v[112:115]
    ds_read_b64_tr_b16 v[164:165], v220 offset:62464
    ds_read_b64_tr_b16 v[166:167], v221 offset:1536
    v_mfma_f32_16x16x32_bf16 v[116:119], v[168:171], a[116:119], v[116:119]
    v_mfma_f32_16x16x32_bf16 v[116:119], v[172:175], a[124:127], v[116:119]
    s_waitcnt lgkmcnt(10)
    buffer_load_dwordx4 a[188:191], v209, s[20:23], s100 offen sc1
    v_mfma_f32_16x16x32_bf16 v[120:123], v[176:179], a[112:115], v[120:123]
    s_add_u32 s99, s54, 22528
    ds_read_b64_tr_b16 v[168:169], v220 offset:53280
    ds_read_b64_tr_b16 v[170:171], v220 offset:57888
    s_waitcnt lgkmcnt(10)
    v_mfma_f32_16x16x32_bf16 v[120:123], v[180:183], a[120:123], v[120:123]
    ds_read_b64_tr_b16 v[172:173], v220 offset:62496
    ds_read_b64_tr_b16 v[174:175], v221 offset:1568
    v_mfma_f32_16x16x32_bf16 v[124:127], v[176:179], a[116:119], v[124:127]
    v_mfma_f32_16x16x32_bf16 v[124:127], v[180:183], a[124:127], v[124:127]
    s_waitcnt lgkmcnt(10)
    buffer_load_dwordx4 v232, s[16:19], s92 offen lds
    v_mfma_f32_16x16x32_bf16 v[128:131], v[184:187], a[112:115], v[128:131]
    s_waitcnt lgkmcnt(8)
    ds_read_b64_tr_b16 v[176:177], v220 offset:53312
    ds_read_b64_tr_b16 v[178:179], v220 offset:57920
    v_mfma_f32_16x16x32_bf16 v[128:131], v[188:191], a[120:123], v[128:131]
    ds_read_b64_tr_b16 v[180:181], v220 offset:62528
    ds_read_b64_tr_b16 v[182:183], v221 offset:1600
    v_mfma_f32_16x16x32_bf16 v[132:135], v[184:187], a[116:119], v[132:135]
    v_mfma_f32_16x16x32_bf16 v[132:135], v[188:191], a[124:127], v[132:135]
    s_waitcnt vmcnt(25) lgkmcnt(10)
    buffer_load_dwordx4 v233, s[16:19], s92 offen offset:1024 lds
    v_mfma_f32_16x16x32_bf16 v[64:67], v[160:163], a[128:131], v[64:67]
    s_waitcnt vmcnt(24) lgkmcnt(8)
    ds_read_b64_tr_b16 v[184:185], v220 offset:53344
    ds_read_b64_tr_b16 v[186:187], v220 offset:57952
    v_mfma_f32_16x16x32_bf16 v[64:67], v[164:167], a[136:139], v[64:67]
    s_barrier
    ds_read_b64_tr_b16 v[188:189], v220 offset:62560
    ds_read_b64_tr_b16 v[190:191], v221 offset:1632
    v_mfma_f32_16x16x32_bf16 v[68:71], v[160:163], a[132:135], v[68:71]
    s_waitcnt vmcnt(23)
    v_mfma_f32_16x16x32_bf16 v[68:71], v[164:167], a[140:143], v[68:71]
    s_waitcnt lgkmcnt(10)
    buffer_load_dwordx4 v234, s[16:19], s92 offen offset:2048 lds
    v_mfma_f32_16x16x32_bf16 v[72:75], v[168:171], a[128:131], v[72:75]
    s_waitcnt lgkmcnt(8)
    ds_read_b64_tr_b16 v[160:161], v220 offset:53376
    ds_read_b64_tr_b16 v[162:163], v220 offset:57984
    v_mfma_f32_16x16x32_bf16 v[72:75], v[172:175], a[136:139], v[72:75]
    ds_read_b64_tr_b16 v[164:165], v220 offset:62592
    ds_read_b64_tr_b16 v[166:167], v221 offset:1664
    v_mfma_f32_16x16x32_bf16 v[76:79], v[168:171], a[132:135], v[76:79]
    v_mfma_f32_16x16x32_bf16 v[76:79], v[172:175], a[140:143], v[76:79]
    s_waitcnt lgkmcnt(10)
    buffer_load_dwordx4 v235, s[16:19], s92 offen offset:3072 lds
    v_mfma_f32_16x16x32_bf16 v[80:83], v[176:179], a[128:131], v[80:83]
    s_add_u32 m0, s42, 4096
    ds_read_b64_tr_b16 v[168:169], v220 offset:53408
    ds_read_b64_tr_b16 v[170:171], v220 offset:58016
    s_waitcnt lgkmcnt(10)
    v_mfma_f32_16x16x32_bf16 v[80:83], v[180:183], a[136:139], v[80:83]
    ds_read_b64_tr_b16 v[172:173], v220 offset:62624
    ds_read_b64_tr_b16 v[174:175], v221 offset:1696
    v_mfma_f32_16x16x32_bf16 v[84:87], v[176:179], a[132:135], v[84:87]
    v_mfma_f32_16x16x32_bf16 v[84:87], v[180:183], a[140:143], v[84:87]
    s_waitcnt lgkmcnt(10)
    buffer_load_dwordx4 v236, s[16:19], s92 offen lds
    v_mfma_f32_16x16x32_bf16 v[88:91], v[184:187], a[128:131], v[88:91]
    s_waitcnt lgkmcnt(8)
    ds_read_b64_tr_b16 v[176:177], v220 offset:53440
    ds_read_b64_tr_b16 v[178:179], v220 offset:58048
    v_mfma_f32_16x16x32_bf16 v[88:91], v[188:191], a[136:139], v[88:91]
    ds_read_b64_tr_b16 v[180:181], v220 offset:62656
    ds_read_b64_tr_b16 v[182:183], v221 offset:1728
    v_mfma_f32_16x16x32_bf16 v[92:95], v[184:187], a[132:135], v[92:95]
    v_mfma_f32_16x16x32_bf16 v[92:95], v[188:191], a[140:143], v[92:95]
    s_waitcnt lgkmcnt(10)
    buffer_load_dwordx4 v237, s[16:19], s92 offen offset:1024 lds
    v_mfma_f32_16x16x32_bf16 v[96:99], v[160:163], a[128:131], v[96:99]
    s_waitcnt lgkmcnt(8)
    ds_read_b64_tr_b16 v[184:185], v220 offset:53472
    ds_read_b64_tr_b16 v[186:187], v220 offset:58080
    v_mfma_f32_16x16x32_bf16 v[96:99], v[164:167], a[136:139], v[96:99]
    ds_read_b64_tr_b16 v[188:189], v220 offset:62688
    ds_read_b64_tr_b16 v[190:191], v221 offset:1760
    v_mfma_f32_16x16x32_bf16 v[100:103], v[160:163], a[132:135], v[100:103]
    v_mfma_f32_16x16x32_bf16 v[100:103], v[164:167], a[140:143], v[100:103]
    s_waitcnt lgkmcnt(10)
    buffer_load_dwordx4 v238, s[16:19], s92 offen offset:2048 lds
    v_mfma_f32_16x16x32_bf16 v[104:107], v[168:171], a[128:131], v[104:107]
    s_waitcnt lgkmcnt(8)
    ds_read_b64_tr_b16 v[160:161], v220 offset:53504
    ds_read_b64_tr_b16 v[162:163], v220 offset:58112
    v_mfma_f32_16x16x32_bf16 v[104:107], v[172:175], a[136:139], v[104:107]
    ds_read_b64_tr_b16 v[164:165], v220 offset:62720
    ds_read_b64_tr_b16 v[166:167], v221 offset:1792
    v_mfma_f32_16x16x32_bf16 v[108:111], v[168:171], a[132:135], v[108:111]
    v_mfma_f32_16x16x32_bf16 v[108:111], v[172:175], a[140:143], v[108:111]
    s_waitcnt lgkmcnt(10)
    buffer_load_dwordx4 v239, s[16:19], s92 offen offset:3072 lds
    v_mfma_f32_16x16x32_bf16 v[112:115], v[176:179], a[128:131], v[112:115]
    s_add_u32 m0, s42, 8192
    ds_read_b64_tr_b16 v[168:169], v221 offset:6144
    ds_read_b64_tr_b16 v[170:171], v221 offset:10752
    s_waitcnt lgkmcnt(10)
    v_mfma_f32_16x16x32_bf16 v[112:115], v[180:183], a[136:139], v[112:115]
    ds_read_b64_tr_b16 v[172:173], v221 offset:15360
    ds_read_b64_tr_b16 v[174:175], v221 offset:19968
    v_mfma_f32_16x16x32_bf16 v[116:119], v[176:179], a[132:135], v[116:119]
    v_mfma_f32_16x16x32_bf16 v[116:119], v[180:183], a[140:143], v[116:119]
    s_waitcnt lgkmcnt(10)
    buffer_load_dwordx4 v240, s[16:19], s92 offen lds
    v_mfma_f32_16x16x32_bf16 v[120:123], v[184:187], a[128:131], v[120:123]
    s_waitcnt lgkmcnt(8)
    ds_read_b64_tr_b16 v[176:177], v221 offset:6176
    ds_read_b64_tr_b16 v[178:179], v221 offset:10784
    v_mfma_f32_16x16x32_bf16 v[120:123], v[188:191], a[136:139], v[120:123]
    ds_read_b64_tr_b16 v[180:181], v221 offset:15392
    ds_read_b64_tr_b16 v[182:183], v221 offset:20000
    v_mfma_f32_16x16x32_bf16 v[124:127], v[184:187], a[132:135], v[124:127]
    s_add_u32 m0, s42, 36864
    s_add_u32 s93, s52, 221184
    v_mfma_f32_16x16x32_bf16 v[124:127], v[188:191], a[140:143], v[124:127]
    s_waitcnt lgkmcnt(10)
    buffer_load_dwordx4 a[192:195], v209, s[20:23], s99 offen sc1
    v_mfma_f32_16x16x32_bf16 v[128:131], v[160:163], a[128:131], v[128:131]
    s_add_u32 s100, s54, 169984
    ds_read_b64_tr_b16 v[184:185], v221 offset:6208
    ds_read_b64_tr_b16 v[186:187], v221 offset:10816
    s_waitcnt lgkmcnt(10)
    v_mfma_f32_16x16x32_bf16 v[128:131], v[164:167], a[136:139], v[128:131]
    ds_read_b64_tr_b16 v[188:189], v221 offset:15424
    ds_read_b64_tr_b16 v[190:191], v221 offset:20032
    v_mfma_f32_16x16x32_bf16 v[132:135], v[160:163], a[132:135], v[132:135]
    v_mfma_f32_16x16x32_bf16 v[132:135], v[164:167], a[140:143], v[132:135]
    s_waitcnt vmcnt(30) lgkmcnt(10)
    buffer_load_dwordx4 a[196:199], v209, s[20:23], s100 offen sc1
    v_mfma_f32_16x16x32_bf16 v[64:67], v[168:171], a[144:147], v[64:67]
    s_add_u32 s99, s54, 23552
    ds_read_b64_tr_b16 v[160:161], v221 offset:6240
    ds_read_b64_tr_b16 v[162:163], v221 offset:10848
    s_waitcnt vmcnt(29) lgkmcnt(10)
    v_mfma_f32_16x16x32_bf16 v[64:67], v[172:175], a[152:155], v[64:67]
    ds_read_b64_tr_b16 v[164:165], v221 offset:15456
    ds_read_b64_tr_b16 v[166:167], v221 offset:20064
    v_mfma_f32_16x16x32_bf16 v[68:71], v[168:171], a[148:151], v[68:71]
    s_waitcnt vmcnt(28)
    v_mfma_f32_16x16x32_bf16 v[68:71], v[172:175], a[156:159], v[68:71]
    s_waitcnt lgkmcnt(10)
    buffer_load_dwordx4 a[200:203], v209, s[20:23], s99 offen sc1
    v_mfma_f32_16x16x32_bf16 v[72:75], v[176:179], a[144:147], v[72:75]
    s_add_u32 s100, s54, 171008
    ds_read_b64_tr_b16 v[168:169], v221 offset:6272
    ds_read_b64_tr_b16 v[170:171], v221 offset:10880
    s_waitcnt lgkmcnt(10)
    v_mfma_f32_16x16x32_bf16 v[72:75], v[180:183], a[152:155], v[72:75]
    ds_read_b64_tr_b16 v[172:173], v221 offset:15488
    ds_read_b64_tr_b16 v[174:175], v221 offset:20096
    v_mfma_f32_16x16x32_bf16 v[76:79], v[176:179], a[148:151], v[76:79]
    v_mfma_f32_16x16x32_bf16 v[76:79], v[180:183], a[156:159], v[76:79]
    s_waitcnt lgkmcnt(10)
    buffer_load_dwordx4 a[204:207], v209, s[20:23], s100 offen sc1
    v_mfma_f32_16x16x32_bf16 v[80:83], v[184:187], a[144:147], v[80:83]
    s_add_u32 s99, s54, 32768
    ds_read_b64_tr_b16 v[176:177], v221 offset:6304
    ds_read_b64_tr_b16 v[178:179], v221 offset:10912
    s_waitcnt lgkmcnt(10)
    v_mfma_f32_16x16x32_bf16 v[80:83], v[188:191], a[152:155], v[80:83]
    ds_read_b64_tr_b16 v[180:181], v221 offset:15520
    ds_read_b64_tr_b16 v[182:183], v221 offset:20128
    v_mfma_f32_16x16x32_bf16 v[84:87], v[184:187], a[148:151], v[84:87]
    v_mfma_f32_16x16x32_bf16 v[84:87], v[188:191], a[156:159], v[84:87]
    s_waitcnt lgkmcnt(10)
    buffer_load_dwordx4 a[208:211], v209, s[20:23], s99 offen sc1
    v_mfma_f32_16x16x32_bf16 v[88:91], v[160:163], a[144:147], v[88:91]
    s_add_u32 s100, s54, 180224
    ds_read_b64_tr_b16 v[184:185], v221 offset:6336
    ds_read_b64_tr_b16 v[186:187], v221 offset:10944
    s_waitcnt lgkmcnt(10)
    v_mfma_f32_16x16x32_bf16 v[88:91], v[164:167], a[152:155], v[88:91]
    ds_read_b64_tr_b16 v[188:189], v221 offset:15552
    ds_read_b64_tr_b16 v[190:191], v221 offset:20160
    v_mfma_f32_16x16x32_bf16 v[92:95], v[160:163], a[148:151], v[92:95]
    v_mfma_f32_16x16x32_bf16 v[92:95], v[164:167], a[156:159], v[92:95]
    s_waitcnt lgkmcnt(10)
    buffer_load_dwordx4 a[212:215], v209, s[20:23], s100 offen sc1
    v_mfma_f32_16x16x32_bf16 v[96:99], v[168:171], a[144:147], v[96:99]
    s_add_u32 s99, s54, 33792
    ds_read_b64_tr_b16 v[160:161], v221 offset:6368
    ds_read_b64_tr_b16 v[162:163], v221 offset:10976
    s_waitcnt lgkmcnt(10)
    v_mfma_f32_16x16x32_bf16 v[96:99], v[172:175], a[152:155], v[96:99]
    ds_read_b64_tr_b16 v[164:165], v221 offset:15584
    ds_read_b64_tr_b16 v[166:167], v221 offset:20192
    v_mfma_f32_16x16x32_bf16 v[100:103], v[168:171], a[148:151], v[100:103]
    v_mfma_f32_16x16x32_bf16 v[100:103], v[172:175], a[156:159], v[100:103]
    s_waitcnt lgkmcnt(10)
    buffer_load_dwordx4 a[216:219], v209, s[20:23], s99 offen sc1
    v_mfma_f32_16x16x32_bf16 v[104:107], v[176:179], a[144:147], v[104:107]
    s_waitcnt vmcnt(24)
    ds_read_b64_tr_b16 v[168:169], v221 offset:6400
    ds_read_b64_tr_b16 v[170:171], v221 offset:11008
    s_waitcnt lgkmcnt(10)
    v_mfma_f32_16x16x32_bf16 v[104:107], v[180:183], a[152:155], v[104:107]
    s_barrier
    ds_read_b64_tr_b16 v[172:173], v221 offset:15616
    ds_read_b64_tr_b16 v[174:175], v221 offset:20224
    v_mfma_f32_16x16x32_bf16 v[108:111], v[176:179], a[148:151], v[108:111]
    s_add_u32 s100, s54, 181248
    v_mfma_f32_16x16x32_bf16 v[108:111], v[180:183], a[156:159], v[108:111]
    s_waitcnt lgkmcnt(10)
    buffer_load_dwordx4 a[220:223], v209, s[20:23], s100 offen sc1
    v_mfma_f32_16x16x32_bf16 v[112:115], v[184:187], a[144:147], v[112:115]
    s_add_u32 s99, s54, 6144
    ds_read_b64_tr_b16 v[176:177], v220 offset:16448
    ds_read_b64_tr_b16 v[178:179], v220 offset:21056
    s_waitcnt lgkmcnt(10)
    v_mfma_f32_16x16x32_bf16 v[112:115], v[188:191], a[152:155], v[112:115]
    ds_read_b64_tr_b16 v[180:181], v220 offset:25664
    ds_read_b64_tr_b16 v[182:183], v220 offset:30272
    v_mfma_f32_16x16x32_bf16 v[116:119], v[184:187], a[148:151], v[116:119]
    v_mfma_f32_16x16x32_bf16 v[116:119], v[188:191], a[156:159], v[116:119]
    s_waitcnt lgkmcnt(10)
    buffer_load_dwordx4 v232, s[16:19], s93 offen lds
    v_mfma_f32_16x16x32_bf16 v[120:123], v[160:163], a[144:147], v[120:123]
    s_waitcnt lgkmcnt(8)
    ds_read_b64_tr_b16 v[184:185], v220 offset:16480
    ds_read_b64_tr_b16 v[186:187], v220 offset:21088
    v_mfma_f32_16x16x32_bf16 v[120:123], v[164:167], a[152:155], v[120:123]
    ds_read_b64_tr_b16 v[188:189], v220 offset:25696
    ds_read_b64_tr_b16 v[190:191], v220 offset:30304
    v_mfma_f32_16x16x32_bf16 v[124:127], v[160:163], a[148:151], v[124:127]
    v_mfma_f32_16x16x32_bf16 v[124:127], v[164:167], a[156:159], v[124:127]
    s_waitcnt lgkmcnt(10)
    buffer_load_dwordx4 v233, s[16:19], s93 offen offset:1024 lds
    v_mfma_f32_16x16x32_bf16 v[128:131], v[168:171], a[144:147], v[128:131]
    s_waitcnt lgkmcnt(8)
    ds_read_b64_tr_b16 v[160:161], v220 offset:16512
    ds_read_b64_tr_b16 v[162:163], v220 offset:21120
    v_mfma_f32_16x16x32_bf16 v[128:131], v[172:175], a[152:155], v[128:131]
    ds_read_b64_tr_b16 v[164:165], v220 offset:25728
    ds_read_b64_tr_b16 v[166:167], v220 offset:30336
    v_mfma_f32_16x16x32_bf16 v[132:135], v[168:171], a[148:151], v[132:135]
    v_mfma_f32_16x16x32_bf16 v[132:135], v[172:175], a[156:159], v[132:135]
    s_waitcnt vmcnt(26) lgkmcnt(10)
    buffer_load_dwordx4 v234, s[16:19], s93 offen offset:2048 lds
    v_mfma_f32_16x16x32_bf16 v[80:83], v[176:179], a[160:163], v[80:83]
    s_waitcnt vmcnt(25) lgkmcnt(8)
    ds_read_b64_tr_b16 v[168:169], v220 offset:16544
    ds_read_b64_tr_b16 v[170:171], v220 offset:21152
    v_mfma_f32_16x16x32_bf16 v[80:83], v[180:183], a[168:171], v[80:83]
    s_barrier
    ds_read_b64_tr_b16 v[172:173], v220 offset:25760
    ds_read_b64_tr_b16 v[174:175], v220 offset:30368
    v_mfma_f32_16x16x32_bf16 v[84:87], v[176:179], a[164:167], v[84:87]
    s_waitcnt vmcnt(24)
    v_mfma_f32_16x16x32_bf16 v[84:87], v[180:183], a[172:175], v[84:87]
    s_waitcnt lgkmcnt(10)
    buffer_load_dwordx4 v235, s[16:19], s93 offen offset:3072 lds
    v_mfma_f32_16x16x32_bf16 v[88:91], v[184:187], a[160:163], v[88:91]
    s_add_u32 m0, s42, 40960
    ds_read_b64_tr_b16 v[176:177], v220 offset:16576
    ds_read_b64_tr_b16 v[178:179], v220 offset:21184
    s_waitcnt lgkmcnt(10)
    v_mfma_f32_16x16x32_bf16 v[88:91], v[188:191], a[168:171], v[88:91]
    ds_read_b64_tr_b16 v[180:181], v220 offset:25792
    ds_read_b64_tr_b16 v[182:183], v220 offset:30400
    v_mfma_f32_16x16x32_bf16 v[92:95], v[184:187], a[164:167], v[92:95]
    v_mfma_f32_16x16x32_bf16 v[92:95], v[188:191], a[172:175], v[92:95]
    s_waitcnt lgkmcnt(10)
    buffer_load_dwordx4 v236, s[16:19], s93 offen lds
    v_mfma_f32_16x16x32_bf16 v[96:99], v[160:163], a[160:163], v[96:99]
    s_waitcnt lgkmcnt(8)
    ds_read_b64_tr_b16 v[184:185], v220 offset:16608
    ds_read_b64_tr_b16 v[186:187], v220 offset:21216
    v_mfma_f32_16x16x32_bf16 v[96:99], v[164:167], a[168:171], v[96:99]
    ds_read_b64_tr_b16 v[188:189], v220 offset:25824
    ds_read_b64_tr_b16 v[190:191], v220 offset:30432
    v_mfma_f32_16x16x32_bf16 v[100:103], v[160:163], a[164:167], v[100:103]
    v_mfma_f32_16x16x32_bf16 v[100:103], v[164:167], a[172:175], v[100:103]
    s_waitcnt lgkmcnt(10)
    buffer_load_dwordx4 v237, s[16:19], s93 offen offset:1024 lds
    v_mfma_f32_16x16x32_bf16 v[104:107], v[168:171], a[160:163], v[104:107]
    s_waitcnt lgkmcnt(8)
    ds_read_b64_tr_b16 v[160:161], v220 offset:16640
    ds_read_b64_tr_b16 v[162:163], v220 offset:21248
    v_mfma_f32_16x16x32_bf16 v[104:107], v[172:175], a[168:171], v[104:107]
    ds_read_b64_tr_b16 v[164:165], v220 offset:25856
    ds_read_b64_tr_b16 v[166:167], v220 offset:30464
    v_mfma_f32_16x16x32_bf16 v[108:111], v[168:171], a[164:167], v[108:111]
    v_mfma_f32_16x16x32_bf16 v[108:111], v[172:175], a[172:175], v[108:111]
    s_waitcnt lgkmcnt(10)
    buffer_load_dwordx4 v238, s[16:19], s93 offen offset:2048 lds
    v_mfma_f32_16x16x32_bf16 v[112:115], v[176:179], a[160:163], v[112:115]
    s_waitcnt lgkmcnt(8)
    ds_read_b64_tr_b16 v[168:169], v220 offset:34880
    ds_read_b64_tr_b16 v[170:171], v220 offset:39488
    v_mfma_f32_16x16x32_bf16 v[112:115], v[180:183], a[168:171], v[112:115]
    ds_read_b64_tr_b16 v[172:173], v220 offset:44096
    ds_read_b64_tr_b16 v[174:175], v220 offset:48704
    v_mfma_f32_16x16x32_bf16 v[116:119], v[176:179], a[164:167], v[116:119]
    v_mfma_f32_16x16x32_bf16 v[116:119], v[180:183], a[172:175], v[116:119]
    s_waitcnt lgkmcnt(10)
    buffer_load_dwordx4 v239, s[16:19], s93 offen offset:3072 lds
    v_mfma_f32_16x16x32_bf16 v[120:123], v[184:187], a[160:163], v[120:123]
    s_add_u32 m0, s42, 45056
    ds_read_b64_tr_b16 v[176:177], v220 offset:34912
    ds_read_b64_tr_b16 v[178:179], v220 offset:39520
    s_waitcnt lgkmcnt(10)
    v_mfma_f32_16x16x32_bf16 v[120:123], v[188:191], a[168:171], v[120:123]
    ds_read_b64_tr_b16 v[180:181], v220 offset:44128
    ds_read_b64_tr_b16 v[182:183], v220 offset:48736
    v_mfma_f32_16x16x32_bf16 v[124:127], v[184:187], a[164:167], v[124:127]
    v_mfma_f32_16x16x32_bf16 v[124:127], v[188:191], a[172:175], v[124:127]
    s_waitcnt lgkmcnt(10)
    buffer_load_dwordx4 v240, s[16:19], s93 offen lds
    v_mfma_f32_16x16x32_bf16 v[128:131], v[160:163], a[160:163], v[128:131]
    s_waitcnt lgkmcnt(8)
    ds_read_b64_tr_b16 v[184:185], v220 offset:34944
    ds_read_b64_tr_b16 v[186:187], v220 offset:39552
    v_mfma_f32_16x16x32_bf16 v[128:131], v[164:167], a[168:171], v[128:131]
    ds_read_b64_tr_b16 v[188:189], v220 offset:44160
    ds_read_b64_tr_b16 v[190:191], v220 offset:48768
    v_mfma_f32_16x16x32_bf16 v[132:135], v[160:163], a[164:167], v[132:135]
    s_add_u32 m0, s42, 118784
    s_add_u32 s92, s52, 884736
    v_mfma_f32_16x16x32_bf16 v[132:135], v[164:167], a[172:175], v[132:135]
    s_waitcnt vmcnt(29) lgkmcnt(10)
    buffer_load_dwordx4 v232, s[16:19], s92 offen lds
    v_mfma_f32_16x16x32_bf16 v[80:83], v[168:171], a[176:179], v[80:83]
    s_waitcnt vmcnt(28) lgkmcnt(8)
    ds_read_b64_tr_b16 v[160:161], v220 offset:34976
    ds_read_b64_tr_b16 v[162:163], v220 offset:39584
    v_mfma_f32_16x16x32_bf16 v[80:83], v[172:175], a[184:187], v[80:83]
    ds_read_b64_tr_b16 v[164:165], v220 offset:44192
    ds_read_b64_tr_b16 v[166:167], v220 offset:48800
    v_mfma_f32_16x16x32_bf16 v[84:87], v[168:171], a[180:183], v[84:87]
    s_waitcnt vmcnt(27)
    v_mfma_f32_16x16x32_bf16 v[84:87], v[172:175], a[188:191], v[84:87]
    s_waitcnt lgkmcnt(10)
    buffer_load_dwordx4 v233, s[16:19], s92 offen offset:1024 lds
    v_mfma_f32_16x16x32_bf16 v[88:91], v[176:179], a[176:179], v[88:91]
    s_waitcnt lgkmcnt(8)
    ds_read_b64_tr_b16 v[168:169], v220 offset:35008
    ds_read_b64_tr_b16 v[170:171], v220 offset:39616
    v_mfma_f32_16x16x32_bf16 v[88:91], v[180:183], a[184:187], v[88:91]
    ds_read_b64_tr_b16 v[172:173], v220 offset:44224
    ds_read_b64_tr_b16 v[174:175], v220 offset:48832
    v_mfma_f32_16x16x32_bf16 v[92:95], v[176:179], a[180:183], v[92:95]
    v_mfma_f32_16x16x32_bf16 v[92:95], v[180:183], a[188:191], v[92:95]
    s_waitcnt lgkmcnt(10)
    buffer_load_dwordx4 v234, s[16:19], s92 offen offset:2048 lds
    v_mfma_f32_16x16x32_bf16 v[96:99], v[184:187], a[176:179], v[96:99]
    s_waitcnt lgkmcnt(8)
    ds_read_b64_tr_b16 v[176:177], v220 offset:35040
    ds_read_b64_tr_b16 v[178:179], v220 offset:39648
    v_mfma_f32_16x16x32_bf16 v[96:99], v[188:191], a[184:187], v[96:99]
    ds_read_b64_tr_b16 v[180:181], v220 offset:44256
    ds_read_b64_tr_b16 v[182:183], v220 offset:48864
    v_mfma_f32_16x16x32_bf16 v[100:103], v[184:187], a[180:183], v[100:103]
    v_mfma_f32_16x16x32_bf16 v[100:103], v[188:191], a[188:191], v[100:103]
    s_waitcnt lgkmcnt(10)
    buffer_load_dwordx4 v235, s[16:19], s92 offen offset:3072 lds
    v_mfma_f32_16x16x32_bf16 v[104:107], v[160:163], a[176:179], v[104:107]
    s_waitcnt vmcnt(21)
    ds_read_b64_tr_b16 v[184:185], v220 offset:35072
    ds_read_b64_tr_b16 v[186:187], v220 offset:39680
    s_waitcnt lgkmcnt(10)
    v_mfma_f32_16x16x32_bf16 v[104:107], v[164:167], a[184:187], v[104:107]
    s_barrier
    ds_read_b64_tr_b16 v[188:189], v220 offset:44288
    ds_read_b64_tr_b16 v[190:191], v220 offset:48896
    v_mfma_f32_16x16x32_bf16 v[108:111], v[160:163], a[180:183], v[108:111]
    s_add_u32 m0, s42, 122880
    v_mfma_f32_16x16x32_bf16 v[108:111], v[164:167], a[188:191], v[108:111]
    s_waitcnt lgkmcnt(10)
    buffer_load_dword v244, v246, s[28:31], s90 offen sc1
    v_mfma_f32_16x16x32_bf16 v[112:115], v[168:171], a[176:179], v[112:115]
    s_waitcnt lgkmcnt(8)
    ds_read_b64_tr_b16 v[160:161], v219 offset:64
    ds_read_b64_tr_b16 v[162:163], v219 offset:4672
    v_mfma_f32_16x16x32_bf16 v[112:115], v[172:175], a[184:187], v[112:115]
    ds_read_b64_tr_b16 v[164:165], v219 offset:9280
    ds_read_b64_tr_b16 v[166:167], v219 offset:13888
    v_mfma_f32_16x16x32_bf16 v[116:119], v[168:171], a[180:183], v[116:119]
    v_mfma_f32_16x16x32_bf16 v[116:119], v[172:175], a[188:191], v[116:119]
    s_waitcnt lgkmcnt(10)
    buffer_load_dwordx4 v236, s[16:19], s92 offen lds
    v_mfma_f32_16x16x32_bf16 v[120:123], v[176:179], a[176:179], v[120:123]
    s_waitcnt lgkmcnt(8)
    ds_read_b64_tr_b16 v[168:169], v219 offset:96
    ds_read_b64_tr_b16 v[170:171], v219 offset:4704
    v_mfma_f32_16x16x32_bf16 v[120:123], v[180:183], a[184:187], v[120:123]
    ds_read_b64_tr_b16 v[172:173], v219 offset:9312
    ds_read_b64_tr_b16 v[174:175], v219 offset:13920
    v_mfma_f32_16x16x32_bf16 v[124:127], v[176:179], a[180:183], v[124:127]
    v_mfma_f32_16x16x32_bf16 v[124:127], v[180:183], a[188:191], v[124:127]
    s_waitcnt lgkmcnt(10)
    buffer_load_dwordx4 v237, s[16:19], s92 offen offset:1024 lds
    v_mfma_f32_16x16x32_bf16 v[128:131], v[184:187], a[176:179], v[128:131]
    s_waitcnt lgkmcnt(8)
    ds_read_b64_tr_b16 v[176:177], v219 offset:128
    ds_read_b64_tr_b16 v[178:179], v219 offset:4736
    v_mfma_f32_16x16x32_bf16 v[128:131], v[188:191], a[184:187], v[128:131]
    ds_read_b64_tr_b16 v[180:181], v219 offset:9344
    ds_read_b64_tr_b16 v[182:183], v219 offset:13952
    v_mfma_f32_16x16x32_bf16 v[132:135], v[184:187], a[180:183], v[132:135]
    v_mfma_f32_16x16x32_bf16 v[132:135], v[188:191], a[188:191], v[132:135]
    s_waitcnt vmcnt(23) lgkmcnt(10)
    buffer_load_dwordx4 v238, s[16:19], s92 offen offset:2048 lds
    v_mfma_f32_16x16x32_bf16 v[80:83], v[160:163], a[192:195], v[80:83]
    s_waitcnt vmcnt(22) lgkmcnt(8)
    ds_read_b64_tr_b16 v[184:185], v219 offset:160
    ds_read_b64_tr_b16 v[186:187], v219 offset:4768
    v_mfma_f32_16x16x32_bf16 v[80:83], v[164:167], a[200:203], v[80:83]
    ds_read_b64_tr_b16 v[188:189], v219 offset:9376
    ds_read_b64_tr_b16 v[190:191], v219 offset:13984
    v_mfma_f32_16x16x32_bf16 v[84:87], v[160:163], a[196:199], v[84:87]
    s_waitcnt vmcnt(21)
    v_mfma_f32_16x16x32_bf16 v[84:87], v[164:167], a[204:207], v[84:87]
    s_waitcnt lgkmcnt(10)
    buffer_load_dwordx4 v239, s[16:19], s92 offen offset:3072 lds
    v_mfma_f32_16x16x32_bf16 v[88:91], v[168:171], a[192:195], v[88:91]
    s_add_u32 m0, s42, 126976
    ds_read_b64_tr_b16 v[160:161], v219 offset:192
    ds_read_b64_tr_b16 v[162:163], v219 offset:4800
    s_waitcnt lgkmcnt(10)
    v_mfma_f32_16x16x32_bf16 v[88:91], v[172:175], a[200:203], v[88:91]
    ds_read_b64_tr_b16 v[164:165], v219 offset:9408
    ds_read_b64_tr_b16 v[166:167], v219 offset:14016
    v_mfma_f32_16x16x32_bf16 v[92:95], v[168:171], a[196:199], v[92:95]
    v_mfma_f32_16x16x32_bf16 v[92:95], v[172:175], a[204:207], v[92:95]
    s_waitcnt lgkmcnt(10)
    buffer_load_dwordx4 v240, s[16:19], s92 offen lds
    v_mfma_f32_16x16x32_bf16 v[96:99], v[176:179], a[192:195], v[96:99]
    s_waitcnt lgkmcnt(8)
    ds_read_b64_tr_b16 v[168:169], v219 offset:224
    ds_read_b64_tr_b16 v[170:171], v219 offset:4832
    v_mfma_f32_16x16x32_bf16 v[96:99], v[180:183], a[200:203], v[96:99]
    ds_read_b64_tr_b16 v[172:173], v219 offset:9440
    ds_read_b64_tr_b16 v[174:175], v219 offset:14048
    v_mfma_f32_16x16x32_bf16 v[100:103], v[176:179], a[196:199], v[100:103]
    v_mfma_f32_16x16x32_bf16 v[100:103], v[180:183], a[204:207], v[100:103]
    s_waitcnt lgkmcnt(10)
    buffer_load_dwordx4 a[224:227], v209, s[20:23], s99 offen sc1
    v_mfma_f32_16x16x32_bf16 v[104:107], v[184:187], a[192:195], v[104:107]
    s_add_u32 s100, s54, 153600
    ds_read_b64_tr_b16 v[176:177], v219 offset:256
    ds_read_b64_tr_b16 v[178:179], v219 offset:4864
    s_waitcnt lgkmcnt(10)
    v_mfma_f32_16x16x32_bf16 v[104:107], v[188:191], a[200:203], v[104:107]
    ds_read_b64_tr_b16 v[180:181], v219 offset:9472
    ds_read_b64_tr_b16 v[182:183], v219 offset:14080
    v_mfma_f32_16x16x32_bf16 v[108:111], v[184:187], a[196:199], v[108:111]
    v_mfma_f32_16x16x32_bf16 v[108:111], v[188:191], a[204:207], v[108:111]
    s_waitcnt lgkmcnt(10)
    buffer_load_dwordx4 a[228:231], v209, s[20:23], s100 offen sc1
    v_mfma_f32_16x16x32_bf16 v[112:115], v[160:163], a[192:195], v[112:115]
    s_add_u32 s99, s54, 7168
    ds_read_b64_tr_b16 v[184:185], v219 offset:18496
    ds_read_b64_tr_b16 v[186:187], v219 offset:23104
    s_waitcnt lgkmcnt(10)
    v_mfma_f32_16x16x32_bf16 v[112:115], v[164:167], a[200:203], v[112:115]
    ds_read_b64_tr_b16 v[188:189], v219 offset:27712
    ds_read_b64_tr_b16 v[190:191], v219 offset:32320
    v_mfma_f32_16x16x32_bf16 v[116:119], v[160:163], a[196:199], v[116:119]
    v_mfma_f32_16x16x32_bf16 v[116:119], v[164:167], a[204:207], v[116:119]
    s_waitcnt lgkmcnt(10)
    buffer_load_dwordx4 a[232:235], v209, s[20:23], s99 offen sc1
    v_mfma_f32_16x16x32_bf16 v[120:123], v[168:171], a[192:195], v[120:123]
    s_add_u32 s100, s54, 154624
    ds_read_b64_tr_b16 v[160:161], v219 offset:18528
    ds_read_b64_tr_b16 v[162:163], v219 offset:23136
    s_waitcnt lgkmcnt(10)
    v_mfma_f32_16x16x32_bf16 v[120:123], v[172:175], a[200:203], v[120:123]
    ds_read_b64_tr_b16 v[164:165], v219 offset:27744
    ds_read_b64_tr_b16 v[166:167], v219 offset:32352
    v_mfma_f32_16x16x32_bf16 v[124:127], v[168:171], a[196:199], v[124:127]
    v_mfma_f32_16x16x32_bf16 v[124:127], v[172:175], a[204:207], v[124:127]
    s_waitcnt lgkmcnt(10)
    buffer_load_dwordx4 a[236:239], v209, s[20:23], s100 offen sc1
    v_mfma_f32_16x16x32_bf16 v[128:131], v[176:179], a[192:195], v[128:131]
    s_add_u32 s99, s54, 16384
    ds_read_b64_tr_b16 v[168:169], v219 offset:18560
    ds_read_b64_tr_b16 v[170:171], v219 offset:23168
    s_waitcnt lgkmcnt(10)
    v_mfma_f32_16x16x32_bf16 v[128:131], v[180:183], a[200:203], v[128:131]
    ds_read_b64_tr_b16 v[172:173], v219 offset:27776
    ds_read_b64_tr_b16 v[174:175], v219 offset:32384
    v_mfma_f32_16x16x32_bf16 v[132:135], v[176:179], a[196:199], v[132:135]
    v_mfma_f32_16x16x32_bf16 v[132:135], v[180:183], a[204:207], v[132:135]
    s_waitcnt vmcnt(26) lgkmcnt(10)
    buffer_load_dwordx4 a[240:243], v209, s[20:23], s99 offen sc1
    v_mfma_f32_16x16x32_bf16 v[80:83], v[184:187], a[208:211], v[80:83]
    s_add_u32 s100, s54, 163840
    ds_read_b64_tr_b16 v[176:177], v219 offset:18592
    ds_read_b64_tr_b16 v[178:179], v219 offset:23200
    s_waitcnt vmcnt(25) lgkmcnt(10)
    v_mfma_f32_16x16x32_bf16 v[80:83], v[188:191], a[216:219], v[80:83]
    ds_read_b64_tr_b16 v[180:181], v219 offset:27808
    ds_read_b64_tr_b16 v[182:183], v219 offset:32416
    v_mfma_f32_16x16x32_bf16 v[84:87], v[184:187], a[212:215], v[84:87]
    s_waitcnt vmcnt(24)
    v_mfma_f32_16x16x32_bf16 v[84:87], v[188:191], a[220:223], v[84:87]
    s_waitcnt lgkmcnt(10)
    buffer_load_dwordx4 a[244:247], v209, s[20:23], s100 offen sc1
    s_add_u32 s99, s54, 17408
    buffer_load_dwordx4 a[248:251], v209, s[20:23], s99 offen sc1
    s_add_u32 s100, s54, 164864
    v_mfma_f32_16x16x32_bf16 v[88:91], v[160:163], a[208:211], v[88:91]
    s_waitcnt lgkmcnt(8)
    ds_read_b64_tr_b16 v[184:185], v219 offset:18624
    ds_read_b64_tr_b16 v[186:187], v219 offset:23232
    v_mfma_f32_16x16x32_bf16 v[88:91], v[164:167], a[216:219], v[88:91]
    buffer_load_dwordx4 a[252:255], v209, s[20:23], s100 offen sc1
    v_mfma_f32_16x16x32_bf16 v[92:95], v[160:163], a[212:215], v[92:95]
    s_add_u32 s99, s54, 24576
    buffer_load_dwordx4 a[0:3], v209, s[20:23], s99 offen sc1
    s_add_u32 s100, s54, 172032
    v_mfma_f32_16x16x32_bf16 v[92:95], v[164:167], a[220:223], v[92:95]
    s_waitcnt lgkmcnt(8)
    buffer_load_dwordx4 a[4:7], v209, s[20:23], s100 offen sc1
    s_add_u32 s99, s54, 25600
    buffer_load_dwordx4 a[8:11], v209, s[20:23], s99 offen sc1
    s_add_u32 s100, s54, 173056
    v_mfma_f32_16x16x32_bf16 v[96:99], v[168:171], a[208:211], v[96:99]
    s_waitcnt lgkmcnt(6)
    ds_read_b64_tr_b16 v[188:189], v219 offset:27840
    ds_read_b64_tr_b16 v[190:191], v219 offset:32448
    v_mfma_f32_16x16x32_bf16 v[96:99], v[172:175], a[216:219], v[96:99]
    buffer_load_dwordx4 a[12:15], v209, s[20:23], s100 offen sc1
    v_mfma_f32_16x16x32_bf16 v[100:103], v[168:171], a[212:215], v[100:103]
    s_add_u32 s99, s54, 34816
    buffer_load_dwordx4 a[16:19], v209, s[20:23], s99 offen sc1
    s_add_u32 s100, s54, 182272
    v_mfma_f32_16x16x32_bf16 v[100:103], v[172:175], a[220:223], v[100:103]
    s_waitcnt lgkmcnt(6)
    buffer_load_dwordx4 a[20:23], v209, s[20:23], s100 offen sc1
    s_add_u32 s99, s54, 35840
    buffer_load_dwordx4 a[24:27], v209, s[20:23], s99 offen sc1
    s_add_u32 s100, s54, 183296
    v_mfma_f32_16x16x32_bf16 v[104:107], v[176:179], a[208:211], v[104:107]
    s_waitcnt vmcnt(25)
    ds_read_b64_tr_b16 v[160:161], v219 offset:18656
    ds_read_b64_tr_b16 v[162:163], v219 offset:23264
    s_waitcnt lgkmcnt(6)
    v_mfma_f32_16x16x32_bf16 v[104:107], v[180:183], a[216:219], v[104:107]
    s_barrier
    buffer_load_dwordx4 a[28:31], v209, s[20:23], s100 offen sc1
    ds_read_b64_tr_b16 v[164:165], v219 offset:27872
    ds_read_b64_tr_b16 v[166:167], v219 offset:32480
    v_mfma_f32_16x16x32_bf16 v[108:111], v[176:179], a[212:215], v[108:111]
    ds_read_b64_tr_b16 v[168:169], v219 offset:18688
    ds_read_b64_tr_b16 v[170:171], v219 offset:23296
    v_mfma_f32_16x16x32_bf16 v[108:111], v[180:183], a[220:223], v[108:111]
    s_waitcnt lgkmcnt(8)
    ds_read_b64_tr_b16 v[172:173], v219 offset:27904
    ds_read_b64_tr_b16 v[174:175], v219 offset:32512
    v_mfma_f32_16x16x32_bf16 v[112:115], v[184:187], a[208:211], v[112:115]
    s_waitcnt lgkmcnt(8)
    ds_read_b64_tr_b16 v[176:177], v219 offset:36928
    ds_read_b64_tr_b16 v[178:179], v219 offset:41536
    v_mfma_f32_16x16x32_bf16 v[112:115], v[188:191], a[216:219], v[112:115]
    ds_read_b64_tr_b16 v[180:181], v219 offset:46144
    ds_read_b64_tr_b16 v[182:183], v219 offset:50752
    v_mfma_f32_16x16x32_bf16 v[116:119], v[184:187], a[212:215], v[116:119]
    v_mfma_f32_16x16x32_bf16 v[116:119], v[188:191], a[220:223], v[116:119]
    s_waitcnt lgkmcnt(10)
    ds_read_b64_tr_b16 v[184:185], v219 offset:55360
    ds_read_b64_tr_b16 v[186:187], v219 offset:59968
    v_mfma_f32_16x16x32_bf16 v[120:123], v[160:163], a[208:211], v[120:123]
    s_waitcnt vmcnt(16)
    ds_read_b64_tr_b16 v[188:189], v219 offset:64576
    ds_read_b64_tr_b16 v[190:191], v220 offset:3648
    s_waitcnt lgkmcnt(12)
    v_mfma_f32_16x16x32_bf16 v[120:123], v[164:167], a[216:219], v[120:123]
    s_barrier
    v_mfma_f32_16x16x32_bf16 v[124:127], v[160:163], a[212:215], v[124:127]
    v_mfma_f32_16x16x32_bf16 v[124:127], v[164:167], a[220:223], v[124:127]
    s_waitcnt lgkmcnt(10)
    ds_read_b64_tr_b16 v[160:161], v220 offset:53312
    ds_read_b64_tr_b16 v[162:163], v220 offset:57920
    v_mfma_f32_16x16x32_bf16 v[128:131], v[168:171], a[208:211], v[128:131]
    s_waitcnt lgkmcnt(10)
    ds_read_b64_tr_b16 v[164:165], v220 offset:62528
    ds_read_b64_tr_b16 v[166:167], v221 offset:1600
    v_mfma_f32_16x16x32_bf16 v[128:131], v[172:175], a[216:219], v[128:131]
    v_mfma_f32_16x16x32_bf16 v[132:135], v[168:171], a[212:215], v[132:135]
    v_mfma_f32_16x16x32_bf16 v[132:135], v[172:175], a[220:223], v[132:135]
    s_waitcnt vmcnt(15) lgkmcnt(10)
    ds_read_b64_tr_b16 v[168:169], v221 offset:6208
    ds_read_b64_tr_b16 v[170:171], v221 offset:10816
    v_mfma_f32_16x16x32_bf16 v[80:83], v[176:179], a[224:227], v[80:83]
    s_waitcnt vmcnt(13) lgkmcnt(10)
    ds_read_b64_tr_b16 v[172:173], v221 offset:15424
    ds_read_b64_tr_b16 v[174:175], v221 offset:20032
    v_mfma_f32_16x16x32_bf16 v[80:83], v[180:183], a[232:235], v[80:83]
    v_mfma_f32_16x16x32_bf16 v[84:87], v[176:179], a[228:231], v[84:87]
    s_waitcnt vmcnt(12)
    v_mfma_f32_16x16x32_bf16 v[84:87], v[180:183], a[236:239], v[84:87]
    s_waitcnt vmcnt(11) lgkmcnt(10)
    ds_read_b64_tr_b16 v[176:177], v219 offset:36960
    ds_read_b64_tr_b16 v[178:179], v219 offset:41568
    v_mfma_f32_16x16x32_bf16 v[80:83], v[184:187], a[240:243], v[80:83]
    s_add_u32 s69, s55, 3
    v_subrev_u32 v245, s69, v244
    v_cmp_le_u32 vcc, 8, v245
    s_nop 1
    s_cbranch_vccnz L_spin4
L_back4:
    s_waitcnt vmcnt(9) lgkmcnt(10)
    v_mfma_f32_16x16x32_bf16 v[80:83], v[188:191], a[248:251], v[80:83]
    ds_read_b64_tr_b16 v[180:181], v219 offset:46176
    ds_read_b64_tr_b16 v[182:183], v219 offset:50784
    v_mfma_f32_16x16x32_bf16 v[84:87], v[184:187], a[244:247], v[84:87]
    s_waitcnt vmcnt(8)
    v_mfma_f32_16x16x32_bf16 v[84:87], v[188:191], a[252:255], v[84:87]
    s_waitcnt vmcnt(7) lgkmcnt(10)
    ds_read_b64_tr_b16 v[184:185], v219 offset:55392
    ds_read_b64_tr_b16 v[186:187], v219 offset:60000
    v_mfma_f32_16x16x32_bf16 v[80:83], v[160:163], a[0:3], v[80:83]
    s_waitcnt vmcnt(5) lgkmcnt(10)
    ds_read_b64_tr_b16 v[188:189], v219 offset:64608
    ds_read_b64_tr_b16 v[190:191], v220 offset:3680
    v_mfma_f32_16x16x32_bf16 v[80:83], v[164:167], a[8:11], v[80:83]
    v_mfma_f32_16x16x32_bf16 v[84:87], v[160:163], a[4:7], v[84:87]
    s_waitcnt vmcnt(4)
    v_mfma_f32_16x16x32_bf16 v[84:87], v[164:167], a[12:15], v[84:87]
    s_waitcnt vmcnt(3) lgkmcnt(10)
    ds_read_b64_tr_b16 v[160:161], v220 offset:53344
    ds_read_b64_tr_b16 v[162:163], v220 offset:57952
    v_mfma_f32_16x16x32_bf16 v[80:83], v[168:171], a[16:19], v[80:83]
    s_waitcnt vmcnt(1) lgkmcnt(10)
    ds_read_b64_tr_b16 v[164:165], v220 offset:62560
    ds_read_b64_tr_b16 v[166:167], v221 offset:1632
    v_mfma_f32_16x16x32_bf16 v[80:83], v[172:175], a[24:27], v[80:83]
    v_mfma_f32_16x16x32_bf16 v[84:87], v[168:171], a[20:23], v[84:87]
    s_waitcnt vmcnt(0)
    v_mfma_f32_16x16x32_bf16 v[84:87], v[172:175], a[28:31], v[84:87]
    s_waitcnt lgkmcnt(10)
    ds_read_b64_tr_b16 v[168:169], v221 offset:6240
    ds_read_b64_tr_b16 v[170:171], v221 offset:10848
    v_mfma_f32_16x16x32_bf16 v[88:91], v[176:179], a[224:227], v[88:91]
    s_waitcnt lgkmcnt(10)
    ds_read_b64_tr_b16 v[172:173], v221 offset:15456
    ds_read_b64_tr_b16 v[174:175], v221 offset:20064
    v_mfma_f32_16x16x32_bf16 v[88:91], v[180:183], a[232:235], v[88:91]
    v_mfma_f32_16x16x32_bf16 v[92:95], v[176:179], a[228:231], v[92:95]
    v_mfma_f32_16x16x32_bf16 v[92:95], v[180:183], a[236:239], v[92:95]
    s_waitcnt lgkmcnt(10)
    ds_read_b64_tr_b16 v[176:177], v219 offset:36992
    ds_read_b64_tr_b16 v[178:179], v219 offset:41600
    v_mfma_f32_16x16x32_bf16 v[88:91], v[184:187], a[240:243], v[88:91]
    s_waitcnt lgkmcnt(10)
    ds_read_b64_tr_b16 v[180:181], v219 offset:46208
    ds_read_b64_tr_b16 v[182:183], v219 offset:50816
    v_mfma_f32_16x16x32_bf16 v[88:91], v[188:191], a[248:251], v[88:91]
    v_cvt_pk_bf16_f32 v8, v80, v81
    v_cvt_pk_bf16_f32 v9, v82, v83
    v_mfma_f32_16x16x32_bf16 v[92:95], v[184:187], a[244:247], v[92:95]
    v_min_u32 v8, -2, v8
    v_min_u32 v9, -2, v9
    v_mfma_f32_16x16x32_bf16 v[92:95], v[188:191], a[252:255], v[92:95]
    s_waitcnt lgkmcnt(10)
    ds_read_b64_tr_b16 v[184:185], v219 offset:55424
    ds_read_b64_tr_b16 v[186:187], v219 offset:60032
    v_mfma_f32_16x16x32_bf16 v[88:91], v[160:163], a[0:3], v[88:91]
    s_waitcnt lgkmcnt(10)
    ds_read_b64_tr_b16 v[188:189], v219 offset:64640
    ds_read_b64_tr_b16 v[190:191], v220 offset:3712
    v_mfma_f32_16x16x32_bf16 v[88:91], v[164:167], a[8:11], v[88:91]
    v_cvt_pk_bf16_f32 v10, v84, v85
    v_cvt_pk_bf16_f32 v11, v86, v87
    v_mfma_f32_16x16x32_bf16 v[92:95], v[160:163], a[4:7], v[92:95]
    v_min_u32 v10, -2, v10
    v_min_u32 v11, -2, v11
    v_mfma_f32_16x16x32_bf16 v[92:95], v[164:167], a[12:15], v[92:95]
    s_waitcnt lgkmcnt(10)
    buffer_store_dwordx4 v[8:11], v209, s[24:27], s56 offen sc1
    v_mfma_f32_16x16x32_bf16 v[88:91], v[168:171], a[16:19], v[88:91]
    s_waitcnt lgkmcnt(8)
    ds_read_b64_tr_b16 v[160:161], v220 offset:53376
    ds_read_b64_tr_b16 v[162:163], v220 offset:57984
    v_mfma_f32_16x16x32_bf16 v[88:91], v[172:175], a[24:27], v[88:91]
    ds_read_b64_tr_b16 v[164:165], v220 offset:62592
    ds_read_b64_tr_b16 v[166:167], v221 offset:1664
    v_mfma_f32_16x16x32_bf16 v[92:95], v[168:171], a[20:23], v[92:95]
    v_mfma_f32_16x16x32_bf16 v[92:95], v[172:175], a[28:31], v[92:95]
    s_waitcnt lgkmcnt(10)
    ds_read_b64_tr_b16 v[168:169], v221 offset:6272
    ds_read_b64_tr_b16 v[170:171], v221 offset:10880
    v_mfma_f32_16x16x32_bf16 v[96:99], v[176:179], a[224:227], v[96:99]
    s_waitcnt lgkmcnt(10)
    ds_read_b64_tr_b16 v[172:173], v221 offset:15488
    ds_read_b64_tr_b16 v[174:175], v221 offset:20096
    v_mfma_f32_16x16x32_bf16 v[96:99], v[180:183], a[232:235], v[96:99]
    v_mfma_f32_16x16x32_bf16 v[100:103], v[176:179], a[228:231], v[100:103]
    v_mfma_f32_16x16x32_bf16 v[100:103], v[180:183], a[236:239], v[100:103]
    s_waitcnt lgkmcnt(10)
    ds_read_b64_tr_b16 v[176:177], v219 offset:37024
    ds_read_b64_tr_b16 v[178:179], v219 offset:41632
    v_mfma_f32_16x16x32_bf16 v[96:99], v[184:187], a[240:243], v[96:99]
    s_waitcnt lgkmcnt(10)
    ds_read_b64_tr_b16 v[180:181], v219 offset:46240
    ds_read_b64_tr_b16 v[182:183], v219 offset:50848
    v_mfma_f32_16x16x32_bf16 v[96:99], v[188:191], a[248:251], v[96:99]
    v_cvt_pk_bf16_f32 v12, v88, v89
    v_cvt_pk_bf16_f32 v13, v90, v91
    v_mfma_f32_16x16x32_bf16 v[100:103], v[184:187], a[244:247], v[100:103]
    v_min_u32 v12, -2, v12
    v_min_u32 v13, -2, v13
    v_mfma_f32_16x16x32_bf16 v[100:103], v[188:191], a[252:255], v[100:103]
    s_waitcnt lgkmcnt(10)
    ds_read_b64_tr_b16 v[184:185], v219 offset:55456
    ds_read_b64_tr_b16 v[186:187], v219 offset:60064
    v_mfma_f32_16x16x32_bf16 v[96:99], v[160:163], a[0:3], v[96:99]
    s_waitcnt lgkmcnt(10)
    ds_read_b64_tr_b16 v[188:189], v219 offset:64672
    ds_read_b64_tr_b16 v[190:191], v220 offset:3744
    v_mfma_f32_16x16x32_bf16 v[96:99], v[164:167], a[8:11], v[96:99]
    v_cvt_pk_bf16_f32 v14, v92, v93
    v_cvt_pk_bf16_f32 v15, v94, v95
    v_mfma_f32_16x16x32_bf16 v[100:103], v[160:163], a[4:7], v[100:103]
    v_min_u32 v14, -2, v14
    v_min_u32 v15, -2, v15
    v_mfma_f32_16x16x32_bf16 v[100:103], v[164:167], a[12:15], v[100:103]
    s_waitcnt lgkmcnt(10)
    buffer_store_dwordx4 v[12:15], v209, s[24:27], s56 offen offset:1024 sc1
    v_mfma_f32_16x16x32_bf16 v[96:99], v[168:171], a[16:19], v[96:99]
    s_waitcnt lgkmcnt(8)
    ds_read_b64_tr_b16 v[160:161], v220 offset:53408
    ds_read_b64_tr_b16 v[162:163], v220 offset:58016
    v_mfma_f32_16x16x32_bf16 v[96:99], v[172:175], a[24:27], v[96:99]
    ds_read_b64_tr_b16 v[164:165], v220 offset:62624
    ds_read_b64_tr_b16 v[166:167], v221 offset:1696
    v_mfma_f32_16x16x32_bf16 v[100:103], v[168:171], a[20:23], v[100:103]
    v_mfma_f32_16x16x32_bf16 v[100:103], v[172:175], a[28:31], v[100:103]
    s_waitcnt lgkmcnt(10)
    ds_read_b64_tr_b16 v[168:169], v221 offset:6304
    ds_read_b64_tr_b16 v[170:171], v221 offset:10912
    v_mfma_f32_16x16x32_bf16 v[104:107], v[176:179], a[224:227], v[104:107]
    s_waitcnt lgkmcnt(10)
    ds_read_b64_tr_b16 v[172:173], v221 offset:15520
    ds_read_b64_tr_b16 v[174:175], v221 offset:20128
    v_mfma_f32_16x16x32_bf16 v[104:107], v[180:183], a[232:235], v[104:107]
    v_mfma_f32_16x16x32_bf16 v[108:111], v[176:179], a[228:231], v[108:111]
    v_mfma_f32_16x16x32_bf16 v[108:111], v[180:183], a[236:239], v[108:111]
    s_waitcnt lgkmcnt(10)
    ds_read_b64_tr_b16 v[176:177], v219 offset:37056
    ds_read_b64_tr_b16 v[178:179], v219 offset:41664
    v_mfma_f32_16x16x32_bf16 v[104:107], v[184:187], a[240:243], v[104:107]
    s_waitcnt lgkmcnt(10)
    ds_read_b64_tr_b16 v[180:181], v219 offset:46272
    ds_read_b64_tr_b16 v[182:183], v219 offset:50880
    v_mfma_f32_16x16x32_bf16 v[104:107], v[188:191], a[248:251], v[104:107]
    v_cvt_pk_bf16_f32 v16, v96, v97
    v_cvt_pk_bf16_f32 v17, v98, v99
    v_mfma_f32_16x16x32_bf16 v[108:111], v[184:187], a[244:247], v[108:111]
    v_min_u32 v16, -2, v16
    v_min_u32 v17, -2, v17
    v_mfma_f32_16x16x32_bf16 v[108:111], v[188:191], a[252:255], v[108:111]
    s_waitcnt lgkmcnt(10)
    ds_read_b64_tr_b16 v[184:185], v219 offset:55488
    ds_read_b64_tr_b16 v[186:187], v219 offset:60096
    v_mfma_f32_16x16x32_bf16 v[104:107], v[160:163], a[0:3], v[104:107]
    s_waitcnt lgkmcnt(10)
    ds_read_b64_tr_b16 v[188:189], v219 offset:64704
    ds_read_b64_tr_b16 v[190:191], v220 offset:3776
    v_mfma_f32_16x16x32_bf16 v[104:107], v[164:167], a[8:11], v[104:107]
    v_cvt_pk_bf16_f32 v18, v100, v101
    v_cvt_pk_bf16_f32 v19, v102, v103
    v_mfma_f32_16x16x32_bf16 v[108:111], v[160:163], a[4:7], v[108:111]
    v_min_u32 v18, -2, v18
    v_min_u32 v19, -2, v19
    v_mfma_f32_16x16x32_bf16 v[108:111], v[164:167], a[12:15], v[108:111]
    s_waitcnt lgkmcnt(10)
    buffer_store_dwordx4 v[16:19], v209, s[24:27], s57 offen sc1
    v_mfma_f32_16x16x32_bf16 v[104:107], v[168:171], a[16:19], v[104:107]
    s_waitcnt lgkmcnt(8)
    ds_read_b64_tr_b16 v[160:161], v220 offset:53440
    ds_read_b64_tr_b16 v[162:163], v220 offset:58048
    v_mfma_f32_16x16x32_bf16 v[104:107], v[172:175], a[24:27], v[104:107]
    ds_read_b64_tr_b16 v[164:165], v220 offset:62656
    ds_read_b64_tr_b16 v[166:167], v221 offset:1728
    v_mfma_f32_16x16x32_bf16 v[108:111], v[168:171], a[20:23], v[108:111]
    v_mfma_f32_16x16x32_bf16 v[108:111], v[172:175], a[28:31], v[108:111]
    s_waitcnt lgkmcnt(10)
    ds_read_b64_tr_b16 v[168:169], v221 offset:6336
    ds_read_b64_tr_b16 v[170:171], v221 offset:10944
    v_mfma_f32_16x16x32_bf16 v[112:115], v[176:179], a[224:227], v[112:115]
    s_waitcnt lgkmcnt(10)
    ds_read_b64_tr_b16 v[172:173], v221 offset:15552
    ds_read_b64_tr_b16 v[174:175], v221 offset:20160
    v_mfma_f32_16x16x32_bf16 v[112:115], v[180:183], a[232:235], v[112:115]
    v_mfma_f32_16x16x32_bf16 v[116:119], v[176:179], a[228:231], v[116:119]
    v_mfma_f32_16x16x32_bf16 v[116:119], v[180:183], a[236:239], v[116:119]
    s_waitcnt lgkmcnt(10)
    ds_read_b64_tr_b16 v[176:177], v219 offset:37088
    ds_read_b64_tr_b16 v[178:179], v219 offset:41696
    v_mfma_f32_16x16x32_bf16 v[112:115], v[184:187], a[240:243], v[112:115]
    s_waitcnt lgkmcnt(10)
    ds_read_b64_tr_b16 v[180:181], v219 offset:46304
    ds_read_b64_tr_b16 v[182:183], v219 offset:50912
    v_mfma_f32_16x16x32_bf16 v[112:115], v[188:191], a[248:251], v[112:115]
    v_cvt_pk_bf16_f32 v20, v104, v105
    v_cvt_pk_bf16_f32 v21, v106, v107
    v_mfma_f32_16x16x32_bf16 v[116:119], v[184:187], a[244:247], v[116:119]
    v_min_u32 v20, -2, v20
    v_min_u32 v21, -2, v21
    v_mfma_f32_16x16x32_bf16 v[116:119], v[188:191], a[252:255], v[116:119]
    s_waitcnt lgkmcnt(10)
    ds_read_b64_tr_b16 v[184:185], v219 offset:55520
    ds_read_b64_tr_b16 v[186:187], v219 offset:60128
    v_mfma_f32_16x16x32_bf16 v[112:115], v[160:163], a[0:3], v[112:115]
    s_waitcnt lgkmcnt(10)
    ds_read_b64_tr_b16 v[188:189], v219 offset:64736
    ds_read_b64_tr_b16 v[190:191], v220 offset:3808
    v_mfma_f32_16x16x32_bf16 v[112:115], v[164:167], a[8:11], v[112:115]
    v_cvt_pk_bf16_f32 v22, v108, v109
    v_cvt_pk_bf16_f32 v23, v110, v111
    v_mfma_f32_16x16x32_bf16 v[116:119], v[160:163], a[4:7], v[116:119]
    v_min_u32 v22, -2, v22
    v_min_u32 v23, -2, v23
    v_mfma_f32_16x16x32_bf16 v[116:119], v[164:167], a[12:15], v[116:119]
    s_waitcnt lgkmcnt(10)
    buffer_store_dwordx4 v[20:23], v209, s[24:27], s57 offen offset:1024 sc1
    v_mfma_f32_16x16x32_bf16 v[112:115], v[168:171], a[16:19], v[112:115]
    s_waitcnt lgkmcnt(8)
    ds_read_b64_tr_b16 v[160:161], v220 offset:53472
    ds_read_b64_tr_b16 v[162:163], v220 offset:58080
    v_mfma_f32_16x16x32_bf16 v[112:115], v[172:175], a[24:27], v[112:115]
    ds_read_b64_tr_b16 v[164:165], v220 offset:62688
    ds_read_b64_tr_b16 v[166:167], v221 offset:1760
    v_mfma_f32_16x16x32_bf16 v[116:119], v[168:171], a[20:23], v[116:119]
    v_mfma_f32_16x16x32_bf16 v[116:119], v[172:175], a[28:31], v[116:119]
    s_waitcnt lgkmcnt(10)
    ds_read_b64_tr_b16 v[168:169], v221 offset:6368
    ds_read_b64_tr_b16 v[170:171], v221 offset:10976
    v_mfma_f32_16x16x32_bf16 v[120:123], v[176:179], a[224:227], v[120:123]
    s_waitcnt lgkmcnt(10)
    ds_read_b64_tr_b16 v[172:173], v221 offset:15584
    ds_read_b64_tr_b16 v[174:175], v221 offset:20192
    v_mfma_f32_16x16x32_bf16 v[120:123], v[180:183], a[232:235], v[120:123]
    v_mfma_f32_16x16x32_bf16 v[124:127], v[176:179], a[228:231], v[124:127]
    v_mfma_f32_16x16x32_bf16 v[124:127], v[180:183], a[236:239], v[124:127]
    s_waitcnt lgkmcnt(10)
    ds_read_b64_tr_b16 v[176:177], v219 offset:37120
    ds_read_b64_tr_b16 v[178:179], v219 offset:41728
    v_mfma_f32_16x16x32_bf16 v[120:123], v[184:187], a[240:243], v[120:123]
    s_waitcnt lgkmcnt(10)
    ds_read_b64_tr_b16 v[180:181], v219 offset:46336
    ds_read_b64_tr_b16 v[182:183], v219 offset:50944
    v_mfma_f32_16x16x32_bf16 v[120:123], v[188:191], a[248:251], v[120:123]
    v_cvt_pk_bf16_f32 v24, v112, v113
    v_cvt_pk_bf16_f32 v25, v114, v115
    v_mfma_f32_16x16x32_bf16 v[124:127], v[184:187], a[244:247], v[124:127]
    v_min_u32 v24, -2, v24
    v_min_u32 v25, -2, v25
    v_mfma_f32_16x16x32_bf16 v[124:127], v[188:191], a[252:255], v[124:127]
    s_waitcnt lgkmcnt(10)
    ds_read_b64_tr_b16 v[184:185], v219 offset:55552
    ds_read_b64_tr_b16 v[186:187], v219 offset:60160
    v_mfma_f32_16x16x32_bf16 v[120:123], v[160:163], a[0:3], v[120:123]
    s_waitcnt lgkmcnt(10)
    ds_read_b64_tr_b16 v[188:189], v219 offset:64768
    ds_read_b64_tr_b16 v[190:191], v220 offset:3840
    v_mfma_f32_16x16x32_bf16 v[120:123], v[164:167], a[8:11], v[120:123]
    v_cvt_pk_bf16_f32 v26, v116, v117
    v_cvt_pk_bf16_f32 v27, v118, v119
    v_mfma_f32_16x16x32_bf16 v[124:127], v[160:163], a[4:7], v[124:127]
    v_min_u32 v26, -2, v26
    v_min_u32 v27, -2, v27
    v_mfma_f32_16x16x32_bf16 v[124:127], v[164:167], a[12:15], v[124:127]
    s_waitcnt lgkmcnt(10)
    buffer_store_dwordx4 v[24:27], v209, s[24:27], s58 offen sc1
    v_mfma_f32_16x16x32_bf16 v[120:123], v[168:171], a[16:19], v[120:123]
    s_waitcnt lgkmcnt(8)
    ds_read_b64_tr_b16 v[160:161], v220 offset:53504
    ds_read_b64_tr_b16 v[162:163], v220 offset:58112
    v_mfma_f32_16x16x32_bf16 v[120:123], v[172:175], a[24:27], v[120:123]
    ds_read_b64_tr_b16 v[164:165], v220 offset:62720
    ds_read_b64_tr_b16 v[166:167], v221 offset:1792
    v_mfma_f32_16x16x32_bf16 v[124:127], v[168:171], a[20:23], v[124:127]
    v_mfma_f32_16x16x32_bf16 v[124:127], v[172:175], a[28:31], v[124:127]
    s_waitcnt lgkmcnt(10)
    ds_read_b64_tr_b16 v[168:169], v221 offset:6400
    ds_read_b64_tr_b16 v[170:171], v221 offset:11008
    v_mfma_f32_16x16x32_bf16 v[128:131], v[176:179], a[224:227], v[128:131]
    s_waitcnt lgkmcnt(10)
    ds_read_b64_tr_b16 v[172:173], v221 offset:15616
    ds_read_b64_tr_b16 v[174:175], v221 offset:20224
    v_mfma_f32_16x16x32_bf16 v[128:131], v[180:183], a[232:235], v[128:131]
    v_mfma_f32_16x16x32_bf16 v[132:135], v[176:179], a[228:231], v[132:135]
    v_mfma_f32_16x16x32_bf16 v[132:135], v[180:183], a[236:239], v[132:135]
    s_waitcnt lgkmcnt(10)
    ds_read_b64_tr_b16 v[176:177], v220 offset:16384
    ds_read_b64_tr_b16 v[178:179], v220 offset:20992
    v_mfma_f32_16x16x32_bf16 v[128:131], v[184:187], a[240:243], v[128:131]
    s_waitcnt lgkmcnt(10)
    ds_read_b64_tr_b16 v[180:181], v220 offset:25600
    ds_read_b64_tr_b16 v[182:183], v220 offset:30208
    v_mfma_f32_16x16x32_bf16 v[128:131], v[188:191], a[248:251], v[128:131]
    v_cvt_pk_bf16_f32 v28, v120, v121
    v_cvt_pk_bf16_f32 v29, v122, v123
    v_mfma_f32_16x16x32_bf16 v[132:135], v[184:187], a[244:247], v[132:135]
    v_min_u32 v28, -2, v28
    v_min_u32 v29, -2, v29
    v_mfma_f32_16x16x32_bf16 v[132:135], v[188:191], a[252:255], v[132:135]
    s_waitcnt lgkmcnt(10)
    ds_read_b64_tr_b16 v[184:185], v220 offset:34816
    ds_read_b64_tr_b16 v[186:187], v220 offset:39424
    v_mfma_f32_16x16x32_bf16 v[128:131], v[160:163], a[0:3], v[128:131]
    s_waitcnt lgkmcnt(10)
    ds_read_b64_tr_b16 v[188:189], v220 offset:44032
    ds_read_b64_tr_b16 v[190:191], v220 offset:48640
    v_mfma_f32_16x16x32_bf16 v[128:131], v[164:167], a[8:11], v[128:131]
    v_cvt_pk_bf16_f32 v30, v124, v125
    v_cvt_pk_bf16_f32 v31, v126, v127
    v_mfma_f32_16x16x32_bf16 v[132:135], v[160:163], a[4:7], v[132:135]
    v_min_u32 v30, -2, v30
    v_min_u32 v31, -2, v31
    v_mfma_f32_16x16x32_bf16 v[132:135], v[164:167], a[12:15], v[132:135]
    s_waitcnt lgkmcnt(10)
    buffer_store_dwordx4 v[28:31], v209, s[24:27], s58 offen offset:1024 sc1
    v_mfma_f32_16x16x32_bf16 v[128:131], v[168:171], a[16:19], v[128:131]
    s_waitcnt lgkmcnt(8)
    ds_read_b64_tr_b16 v[160:161], v219 offset:0
    ds_read_b64_tr_b16 v[162:163], v219 offset:4608
    v_mfma_f32_16x16x32_bf16 v[128:131], v[172:175], a[24:27], v[128:131]
    ds_read_b64_tr_b16 v[164:165], v219 offset:9216
    ds_read_b64_tr_b16 v[166:167], v219 offset:13824
    v_mfma_f32_16x16x32_bf16 v[132:135], v[168:171], a[20:23], v[132:135]
    v_lshlrev_b32 v36, 3, v247
    v_mfma_f32_16x16x32_bf16 v[132:135], v[172:175], a[28:31], v[132:135]
    s_waitcnt lgkmcnt(10)
    ds_read_b64_tr_b16 v[168:169], v219 offset:18432
    ds_read_b64_tr_b16 v[170:171], v219 offset:23040
    v_mfma_f32_16x16x32_bf16 v[64:67], v[176:179], a[160:163], v[64:67]
    s_waitcnt lgkmcnt(10)
    ds_read_b64_tr_b16 v[172:173], v219 offset:27648
    ds_read_b64_tr_b16 v[174:175], v219 offset:32256
    v_mfma_f32_16x16x32_bf16 v[64:67], v[180:183], a[168:171], v[64:67]
    v_mfma_f32_16x16x32_bf16 v[68:71], v[176:179], a[164:167], v[68:71]
    v_mfma_f32_16x16x32_bf16 v[68:71], v[180:183], a[172:175], v[68:71]
    s_waitcnt lgkmcnt(10)
    ds_read_b64_tr_b16 v[176:177], v219 offset:36864
    ds_read_b64_tr_b16 v[178:179], v219 offset:41472
    v_mfma_f32_16x16x32_bf16 v[64:67], v[184:187], a[176:179], v[64:67]
    s_waitcnt lgkmcnt(10)
    ds_read_b64_tr_b16 v[180:181], v219 offset:46080
    ds_read_b64_tr_b16 v[182:183], v219 offset:50688
    v_mfma_f32_16x16x32_bf16 v[64:67], v[188:191], a[184:187], v[64:67]
    v_cvt_pk_bf16_f32 v32, v128, v129
    v_cvt_pk_bf16_f32 v33, v130, v131
    v_mfma_f32_16x16x32_bf16 v[68:71], v[184:187], a[180:183], v[68:71]
    v_min_u32 v32, -2, v32
    v_min_u32 v33, -2, v33
    v_mfma_f32_16x16x32_bf16 v[68:71], v[188:191], a[188:191], v[68:71]
    s_waitcnt lgkmcnt(10)
    buffer_store_dwordx2 v[32:33], v36, s[24:27], s59 offen sc1
    v_mfma_f32_16x16x32_bf16 v[64:67], v[160:163], a[192:195], v[64:67]
    s_waitcnt lgkmcnt(8)
    ds_read_b64_tr_b16 v[184:185], v219 offset:55296
    ds_read_b64_tr_b16 v[186:187], v219 offset:59904
    v_mfma_f32_16x16x32_bf16 v[64:67], v[164:167], a[200:203], v[64:67]
    ds_read_b64_tr_b16 v[188:189], v219 offset:64512
    ds_read_b64_tr_b16 v[190:191], v220 offset:3584
    v_mfma_f32_16x16x32_bf16 v[68:71], v[160:163], a[196:199], v[68:71]
    v_cvt_pk_bf16_f32 v34, v132, v133
    v_cvt_pk_bf16_f32 v35, v134, v135
    v_mfma_f32_16x16x32_bf16 v[68:71], v[164:167], a[204:207], v[68:71]
    s_waitcnt lgkmcnt(10)
    ds_read_b64_tr_b16 v[160:161], v220 offset:53248
    ds_read_b64_tr_b16 v[162:163], v220 offset:57856
    v_mfma_f32_16x16x32_bf16 v[64:67], v[168:171], a[208:211], v[64:67]
    s_waitcnt lgkmcnt(10)
    ds_read_b64_tr_b16 v[164:165], v220 offset:62464
    ds_read_b64_tr_b16 v[166:167], v221 offset:1536
    v_mfma_f32_16x16x32_bf16 v[64:67], v[172:175], a[216:219], v[64:67]
    v_min_u32 v34, -2, v34
    v_min_u32 v35, -2, v35
    v_mfma_f32_16x16x32_bf16 v[68:71], v[168:171], a[212:215], v[68:71]
    buffer_store_dwordx2 v[34:35], v36, s[24:27], s60 offen sc1
    v_mfma_f32_16x16x32_bf16 v[68:71], v[172:175], a[220:223], v[68:71]
    s_waitcnt lgkmcnt(10)
    ds_read_b64_tr_b16 v[168:169], v221 offset:6144
    ds_read_b64_tr_b16 v[170:171], v221 offset:10752
    v_mfma_f32_16x16x32_bf16 v[64:67], v[176:179], a[224:227], v[64:67]
    s_waitcnt lgkmcnt(10)
    ds_read_b64_tr_b16 v[172:173], v221 offset:15360
    ds_read_b64_tr_b16 v[174:175], v221 offset:19968
    v_mfma_f32_16x16x32_bf16 v[64:67], v[180:183], a[232:235], v[64:67]
    s_cmp_eq_u32 s38, 1
    s_cselect_b64 s[92:93], -1, 0
    v_cndmask_b32 v40, v128, v132, s[92:93]
    v_mfma_f32_16x16x32_bf16 v[68:71], v[176:179], a[228:231], v[68:71]
    v_cndmask_b32 v41, v129, v133, s[92:93]
    v_cndmask_b32 v42, v130, v134, s[92:93]
    v_mfma_f32_16x16x32_bf16 v[68:71], v[180:183], a[236:239], v[68:71]
    s_waitcnt lgkmcnt(10)
    ds_read_b64_tr_b16 v[176:177], v220 offset:16416
    ds_read_b64_tr_b16 v[178:179], v220 offset:21024
    v_mfma_f32_16x16x32_bf16 v[64:67], v[184:187], a[240:243], v[64:67]
    s_waitcnt lgkmcnt(10)
    ds_read_b64_tr_b16 v[180:181], v220 offset:25632
    ds_read_b64_tr_b16 v[182:183], v220 offset:30240
    v_mfma_f32_16x16x32_bf16 v[64:67], v[188:191], a[248:251], v[64:67]
    v_cndmask_b32 v43, v131, v135, s[92:93]
    v_and_b32 v44, 15, v247
    v_mfma_f32_16x16x32_bf16 v[68:71], v[184:187], a[244:247], v[68:71]
    v_mul_u32_u24 v44, 1152, v44
    v_lshrrev_b32 v45, 4, v247
    v_mfma_f32_16x16x32_bf16 v[68:71], v[188:191], a[252:255], v[68:71]
    s_waitcnt lgkmcnt(10)
    ds_read_b64_tr_b16 v[184:185], v220 offset:34848
    ds_read_b64_tr_b16 v[186:187], v220 offset:39456
    v_mfma_f32_16x16x32_bf16 v[64:67], v[160:163], a[0:3], v[64:67]
    s_waitcnt lgkmcnt(10)
    ds_read_b64_tr_b16 v[188:189], v220 offset:44064
    ds_read_b64_tr_b16 v[190:191], v220 offset:48672
    v_mfma_f32_16x16x32_bf16 v[64:67], v[164:167], a[8:11], v[64:67]
    v_lshl_add_u32 v46, v45, 3, v44
    v_mfma_f32_16x16x32_bf16 v[68:71], v[160:163], a[4:7], v[68:71]
    v_mfma_f32_16x16x32_bf16 v[68:71], v[164:167], a[12:15], v[68:71]
    s_waitcnt lgkmcnt(10)
    ds_read_b64_tr_b16 v[160:161], v219 offset:32
    ds_read_b64_tr_b16 v[162:163], v219 offset:4640
    v_mfma_f32_16x16x32_bf16 v[64:67], v[168:171], a[16:19], v[64:67]
    s_waitcnt lgkmcnt(10)
    ds_read_b64_tr_b16 v[164:165], v219 offset:9248
    ds_read_b64_tr_b16 v[166:167], v219 offset:13856
    v_mfma_f32_16x16x32_bf16 v[64:67], v[172:175], a[24:27], v[64:67]
    v_mfma_f32_16x16x32_bf16 v[68:71], v[168:171], a[20:23], v[68:71]
    v_mfma_f32_16x16x32_bf16 v[68:71], v[172:175], a[28:31], v[68:71]
    s_waitcnt lgkmcnt(10)
    ds_read_b64_tr_b16 v[168:169], v219 offset:18464
    ds_read_b64_tr_b16 v[170:171], v219 offset:23072
    v_mfma_f32_16x16x32_bf16 v[72:75], v[176:179], a[160:163], v[72:75]
    s_waitcnt lgkmcnt(10)
    ds_read_b64_tr_b16 v[172:173], v219 offset:27680
    ds_read_b64_tr_b16 v[174:175], v219 offset:32288
    v_mfma_f32_16x16x32_bf16 v[72:75], v[180:183], a[168:171], v[72:75]
    v_mfma_f32_16x16x32_bf16 v[76:79], v[176:179], a[164:167], v[76:79]
    v_mfma_f32_16x16x32_bf16 v[76:79], v[180:183], a[172:175], v[76:79]
    s_waitcnt lgkmcnt(10)
    ds_read_b64_tr_b16 v[176:177], v219 offset:36896
    ds_read_b64_tr_b16 v[178:179], v219 offset:41504
    v_mfma_f32_16x16x32_bf16 v[72:75], v[184:187], a[176:179], v[72:75]
    s_waitcnt lgkmcnt(10)
    ds_read_b64_tr_b16 v[180:181], v219 offset:46112
    ds_read_b64_tr_b16 v[182:183], v219 offset:50720
    v_mfma_f32_16x16x32_bf16 v[72:75], v[188:191], a[184:187], v[72:75]
    v_mfma_f32_16x16x32_bf16 v[76:79], v[184:187], a[180:183], v[76:79]
    v_mfma_f32_16x16x32_bf16 v[76:79], v[188:191], a[188:191], v[76:79]
    s_waitcnt lgkmcnt(10)
    ds_read_b64_tr_b16 v[184:185], v219 offset:55328
    ds_read_b64_tr_b16 v[186:187], v219 offset:59936
    v_mfma_f32_16x16x32_bf16 v[72:75], v[160:163], a[192:195], v[72:75]
    s_waitcnt lgkmcnt(10)
    ds_read_b64_tr_b16 v[188:189], v219 offset:64544
    ds_read_b64_tr_b16 v[190:191], v220 offset:3616
    v_mfma_f32_16x16x32_bf16 v[72:75], v[164:167], a[200:203], v[72:75]
    v_mfma_f32_16x16x32_bf16 v[76:79], v[160:163], a[196:199], v[76:79]
    v_mfma_f32_16x16x32_bf16 v[76:79], v[164:167], a[204:207], v[76:79]
    s_waitcnt lgkmcnt(10)
    ds_read_b64_tr_b16 v[160:161], v220 offset:53280
    ds_read_b64_tr_b16 v[162:163], v220 offset:57888
    v_mfma_f32_16x16x32_bf16 v[72:75], v[168:171], a[208:211], v[72:75]
    s_waitcnt lgkmcnt(10)
    ds_read_b64_tr_b16 v[164:165], v220 offset:62496
    ds_read_b64_tr_b16 v[166:167], v221 offset:1568
    v_mfma_f32_16x16x32_bf16 v[72:75], v[172:175], a[216:219], v[72:75]
    v_mfma_f32_16x16x32_bf16 v[76:79], v[168:171], a[212:215], v[76:79]
    v_mfma_f32_16x16x32_bf16 v[76:79], v[172:175], a[220:223], v[76:79]
    s_waitcnt lgkmcnt(10)
    ds_read_b64_tr_b16 v[168:169], v221 offset:6176
    ds_read_b64_tr_b16 v[170:171], v221 offset:10784
    v_mfma_f32_16x16x32_bf16 v[72:75], v[176:179], a[224:227], v[72:75]
    s_waitcnt lgkmcnt(10)
    ds_read_b64_tr_b16 v[172:173], v221 offset:15392
    ds_read_b64_tr_b16 v[174:175], v221 offset:20000
    v_mfma_f32_16x16x32_bf16 v[72:75], v[180:183], a[232:235], v[72:75]
    v_mfma_f32_16x16x32_bf16 v[76:79], v[176:179], a[228:231], v[76:79]
    v_mfma_f32_16x16x32_bf16 v[76:79], v[180:183], a[236:239], v[76:79]
    s_waitcnt lgkmcnt(10)
    v_mfma_f32_16x16x32_bf16 v[72:75], v[184:187], a[240:243], v[72:75]
    s_waitcnt lgkmcnt(8)
    v_mfma_f32_16x16x32_bf16 v[72:75], v[188:191], a[248:251], v[72:75]
    v_mfma_f32_16x16x32_bf16 v[76:79], v[184:187], a[244:247], v[76:79]
    v_mfma_f32_16x16x32_bf16 v[76:79], v[188:191], a[252:255], v[76:79]
    s_waitcnt lgkmcnt(6)
    v_mfma_f32_16x16x32_bf16 v[72:75], v[160:163], a[0:3], v[72:75]
    s_waitcnt lgkmcnt(4)
    v_mfma_f32_16x16x32_bf16 v[72:75], v[164:167], a[8:11], v[72:75]
    v_mfma_f32_16x16x32_bf16 v[76:79], v[160:163], a[4:7], v[76:79]
    v_mfma_f32_16x16x32_bf16 v[76:79], v[164:167], a[12:15], v[76:79]
    s_waitcnt lgkmcnt(2)
    v_mfma_f32_16x16x32_bf16 v[72:75], v[168:171], a[16:19], v[72:75]
    s_waitcnt lgkmcnt(0)
    v_mfma_f32_16x16x32_bf16 v[72:75], v[172:175], a[24:27], v[72:75]
    v_mfma_f32_16x16x32_bf16 v[76:79], v[168:171], a[20:23], v[76:79]
    v_mfma_f32_16x16x32_bf16 v[76:79], v[172:175], a[28:31], v[76:79]
L_rx:
    buffer_load_dwordx4 v[136:139], v209, s[24:27], s61 offen sc1
    buffer_load_dwordx4 v[140:143], v209, s[24:27], s61 offen offset:1024 sc1
    buffer_load_dwordx2 v[48:49], v36, s[24:27], s64 offen sc1
    buffer_load_dwordx4 v[144:147], v209, s[24:27], s62 offen sc1
    buffer_load_dwordx4 v[148:151], v209, s[24:27], s62 offen offset:1024 sc1
    buffer_load_dwordx2 v[50:51], v36, s[24:27], s65 offen sc1
    buffer_load_dwordx4 v[152:155], v209, s[24:27], s63 offen sc1
    buffer_load_dwordx4 v[156:159], v209, s[24:27], s63 offen offset:1024 sc1
    buffer_load_dwordx2 v[52:53], v36, s[24:27], s66 offen sc1
    s_waitcnt vmcnt(0)
    v_max3_u32 v47, v136, v137, v138
    v_max3_u32 v47, v47, v139, v140
    v_max3_u32 v47, v47, v141, v142
    v_max3_u32 v47, v47, v143, v144
    v_max3_u32 v47, v47, v145, v146
    v_max3_u32 v47, v47, v147, v148
    v_max3_u32 v47, v47, v149, v150
    v_max3_u32 v47, v47, v151, v152
    v_max3_u32 v47, v47, v153, v154
    v_max3_u32 v47, v47, v155, v156
    v_max3_u32 v47, v47, v157, v158
    v_max3_u32 v47, v47, v159, v48
    v_max3_u32 v47, v47, v49, v50
    v_max3_u32 v47, v47, v51, v52
    v_max_u32 v47, v47, v53
    v_cmp_eq_u32 vcc, -1, v47
    s_nop 1
    s_cbranch_vccz L_rx_ok
    s_sub_u32 s96, s96, 1
    s_cbranch_scc0 L_rx
    s_mov_b32 s96, 0
L_rx_ok:
    v_and_b32 v44, 15, v247
    v_mul_u32_u24 v44, 1152, v44
    v_lshrrev_b32 v45, 4, v247
    v_lshl_add_u32 v39, v45, 4, v44
    v_lshlrev_b32 v184, 16, v136
    v_and_b32 v185, 0xffff0000, v136
    v_pk_add_f32 v[64:65], v[64:65], v[184:185]
    v_lshlrev_b32 v186, 16, v137
    v_and_b32 v187, 0xffff0000, v137
    v_pk_add_f32 v[66:67], v[66:67], v[186:187]
    v_lshlrev_b32 v188, 16, v144
    v_and_b32 v189, 0xffff0000, v144
    v_pk_add_f32 v[64:65], v[64:65], v[188:189]
    v_lshlrev_b32 v190, 16, v145
    v_and_b32 v191, 0xffff0000, v145
    v_pk_add_f32 v[66:67], v[66:67], v[190:191]
    v_lshlrev_b32 v184, 16, v152
    v_and_b32 v185, 0xffff0000, v152
    v_pk_add_f32 v[64:65], v[64:65], v[184:185]
    v_lshlrev_b32 v186, 16, v153
    v_and_b32 v187, 0xffff0000, v153
    v_pk_add_f32 v[66:67], v[66:67], v[186:187]
    v_lshlrev_b32 v188, 16, v140
    v_and_b32 v189, 0xffff0000, v140
    v_pk_add_f32 v[72:73], v[72:73], v[188:189]
    v_lshlrev_b32 v190, 16, v141
    v_and_b32 v191, 0xffff0000, v141
    v_pk_add_f32 v[74:75], v[74:75], v[190:191]
    v_lshlrev_b32 v184, 16, v148
    v_and_b32 v185, 0xffff0000, v148
    v_pk_add_f32 v[72:73], v[72:73], v[184:185]
    v_lshlrev_b32 v186, 16, v149
    v_and_b32 v187, 0xffff0000, v149
    v_pk_add_f32 v[74:75], v[74:75], v[186:187]
    v_lshlrev_b32 v188, 16, v156
    v_and_b32 v189, 0xffff0000, v156
    v_pk_add_f32 v[72:73], v[72:73], v[188:189]
    v_lshlrev_b32 v190, 16, v157
    v_and_b32 v191, 0xffff0000, v157
    v_pk_add_f32 v[74:75], v[74:75], v[190:191]
    v_cvt_pk_bf16_f32 v0, v64, v65
    v_cvt_pk_bf16_f32 v1, v66, v67
    v_cvt_pk_bf16_f32 v2, v72, v73
    v_cvt_pk_bf16_f32 v3, v74, v75
    s_nop 1
    v_permlane32_swap_b32 v0, v2
    v_permlane32_swap_b32 v1, v3
    s_nop 1
    v_permlane16_swap_b32 v0, v2
    v_permlane16_swap_b32 v1, v3
    s_nop 1
    s_add_u32 s74, s67, 0
    buffer_store_dwordx4 v[0:3], v39, s[32:35], s74 offen sc0 sc1
    v_lshlrev_b32 v184, 16, v138
    v_and_b32 v185, 0xffff0000, v138
    v_pk_add_f32 v[68:69], v[68:69], v[184:185]
    v_lshlrev_b32 v186, 16, v139
    v_and_b32 v187, 0xffff0000, v139
    v_pk_add_f32 v[70:71], v[70:71], v[186:187]
    v_lshlrev_b32 v188, 16, v146
    v_and_b32 v189, 0xffff0000, v146
    v_pk_add_f32 v[68:69], v[68:69], v[188:189]
    v_lshlrev_b32 v190, 16, v147
    v_and_b32 v191, 0xffff0000, v147
    v_pk_add_f32 v[70:71], v[70:71], v[190:191]
    v_lshlrev_b32 v184, 16, v154
    v_and_b32 v185, 0xffff0000, v154
    v_pk_add_f32 v[68:69], v[68:69], v[184:185]
    v_lshlrev_b32 v186, 16, v155
    v_and_b32 v187, 0xffff0000, v155
    v_pk_add_f32 v[70:71], v[70:71], v[186:187]
    v_lshlrev_b32 v188, 16, v142
    v_and_b32 v189, 0xffff0000, v142
    v_pk_add_f32 v[76:77], v[76:77], v[188:189]
    v_lshlrev_b32 v190, 16, v143
    v_and_b32 v191, 0xffff0000, v143
    v_pk_add_f32 v[78:79], v[78:79], v[190:191]
    v_lshlrev_b32 v184, 16, v150
    v_and_b32 v185, 0xffff0000, v150
    v_pk_add_f32 v[76:77], v[76:77], v[184:185]
    v_lshlrev_b32 v186, 16, v151
    v_and_b32 v187, 0xffff0000, v151
    v_pk_add_f32 v[78:79], v[78:79], v[186:187]
    v_lshlrev_b32 v188, 16, v158
    v_and_b32 v189, 0xffff0000, v158
    v_pk_add_f32 v[76:77], v[76:77], v[188:189]
    v_lshlrev_b32 v190, 16, v159
    v_and_b32 v191, 0xffff0000, v159
    v_pk_add_f32 v[78:79], v[78:79], v[190:191]
    v_cvt_pk_bf16_f32 v4, v68, v69
    v_cvt_pk_bf16_f32 v5, v70, v71
    v_cvt_pk_bf16_f32 v6, v76, v77
    v_cvt_pk_bf16_f32 v7, v78, v79
    s_nop 1
    v_permlane32_swap_b32 v4, v6
    v_permlane32_swap_b32 v5, v7
    s_nop 1
    v_permlane16_swap_b32 v4, v6
    v_permlane16_swap_b32 v5, v7
    s_nop 1
    s_add_u32 s75, s67, 18432
    buffer_store_dwordx4 v[4:7], v39, s[32:35], s75 offen sc0 sc1
    v_lshlrev_b32 v184, 16, v48
    v_and_b32 v185, 0xffff0000, v48
    v_pk_add_f32 v[40:41], v[40:41], v[184:185]
    v_lshlrev_b32 v186, 16, v49
    v_and_b32 v187, 0xffff0000, v49
    v_pk_add_f32 v[42:43], v[42:43], v[186:187]
    v_lshlrev_b32 v188, 16, v50
    v_and_b32 v189, 0xffff0000, v50
    v_pk_add_f32 v[40:41], v[40:41], v[188:189]
    v_lshlrev_b32 v190, 16, v51
    v_and_b32 v191, 0xffff0000, v51
    v_pk_add_f32 v[42:43], v[42:43], v[190:191]
    v_lshlrev_b32 v184, 16, v52
    v_and_b32 v185, 0xffff0000, v52
    v_pk_add_f32 v[40:41], v[40:41], v[184:185]
    v_lshlrev_b32 v186, 16, v53
    v_and_b32 v187, 0xffff0000, v53
    v_pk_add_f32 v[42:43], v[42:43], v[186:187]
    v_cvt_pk_bf16_f32 v8, v40, v41
    v_cvt_pk_bf16_f32 v9, v42, v43
    buffer_store_dwordx2 v[8:9], v46, s[32:35], s68 offen sc0 sc1
    s_or_b32 s72, s38, s39
    s_cmp_eq_u32 s72, 0
    s_cselect_b32 s72, 0, 0x80000000
    v_and_b32 v44, 0x80000000, v241
    v_or_b32 v44, v44, v253
    v_or_b32 v44, s72, v44
    s_add_u32 s73, s55, 7
    v_mov_b32 v45, s73
    buffer_store_dword v45, v44, s[28:31], 0 offen sc1
L_end:
    s_endpgm
L_spin0:
    s_sub_u32 s96, s96, 1
    s_cbranch_scc1 L_giveup0
    s_sleep 1
    buffer_load_dword v244, v243, s[28:31], 0 offen sc1
    s_waitcnt vmcnt(0)
    v_subrev_u32 v245, s69, v244
    v_cmp_le_u32 vcc, 8, v245
    s_nop 1
    s_cbranch_vccnz L_spin0
    s_branch L_back0
L_giveup0:
    s_mov_b32 s96, 0
    s_branch L_back0
L_spin1:
    s_sub_u32 s96, s96, 1
    s_cbranch_scc1 L_giveup1
    s_sleep 1
    buffer_load_dword v244, v243, s[28:31], 0 offen sc1
    s_waitcnt vmcnt(0)
    v_subrev_u32 v245, s69, v244
    v_cmp_le_u32 vcc, 8, v245
    s_nop 1
    s_cbranch_vccnz L_spin1
    s_branch L_back1
L_giveup1:
    s_mov_b32 s96, 0
    s_branch L_back1
L_spin2:
    s_sub_u32 s96, s96, 1
    s_cbranch_scc1 L_giveup2
    s_sleep 1
    buffer_load_dword v244, v243, s[28:31], 0 offen sc1
    s_waitcnt vmcnt(0)
    v_subrev_u32 v245, s69, v244
    v_cmp_le_u32 vcc, 8, v245
    s_nop 1
    s_cbranch_vccnz L_spin2
    s_branch L_back2
L_giveup2:
    s_mov_b32 s96, 0
    s_branch L_back2
L_spin4:
    s_sub_u32 s96, s96, 1
    s_cbranch_scc1 L_giveup4
    s_sleep 1
    buffer_load_dword v244, v246, s[28:31], s90 offen sc1
    s_waitcnt vmcnt(0)
    v_subrev_u32 v245, s69, v244
    v_cmp_le_u32 vcc, 8, v245
    s_nop 1
    s_cbranch_vccnz L_spin4
    s_branch L_back4
L_giveup4:
    s_mov_b32 s96, 0
    s_branch L_back4
L_fastend:
L_slow:
    v_mfma_f32_16x16x32_bf16 v[76:79], v[172:175], v[148:151], v[76:79]
    s_waitcnt lgkmcnt(10)
    buffer_load_dwordx4 v211, s[12:15], s71 offen offset:1024 lds
    v_mfma_f32_16x16x32_bf16 v[80:83], v[176:179], v[128:131], v[80:83]
    s_waitcnt lgkmcnt(8)
    ds_read_b64_tr_b16 v[168:169], v213 offset:18432
    ds_read_b64_tr_b16 v[170:171], v213 offset:18944
    v_mfma_f32_16x16x32_bf16 v[80:83], v[180:183], v[144:147], v[80:83]
    ds_read_b64_tr_b16 v[172:173], v213 offset:26624
    ds_read_b64_tr_b16 v[174:175], v213 offset:27136
    v_mfma_f32_16x16x32_bf16 v[84:87], v[176:179], v[132:135], v[84:87]
    v_lshlrev_b32 v244, 3, v209
    v_cmp_gt_u32 vcc, 9, v247
    v_mfma_f32_16x16x32_bf16 v[84:87], v[180:183], v[148:151], v[84:87]
    s_waitcnt lgkmcnt(10)
    ds_read_b64_tr_b16 v[176:177], v216 offset:16384
    ds_read_b64_tr_b16 v[178:179], v216 offset:16896
    v_mfma_f32_16x16x32_bf16 v[88:91], v[184:187], v[128:131], v[88:91]
    s_waitcnt lgkmcnt(10)
    ds_read_b64_tr_b16 v[180:181], v216 offset:24576
    ds_read_b64_tr_b16 v[182:183], v216 offset:25088
    v_mfma_f32_16x16x32_bf16 v[88:91], v[188:191], v[144:147], v[88:91]
    s_add_u32 m0, s40, 98304
    s_add_u32 s70, s44, 1769600
    v_mfma_f32_16x16x32_bf16 v[92:95], v[184:187], v[132:135], v[92:95]
    buffer_load_dwordx4 v210, s[8:11], s70 offen lds
    v_mfma_f32_16x16x32_bf16 v[92:95], v[188:191], v[148:151], v[92:95]
    s_waitcnt lgkmcnt(10)
    ds_read_b64_tr_b16 v[184:185], v216 offset:18432
    ds_read_b64_tr_b16 v[186:187], v216 offset:18944
    v_mfma_f32_16x16x32_bf16 v[0:3], v[160:163], v[128:131], v[0:3]
    s_waitcnt lgkmcnt(10)
    ds_read_b64_tr_b16 v[188:189], v216 offset:26624
    ds_read_b64_tr_b16 v[190:191], v216 offset:27136
    v_mfma_f32_16x16x32_bf16 v[0:3], v[164:167], v[144:147], v[0:3]
    v_cndmask_b32 v244, v248, v244, vcc
    v_mfma_f32_16x16x32_bf16 v[4:7], v[160:163], v[132:135], v[4:7]
    buffer_load_dwordx4 v211, s[8:11], s70 offen offset:1024 lds
    v_mfma_f32_16x16x32_bf16 v[4:7], v[164:167], v[148:151], v[4:7]
    s_add_u32 m0, s40, 100352
    v_mul_f32 v192, v64, v64
    v_fmaak_f32 v192, v192, v208, 0xc0135761
    v_mul_f32 v192, v192, v64
    v_exp_f32 v192, v192
    v_mfma_f32_16x16x32_bf16 v[8:11], v[160:163], v[136:139], v[8:11]
    v_mul_f32 v196, v64, v72
    v_add_f32 v192, 1.0, v192
    v_rcp_f32 v192, v192
    v_mul_f32 v193, v65, v65
    v_mfma_f32_16x16x32_bf16 v[8:11], v[164:167], v[152:155], v[8:11]
    v_mul_f32 v196, v196, v192
    v_fmaak_f32 v193, v193, v208, 0xc0135761
    v_mul_f32 v193, v193, v65
    v_mul_f32 v197, v65, v73
    v_mfma_f32_16x16x32_bf16 v[12:15], v[160:163], v[140:143], v[12:15]
    buffer_load_dwordx4 v210, s[12:15], s70 offen lds
    v_exp_f32 v193, v193
    v_mul_f32 v194, v66, v66
    v_mfma_f32_16x16x32_bf16 v[12:15], v[164:167], v[156:159], v[12:15]
    s_waitcnt lgkmcnt(10)
    v_add_f32 v193, 1.0, v193
    v_rcp_f32 v193, v193
    v_fmaak_f32 v194, v194, v208, 0xc0135761
    v_mul_f32 v194, v194, v66
    v_mfma_f32_16x16x32_bf16 v[16:19], v[168:171], v[128:131], v[16:19]
    s_waitcnt lgkmcnt(8)
    v_exp_f32 v194, v194
    v_mul_f32 v197, v197, v193
    v_mul_f32 v198, v66, v74
    v_mul_f32 v195, v67, v67
    v_mfma_f32_16x16x32_bf16 v[16:19], v[172:175], v[144:147], v[16:19]
    v_add_f32 v194, 1.0, v194
    v_rcp_f32 v194, v194
    v_fmaak_f32 v195, v195, v208, 0xc0135761
    v_mfma_f32_16x16x32_bf16 v[20:23], v[168:171], v[132:135], v[20:23]
    s_waitcnt vmcnt(11)
    v_mul_f32 v198, v198, v194
    v_mul_f32 v195, v195, v67
    v_exp_f32 v195, v195
    v_mul_f32 v199, v67, v75
    v_mfma_f32_16x16x32_bf16 v[20:23], v[172:175], v[148:151], v[20:23]
    s_barrier
    v_add_f32 v195, 1.0, v195
    v_rcp_f32 v195, v195
    v_cvt_pk_bf16_f32 v200, v196, v197
    v_mfma_f32_16x16x32_bf16 v[24:27], v[168:171], v[136:139], v[24:27]
    buffer_load_dwordx4 v211, s[12:15], s70 offen offset:1024 lds
    v_mul_f32 v199, v199, v195
    v_cvt_pk_bf16_f32 v201, v198, v199
    v_mul_f32 v222, v80, v80
    v_mfma_f32_16x16x32_bf16 v[24:27], v[172:175], v[152:155], v[24:27]
    ds_read_b64_tr_b16 v[160:161], v216 offset:40960
    ds_read_b64_tr_b16 v[162:163], v216 offset:41472
    v_fmaak_f32 v222, v222, v208, 0xc0135761
    v_mul_f32 v222, v222, v80
    v_mul_f32 v226, v80, v88
    v_mfma_f32_16x16x32_bf16 v[28:31], v[168:171], v[140:143], v[28:31]
    ds_read_b64_tr_b16 v[164:165], v216 offset:49152
    ds_read_b64_tr_b16 v[166:167], v216 offset:49664
    v_exp_f32 v222, v222
    v_mfma_f32_16x16x32_bf16 v[28:31], v[172:175], v[156:159], v[28:31]
    s_waitcnt lgkmcnt(10)
    ds_read_b64_tr_b16 v[168:169], v216 offset:43008
    ds_read_b64_tr_b16 v[170:171], v216 offset:43520
    v_add_f32 v222, 1.0, v222
    v_rcp_f32 v222, v222
    v_mfma_f32_16x16x32_bf16 v[32:35], v[176:179], v[128:131], v[32:35]
    s_waitcnt lgkmcnt(10)
    ds_read_b64_tr_b16 v[172:173], v216 offset:51200
    ds_read_b64_tr_b16 v[174:175], v216 offset:51712
    v_mul_f32 v226, v226, v222
    v_mul_f32 v223, v81, v81
    v_fmaak_f32 v223, v223, v208, 0xc0135761
    v_mfma_f32_16x16x32_bf16 v[32:35], v[180:183], v[144:147], v[32:35]
    s_add_u32 m0, s40, 122880
    s_add_u32 s71, s44, 2359424
    v_mul_f32 v223, v223, v81
    v_exp_f32 v223, v223
    v_mul_f32 v227, v81, v89
    v_mfma_f32_16x16x32_bf16 v[36:39], v[176:179], v[132:135], v[36:39]
    buffer_load_dwordx4 v210, s[8:11], s71 offen lds
    v_add_f32 v223, 1.0, v223
    v_mul_f32 v224, v82, v82
    v_mfma_f32_16x16x32_bf16 v[36:39], v[180:183], v[148:151], v[36:39]
    v_rcp_f32 v223, v223
    v_fmaak_f32 v224, v224, v208, 0xc0135761
    v_mul_f32 v224, v224, v82
    v_mul_f32 v228, v82, v90
    v_mfma_f32_16x16x32_bf16 v[40:43], v[176:179], v[136:139], v[40:43]
    v_exp_f32 v224, v224
    v_mul_f32 v227, v227, v223
    v_mul_f32 v225, v83, v83
    v_fmaak_f32 v225, v225, v208, 0xc0135761
    v_mfma_f32_16x16x32_bf16 v[40:43], v[180:183], v[152:155], v[40:43]
    v_add_f32 v224, 1.0, v224
    v_rcp_f32 v224, v224
    v_mul_f32 v225, v225, v83
    v_mul_f32 v229, v83, v91
    v_mfma_f32_16x16x32_bf16 v[44:47], v[176:179], v[140:143], v[44:47]
    buffer_load_dwordx4 v211, s[8:11], s71 offen offset:1024 lds
    v_exp_f32 v225, v225
    v_mul_f32 v228, v228, v224
    v_mfma_f32_16x16x32_bf16 v[44:47], v[180:183], v[156:159], v[44:47]
    s_add_u32 m0, s40, 124928
    ds_read_b64_tr_b16 v[176:177], v213 offset:40960
    ds_read_b64_tr_b16 v[178:179], v213 offset:41472
    v_add_f32 v225, 1.0, v225
    v_cvt_pk_bf16_f32 v202, v226, v227
    s_waitcnt lgkmcnt(12)
    v_mfma_f32_16x16x32_bf16 v[48:51], v[184:187], v[128:131], v[48:51]
    s_waitcnt lgkmcnt(10)
    ds_read_b64_tr_b16 v[180:181], v213 offset:49152
    ds_read_b64_tr_b16 v[182:183], v213 offset:49664
    v_rcp_f32 v225, v225
    v_mul_f32 v192, v68, v68
    v_mfma_f32_16x16x32_bf16 v[48:51], v[188:191], v[144:147], v[48:51]
    v_mul_f32 v229, v229, v225
    v_cvt_pk_bf16_f32 v203, v228, v229
    v_fmaak_f32 v192, v192, v208, 0xc0135761
    v_mul_f32 v192, v192, v68
    v_mul_f32 v196, v68, v76
    v_mfma_f32_16x16x32_bf16 v[52:55], v[184:187], v[132:135], v[52:55]
    buffer_store_dwordx4 v[200:203], v209, s[20:23], s50 offen sc1
    v_exp_f32 v192, v192
    v_mul_f32 v193, v69, v69
    v_mfma_f32_16x16x32_bf16 v[52:55], v[188:191], v[148:151], v[52:55]
    v_add_f32 v192, 1.0, v192
    v_rcp_f32 v192, v192
    v_fmaak_f32 v193, v193, v208, 0xc0135761
    v_mul_f32 v193, v193, v69
    v_mfma_f32_16x16x32_bf16 v[56:59], v[184:187], v[136:139], v[56:59]
    v_exp_f32 v193, v193
    v_mul_f32 v196, v196, v192
    v_mul_f32 v197, v69, v77
    v_mfma_f32_16x16x32_bf16 v[56:59], v[188:191], v[152:155], v[56:59]
    v_add_f32 v193, 1.0, v193
    v_rcp_f32 v193, v193
    v_mul_f32 v194, v70, v70
    v_fmaak_f32 v194, v194, v208, 0xc0135761
    v_mfma_f32_16x16x32_bf16 v[60:63], v[184:187], v[140:143], v[60:63]
    buffer_load_dwordx4 v210, s[12:15], s71 offen lds
    v_mul_f32 v197, v197, v193
    v_mul_f32 v194, v194, v70
    v_mul_f32 v198, v70, v78
    v_mfma_f32_16x16x32_bf16 v[60:63], v[188:191], v[156:159], v[60:63]
    s_waitcnt lgkmcnt(10)
    ds_read_b64_tr_b16 v[184:185], v213 offset:43008
    ds_read_b64_tr_b16 v[186:187], v213 offset:43520
    v_exp_f32 v194, v194
    v_mul_f32 v195, v71, v71
    v_mfma_f32_16x16x32_bf16 v[96:99], v[160:163], a[0:3], 0
    s_waitcnt lgkmcnt(10)
    ds_read_b64_tr_b16 v[188:189], v213 offset:51200
    ds_read_b64_tr_b16 v[190:191], v213 offset:51712
    v_add_f32 v194, 1.0, v194
    v_fmaak_f32 v195, v195, v208, 0xc0135761
    v_mfma_f32_16x16x32_bf16 v[96:99], v[164:167], a[16:19], v[96:99]
    v_rcp_f32 v194, v194
    v_mul_f32 v195, v195, v71
    v_exp_f32 v195, v195
    v_mfma_f32_16x16x32_bf16 v[100:103], v[160:163], a[4:7], 0
    v_mul_f32 v198, v198, v194
    v_mul_f32 v199, v71, v79
    v_add_f32 v195, 1.0, v195
    v_rcp_f32 v195, v195
    v_mfma_f32_16x16x32_bf16 v[100:103], v[164:167], a[20:23], v[100:103]
    s_add_u32 s73, s77, 0
    buffer_load_dword v255, v244, s[16:19], s73 offen
    v_mul_f32 v199, v199, v195
    v_cvt_pk_bf16_f32 v204, v196, v197
    v_cvt_pk_bf16_f32 v205, v198, v199
    v_mfma_f32_16x16x32_bf16 v[104:107], v[160:163], a[8:11], 0
    v_mul_f32 v222, v84, v84
    v_fmaak_f32 v222, v222, v208, 0xc0135761
    v_mul_f32 v222, v222, v84
    v_exp_f32 v222, v222
    v_mfma_f32_16x16x32_bf16 v[104:107], v[164:167], a[24:27], v[104:107]
    v_mul_f32 v226, v84, v92
    v_add_f32 v222, 1.0, v222
    v_rcp_f32 v222, v222
    v_mfma_f32_16x16x32_bf16 v[108:111], v[160:163], a[12:15], 0
    v_mul_f32 v226, v226, v222
    v_mul_f32 v223, v85, v85
    v_fmaak_f32 v223, v223, v208, 0xc0135761
    v_mul_f32 v223, v223, v85
    v_mul_f32 v227, v85, v93
    v_mfma_f32_16x16x32_bf16 v[108:111], v[164:167], a[28:31], v[108:111]
    s_waitcnt lgkmcnt(10)
    v_exp_f32 v223, v223
    v_mul_f32 v224, v86, v86
    v_fmaak_f32 v224, v224, v208, 0xc0135761
    v_mul_f32 v224, v224, v86
    v_mfma_f32_16x16x32_bf16 v[112:115], v[168:171], a[0:3], 0
    s_add_u32 s74, s85, 256
    buffer_load_dword v255, v254, s[8:11], s74 offen
    v_exp_f32 v224, v224
    s_waitcnt lgkmcnt(8)
    v_mfma_f32_16x16x32_bf16 v[112:115], v[172:175], a[16:19], v[112:115]
    v_add_f32 v223, 1.0, v223
    v_rcp_f32 v223, v223
    v_mul_f32 v228, v86, v94
    v_add_f32 v224, 1.0, v224
    v_mfma_f32_16x16x32_bf16 v[116:119], v[168:171], a[4:7], 0
    s_waitcnt vmcnt(14)
    v_rcp_f32 v224, v224
    v_mul_f32 v227, v227, v223
    v_mul_f32 v225, v87, v87
    v_mfma_f32_16x16x32_bf16 v[116:119], v[172:175], a[20:23], v[116:119]
    s_barrier
    v_mul_f32 v228, v228, v224
    v_fmaak_f32 v225, v225, v208, 0xc0135761
    v_mul_f32 v225, v225, v87
    v_exp_f32 v225, v225
    v_mfma_f32_16x16x32_bf16 v[120:123], v[168:171], a[8:11], 0
    ds_read_b64_tr_b16 v[160:161], v213 offset:57344
    ds_read_b64_tr_b16 v[162:163], v213 offset:57856
    v_mul_f32 v229, v87, v95
    v_add_f32 v225, 1.0, v225
    v_mfma_f32_16x16x32_bf16 v[120:123], v[172:175], a[24:27], v[120:123]
    s_add_u32 s75, s85, 256
    buffer_load_dword v255, v254, s[12:15], s75 offen
    v_mfma_f32_16x16x32_bf16 v[124:127], v[168:171], a[12:15], 0
    ds_read_b64_tr_b16 v[164:165], v214 offset:0
    ds_read_b64_tr_b16 v[166:167], v214 offset:512
    v_mfma_f32_16x16x32_bf16 v[124:127], v[172:175], a[28:31], v[124:127]
    s_waitcnt lgkmcnt(10)
    ds_read_b64_tr_b16 v[168:169], v213 offset:59392
    ds_read_b64_tr_b16 v[170:171], v213 offset:59904
    v_mfma_f32_16x16x32_bf16 v[64:67], v[176:179], a[0:3], 0
    s_add_u32 s97, s46, 0
    ds_read_b64_tr_b16 v[172:173], v214 offset:2048
    ds_read_b64_tr_b16 v[174:175], v214 offset:2560
    s_waitcnt lgkmcnt(12)
    v_mfma_f32_16x16x32_bf16 v[64:67], v[180:183], a[16:19], v[64:67]
    v_rcp_f32 v225, v225
    v_mfma_f32_16x16x32_bf16 v[68:71], v[176:179], a[4:7], 0
    buffer_load_dwordx4 v211, s[12:15], s71 offen offset:1024 lds
    v_mfma_f32_16x16x32_bf16 v[68:71], v[180:183], a[20:23], v[68:71]
    s_add_u32 m0, s40, 139264
    s_add_u32 s70, s44, 2949248
    v_mul_f32 v229, v229, v225
    v_mfma_f32_16x16x32_bf16 v[72:75], v[176:179], a[8:11], 0
    v_cvt_pk_bf16_f32 v206, v226, v227
    v_cvt_pk_bf16_f32 v207, v228, v229
    v_mfma_f32_16x16x32_bf16 v[72:75], v[180:183], a[24:27], v[72:75]
    v_mul_f32 v192, v0, v0
    v_fmaak_f32 v192, v192, v208, 0xc0135761
    v_mfma_f32_16x16x32_bf16 v[76:79], v[176:179], a[12:15], 0
    v_mul_f32 v192, v192, v0
    v_mul_f32 v196, v0, v16
    v_mfma_f32_16x16x32_bf16 v[76:79], v[180:183], a[28:31], v[76:79]
    s_waitcnt lgkmcnt(10)
    buffer_store_dwordx4 v[204:207], v209, s[20:23], s51 offen sc1
    v_mfma_f32_16x16x32_bf16 v[80:83], v[184:187], a[0:3], 0
    s_waitcnt lgkmcnt(8)
    ds_read_b64_tr_b16 v[176:177], v216 offset:57344
    ds_read_b64_tr_b16 v[178:179], v216 offset:57856
    v_mfma_f32_16x16x32_bf16 v[80:83], v[188:191], a[16:19], v[80:83]
    ds_read_b64_tr_b16 v[180:181], v217 offset:0
    ds_read_b64_tr_b16 v[182:183], v217 offset:512
    v_mfma_f32_16x16x32_bf16 v[84:87], v[184:187], a[4:7], 0
    v_exp_f32 v192, v192
    v_mfma_f32_16x16x32_bf16 v[84:87], v[188:191], a[20:23], v[84:87]
    v_add_f32 v192, 1.0, v192
    v_mul_f32 v193, v1, v1
    v_mfma_f32_16x16x32_bf16 v[88:91], v[184:187], a[8:11], 0
    buffer_load_dwordx4 v210, s[8:11], s70 offen lds
    v_mfma_f32_16x16x32_bf16 v[88:91], v[188:191], a[24:27], v[88:91]
    v_rcp_f32 v192, v192
    v_fmaak_f32 v193, v193, v208, 0xc0135761
    v_mfma_f32_16x16x32_bf16 v[92:95], v[184:187], a[12:15], 0
    v_mul_f32 v196, v196, v192
    v_mul_f32 v193, v193, v1
    v_mfma_f32_16x16x32_bf16 v[92:95], v[188:191], a[28:31], v[92:95]
    s_waitcnt lgkmcnt(10)
    ds_read_b64_tr_b16 v[184:185], v216 offset:59392
    ds_read_b64_tr_b16 v[186:187], v216 offset:59904
    v_mfma_f32_16x16x32_bf16 v[64:67], v[160:163], a[32:35], v[64:67]
    s_waitcnt lgkmcnt(10)
    ds_read_b64_tr_b16 v[188:189], v217 offset:2048
    ds_read_b64_tr_b16 v[190:191], v217 offset:2560
    v_mfma_f32_16x16x32_bf16 v[64:67], v[164:167], a[48:51], v[64:67]
    s_add_u32 s72, s78, 0
    buffer_load_dword v255, v244, s[16:19], s72 offen
    v_mfma_f32_16x16x32_bf16 v[68:71], v[160:163], a[36:39], v[68:71]
    v_exp_f32 v193, v193
    v_mfma_f32_16x16x32_bf16 v[68:71], v[164:167], a[52:55], v[68:71]
    v_mul_f32 v197, v1, v17
    v_add_f32 v193, 1.0, v193
    v_mfma_f32_16x16x32_bf16 v[72:75], v[160:163], a[40:43], v[72:75]
    v_rcp_f32 v193, v193
    v_mul_f32 v194, v2, v2
    v_mfma_f32_16x16x32_bf16 v[72:75], v[164:167], a[56:59], v[72:75]
    s_add_u32 s98, s47, 0
    v_mul_f32 v197, v197, v193
    v_fmaak_f32 v194, v194, v208, 0xc0135761
    v_mfma_f32_16x16x32_bf16 v[76:79], v[160:163], a[44:47], v[76:79]
    buffer_load_dwordx4 v211, s[8:11], s70 offen offset:1024 lds
    v_mfma_f32_16x16x32_bf16 v[76:79], v[164:167], a[60:63], v[76:79]
    s_add_u32 m0, s40, 141312
    v_mul_f32 v194, v194, v2
    v_mul_f32 v198, v2, v18
    s_waitcnt lgkmcnt(10)
    v_mfma_f32_16x16x32_bf16 v[80:83], v[168:171], a[32:35], v[80:83]
    s_waitcnt lgkmcnt(8)
    v_exp_f32 v194, v194
    v_mfma_f32_16x16x32_bf16 v[80:83], v[172:175], a[48:51], v[80:83]
    v_add_f32 v194, 1.0, v194
    v_mul_f32 v195, v3, v3
    v_mfma_f32_16x16x32_bf16 v[84:87], v[168:171], a[36:39], v[84:87]
    s_waitcnt vmcnt(16)
    v_rcp_f32 v194, v194
    v_fmaak_f32 v195, v195, v208, 0xc0135761
    v_mfma_f32_16x16x32_bf16 v[84:87], v[172:175], a[52:55], v[84:87]
    s_barrier
    v_mul_f32 v198, v198, v194
    v_mul_f32 v195, v195, v3
    v_mfma_f32_16x16x32_bf16 v[88:91], v[168:171], a[40:43], v[88:91]
    buffer_load_dwordx4 v210, s[12:15], s70 offen lds
    v_mfma_f32_16x16x32_bf16 v[88:91], v[172:175], a[56:59], v[88:91]
    ds_read_b64_tr_b16 v[160:161], v214 offset:16384
    ds_read_b64_tr_b16 v[162:163], v214 offset:16896
    v_mfma_f32_16x16x32_bf16 v[92:95], v[168:171], a[44:47], v[92:95]
    ds_read_b64_tr_b16 v[164:165], v214 offset:24576
    ds_read_b64_tr_b16 v[166:167], v214 offset:25088
    v_mfma_f32_16x16x32_bf16 v[92:95], v[172:175], a[60:63], v[92:95]
    s_waitcnt lgkmcnt(10)
    ds_read_b64_tr_b16 v[168:169], v214 offset:18432
    ds_read_b64_tr_b16 v[170:171], v214 offset:18944
    v_mfma_f32_16x16x32_bf16 v[96:99], v[176:179], a[32:35], v[96:99]
    s_waitcnt lgkmcnt(10)
    ds_read_b64_tr_b16 v[172:173], v214 offset:26624
    ds_read_b64_tr_b16 v[174:175], v214 offset:27136
    v_mfma_f32_16x16x32_bf16 v[96:99], v[180:183], a[48:51], v[96:99]
    buffer_load_dwordx4 v211, s[12:15], s70 offen offset:1024 lds
    v_mul_f32 v199, v3, v19
    v_mfma_f32_16x16x32_bf16 v[100:103], v[176:179], a[36:39], v[100:103]
    s_add_u32 m0, s40, 0
    s_add_u32 s71, s44, 3539072
    v_cvt_pk_bf16_f32 v200, v196, v197
    v_mfma_f32_16x16x32_bf16 v[100:103], v[180:183], a[52:55], v[100:103]
    v_exp_f32 v195, v195
    v_mfma_f32_16x16x32_bf16 v[104:107], v[176:179], a[40:43], v[104:107]
    v_add_f32 v195, 1.0, v195
    v_mul_f32 v222, v32, v32
    v_mfma_f32_16x16x32_bf16 v[104:107], v[180:183], a[56:59], v[104:107]
    v_rcp_f32 v195, v195
    v_mfma_f32_16x16x32_bf16 v[108:111], v[176:179], a[44:47], v[108:111]
    buffer_load_dwordx4 v210, s[8:11], s71 offen lds
    v_mfma_f32_16x16x32_bf16 v[108:111], v[180:183], a[60:63], v[108:111]
    s_waitcnt lgkmcnt(10)
    ds_read_b64_tr_b16 v[176:177], v217 offset:16384
    ds_read_b64_tr_b16 v[178:179], v217 offset:16896
    v_mfma_f32_16x16x32_bf16 v[112:115], v[184:187], a[32:35], v[112:115]
    s_waitcnt lgkmcnt(10)
    ds_read_b64_tr_b16 v[180:181], v217 offset:24576
    ds_read_b64_tr_b16 v[182:183], v217 offset:25088
    v_mul_f32 v199, v199, v195
    v_mfma_f32_16x16x32_bf16 v[112:115], v[188:191], a[48:51], v[112:115]
    v_cvt_pk_bf16_f32 v201, v198, v199
    v_fmaak_f32 v222, v222, v208, 0xc0135761
    v_mfma_f32_16x16x32_bf16 v[116:119], v[184:187], a[36:39], v[116:119]
    v_mul_f32 v222, v222, v32
    v_mul_f32 v226, v32, v48
    v_mfma_f32_16x16x32_bf16 v[116:119], v[188:191], a[52:55], v[116:119]
    buffer_load_dwordx4 v211, s[8:11], s71 offen offset:1024 lds
    v_mfma_f32_16x16x32_bf16 v[120:123], v[184:187], a[40:43], v[120:123]
    s_add_u32 m0, s40, 2048
    v_exp_f32 v222, v222
    v_mfma_f32_16x16x32_bf16 v[120:123], v[188:191], a[56:59], v[120:123]
    v_add_f32 v222, 1.0, v222
    v_mul_f32 v223, v33, v33
    v_mfma_f32_16x16x32_bf16 v[124:127], v[184:187], a[44:47], v[124:127]
    v_rcp_f32 v222, v222
    v_fmaak_f32 v223, v223, v208, 0xc0135761
    v_mfma_f32_16x16x32_bf16 v[124:127], v[188:191], a[60:63], v[124:127]
    s_waitcnt lgkmcnt(10)
    ds_read_b64_tr_b16 v[184:185], v217 offset:18432
    ds_read_b64_tr_b16 v[186:187], v217 offset:18944
    v_mfma_f32_16x16x32_bf16 v[64:67], v[160:163], a[64:67], v[64:67]
    s_waitcnt lgkmcnt(10)
    buffer_load_dwordx4 v210, s[12:15], s71 offen lds
    v_mfma_f32_16x16x32_bf16 v[64:67], v[164:167], a[80:83], v[64:67]
    ds_read_b64_tr_b16 v[188:189], v217 offset:26624
    ds_read_b64_tr_b16 v[190:191], v217 offset:27136
    v_mfma_f32_16x16x32_bf16 v[68:71], v[160:163], a[68:71], v[68:71]
    v_mul_f32 v226, v226, v222
    v_mul_f32 v223, v223, v33
    v_mfma_f32_16x16x32_bf16 v[68:71], v[164:167], a[84:87], v[68:71]
    v_exp_f32 v223, v223
    v_mfma_f32_16x16x32_bf16 v[72:75], v[160:163], a[72:75], v[72:75]
    v_mul_f32 v227, v33, v49
    v_add_f32 v223, 1.0, v223
    v_mul_f32 v224, v34, v34
    v_mfma_f32_16x16x32_bf16 v[72:75], v[164:167], a[88:91], v[72:75]
    buffer_load_dwordx4 v211, s[12:15], s71 offen offset:1024 lds
    v_mfma_f32_16x16x32_bf16 v[76:79], v[160:163], a[76:79], v[76:79]
    s_add_u32 m0, s40, 16384
    s_add_u32 s70, s44, 4128896
    v_fmaak_f32 v224, v224, v208, 0xc0135761
    v_mfma_f32_16x16x32_bf16 v[76:79], v[164:167], a[92:95], v[76:79]
    s_waitcnt lgkmcnt(10)
    v_rcp_f32 v223, v223
    v_mfma_f32_16x16x32_bf16 v[80:83], v[168:171], a[64:67], v[80:83]
    s_waitcnt lgkmcnt(8)
    v_mul_f32 v227, v227, v223
    v_mul_f32 v224, v224, v34
    v_mfma_f32_16x16x32_bf16 v[80:83], v[172:175], a[80:83], v[80:83]
    v_exp_f32 v224, v224
    v_mfma_f32_16x16x32_bf16 v[84:87], v[168:171], a[68:71], v[84:87]
    s_waitcnt vmcnt(18)
    v_mul_f32 v228, v34, v50
    v_add_f32 v224, 1.0, v224
    v_mfma_f32_16x16x32_bf16 v[84:87], v[172:175], a[84:87], v[84:87]
    s_barrier
    v_rcp_f32 v224, v224
    v_mul_f32 v225, v35, v35
    v_mfma_f32_16x16x32_bf16 v[88:91], v[168:171], a[72:75], v[88:91]
    buffer_load_dwordx4 v210, s[8:11], s70 offen lds
    v_mfma_f32_16x16x32_bf16 v[88:91], v[172:175], a[88:91], v[88:91]
    ds_read_b64_tr_b16 v[160:161], v214 offset:32768
    ds_read_b64_tr_b16 v[162:163], v214 offset:33280
    v_mfma_f32_16x16x32_bf16 v[92:95], v[168:171], a[76:79], v[92:95]
    ds_read_b64_tr_b16 v[164:165], v214 offset:40960
    ds_read_b64_tr_b16 v[166:167], v214 offset:41472
    v_mfma_f32_16x16x32_bf16 v[92:95], v[172:175], a[92:95], v[92:95]
    s_waitcnt lgkmcnt(10)
    ds_read_b64_tr_b16 v[168:169], v214 offset:34816
    ds_read_b64_tr_b16 v[170:171], v214 offset:35328
    v_mfma_f32_16x16x32_bf16 v[96:99], v[176:179], a[64:67], v[96:99]
    s_waitcnt lgkmcnt(10)
    ds_read_b64_tr_b16 v[172:173], v214 offset:43008
    ds_read_b64_tr_b16 v[174:175], v214 offset:43520
    v_mfma_f32_16x16x32_bf16 v[96:99], v[180:183], a[80:83], v[96:99]
    buffer_load_dwordx4 v211, s[8:11], s70 offen offset:1024 lds
    v_mul_f32 v228, v228, v224
    v_mfma_f32_16x16x32_bf16 v[100:103], v[176:179], a[68:71], v[100:103]
    s_add_u32 m0, s40, 18432
    v_fmaak_f32 v225, v225, v208, 0xc0135761
    v_mul_f32 v225, v225, v35
    v_mfma_f32_16x16x32_bf16 v[100:103], v[180:183], a[84:87], v[100:103]
    v_exp_f32 v225, v225
    v_mfma_f32_16x16x32_bf16 v[104:107], v[176:179], a[72:75], v[104:107]
    v_mul_f32 v229, v35, v51
    v_add_f32 v225, 1.0, v225
    v_mfma_f32_16x16x32_bf16 v[104:107], v[180:183], a[88:91], v[104:107]
    v_rcp_f32 v225, v225
    v_mfma_f32_16x16x32_bf16 v[108:111], v[176:179], a[76:79], v[108:111]
    buffer_load_dwordx4 v210, s[12:15], s70 offen lds
    v_mfma_f32_16x16x32_bf16 v[108:111], v[180:183], a[92:95], v[108:111]
    s_waitcnt lgkmcnt(10)
    ds_read_b64_tr_b16 v[176:177], v217 offset:32768
    ds_read_b64_tr_b16 v[178:179], v217 offset:33280
    v_mul_f32 v229, v229, v225
    v_mfma_f32_16x16x32_bf16 v[112:115], v[184:187], a[64:67], v[112:115]
    s_waitcnt lgkmcnt(10)
    ds_read_b64_tr_b16 v[180:181], v217 offset:40960
    ds_read_b64_tr_b16 v[182:183], v217 offset:41472
    v_mfma_f32_16x16x32_bf16 v[112:115], v[188:191], a[80:83], v[112:115]
    v_cvt_pk_bf16_f32 v202, v226, v227
    v_cvt_pk_bf16_f32 v203, v228, v229
    v_mfma_f32_16x16x32_bf16 v[116:119], v[184:187], a[68:71], v[116:119]
    v_mul_f32 v192, v4, v4
    v_fmaak_f32 v192, v192, v208, 0xc0135761
    v_mfma_f32_16x16x32_bf16 v[116:119], v[188:191], a[84:87], v[116:119]
    buffer_load_dwordx4 v211, s[12:15], s70 offen offset:1024 lds
    v_mfma_f32_16x16x32_bf16 v[120:123], v[184:187], a[72:75], v[120:123]
    v_mul_f32 v192, v192, v4
    v_mul_f32 v196, v4, v20
    v_mfma_f32_16x16x32_bf16 v[120:123], v[188:191], a[88:91], v[120:123]
    v_exp_f32 v192, v192
    v_mul_f32 v193, v5, v5
    v_mfma_f32_16x16x32_bf16 v[124:127], v[184:187], a[76:79], v[124:127]
    v_add_f32 v192, 1.0, v192
    v_fmaak_f32 v193, v193, v208, 0xc0135761
    v_mfma_f32_16x16x32_bf16 v[124:127], v[188:191], a[92:95], v[124:127]
    s_waitcnt lgkmcnt(10)
    ds_read_b64_tr_b16 v[184:185], v217 offset:34816
    ds_read_b64_tr_b16 v[186:187], v217 offset:35328
    v_mfma_f32_16x16x32_bf16 v[64:67], v[160:163], a[96:99], v[64:67]
    s_add_u32 s73, s78, 663552
    buffer_load_dword v255, v244, s[16:19], s73 offen
    s_waitcnt lgkmcnt(10)
    v_mfma_f32_16x16x32_bf16 v[64:67], v[164:167], a[112:115], v[64:67]
    ds_read_b64_tr_b16 v[188:189], v217 offset:43008
    ds_read_b64_tr_b16 v[190:191], v217 offset:43520
    v_mfma_f32_16x16x32_bf16 v[68:71], v[160:163], a[100:103], v[68:71]
    v_rcp_f32 v192, v192
    v_mfma_f32_16x16x32_bf16 v[68:71], v[164:167], a[116:119], v[68:71]
    v_mul_f32 v196, v196, v192
    v_mul_f32 v193, v193, v5
    v_mul_f32 v197, v5, v21
    v_mfma_f32_16x16x32_bf16 v[72:75], v[160:163], a[104:107], v[72:75]
    v_exp_f32 v193, v193
    v_mfma_f32_16x16x32_bf16 v[72:75], v[164:167], a[120:123], v[72:75]
    buffer_store_dwordx4 v[200:203], v209, s[20:23], s97 offen sc1
    v_mfma_f32_16x16x32_bf16 v[76:79], v[160:163], a[108:111], v[76:79]
    v_add_f32 v193, 1.0, v193
    v_mul_f32 v194, v6, v6
    v_mfma_f32_16x16x32_bf16 v[76:79], v[164:167], a[124:127], v[76:79]
    s_waitcnt lgkmcnt(10)
    v_rcp_f32 v193, v193
    v_mfma_f32_16x16x32_bf16 v[80:83], v[168:171], a[96:99], v[80:83]
    s_add_u32 s97, s48, 0
    v_mul_f32 v197, v197, v193
    v_fmaak_f32 v194, v194, v208, 0xc0135761
    s_waitcnt lgkmcnt(8)
    v_mfma_f32_16x16x32_bf16 v[80:83], v[172:175], a[112:115], v[80:83]
    v_mul_f32 v194, v194, v6
    v_mul_f32 v198, v6, v22
    v_mfma_f32_16x16x32_bf16 v[84:87], v[168:171], a[100:103], v[84:87]
    s_waitcnt vmcnt(16)
    v_exp_f32 v194, v194
    v_mul_f32 v195, v7, v7
    v_mfma_f32_16x16x32_bf16 v[84:87], v[172:175], a[116:119], v[84:87]
    s_barrier
    v_add_f32 v194, 1.0, v194
    v_fmaak_f32 v195, v195, v208, 0xc0135761
    v_mfma_f32_16x16x32_bf16 v[88:91], v[168:171], a[104:107], v[88:91]
    ds_read_b64_tr_b16 v[160:161], v214 offset:57344
    ds_read_b64_tr_b16 v[162:163], v214 offset:57856
    v_mfma_f32_16x16x32_bf16 v[88:91], v[172:175], a[120:123], v[88:91]
    ds_read_b64_tr_b16 v[164:165], v215 offset:0
    ds_read_b64_tr_b16 v[166:167], v215 offset:512
    v_mfma_f32_16x16x32_bf16 v[92:95], v[168:171], a[108:111], v[92:95]
    s_add_u32 m0, s40, 81920
    s_add_u32 s71, s44, 4718720
    v_mul_f32 v195, v195, v7
    v_mfma_f32_16x16x32_bf16 v[92:95], v[172:175], a[124:127], v[92:95]
    s_waitcnt lgkmcnt(10)
    buffer_load_dwordx4 v210, s[8:11], s71 offen lds
    v_mfma_f32_16x16x32_bf16 v[96:99], v[176:179], a[96:99], v[96:99]
    s_waitcnt lgkmcnt(8)
    ds_read_b64_tr_b16 v[168:169], v214 offset:59392
    ds_read_b64_tr_b16 v[170:171], v214 offset:59904
    v_mfma_f32_16x16x32_bf16 v[96:99], v[180:183], a[112:115], v[96:99]
    ds_read_b64_tr_b16 v[172:173], v215 offset:2048
    ds_read_b64_tr_b16 v[174:175], v215 offset:2560
    v_mul_f32 v199, v7, v23
    v_mfma_f32_16x16x32_bf16 v[100:103], v[176:179], a[100:103], v[100:103]
    v_rcp_f32 v194, v194
    v_mfma_f32_16x16x32_bf16 v[100:103], v[180:183], a[116:119], v[100:103]
    v_exp_f32 v195, v195
    v_mfma_f32_16x16x32_bf16 v[104:107], v[176:179], a[104:107], v[104:107]
    buffer_load_dwordx4 v211, s[8:11], s71 offen offset:1024 lds
    v_mfma_f32_16x16x32_bf16 v[104:107], v[180:183], a[120:123], v[104:107]
    s_add_u32 m0, s40, 83968
    v_mul_f32 v198, v198, v194
    v_add_f32 v195, 1.0, v195
    v_mfma_f32_16x16x32_bf16 v[108:111], v[176:179], a[108:111], v[108:111]
    v_rcp_f32 v195, v195
    v_mfma_f32_16x16x32_bf16 v[108:111], v[180:183], a[124:127], v[108:111]
    s_waitcnt lgkmcnt(10)
    ds_read_b64_tr_b16 v[176:177], v217 offset:57344
    ds_read_b64_tr_b16 v[178:179], v217 offset:57856
    v_mul_f32 v199, v199, v195
    v_mfma_f32_16x16x32_bf16 v[112:115], v[184:187], a[96:99], v[112:115]
    s_waitcnt lgkmcnt(10)
    ds_read_b64_tr_b16 v[180:181], v218 offset:0
    ds_read_b64_tr_b16 v[182:183], v218 offset:512
    v_mfma_f32_16x16x32_bf16 v[112:115], v[188:191], a[112:115], v[112:115]
    buffer_load_dwordx4 v210, s[12:15], s71 offen lds
    v_mfma_f32_16x16x32_bf16 v[116:119], v[184:187], a[100:103], v[116:119]
    v_cvt_pk_bf16_f32 v204, v196, v197
    v_cvt_pk_bf16_f32 v205, v198, v199
    v_mfma_f32_16x16x32_bf16 v[116:119], v[188:191], a[116:119], v[116:119]
    v_mul_f32 v222, v36, v36
    v_fmaak_f32 v222, v222, v208, 0xc0135761
    v_mfma_f32_16x16x32_bf16 v[120:123], v[184:187], a[104:107], v[120:123]
    v_mul_f32 v222, v222, v36
    v_mul_f32 v226, v36, v52
    v_mfma_f32_16x16x32_bf16 v[120:123], v[188:191], a[120:123], v[120:123]
    v_exp_f32 v222, v222
    v_mul_f32 v223, v37, v37
    v_mfma_f32_16x16x32_bf16 v[124:127], v[184:187], a[108:111], v[124:127]
    buffer_load_dwordx4 v211, s[12:15], s71 offen offset:1024 lds
    v_mfma_f32_16x16x32_bf16 v[124:127], v[188:191], a[124:127], v[124:127]
    s_waitcnt lgkmcnt(10)
    ds_read_b64_tr_b16 v[184:185], v217 offset:59392
    ds_read_b64_tr_b16 v[186:187], v217 offset:59904
    v_mfma_f32_16x16x32_bf16 v[64:67], v[160:163], a[128:131], v[64:67]
    s_waitcnt lgkmcnt(10)
    ds_read_b64_tr_b16 v[188:189], v218 offset:2048
    ds_read_b64_tr_b16 v[190:191], v218 offset:2560
    v_mfma_f32_16x16x32_bf16 v[64:67], v[164:167], a[144:147], v[64:67]
    s_add_u32 m0, s40, 32768
    s_add_u32 s70, s44, 256
    v_add_f32 v222, 1.0, v222
    v_mfma_f32_16x16x32_bf16 v[68:71], v[160:163], a[132:135], v[68:71]
    v_rcp_f32 v222, v222
    v_mfma_f32_16x16x32_bf16 v[68:71], v[164:167], a[148:151], v[68:71]
    buffer_load_dwordx4 v210, s[8:11], s70 offen lds
    v_mul_f32 v226, v226, v222
    v_mfma_f32_16x16x32_bf16 v[72:75], v[160:163], a[136:139], v[72:75]
    v_fmaak_f32 v223, v223, v208, 0xc0135761
    v_mul_f32 v223, v223, v37
    v_mfma_f32_16x16x32_bf16 v[72:75], v[164:167], a[152:155], v[72:75]
    v_exp_f32 v223, v223
    v_mfma_f32_16x16x32_bf16 v[76:79], v[160:163], a[140:143], v[76:79]
    v_mul_f32 v227, v37, v53
    v_add_f32 v223, 1.0, v223
    v_mfma_f32_16x16x32_bf16 v[76:79], v[164:167], a[156:159], v[76:79]
    s_waitcnt lgkmcnt(10)
    v_rcp_f32 v223, v223
    v_mfma_f32_16x16x32_bf16 v[80:83], v[168:171], a[128:131], v[80:83]
    s_waitcnt lgkmcnt(8)
    buffer_load_dwordx4 v211, s[8:11], s70 offen offset:1024 lds
    v_mfma_f32_16x16x32_bf16 v[80:83], v[172:175], a[144:147], v[80:83]
    s_add_u32 m0, s40, 34816
    v_mul_f32 v227, v227, v223
    v_mul_f32 v224, v38, v38
    v_fmaak_f32 v224, v224, v208, 0xc0135761
    v_mfma_f32_16x16x32_bf16 v[84:87], v[168:171], a[132:135], v[84:87]
    s_waitcnt vmcnt(16)
    v_mul_f32 v224, v224, v38
    v_mul_f32 v228, v38, v54
    v_mfma_f32_16x16x32_bf16 v[84:87], v[172:175], a[148:151], v[84:87]
    s_barrier
    v_exp_f32 v224, v224
    v_mfma_f32_16x16x32_bf16 v[88:91], v[168:171], a[136:139], v[88:91]
    ds_read_b64_tr_b16 v[160:161], v215 offset:8192
    ds_read_b64_tr_b16 v[162:163], v215 offset:8704
    v_mfma_f32_16x16x32_bf16 v[88:91], v[172:175], a[152:155], v[88:91]
    buffer_load_dwordx4 v210, s[12:15], s70 offen lds
    v_mfma_f32_16x16x32_bf16 v[92:95], v[168:171], a[140:143], v[92:95]
    ds_read_b64_tr_b16 v[164:165], v215 offset:16384
    ds_read_b64_tr_b16 v[166:167], v215 offset:16896
    v_mfma_f32_16x16x32_bf16 v[92:95], v[172:175], a[156:159], v[92:95]
    s_waitcnt lgkmcnt(10)
    ds_read_b64_tr_b16 v[168:169], v215 offset:10240
    ds_read_b64_tr_b16 v[170:171], v215 offset:10752
    v_mfma_f32_16x16x32_bf16 v[96:99], v[176:179], a[128:131], v[96:99]
    s_waitcnt lgkmcnt(10)
    ds_read_b64_tr_b16 v[172:173], v215 offset:18432
    ds_read_b64_tr_b16 v[174:175], v215 offset:18944
    v_add_f32 v224, 1.0, v224
    v_mfma_f32_16x16x32_bf16 v[96:99], v[180:183], a[144:147], v[96:99]
    v_rcp_f32 v224, v224
    v_mfma_f32_16x16x32_bf16 v[100:103], v[176:179], a[132:135], v[100:103]
    buffer_load_dwordx4 v211, s[12:15], s70 offen offset:1024 lds
    v_mfma_f32_16x16x32_bf16 v[100:103], v[180:183], a[148:151], v[100:103]
    s_add_u32 m0, s40, 49152
    s_add_u32 s71, s44, 590080
    v_mul_f32 v228, v228, v224
    v_mfma_f32_16x16x32_bf16 v[104:107], v[176:179], a[136:139], v[104:107]
    v_mul_f32 v225, v39, v39
    v_fmaak_f32 v225, v225, v208, 0xc0135761
    v_mfma_f32_16x16x32_bf16 v[104:107], v[180:183], a[152:155], v[104:107]
    v_mul_f32 v225, v225, v39
    v_exp_f32 v225, v225
    v_mfma_f32_16x16x32_bf16 v[108:111], v[176:179], a[140:143], v[108:111]
    v_mul_f32 v229, v39, v55
    v_add_f32 v225, 1.0, v225
    v_mfma_f32_16x16x32_bf16 v[108:111], v[180:183], a[156:159], v[108:111]
    s_waitcnt lgkmcnt(10)
    buffer_load_dwordx4 v210, s[8:11], s71 offen lds
    v_mfma_f32_16x16x32_bf16 v[112:115], v[184:187], a[128:131], v[112:115]
    s_waitcnt lgkmcnt(8)
    ds_read_b64_tr_b16 v[176:177], v218 offset:8192
    ds_read_b64_tr_b16 v[178:179], v218 offset:8704
    v_mfma_f32_16x16x32_bf16 v[112:115], v[188:191], a[144:147], v[112:115]
    ds_read_b64_tr_b16 v[180:181], v218 offset:16384
    ds_read_b64_tr_b16 v[182:183], v218 offset:16896
    v_mfma_f32_16x16x32_bf16 v[116:119], v[184:187], a[132:135], v[116:119]
    v_rcp_f32 v225, v225
    v_mfma_f32_16x16x32_bf16 v[116:119], v[188:191], a[148:151], v[116:119]
    v_mul_f32 v229, v229, v225
    v_cvt_pk_bf16_f32 v206, v226, v227
    v_cvt_pk_bf16_f32 v207, v228, v229
    v_mfma_f32_16x16x32_bf16 v[120:123], v[184:187], a[136:139], v[120:123]
    buffer_load_dwordx4 v211, s[8:11], s71 offen offset:1024 lds
    v_mfma_f32_16x16x32_bf16 v[120:123], v[188:191], a[152:155], v[120:123]
    s_add_u32 m0, s40, 51200
    v_mul_f32 v192, v8, v8
    v_fmaak_f32 v192, v192, v208, 0xc0135761
    v_mfma_f32_16x16x32_bf16 v[124:127], v[184:187], a[140:143], v[124:127]
    v_mul_f32 v192, v192, v8
    v_mul_f32 v196, v8, v24
    v_mfma_f32_16x16x32_bf16 v[124:127], v[188:191], a[156:159], v[124:127]
    s_waitcnt lgkmcnt(10)
    ds_read_b64_tr_b16 v[184:185], v218 offset:10240
    ds_read_b64_tr_b16 v[186:187], v218 offset:10752
    v_mfma_f32_16x16x32_bf16 v[64:67], v[160:163], a[160:163], v[64:67]
    s_waitcnt lgkmcnt(10)
    ds_read_b64_tr_b16 v[188:189], v218 offset:18432
    ds_read_b64_tr_b16 v[190:191], v218 offset:18944
    v_mul_f32 v193, v9, v9
    v_mfma_f32_16x16x32_bf16 v[64:67], v[164:167], a[176:179], v[64:67]
    s_add_u32 s74, s78, 73728
    buffer_load_dword v255, v244, s[16:19], s74 offen
    v_mfma_f32_16x16x32_bf16 v[68:71], v[160:163], a[164:167], v[68:71]
    v_exp_f32 v192, v192
    v_mfma_f32_16x16x32_bf16 v[68:71], v[164:167], a[180:183], v[68:71]
    v_add_f32 v192, 1.0, v192
    v_fmaak_f32 v193, v193, v208, 0xc0135761
    v_mfma_f32_16x16x32_bf16 v[72:75], v[160:163], a[168:171], v[72:75]
    v_rcp_f32 v192, v192
    v_mfma_f32_16x16x32_bf16 v[72:75], v[164:167], a[184:187], v[72:75]
    v_mul_f32 v196, v196, v192
    v_mul_f32 v193, v193, v9
    v_mfma_f32_16x16x32_bf16 v[76:79], v[160:163], a[172:175], v[76:79]
    s_add_u32 s75, s85, 384
    buffer_load_dword v255, v254, s[8:11], s75 offen
    v_mul_f32 v197, v9, v25
    v_mfma_f32_16x16x32_bf16 v[76:79], v[164:167], a[188:191], v[76:79]
    s_waitcnt lgkmcnt(10)
    v_exp_f32 v193, v193
    v_mfma_f32_16x16x32_bf16 v[80:83], v[168:171], a[160:163], v[80:83]
    s_waitcnt lgkmcnt(8)
    v_add_f32 v193, 1.0, v193
    v_mul_f32 v194, v10, v10
    v_mfma_f32_16x16x32_bf16 v[80:83], v[172:175], a[176:179], v[80:83]
    v_rcp_f32 v193, v193
    v_mfma_f32_16x16x32_bf16 v[84:87], v[168:171], a[164:167], v[84:87]
    s_waitcnt vmcnt(18)
    v_mul_f32 v197, v197, v193
    v_fmaak_f32 v194, v194, v208, 0xc0135761
    v_mfma_f32_16x16x32_bf16 v[84:87], v[172:175], a[180:183], v[84:87]
    s_barrier
    buffer_store_dwordx4 v[204:207], v209, s[20:23], s98 offen sc1
    v_mul_f32 v194, v194, v10
    v_mfma_f32_16x16x32_bf16 v[88:91], v[168:171], a[168:171], v[88:91]
    s_add_u32 s98, s49, 0
    ds_read_b64_tr_b16 v[160:161], v213 offset:0
    ds_read_b64_tr_b16 v[162:163], v213 offset:512
    v_mfma_f32_16x16x32_bf16 v[88:91], v[172:175], a[184:187], v[88:91]
    ds_read_b64_tr_b16 v[164:165], v213 offset:8192
    ds_read_b64_tr_b16 v[166:167], v213 offset:8704
    v_mfma_f32_16x16x32_bf16 v[92:95], v[168:171], a[172:175], v[92:95]
    v_exp_f32 v194, v194
    v_mfma_f32_16x16x32_bf16 v[92:95], v[172:175], a[188:191], v[92:95]
    s_add_u32 s72, s85, 384
    buffer_load_dword v255, v254, s[12:15], s72 offen
    s_waitcnt lgkmcnt(10)
    v_mfma_f32_16x16x32_bf16 v[96:99], v[176:179], a[160:163], v[96:99]
    s_waitcnt lgkmcnt(8)
    ds_read_b64_tr_b16 v[168:169], v213 offset:2048
    ds_read_b64_tr_b16 v[170:171], v213 offset:2560
    v_mfma_f32_16x16x32_bf16 v[96:99], v[180:183], a[176:179], v[96:99]
    ds_read_b64_tr_b16 v[172:173], v213 offset:10240
    ds_read_b64_tr_b16 v[174:175], v213 offset:10752
    v_mul_f32 v198, v10, v26
    v_mfma_f32_16x16x32_bf16 v[100:103], v[176:179], a[164:167], v[100:103]
    v_add_f32 v194, 1.0, v194
    v_mul_f32 v195, v11, v11
    v_mfma_f32_16x16x32_bf16 v[100:103], v[180:183], a[180:183], v[100:103]
    v_rcp_f32 v194, v194
    v_mfma_f32_16x16x32_bf16 v[104:107], v[176:179], a[168:171], v[104:107]
    buffer_load_dwordx4 v210, s[12:15], s71 offen lds
    v_mfma_f32_16x16x32_bf16 v[104:107], v[180:183], a[184:187], v[104:107]
    v_mul_f32 v198, v198, v194
    v_fmaak_f32 v195, v195, v208, 0xc0135761
    v_mfma_f32_16x16x32_bf16 v[108:111], v[176:179], a[172:175], v[108:111]
    v_mul_f32 v195, v195, v11
    v_mul_f32 v199, v11, v27
    v_mfma_f32_16x16x32_bf16 v[108:111], v[180:183], a[188:191], v[108:111]
    s_waitcnt lgkmcnt(10)
    ds_read_b64_tr_b16 v[176:177], v216 offset:0
    ds_read_b64_tr_b16 v[178:179], v216 offset:512
    v_cvt_pk_bf16_f32 v200, v196, v197
    v_mfma_f32_16x16x32_bf16 v[112:115], v[184:187], a[160:163], v[112:115]
    s_waitcnt lgkmcnt(10)
    ds_read_b64_tr_b16 v[180:181], v216 offset:8192
    ds_read_b64_tr_b16 v[182:183], v216 offset:8704
    v_mfma_f32_16x16x32_bf16 v[112:115], v[188:191], a[176:179], v[112:115]
    buffer_load_dwordx4 v211, s[12:15], s71 offen offset:1024 lds
    v_mfma_f32_16x16x32_bf16 v[116:119], v[184:187], a[164:167], v[116:119]
    s_add_u32 m0, s40, 65536
    s_add_u32 s70, s44, 1179904
    v_mul_f32 v222, v40, v40
    v_mfma_f32_16x16x32_bf16 v[116:119], v[188:191], a[180:183], v[116:119]
    v_exp_f32 v195, v195
    v_mfma_f32_16x16x32_bf16 v[120:123], v[184:187], a[168:171], v[120:123]
    v_add_f32 v195, 1.0, v195
    v_rcp_f32 v195, v195
    v_mfma_f32_16x16x32_bf16 v[120:123], v[188:191], a[184:187], v[120:123]
    v_mul_f32 v199, v199, v195
    v_cvt_pk_bf16_f32 v201, v198, v199
    v_mfma_f32_16x16x32_bf16 v[124:127], v[184:187], a[172:175], v[124:127]
    buffer_load_dwordx4 v210, s[8:11], s70 offen lds
    v_mfma_f32_16x16x32_bf16 v[124:127], v[188:191], a[188:191], v[124:127]
    s_waitcnt lgkmcnt(10)
    ds_read_b64_tr_b16 v[184:185], v216 offset:2048
    ds_read_b64_tr_b16 v[186:187], v216 offset:2560
    v_mfma_f32_16x16x32_bf16 v[64:67], v[160:163], a[192:195], v[64:67]
    s_waitcnt lgkmcnt(10)
    ds_read_b64_tr_b16 v[188:189], v216 offset:10240
    ds_read_b64_tr_b16 v[190:191], v216 offset:10752
    v_mfma_f32_16x16x32_bf16 v[64:67], v[164:167], a[208:211], v[64:67]
    v_fmaak_f32 v222, v222, v208, 0xc0135761
    v_mul_f32 v222, v222, v40
    v_mul_f32 v226, v40, v56
    v_mfma_f32_16x16x32_bf16 v[68:71], v[160:163], a[196:199], v[68:71]
    v_exp_f32 v222, v222
    v_mfma_f32_16x16x32_bf16 v[68:71], v[164:167], a[212:215], v[68:71]
    buffer_load_dwordx4 v211, s[8:11], s70 offen offset:1024 lds
    v_mfma_f32_16x16x32_bf16 v[72:75], v[160:163], a[200:203], v[72:75]
    s_add_u32 m0, s40, 67584
    v_add_f32 v222, 1.0, v222
    v_mul_f32 v223, v41, v41
    v_mfma_f32_16x16x32_bf16 v[72:75], v[164:167], a[216:219], v[72:75]
    v_rcp_f32 v222, v222
    v_mfma_f32_16x16x32_bf16 v[76:79], v[160:163], a[204:207], v[76:79]
    v_mul_f32 v226, v226, v222
    v_fmaak_f32 v223, v223, v208, 0xc0135761
    v_mul_f32 v223, v223, v41
    v_mfma_f32_16x16x32_bf16 v[76:79], v[164:167], a[220:223], v[76:79]
    s_waitcnt lgkmcnt(10)
    v_exp_f32 v223, v223
    v_mfma_f32_16x16x32_bf16 v[80:83], v[168:171], a[192:195], v[80:83]
    s_waitcnt lgkmcnt(8)
    buffer_load_dwordx4 v210, s[12:15], s70 offen lds
    v_mfma_f32_16x16x32_bf16 v[80:83], v[172:175], a[208:211], v[80:83]
    v_mul_f32 v227, v41, v57
    v_add_f32 v223, 1.0, v223
    v_mfma_f32_16x16x32_bf16 v[84:87], v[168:171], a[196:199], v[84:87]
    s_waitcnt vmcnt(21)
    v_rcp_f32 v223, v223
    v_mfma_f32_16x16x32_bf16 v[84:87], v[172:175], a[212:215], v[84:87]
    s_barrier
    v_mul_f32 v227, v227, v223
    v_mul_f32 v224, v42, v42
    v_fmaak_f32 v224, v224, v208, 0xc0135761
    v_mfma_f32_16x16x32_bf16 v[88:91], v[168:171], a[200:203], v[88:91]
    ds_read_b64_tr_b16 v[160:161], v213 offset:16384
    ds_read_b64_tr_b16 v[162:163], v213 offset:16896
    v_mfma_f32_16x16x32_bf16 v[88:91], v[172:175], a[216:219], v[88:91]
    buffer_load_dwordx4 v211, s[12:15], s70 offen offset:1024 lds
    v_mfma_f32_16x16x32_bf16 v[92:95], v[168:171], a[204:207], v[92:95]
    ds_read_b64_tr_b16 v[164:165], v213 offset:24576
    ds_read_b64_tr_b16 v[166:167], v213 offset:25088
    v_mfma_f32_16x16x32_bf16 v[92:95], v[172:175], a[220:223], v[92:95]
    s_waitcnt lgkmcnt(10)
    ds_read_b64_tr_b16 v[168:169], v213 offset:18432
    ds_read_b64_tr_b16 v[170:171], v213 offset:18944
    v_mfma_f32_16x16x32_bf16 v[96:99], v[176:179], a[192:195], v[96:99]
    s_waitcnt lgkmcnt(10)
    ds_read_b64_tr_b16 v[172:173], v213 offset:26624
    ds_read_b64_tr_b16 v[174:175], v213 offset:27136
    v_mfma_f32_16x16x32_bf16 v[96:99], v[180:183], a[208:211], v[96:99]
    v_mul_f32 v224, v224, v42
    v_exp_f32 v224, v224
    v_mfma_f32_16x16x32_bf16 v[100:103], v[176:179], a[196:199], v[100:103]
    v_mul_f32 v228, v42, v58
    v_add_f32 v224, 1.0, v224
    v_mfma_f32_16x16x32_bf16 v[100:103], v[180:183], a[212:215], v[100:103]
    v_rcp_f32 v224, v224
    v_mfma_f32_16x16x32_bf16 v[104:107], v[176:179], a[200:203], v[104:107]
    v_mul_f32 v228, v228, v224
    v_mul_f32 v225, v43, v43
    v_mfma_f32_16x16x32_bf16 v[104:107], v[180:183], a[216:219], v[104:107]
    v_fmaak_f32 v225, v225, v208, 0xc0135761
    v_mul_f32 v225, v225, v43
    v_mfma_f32_16x16x32_bf16 v[108:111], v[176:179], a[204:207], v[108:111]
    v_exp_f32 v225, v225
    v_mul_f32 v229, v43, v59
    v_mfma_f32_16x16x32_bf16 v[108:111], v[180:183], a[220:223], v[108:111]
    s_waitcnt lgkmcnt(10)
    ds_read_b64_tr_b16 v[176:177], v216 offset:16384
    ds_read_b64_tr_b16 v[178:179], v216 offset:16896
    v_mfma_f32_16x16x32_bf16 v[112:115], v[184:187], a[192:195], v[112:115]
    s_waitcnt lgkmcnt(10)
    ds_read_b64_tr_b16 v[180:181], v216 offset:24576
    ds_read_b64_tr_b16 v[182:183], v216 offset:25088
    v_mfma_f32_16x16x32_bf16 v[112:115], v[188:191], a[208:211], v[112:115]
    v_add_f32 v225, 1.0, v225
    v_cvt_pk_bf16_f32 v202, v226, v227
    v_mfma_f32_16x16x32_bf16 v[116:119], v[184:187], a[196:199], v[116:119]
    v_rcp_f32 v225, v225
    v_mfma_f32_16x16x32_bf16 v[116:119], v[188:191], a[212:215], v[116:119]
    v_mul_f32 v229, v229, v225
    v_cvt_pk_bf16_f32 v203, v228, v229
    v_mul_f32 v192, v12, v12
    v_mfma_f32_16x16x32_bf16 v[120:123], v[184:187], a[200:203], v[120:123]
    buffer_store_dwordx4 v[200:203], v209, s[20:23], s97 offen sc1
    v_mfma_f32_16x16x32_bf16 v[120:123], v[188:191], a[216:219], v[120:123]
    v_fmaak_f32 v192, v192, v208, 0xc0135761
    v_mul_f32 v192, v192, v12
    v_mfma_f32_16x16x32_bf16 v[124:127], v[184:187], a[204:207], v[124:127]
    v_exp_f32 v192, v192
    v_mfma_f32_16x16x32_bf16 v[124:127], v[188:191], a[220:223], v[124:127]
    s_waitcnt lgkmcnt(10)
    ds_read_b64_tr_b16 v[184:185], v216 offset:18432
    ds_read_b64_tr_b16 v[186:187], v216 offset:18944
    v_mfma_f32_16x16x32_bf16 v[64:67], v[160:163], a[224:227], v[64:67]
    s_waitcnt lgkmcnt(10)
    ds_read_b64_tr_b16 v[188:189], v216 offset:26624
    ds_read_b64_tr_b16 v[190:191], v216 offset:27136
    v_mfma_f32_16x16x32_bf16 v[64:67], v[164:167], a[240:243], v[64:67]
    s_add_u32 s73, s78, 737280
    buffer_load_dword v255, v244, s[16:19], s73 offen
    v_mfma_f32_16x16x32_bf16 v[68:71], v[160:163], a[228:231], v[68:71]
    v_mul_f32 v196, v12, v28
    v_add_f32 v192, 1.0, v192
    v_mul_f32 v193, v13, v13
    v_mfma_f32_16x16x32_bf16 v[68:71], v[164:167], a[244:247], v[68:71]
    v_rcp_f32 v192, v192
    v_mfma_f32_16x16x32_bf16 v[72:75], v[160:163], a[232:235], v[72:75]
    v_mul_f32 v196, v196, v192
    v_fmaak_f32 v193, v193, v208, 0xc0135761
    v_mfma_f32_16x16x32_bf16 v[72:75], v[164:167], a[248:251], v[72:75]
    v_mul_f32 v193, v193, v13
    v_mul_f32 v197, v13, v29
    v_mfma_f32_16x16x32_bf16 v[76:79], v[160:163], a[236:239], v[76:79]
    v_exp_f32 v193, v193
    v_mfma_f32_16x16x32_bf16 v[76:79], v[164:167], a[252:255], v[76:79]
    s_waitcnt lgkmcnt(10)
    v_add_f32 v193, 1.0, v193
    v_mul_f32 v194, v14, v14
    v_mfma_f32_16x16x32_bf16 v[80:83], v[168:171], a[224:227], v[80:83]
    s_waitcnt lgkmcnt(8)
    v_rcp_f32 v193, v193
    v_mfma_f32_16x16x32_bf16 v[80:83], v[172:175], a[240:243], v[80:83]
    v_mul_f32 v197, v197, v193
    v_fmaak_f32 v194, v194, v208, 0xc0135761
    v_mfma_f32_16x16x32_bf16 v[84:87], v[168:171], a[228:231], v[84:87]
    s_waitcnt vmcnt(18)
    v_mul_f32 v194, v194, v14
    v_mul_f32 v198, v14, v30
    v_mfma_f32_16x16x32_bf16 v[84:87], v[172:175], a[244:247], v[84:87]
    s_barrier
    v_exp_f32 v194, v194
    v_mfma_f32_16x16x32_bf16 v[88:91], v[168:171], a[232:235], v[88:91]
    ds_read_b64_tr_b16 v[160:161], v214 offset:16384
    ds_read_b64_tr_b16 v[162:163], v214 offset:16896
    v_mfma_f32_16x16x32_bf16 v[88:91], v[172:175], a[248:251], v[88:91]
    ds_read_b64_tr_b16 v[164:165], v214 offset:24576
    ds_read_b64_tr_b16 v[166:167], v214 offset:25088
    v_mfma_f32_16x16x32_bf16 v[92:95], v[168:171], a[236:239], v[92:95]
    s_add_u32 m0, s40, 0
    s_add_u32 s71, s44, 1769728
    v_add_f32 v194, 1.0, v194
    v_mul_f32 v195, v15, v15
    v_mfma_f32_16x16x32_bf16 v[92:95], v[172:175], a[252:255], v[92:95]
    s_waitcnt lgkmcnt(10)
    buffer_load_dwordx4 v210, s[8:11], s71 offen lds
    v_mfma_f32_16x16x32_bf16 v[96:99], v[176:179], a[224:227], v[96:99]
    s_waitcnt lgkmcnt(8)
    ds_read_b64_tr_b16 v[168:169], v214 offset:18432
    ds_read_b64_tr_b16 v[170:171], v214 offset:18944
    v_mfma_f32_16x16x32_bf16 v[96:99], v[180:183], a[240:243], v[96:99]
    ds_read_b64_tr_b16 v[172:173], v214 offset:26624
    ds_read_b64_tr_b16 v[174:175], v214 offset:27136
    v_mfma_f32_16x16x32_bf16 v[100:103], v[176:179], a[228:231], v[100:103]
    v_rcp_f32 v194, v194
    v_mfma_f32_16x16x32_bf16 v[100:103], v[180:183], a[244:247], v[100:103]
    v_mul_f32 v198, v198, v194
    v_fmaak_f32 v195, v195, v208, 0xc0135761
    v_mfma_f32_16x16x32_bf16 v[104:107], v[176:179], a[232:235], v[104:107]
    buffer_load_dwordx4 v211, s[8:11], s71 offen offset:1024 lds
    v_mfma_f32_16x16x32_bf16 v[104:107], v[180:183], a[248:251], v[104:107]
    s_add_u32 m0, s40, 2048
    v_mul_f32 v195, v195, v15
    v_mul_f32 v199, v15, v31
    v_mfma_f32_16x16x32_bf16 v[108:111], v[176:179], a[236:239], v[108:111]
    v_exp_f32 v195, v195
    v_mfma_f32_16x16x32_bf16 v[108:111], v[180:183], a[252:255], v[108:111]
    s_waitcnt lgkmcnt(10)
    ds_read_b64_tr_b16 v[176:177], v217 offset:16384
    ds_read_b64_tr_b16 v[178:179], v217 offset:16896
    v_add_f32 v195, 1.0, v195
    v_mfma_f32_16x16x32_bf16 v[112:115], v[184:187], a[224:227], v[112:115]
    s_waitcnt lgkmcnt(10)
    ds_read_b64_tr_b16 v[180:181], v217 offset:24576
    ds_read_b64_tr_b16 v[182:183], v217 offset:25088
    v_mfma_f32_16x16x32_bf16 v[112:115], v[188:191], a[240:243], v[112:115]
    buffer_load_dwordx4 v210, s[12:15], s71 offen lds
    v_mfma_f32_16x16x32_bf16 v[116:119], v[184:187], a[228:231], v[116:119]
    v_rcp_f32 v195, v195
    v_mfma_f32_16x16x32_bf16 v[116:119], v[188:191], a[244:247], v[116:119]
    v_mul_f32 v199, v199, v195
    v_cvt_pk_bf16_f32 v204, v196, v197
    v_mfma_f32_16x16x32_bf16 v[120:123], v[184:187], a[232:235], v[120:123]
    v_cvt_pk_bf16_f32 v205, v198, v199
    v_mul_f32 v222, v44, v44
    v_mfma_f32_16x16x32_bf16 v[120:123], v[188:191], a[248:251], v[120:123]
    v_fmaak_f32 v222, v222, v208, 0xc0135761
    v_mul_f32 v222, v222, v44
    v_mfma_f32_16x16x32_bf16 v[124:127], v[184:187], a[236:239], v[124:127]
    buffer_load_dwordx4 v211, s[12:15], s71 offen offset:1024 lds
    v_mfma_f32_16x16x32_bf16 v[124:127], v[188:191], a[252:255], v[124:127]
    s_waitcnt lgkmcnt(10)
    ds_read_b64_tr_b16 v[184:185], v217 offset:18432
    ds_read_b64_tr_b16 v[186:187], v217 offset:18944
    v_mul_f32 v226, v44, v60
    v_mfma_f32_16x16x32_bf16 v[64:67], v[160:163], v[128:131], v[64:67]
    s_waitcnt lgkmcnt(10)
    ds_read_b64_tr_b16 v[188:189], v217 offset:26624
    ds_read_b64_tr_b16 v[190:191], v217 offset:27136
    v_mfma_f32_16x16x32_bf16 v[64:67], v[164:167], v[144:147], v[64:67]
    s_add_u32 s92, s53, 0
    s_add_u32 m0, s42, 118784
    v_mul_f32 v223, v45, v45
    v_mfma_f32_16x16x32_bf16 v[68:71], v[160:163], v[132:135], v[68:71]
    v_exp_f32 v222, v222
    v_mfma_f32_16x16x32_bf16 v[68:71], v[164:167], v[148:151], v[68:71]
    buffer_load_dwordx4 v232, s[16:19], s92 offen lds
    v_mfma_f32_16x16x32_bf16 v[72:75], v[160:163], v[136:139], v[72:75]
    v_add_f32 v222, 1.0, v222
    v_fmaak_f32 v223, v223, v208, 0xc0135761
    v_mfma_f32_16x16x32_bf16 v[72:75], v[164:167], v[152:155], v[72:75]
    s_add_u32 m0, s42, 118784
    v_rcp_f32 v222, v222
    v_mul_f32 v223, v223, v45
    v_mfma_f32_16x16x32_bf16 v[76:79], v[160:163], v[140:143], v[76:79]
    v_exp_f32 v223, v223
    v_mfma_f32_16x16x32_bf16 v[76:79], v[164:167], v[156:159], v[76:79]
    s_waitcnt lgkmcnt(10)
    v_mul_f32 v226, v226, v222
    v_mul_f32 v227, v45, v61
    v_mfma_f32_16x16x32_bf16 v[80:83], v[168:171], v[128:131], v[80:83]
    s_waitcnt lgkmcnt(8)
    buffer_load_dwordx4 v233, s[16:19], s92 offen offset:1024 lds
    v_mfma_f32_16x16x32_bf16 v[80:83], v[172:175], v[144:147], v[80:83]
    v_add_f32 v223, 1.0, v223
    v_mul_f32 v224, v46, v46
    v_mfma_f32_16x16x32_bf16 v[84:87], v[168:171], v[132:135], v[84:87]
    s_waitcnt vmcnt(20)
    v_rcp_f32 v223, v223
    v_mfma_f32_16x16x32_bf16 v[84:87], v[172:175], v[148:151], v[84:87]
    s_barrier
    v_mul_f32 v227, v227, v223
    v_fmaak_f32 v224, v224, v208, 0xc0135761
    v_mfma_f32_16x16x32_bf16 v[88:91], v[168:171], v[136:139], v[88:91]
    ds_read_b64_tr_b16 v[160:161], v213 offset:32768
    ds_read_b64_tr_b16 v[162:163], v213 offset:33280
    v_mfma_f32_16x16x32_bf16 v[88:91], v[172:175], v[152:155], v[88:91]
    ds_read_b64_tr_b16 v[164:165], v213 offset:40960
    ds_read_b64_tr_b16 v[166:167], v213 offset:41472
    v_mfma_f32_16x16x32_bf16 v[92:95], v[168:171], v[140:143], v[92:95]
    s_add_u32 m0, s40, 16384
    s_add_u32 s70, s44, 2359552
    v_mul_f32 v224, v224, v46
    v_mfma_f32_16x16x32_bf16 v[92:95], v[172:175], v[156:159], v[92:95]
    s_waitcnt lgkmcnt(10)
    buffer_load_dwordx4 v210, s[8:11], s70 offen lds
    v_mul_f32 v228, v46, v62
    v_mfma_f32_16x16x32_bf16 v[96:99], v[176:179], v[128:131], v[96:99]
    s_waitcnt lgkmcnt(8)
    ds_read_b64_tr_b16 v[168:169], v213 offset:34816
    ds_read_b64_tr_b16 v[170:171], v213 offset:35328
    v_mfma_f32_16x16x32_bf16 v[96:99], v[180:183], v[144:147], v[96:99]
    ds_read_b64_tr_b16 v[172:173], v213 offset:43008
    ds_read_b64_tr_b16 v[174:175], v213 offset:43520
    v_mfma_f32_16x16x32_bf16 v[100:103], v[176:179], v[132:135], v[100:103]
    v_exp_f32 v224, v224
    v_mfma_f32_16x16x32_bf16 v[100:103], v[180:183], v[148:151], v[100:103]
    v_add_f32 v224, 1.0, v224
    v_rcp_f32 v224, v224
    v_mfma_f32_16x16x32_bf16 v[104:107], v[176:179], v[136:139], v[104:107]
    buffer_load_dwordx4 v211, s[8:11], s70 offen offset:1024 lds
    v_mfma_f32_16x16x32_bf16 v[104:107], v[180:183], v[152:155], v[104:107]
    s_add_u32 m0, s40, 18432
    v_mul_f32 v228, v228, v224
    v_mul_f32 v225, v47, v47
    v_mfma_f32_16x16x32_bf16 v[108:111], v[176:179], v[140:143], v[108:111]
    v_fmaak_f32 v225, v225, v208, 0xc0135761
    v_mul_f32 v225, v225, v47
    v_mul_f32 v229, v47, v63
    v_mfma_f32_16x16x32_bf16 v[108:111], v[180:183], v[156:159], v[108:111]
    s_waitcnt lgkmcnt(10)
    ds_read_b64_tr_b16 v[176:177], v216 offset:32768
    ds_read_b64_tr_b16 v[178:179], v216 offset:33280
    v_mfma_f32_16x16x32_bf16 v[112:115], v[184:187], v[128:131], v[112:115]
    s_waitcnt lgkmcnt(10)
    ds_read_b64_tr_b16 v[180:181], v216 offset:40960
    ds_read_b64_tr_b16 v[182:183], v216 offset:41472
    v_mfma_f32_16x16x32_bf16 v[112:115], v[188:191], v[144:147], v[112:115]
    buffer_load_dwordx4 v210, s[12:15], s70 offen lds
    v_cvt_pk_bf16_f32 v206, v226, v227
    v_mfma_f32_16x16x32_bf16 v[116:119], v[184:187], v[132:135], v[116:119]
    v_exp_f32 v225, v225
    v_mfma_f32_16x16x32_bf16 v[116:119], v[188:191], v[148:151], v[116:119]
    v_add_f32 v225, 1.0, v225
    v_rcp_f32 v225, v225
    v_mfma_f32_16x16x32_bf16 v[120:123], v[184:187], v[136:139], v[120:123]
    v_mul_f32 v229, v229, v225
    v_cvt_pk_bf16_f32 v207, v228, v229
    v_mfma_f32_16x16x32_bf16 v[120:123], v[188:191], v[152:155], v[120:123]
    v_mfma_f32_16x16x32_bf16 v[124:127], v[184:187], v[140:143], v[124:127]
    buffer_store_dwordx4 v[204:207], v209, s[20:23], s98 offen sc1
    v_mfma_f32_16x16x32_bf16 v[124:127], v[188:191], v[156:159], v[124:127]
    s_waitcnt lgkmcnt(10)
    ds_read_b64_tr_b16 v[184:185], v216 offset:34816
    ds_read_b64_tr_b16 v[186:187], v216 offset:35328
    v_mfma_f32_16x16x32_bf16 v[0:3], v[160:163], a[0:3], 0
    s_waitcnt lgkmcnt(10)
    ds_read_b64_tr_b16 v[188:189], v216 offset:43008
    ds_read_b64_tr_b16 v[190:191], v216 offset:43520
    v_mfma_f32_16x16x32_bf16 v[0:3], v[164:167], a[16:19], v[0:3]
    v_mfma_f32_16x16x32_bf16 v[4:7], v[160:163], a[4:7], 0
    v_mfma_f32_16x16x32_bf16 v[4:7], v[164:167], a[20:23], v[4:7]
    s_add_u32 s74, s78, 147456
    buffer_load_dword v255, v244, s[16:19], s74 offen
    v_mfma_f32_16x16x32_bf16 v[8:11], v[160:163], a[8:11], 0
    s_add_u32 s97, s46, 2048
    v_mul_f32 v192, v64, v64
    v_fmaak_f32 v192, v192, v208, 0xc0135761
    v_mfma_f32_16x16x32_bf16 v[8:11], v[164:167], a[24:27], v[8:11]
    v_mul_f32 v192, v192, v64
    v_mul_f32 v196, v64, v80
    v_mfma_f32_16x16x32_bf16 v[12:15], v[160:163], a[12:15], 0
    v_exp_f32 v192, v192
    v_mfma_f32_16x16x32_bf16 v[12:15], v[164:167], a[28:31], v[12:15]
    s_waitcnt lgkmcnt(10)
    v_add_f32 v192, 1.0, v192
    v_rcp_f32 v192, v192
    v_mfma_f32_16x16x32_bf16 v[16:19], v[168:171], a[0:3], 0
    s_waitcnt lgkmcnt(8)
    buffer_load_dwordx4 v211, s[12:15], s70 offen offset:1024 lds
    v_mfma_f32_16x16x32_bf16 v[16:19], v[172:175], a[16:19], v[16:19]
    s_add_u32 m0, s42, 118784
    v_mul_f32 v196, v196, v192
    v_mul_f32 v193, v65, v65
    v_mfma_f32_16x16x32_bf16 v[20:23], v[168:171], a[4:7], 0
    s_waitcnt vmcnt(18)
    v_fmaak_f32 v193, v193, v208, 0xc0135761
    v_mul_f32 v193, v193, v65
    v_mfma_f32_16x16x32_bf16 v[20:23], v[172:175], a[20:23], v[20:23]
    s_barrier
    v_exp_f32 v193, v193
    v_mfma_f32_16x16x32_bf16 v[24:27], v[168:171], a[8:11], 0
    ds_read_b64_tr_b16 v[160:161], v213 offset:49152
    ds_read_b64_tr_b16 v[162:163], v213 offset:49664
    v_mfma_f32_16x16x32_bf16 v[24:27], v[172:175], a[24:27], v[24:27]
    buffer_load_dwordx4 v234, s[16:19], s92 offen offset:2048 lds
    v_mfma_f32_16x16x32_bf16 v[28:31], v[168:171], a[12:15], 0
    s_add_u32 m0, s42, 118784
    ds_read_b64_tr_b16 v[164:165], v213 offset:57344
    ds_read_b64_tr_b16 v[166:167], v213 offset:57856
    v_mfma_f32_16x16x32_bf16 v[28:31], v[172:175], a[28:31], v[28:31]
    s_waitcnt lgkmcnt(10)
    ds_read_b64_tr_b16 v[168:169], v213 offset:51200
    ds_read_b64_tr_b16 v[170:171], v213 offset:51712
    v_mfma_f32_16x16x32_bf16 v[32:35], v[176:179], a[0:3], 0
    s_waitcnt lgkmcnt(10)
    ds_read_b64_tr_b16 v[172:173], v213 offset:59392
    ds_read_b64_tr_b16 v[174:175], v213 offset:59904
    v_mfma_f32_16x16x32_bf16 v[32:35], v[180:183], a[16:19], v[32:35]
    buffer_load_dwordx4 v235, s[16:19], s92 offen offset:3072 lds
    v_mfma_f32_16x16x32_bf16 v[36:39], v[176:179], a[4:7], 0
    v_mul_f32 v197, v65, v81
    v_add_f32 v193, 1.0, v193
    v_mfma_f32_16x16x32_bf16 v[36:39], v[180:183], a[20:23], v[36:39]
    v_rcp_f32 v193, v193
    v_mfma_f32_16x16x32_bf16 v[40:43], v[176:179], a[8:11], 0
    v_mul_f32 v197, v197, v193
    v_mul_f32 v194, v66, v66
    v_mfma_f32_16x16x32_bf16 v[40:43], v[180:183], a[24:27], v[40:43]
    v_fmaak_f32 v194, v194, v208, 0xc0135761
    s_add_u32 s98, s47, 2048
    v_mul_f32 v194, v194, v66
    v_mfma_f32_16x16x32_bf16 v[44:47], v[176:179], a[12:15], 0
    v_exp_f32 v194, v194
    v_mfma_f32_16x16x32_bf16 v[44:47], v[180:183], a[28:31], v[44:47]
    s_waitcnt lgkmcnt(10)
    ds_read_b64_tr_b16 v[176:177], v216 offset:49152
    ds_read_b64_tr_b16 v[178:179], v216 offset:49664
    v_mfma_f32_16x16x32_bf16 v[48:51], v[184:187], a[0:3], 0
    s_waitcnt lgkmcnt(10)
    ds_read_b64_tr_b16 v[180:181], v216 offset:57344
    ds_read_b64_tr_b16 v[182:183], v216 offset:57856
    v_mul_f32 v198, v66, v82
    v_mfma_f32_16x16x32_bf16 v[48:51], v[188:191], a[16:19], v[48:51]
    v_add_f32 v194, 1.0, v194
    v_mul_f32 v195, v67, v67
    v_mfma_f32_16x16x32_bf16 v[52:55], v[184:187], a[4:7], 0
    v_rcp_f32 v194, v194
    v_mfma_f32_16x16x32_bf16 v[52:55], v[188:191], a[20:23], v[52:55]
    v_mul_f32 v198, v198, v194
    v_fmaak_f32 v195, v195, v208, 0xc0135761
    v_mfma_f32_16x16x32_bf16 v[56:59], v[184:187], a[8:11], 0
    v_mul_f32 v195, v195, v67
    v_mul_f32 v199, v67, v83
    v_mfma_f32_16x16x32_bf16 v[56:59], v[188:191], a[24:27], v[56:59]
    v_exp_f32 v195, v195
    v_mfma_f32_16x16x32_bf16 v[60:63], v[184:187], a[12:15], 0
    v_add_f32 v195, 1.0, v195
    v_cvt_pk_bf16_f32 v200, v196, v197
    v_mfma_f32_16x16x32_bf16 v[60:63], v[188:191], a[28:31], v[60:63]
    s_waitcnt lgkmcnt(10)
    ds_read_b64_tr_b16 v[184:185], v216 offset:51200
    ds_read_b64_tr_b16 v[186:187], v216 offset:51712
    v_mfma_f32_16x16x32_bf16 v[0:3], v[160:163], a[32:35], v[0:3]
    s_waitcnt lgkmcnt(10)
    ds_read_b64_tr_b16 v[188:189], v216 offset:59392
    ds_read_b64_tr_b16 v[190:191], v216 offset:59904
    v_mfma_f32_16x16x32_bf16 v[0:3], v[164:167], a[48:51], v[0:3]
    s_add_u32 m0, s42, 122880
    v_rcp_f32 v195, v195
    v_mfma_f32_16x16x32_bf16 v[4:7], v[160:163], a[36:39], v[4:7]
    buffer_load_dwordx4 v236, s[16:19], s92 offen lds
    v_mfma_f32_16x16x32_bf16 v[4:7], v[164:167], a[52:55], v[4:7]
    v_mul_f32 v199, v199, v195
    v_cvt_pk_bf16_f32 v201, v198, v199
    v_mfma_f32_16x16x32_bf16 v[8:11], v[160:163], a[40:43], v[8:11]
    v_mul_f32 v222, v96, v96
    v_fmaak_f32 v222, v222, v208, 0xc0135761
    v_mfma_f32_16x16x32_bf16 v[8:11], v[164:167], a[56:59], v[8:11]
    s_add_u32 m0, s42, 122880
    v_mul_f32 v222, v222, v96
    v_mul_f32 v226, v96, v112
    v_mfma_f32_16x16x32_bf16 v[12:15], v[160:163], a[44:47], v[12:15]
    v_exp_f32 v222, v222
    v_mfma_f32_16x16x32_bf16 v[12:15], v[164:167], a[60:63], v[12:15]
    s_waitcnt lgkmcnt(10)
    buffer_load_dwordx4 v237, s[16:19], s92 offen offset:1024 lds
    v_mfma_f32_16x16x32_bf16 v[16:19], v[168:171], a[32:35], v[16:19]
    s_waitcnt lgkmcnt(8)
    v_add_f32 v222, 1.0, v222
    v_mul_f32 v223, v97, v97
    v_mfma_f32_16x16x32_bf16 v[16:19], v[172:175], a[48:51], v[16:19]
    v_rcp_f32 v222, v222
    v_mfma_f32_16x16x32_bf16 v[20:23], v[168:171], a[36:39], v[20:23]
    s_waitcnt vmcnt(6)
    v_mul_f32 v226, v226, v222
    v_fmaak_f32 v223, v223, v208, 0xc0135761
    v_mfma_f32_16x16x32_bf16 v[20:23], v[172:175], a[52:55], v[20:23]
    s_barrier
    v_mul_f32 v223, v223, v97
    v_exp_f32 v223, v223
    v_mfma_f32_16x16x32_bf16 v[24:27], v[168:171], a[40:43], v[24:27]
    ds_read_b64_tr_b16 v[160:161], v214 offset:0
    ds_read_b64_tr_b16 v[162:163], v214 offset:512
    v_mfma_f32_16x16x32_bf16 v[24:27], v[172:175], a[56:59], v[24:27]
    ds_read_b64_tr_b16 v[164:165], v214 offset:8192
    ds_read_b64_tr_b16 v[166:167], v214 offset:8704
    v_mfma_f32_16x16x32_bf16 v[28:31], v[168:171], a[44:47], v[28:31]
    s_add_u32 s72, s55, 1
    v_mov_b32 v242, s72
    v_mul_f32 v227, v97, v113
    v_mfma_f32_16x16x32_bf16 v[28:31], v[172:175], a[60:63], v[28:31]
    s_waitcnt lgkmcnt(10)
    buffer_store_dword v242, v241, s[28:31], 0 offen sc1
    v_mfma_f32_16x16x32_bf16 v[32:35], v[176:179], a[32:35], v[32:35]
    s_waitcnt lgkmcnt(8)
    ds_read_b64_tr_b16 v[168:169], v214 offset:2048
    ds_read_b64_tr_b16 v[170:171], v214 offset:2560
    v_mfma_f32_16x16x32_bf16 v[32:35], v[180:183], a[48:51], v[32:35]
    ds_read_b64_tr_b16 v[172:173], v214 offset:10240
    ds_read_b64_tr_b16 v[174:175], v214 offset:10752
    v_mfma_f32_16x16x32_bf16 v[36:39], v[176:179], a[36:39], v[36:39]
    s_add_u32 m0, s40, 32768
    s_add_u32 s71, s44, 2949376
    v_add_f32 v223, 1.0, v223
    v_mfma_f32_16x16x32_bf16 v[36:39], v[180:183], a[52:55], v[36:39]
    v_rcp_f32 v223, v223
    v_mfma_f32_16x16x32_bf16 v[40:43], v[176:179], a[40:43], v[40:43]
    buffer_load_dwordx4 v210, s[8:11], s71 offen lds
    v_mfma_f32_16x16x32_bf16 v[40:43], v[180:183], a[56:59], v[40:43]
    v_mul_f32 v227, v227, v223
    v_mul_f32 v224, v98, v98
    v_mfma_f32_16x16x32_bf16 v[44:47], v[176:179], a[44:47], v[44:47]
    v_fmaak_f32 v224, v224, v208, 0xc0135761
    v_mul_f32 v224, v224, v98
    v_mfma_f32_16x16x32_bf16 v[44:47], v[180:183], a[60:63], v[44:47]
    s_waitcnt lgkmcnt(10)
    ds_read_b64_tr_b16 v[176:177], v217 offset:0
    ds_read_b64_tr_b16 v[178:179], v217 offset:512
    v_mfma_f32_16x16x32_bf16 v[48:51], v[184:187], a[32:35], v[48:51]
    s_waitcnt lgkmcnt(10)
    ds_read_b64_tr_b16 v[180:181], v217 offset:8192
    ds_read_b64_tr_b16 v[182:183], v217 offset:8704
    v_mfma_f32_16x16x32_bf16 v[48:51], v[188:191], a[48:51], v[48:51]
    buffer_load_dwordx4 v211, s[8:11], s71 offen offset:1024 lds
    v_mfma_f32_16x16x32_bf16 v[52:55], v[184:187], a[36:39], v[52:55]
    s_add_u32 m0, s40, 34816
    v_exp_f32 v224, v224
    v_mfma_f32_16x16x32_bf16 v[52:55], v[188:191], a[52:55], v[52:55]
    v_mul_f32 v228, v98, v114
    v_add_f32 v224, 1.0, v224
    v_mfma_f32_16x16x32_bf16 v[56:59], v[184:187], a[40:43], v[56:59]
    v_rcp_f32 v224, v224
    v_mfma_f32_16x16x32_bf16 v[56:59], v[188:191], a[56:59], v[56:59]
    v_mul_f32 v228, v228, v224
    v_mul_f32 v225, v99, v99
    v_mfma_f32_16x16x32_bf16 v[60:63], v[184:187], a[44:47], v[60:63]
    buffer_load_dwordx4 v210, s[12:15], s71 offen lds
    v_fmaak_f32 v225, v225, v208, 0xc0135761
    v_mfma_f32_16x16x32_bf16 v[60:63], v[188:191], a[60:63], v[60:63]
    s_waitcnt lgkmcnt(10)
    ds_read_b64_tr_b16 v[184:185], v217 offset:2048
    ds_read_b64_tr_b16 v[186:187], v217 offset:2560
    v_mfma_f32_16x16x32_bf16 v[0:3], v[160:163], a[64:67], v[0:3]
    s_waitcnt lgkmcnt(10)
    ds_read_b64_tr_b16 v[188:189], v217 offset:10240
    ds_read_b64_tr_b16 v[190:191], v217 offset:10752
    v_mfma_f32_16x16x32_bf16 v[0:3], v[164:167], a[80:83], v[0:3]
    v_mul_f32 v225, v225, v99
    v_mul_f32 v229, v99, v115
    v_mfma_f32_16x16x32_bf16 v[4:7], v[160:163], a[68:71], v[4:7]
    v_exp_f32 v225, v225
    v_mfma_f32_16x16x32_bf16 v[4:7], v[164:167], a[84:87], v[4:7]
    s_add_u32 s75, s78, 811008
    buffer_load_dword v255, v244, s[16:19], s75 offen
    v_mfma_f32_16x16x32_bf16 v[8:11], v[160:163], a[72:75], v[8:11]
    v_add_f32 v225, 1.0, v225
    v_cvt_pk_bf16_f32 v202, v226, v227
    v_mfma_f32_16x16x32_bf16 v[8:11], v[164:167], a[88:91], v[8:11]
    v_rcp_f32 v225, v225
    v_mfma_f32_16x16x32_bf16 v[12:15], v[160:163], a[76:79], v[12:15]
    v_mul_f32 v229, v229, v225
    v_cvt_pk_bf16_f32 v203, v228, v229
    v_mfma_f32_16x16x32_bf16 v[12:15], v[164:167], a[92:95], v[12:15]
    s_waitcnt lgkmcnt(10)
    v_mul_f32 v192, v68, v68
    v_fmaak_f32 v192, v192, v208, 0xc0135761
    v_mfma_f32_16x16x32_bf16 v[16:19], v[168:171], a[64:67], v[16:19]
    s_waitcnt lgkmcnt(8)
    buffer_load_dwordx4 v211, s[12:15], s71 offen offset:1024 lds
    v_mfma_f32_16x16x32_bf16 v[16:19], v[172:175], a[80:83], v[16:19]
    s_add_u32 m0, s42, 122880
    v_mul_f32 v192, v192, v68
    v_mul_f32 v196, v68, v84
    v_mfma_f32_16x16x32_bf16 v[20:23], v[168:171], a[68:71], v[20:23]
    v_exp_f32 v192, v192
    v_mfma_f32_16x16x32_bf16 v[20:23], v[172:175], a[84:87], v[20:23]
    s_barrier
    v_add_f32 v192, 1.0, v192
    v_mul_f32 v193, v69, v69
    v_mfma_f32_16x16x32_bf16 v[24:27], v[168:171], a[72:75], v[24:27]
    ds_read_b64_tr_b16 v[160:161], v213 offset:0
    ds_read_b64_tr_b16 v[162:163], v213 offset:512
    v_mfma_f32_16x16x32_bf16 v[24:27], v[172:175], a[88:91], v[24:27]
    buffer_load_dwordx4 v238, s[16:19], s92 offen offset:2048 lds
    v_mfma_f32_16x16x32_bf16 v[28:31], v[168:171], a[76:79], v[28:31]
    s_add_u32 m0, s42, 122880
    ds_read_b64_tr_b16 v[164:165], v213 offset:8192
    ds_read_b64_tr_b16 v[166:167], v213 offset:8704
    v_mfma_f32_16x16x32_bf16 v[28:31], v[172:175], a[92:95], v[28:31]
    s_waitcnt lgkmcnt(10)
    ds_read_b64_tr_b16 v[168:169], v213 offset:2048
    ds_read_b64_tr_b16 v[170:171], v213 offset:2560
    v_mfma_f32_16x16x32_bf16 v[32:35], v[176:179], a[64:67], v[32:35]
    s_waitcnt lgkmcnt(10)
    ds_read_b64_tr_b16 v[172:173], v213 offset:10240
    ds_read_b64_tr_b16 v[174:175], v213 offset:10752
    v_fmaak_f32 v193, v193, v208, 0xc0135761
    v_mfma_f32_16x16x32_bf16 v[32:35], v[180:183], a[80:83], v[32:35]
    buffer_load_dwordx4 v239, s[16:19], s92 offen offset:3072 lds
    v_mfma_f32_16x16x32_bf16 v[36:39], v[176:179], a[68:71], v[36:39]
    s_add_u32 m0, s40, 49152
    s_add_u32 s70, s44, 3539200
    v_mul_f32 v193, v193, v69
    v_mfma_f32_16x16x32_bf16 v[36:39], v[180:183], a[84:87], v[36:39]
    v_rcp_f32 v192, v192
    v_mfma_f32_16x16x32_bf16 v[40:43], v[176:179], a[72:75], v[40:43]
    v_exp_f32 v193, v193
    v_mfma_f32_16x16x32_bf16 v[40:43], v[180:183], a[88:91], v[40:43]
    v_mul_f32 v196, v196, v192
    v_mul_f32 v197, v69, v85
    v_mfma_f32_16x16x32_bf16 v[44:47], v[176:179], a[76:79], v[44:47]
    buffer_load_dwordx4 v210, s[8:11], s70 offen lds
    v_mfma_f32_16x16x32_bf16 v[44:47], v[180:183], a[92:95], v[44:47]
    s_waitcnt lgkmcnt(10)
    ds_read_b64_tr_b16 v[176:177], v216 offset:0
    ds_read_b64_tr_b16 v[178:179], v216 offset:512
    v_mfma_f32_16x16x32_bf16 v[48:51], v[184:187], a[64:67], v[48:51]
    s_waitcnt lgkmcnt(10)
    ds_read_b64_tr_b16 v[180:181], v216 offset:8192
    ds_read_b64_tr_b16 v[182:183], v216 offset:8704
    v_mfma_f32_16x16x32_bf16 v[48:51], v[188:191], a[80:83], v[48:51]
    v_add_f32 v193, 1.0, v193
    v_mul_f32 v194, v70, v70
    v_mfma_f32_16x16x32_bf16 v[52:55], v[184:187], a[68:71], v[52:55]
    v_rcp_f32 v193, v193
    v_mfma_f32_16x16x32_bf16 v[52:55], v[188:191], a[84:87], v[52:55]
    buffer_load_dwordx4 v211, s[8:11], s70 offen offset:1024 lds
    v_mfma_f32_16x16x32_bf16 v[56:59], v[184:187], a[72:75], v[56:59]
    s_add_u32 m0, s40, 51200
    v_mul_f32 v197, v197, v193
    v_fmaak_f32 v194, v194, v208, 0xc0135761
    v_mfma_f32_16x16x32_bf16 v[56:59], v[188:191], a[88:91], v[56:59]
    v_mul_f32 v194, v194, v70
    v_exp_f32 v194, v194
    v_mfma_f32_16x16x32_bf16 v[60:63], v[184:187], a[76:79], v[60:63]
    v_mul_f32 v198, v70, v86
    v_add_f32 v194, 1.0, v194
    v_mfma_f32_16x16x32_bf16 v[60:63], v[188:191], a[92:95], v[60:63]
    s_waitcnt lgkmcnt(10)
    ds_read_b64_tr_b16 v[184:185], v216 offset:2048
    ds_read_b64_tr_b16 v[186:187], v216 offset:2560
    v_mfma_f32_16x16x32_bf16 v[0:3], v[160:163], a[96:99], v[0:3]
    s_waitcnt lgkmcnt(10)
    buffer_load_dwordx4 v210, s[12:15], s70 offen lds
    v_mfma_f32_16x16x32_bf16 v[0:3], v[164:167], a[112:115], v[0:3]
    ds_read_b64_tr_b16 v[188:189], v216 offset:10240
    ds_read_b64_tr_b16 v[190:191], v216 offset:10752
    v_mfma_f32_16x16x32_bf16 v[4:7], v[160:163], a[100:103], v[4:7]
    v_rcp_f32 v194, v194
    v_mfma_f32_16x16x32_bf16 v[4:7], v[164:167], a[116:119], v[4:7]
    v_mul_f32 v198, v198, v194
    v_mul_f32 v195, v71, v71
    v_mfma_f32_16x16x32_bf16 v[8:11], v[160:163], a[104:107], v[8:11]
    v_fmaak_f32 v195, v195, v208, 0xc0135761
    v_mul_f32 v195, v195, v71
    v_mfma_f32_16x16x32_bf16 v[8:11], v[164:167], a[120:123], v[8:11]
    buffer_load_dwordx4 v211, s[12:15], s70 offen offset:1024 lds
    v_mfma_f32_16x16x32_bf16 v[12:15], v[160:163], a[108:111], v[12:15]
    s_add_u32 m0, s42, 126976
    v_exp_f32 v195, v195
    v_mfma_f32_16x16x32_bf16 v[12:15], v[164:167], a[124:127], v[12:15]
    s_waitcnt lgkmcnt(10)
    v_mul_f32 v199, v71, v87
    v_add_f32 v195, 1.0, v195
    v_mfma_f32_16x16x32_bf16 v[16:19], v[168:171], a[96:99], v[16:19]
    s_waitcnt lgkmcnt(8)
    v_rcp_f32 v195, v195
    v_mfma_f32_16x16x32_bf16 v[16:19], v[172:175], a[112:115], v[16:19]
    v_mul_f32 v199, v199, v195
    v_cvt_pk_bf16_f32 v204, v196, v197
    v_mfma_f32_16x16x32_bf16 v[20:23], v[168:171], a[100:103], v[20:23]
    s_waitcnt vmcnt(16)
    buffer_store_dwordx4 v[200:203], v209, s[20:23], s97 offen sc1
    v_mfma_f32_16x16x32_bf16 v[20:23], v[172:175], a[116:119], v[20:23]
    s_barrier
    v_cvt_pk_bf16_f32 v205, v198, v199
    v_mul_f32 v222, v100, v100
    v_fmaak_f32 v222, v222, v208, 0xc0135761
    v_mfma_f32_16x16x32_bf16 v[24:27], v[168:171], a[104:107], v[24:27]
    s_add_u32 s97, s48, 2048
    ds_read_b64_tr_b16 v[160:161], v213 offset:16384
    ds_read_b64_tr_b16 v[162:163], v213 offset:16896
    v_mfma_f32_16x16x32_bf16 v[24:27], v[172:175], a[120:123], v[24:27]
    buffer_load_dwordx4 v240, s[16:19], s92 offen lds
    v_mfma_f32_16x16x32_bf16 v[28:31], v[168:171], a[108:111], v[28:31]
    ds_read_b64_tr_b16 v[164:165], v213 offset:24576
    ds_read_b64_tr_b16 v[166:167], v213 offset:25088
    v_mfma_f32_16x16x32_bf16 v[28:31], v[172:175], a[124:127], v[28:31]
    s_waitcnt lgkmcnt(10)
    ds_read_b64_tr_b16 v[168:169], v213 offset:18432
    ds_read_b64_tr_b16 v[170:171], v213 offset:18944
    v_mfma_f32_16x16x32_bf16 v[32:35], v[176:179], a[96:99], v[32:35]
    s_waitcnt lgkmcnt(10)
    ds_read_b64_tr_b16 v[172:173], v213 offset:26624
    ds_read_b64_tr_b16 v[174:175], v213 offset:27136
    v_mfma_f32_16x16x32_bf16 v[32:35], v[180:183], a[112:115], v[32:35]
    s_add_u32 m0, s40, 65536
    s_add_u32 s71, s44, 4129024
    v_mul_f32 v222, v222, v100
    v_mfma_f32_16x16x32_bf16 v[36:39], v[176:179], a[100:103], v[36:39]
    buffer_load_dwordx4 v210, s[8:11], s71 offen lds
    v_mfma_f32_16x16x32_bf16 v[36:39], v[180:183], a[116:119], v[36:39]
    v_exp_f32 v222, v222
    v_mfma_f32_16x16x32_bf16 v[40:43], v[176:179], a[104:107], v[40:43]
    v_mul_f32 v226, v100, v116
    v_add_f32 v222, 1.0, v222
    v_mfma_f32_16x16x32_bf16 v[40:43], v[180:183], a[120:123], v[40:43]
    v_rcp_f32 v222, v222
    v_mfma_f32_16x16x32_bf16 v[44:47], v[176:179], a[108:111], v[44:47]
    v_mul_f32 v226, v226, v222
    v_mul_f32 v223, v101, v101
    v_mfma_f32_16x16x32_bf16 v[44:47], v[180:183], a[124:127], v[44:47]
    s_waitcnt lgkmcnt(10)
    buffer_load_dwordx4 v211, s[8:11], s71 offen offset:1024 lds
    v_mfma_f32_16x16x32_bf16 v[48:51], v[184:187], a[96:99], v[48:51]
    s_add_u32 m0, s40, 67584
    ds_read_b64_tr_b16 v[176:177], v216 offset:16384
    ds_read_b64_tr_b16 v[178:179], v216 offset:16896
    s_waitcnt lgkmcnt(10)
    v_mfma_f32_16x16x32_bf16 v[48:51], v[188:191], a[112:115], v[48:51]
    ds_read_b64_tr_b16 v[180:181], v216 offset:24576
    ds_read_b64_tr_b16 v[182:183], v216 offset:25088
    v_fmaak_f32 v223, v223, v208, 0xc0135761
    v_mfma_f32_16x16x32_bf16 v[52:55], v[184:187], a[100:103], v[52:55]
    v_mul_f32 v223, v223, v101
    v_mul_f32 v227, v101, v117
    v_mfma_f32_16x16x32_bf16 v[52:55], v[188:191], a[116:119], v[52:55]
    v_exp_f32 v223, v223
    v_mfma_f32_16x16x32_bf16 v[56:59], v[184:187], a[104:107], v[56:59]
    buffer_load_dwordx4 v210, s[12:15], s71 offen lds
    v_mfma_f32_16x16x32_bf16 v[56:59], v[188:191], a[120:123], v[56:59]
    v_add_f32 v223, 1.0, v223
    v_mul_f32 v224, v102, v102
    v_mfma_f32_16x16x32_bf16 v[60:63], v[184:187], a[108:111], v[60:63]
    v_rcp_f32 v223, v223
    v_mfma_f32_16x16x32_bf16 v[60:63], v[188:191], a[124:127], v[60:63]
    s_waitcnt lgkmcnt(10)
    ds_read_b64_tr_b16 v[184:185], v216 offset:18432
    ds_read_b64_tr_b16 v[186:187], v216 offset:18944
    v_mfma_f32_16x16x32_bf16 v[0:3], v[160:163], a[128:131], v[0:3]
    s_waitcnt lgkmcnt(10)
    ds_read_b64_tr_b16 v[188:189], v216 offset:26624
    ds_read_b64_tr_b16 v[190:191], v216 offset:27136
    v_mfma_f32_16x16x32_bf16 v[0:3], v[164:167], a[144:147], v[0:3]
    s_add_u32 s72, s78, 221184
    buffer_load_dword v255, v244, s[16:19], s72 offen
    v_mfma_f32_16x16x32_bf16 v[4:7], v[160:163], a[132:135], v[4:7]
    s_add_u32 s93, s52, 0
    v_mul_f32 v227, v227, v223
    v_fmaak_f32 v224, v224, v208, 0xc0135761
    v_mfma_f32_16x16x32_bf16 v[4:7], v[164:167], a[148:151], v[4:7]
    v_mul_f32 v224, v224, v102
    v_mul_f32 v228, v102, v118
    v_mfma_f32_16x16x32_bf16 v[8:11], v[160:163], a[136:139], v[8:11]
    v_exp_f32 v224, v224
    v_mfma_f32_16x16x32_bf16 v[8:11], v[164:167], a[152:155], v[8:11]
    v_add_f32 v224, 1.0, v224
    v_rcp_f32 v224, v224
    v_mfma_f32_16x16x32_bf16 v[12:15], v[160:163], a[140:143], v[12:15]
    buffer_load_dwordx4 v211, s[12:15], s71 offen offset:1024 lds
    v_mfma_f32_16x16x32_bf16 v[12:15], v[164:167], a[156:159], v[12:15]
    s_add_u32 m0, s42, 81920
    v_mul_f32 v228, v228, v224
    v_mul_f32 v225, v103, v103
    s_waitcnt lgkmcnt(10)
    v_mfma_f32_16x16x32_bf16 v[16:19], v[168:171], a[128:131], v[16:19]
    s_waitcnt lgkmcnt(8)
    v_fmaak_f32 v225, v225, v208, 0xc0135761
    v_mul_f32 v225, v225, v103
    v_mfma_f32_16x16x32_bf16 v[16:19], v[172:175], a[144:147], v[16:19]
    v_exp_f32 v225, v225
    v_mfma_f32_16x16x32_bf16 v[20:23], v[168:171], a[132:135], v[20:23]
    s_waitcnt vmcnt(13)
    v_mul_f32 v229, v103, v119
    v_add_f32 v225, 1.0, v225
    v_mfma_f32_16x16x32_bf16 v[20:23], v[172:175], a[148:151], v[20:23]
    s_barrier
    v_rcp_f32 v225, v225
    v_mfma_f32_16x16x32_bf16 v[24:27], v[168:171], a[136:139], v[24:27]
    buffer_load_dwordx4 v232, s[16:19], s93 offen lds
    v_mfma_f32_16x16x32_bf16 v[24:27], v[172:175], a[152:155], v[24:27]
    s_add_u32 m0, s42, 81920
    ds_read_b64_tr_b16 v[160:161], v213 offset:32768
    ds_read_b64_tr_b16 v[162:163], v213 offset:33280
    v_mfma_f32_16x16x32_bf16 v[28:31], v[168:171], a[140:143], v[28:31]
    ds_read_b64_tr_b16 v[164:165], v213 offset:40960
    ds_read_b64_tr_b16 v[166:167], v213 offset:41472
    v_mfma_f32_16x16x32_bf16 v[28:31], v[172:175], a[156:159], v[28:31]
    s_waitcnt lgkmcnt(10)
    ds_read_b64_tr_b16 v[168:169], v213 offset:34816
    ds_read_b64_tr_b16 v[170:171], v213 offset:35328
    v_mfma_f32_16x16x32_bf16 v[32:35], v[176:179], a[128:131], v[32:35]
    s_waitcnt lgkmcnt(10)
    ds_read_b64_tr_b16 v[172:173], v213 offset:43008
    ds_read_b64_tr_b16 v[174:175], v213 offset:43520
    v_mfma_f32_16x16x32_bf16 v[32:35], v[180:183], a[144:147], v[32:35]
    buffer_load_dwordx4 v233, s[16:19], s93 offen offset:1024 lds
    v_mfma_f32_16x16x32_bf16 v[36:39], v[176:179], a[132:135], v[36:39]
    s_add_u32 m0, s40, 0
    s_add_u32 s70, s44, 4718848
    v_mul_f32 v229, v229, v225
    v_cvt_pk_bf16_f32 v206, v226, v227
    v_mfma_f32_16x16x32_bf16 v[36:39], v[180:183], a[148:151], v[36:39]
    v_cvt_pk_bf16_f32 v207, v228, v229
    v_mul_f32 v192, v72, v72
    v_mfma_f32_16x16x32_bf16 v[40:43], v[176:179], a[136:139], v[40:43]
    v_fmaak_f32 v192, v192, v208, 0xc0135761
    v_mul_f32 v192, v192, v72
    v_mfma_f32_16x16x32_bf16 v[40:43], v[180:183], a[152:155], v[40:43]
    v_exp_f32 v192, v192
    v_mfma_f32_16x16x32_bf16 v[44:47], v[176:179], a[140:143], v[44:47]
    buffer_load_dwordx4 v210, s[8:11], s70 offen lds
    v_mfma_f32_16x16x32_bf16 v[44:47], v[180:183], a[156:159], v[44:47]
    s_waitcnt lgkmcnt(10)
    ds_read_b64_tr_b16 v[176:177], v216 offset:32768
    ds_read_b64_tr_b16 v[178:179], v216 offset:33280
    v_mfma_f32_16x16x32_bf16 v[48:51], v[184:187], a[128:131], v[48:51]
    s_waitcnt lgkmcnt(10)
    ds_read_b64_tr_b16 v[180:181], v216 offset:40960
    ds_read_b64_tr_b16 v[182:183], v216 offset:41472
    v_mfma_f32_16x16x32_bf16 v[48:51], v[188:191], a[144:147], v[48:51]
    v_mul_f32 v196, v72, v88
    v_add_f32 v192, 1.0, v192
    v_mfma_f32_16x16x32_bf16 v[52:55], v[184:187], a[132:135], v[52:55]
    v_rcp_f32 v192, v192
    v_mfma_f32_16x16x32_bf16 v[52:55], v[188:191], a[148:151], v[52:55]
    buffer_load_dwordx4 v211, s[8:11], s70 offen offset:1024 lds
    v_mfma_f32_16x16x32_bf16 v[56:59], v[184:187], a[136:139], v[56:59]
    s_add_u32 m0, s40, 2048
    v_mul_f32 v196, v196, v192
    v_mul_f32 v193, v73, v73
    v_fmaak_f32 v193, v193, v208, 0xc0135761
    v_mfma_f32_16x16x32_bf16 v[56:59], v[188:191], a[152:155], v[56:59]
    v_mul_f32 v193, v193, v73
    v_mul_f32 v197, v73, v89
    v_mfma_f32_16x16x32_bf16 v[60:63], v[184:187], a[140:143], v[60:63]
    v_exp_f32 v193, v193
    v_mfma_f32_16x16x32_bf16 v[60:63], v[188:191], a[156:159], v[60:63]
    s_waitcnt lgkmcnt(10)
    ds_read_b64_tr_b16 v[184:185], v216 offset:34816
    ds_read_b64_tr_b16 v[186:187], v216 offset:35328
    v_mfma_f32_16x16x32_bf16 v[0:3], v[160:163], a[160:163], v[0:3]
    s_waitcnt lgkmcnt(10)
    buffer_load_dwordx4 v210, s[12:15], s70 offen lds
    v_mfma_f32_16x16x32_bf16 v[0:3], v[164:167], a[176:179], v[0:3]
    ds_read_b64_tr_b16 v[188:189], v216 offset:43008
    ds_read_b64_tr_b16 v[190:191], v216 offset:43520
    v_mfma_f32_16x16x32_bf16 v[4:7], v[160:163], a[164:167], v[4:7]
    v_add_f32 v193, 1.0, v193
    v_mul_f32 v194, v74, v74
    v_mfma_f32_16x16x32_bf16 v[4:7], v[164:167], a[180:183], v[4:7]
    v_rcp_f32 v193, v193
    v_mfma_f32_16x16x32_bf16 v[8:11], v[160:163], a[168:171], v[8:11]
    v_mul_f32 v197, v197, v193
    v_fmaak_f32 v194, v194, v208, 0xc0135761
    v_mfma_f32_16x16x32_bf16 v[8:11], v[164:167], a[184:187], v[8:11]
    buffer_load_dwordx4 v211, s[12:15], s70 offen offset:1024 lds
    v_mfma_f32_16x16x32_bf16 v[12:15], v[160:163], a[172:175], v[12:15]
    s_add_u32 m0, s42, 81920
    v_mul_f32 v194, v194, v74
    v_exp_f32 v194, v194
    v_mfma_f32_16x16x32_bf16 v[12:15], v[164:167], a[188:191], v[12:15]
    s_waitcnt lgkmcnt(10)
    v_mul_f32 v198, v74, v90
    v_add_f32 v194, 1.0, v194
    v_mfma_f32_16x16x32_bf16 v[16:19], v[168:171], a[160:163], v[16:19]
    s_waitcnt lgkmcnt(8)
    v_rcp_f32 v194, v194
    v_mfma_f32_16x16x32_bf16 v[16:19], v[172:175], a[176:179], v[16:19]
    v_mul_f32 v198, v198, v194
    v_mul_f32 v195, v75, v75
    v_mfma_f32_16x16x32_bf16 v[20:23], v[168:171], a[164:167], v[20:23]
    s_waitcnt vmcnt(13)
    buffer_store_dwordx4 v[204:207], v209, s[20:23], s98 offen sc1
    v_mfma_f32_16x16x32_bf16 v[20:23], v[172:175], a[180:183], v[20:23]
    s_barrier
    v_fmaak_f32 v195, v195, v208, 0xc0135761
    v_mul_f32 v195, v195, v75
    v_mfma_f32_16x16x32_bf16 v[24:27], v[168:171], a[168:171], v[24:27]
    s_add_u32 s98, s49, 2048
    ds_read_b64_tr_b16 v[160:161], v213 offset:49152
    ds_read_b64_tr_b16 v[162:163], v213 offset:49664
    v_mfma_f32_16x16x32_bf16 v[24:27], v[172:175], a[184:187], v[24:27]
    buffer_load_dwordx4 v234, s[16:19], s93 offen offset:2048 lds
    v_mfma_f32_16x16x32_bf16 v[28:31], v[168:171], a[172:175], v[28:31]
    s_add_u32 m0, s42, 81920
    ds_read_b64_tr_b16 v[164:165], v213 offset:57344
    ds_read_b64_tr_b16 v[166:167], v213 offset:57856
    v_mfma_f32_16x16x32_bf16 v[28:31], v[172:175], a[188:191], v[28:31]
    s_waitcnt lgkmcnt(10)
    ds_read_b64_tr_b16 v[168:169], v213 offset:51200
    ds_read_b64_tr_b16 v[170:171], v213 offset:51712
    v_mfma_f32_16x16x32_bf16 v[32:35], v[176:179], a[160:163], v[32:35]
    s_waitcnt lgkmcnt(10)
    ds_read_b64_tr_b16 v[172:173], v213 offset:59392
    ds_read_b64_tr_b16 v[174:175], v213 offset:59904
    v_mfma_f32_16x16x32_bf16 v[32:35], v[180:183], a[176:179], v[32:35]
    buffer_load_dwordx4 v235, s[16:19], s93 offen offset:3072 lds
    v_mfma_f32_16x16x32_bf16 v[36:39], v[176:179], a[164:167], v[36:39]
    s_add_u32 m0, s40, 16384
    s_add_u32 s71, s44, 384
    v_exp_f32 v195, v195
    v_mfma_f32_16x16x32_bf16 v[36:39], v[180:183], a[180:183], v[36:39]
    v_mul_f32 v199, v75, v91
    v_add_f32 v195, 1.0, v195
    v_mfma_f32_16x16x32_bf16 v[40:43], v[176:179], a[168:171], v[40:43]
    v_rcp_f32 v195, v195
    v_mfma_f32_16x16x32_bf16 v[40:43], v[180:183], a[184:187], v[40:43]
    v_mul_f32 v199, v199, v195
    v_cvt_pk_bf16_f32 v200, v196, v197
    v_mfma_f32_16x16x32_bf16 v[44:47], v[176:179], a[172:175], v[44:47]
    buffer_load_dwordx4 v210, s[8:11], s71 offen lds
    v_mfma_f32_16x16x32_bf16 v[44:47], v[180:183], a[188:191], v[44:47]
    s_waitcnt lgkmcnt(10)
    ds_read_b64_tr_b16 v[176:177], v216 offset:49152
    ds_read_b64_tr_b16 v[178:179], v216 offset:49664
    v_mfma_f32_16x16x32_bf16 v[48:51], v[184:187], a[160:163], v[48:51]
    s_waitcnt lgkmcnt(10)
    ds_read_b64_tr_b16 v[180:181], v216 offset:57344
    ds_read_b64_tr_b16 v[182:183], v216 offset:57856
    v_mfma_f32_16x16x32_bf16 v[48:51], v[188:191], a[176:179], v[48:51]
    v_cvt_pk_bf16_f32 v201, v198, v199
    v_mul_f32 v222, v104, v104
    v_mfma_f32_16x16x32_bf16 v[52:55], v[184:187], a[164:167], v[52:55]
    v_fmaak_f32 v222, v222, v208, 0xc0135761
    v_mul_f32 v222, v222, v104
    v_mfma_f32_16x16x32_bf16 v[52:55], v[188:191], a[180:183], v[52:55]
    buffer_load_dwordx4 v211, s[8:11], s71 offen offset:1024 lds
    v_mul_f32 v226, v104, v120
    v_mfma_f32_16x16x32_bf16 v[56:59], v[184:187], a[168:171], v[56:59]
    s_add_u32 m0, s40, 18432
    v_exp_f32 v222, v222
    v_mfma_f32_16x16x32_bf16 v[56:59], v[188:191], a[184:187], v[56:59]
    v_add_f32 v222, 1.0, v222
    v_mul_f32 v223, v105, v105
    v_mfma_f32_16x16x32_bf16 v[60:63], v[184:187], a[172:175], v[60:63]
    v_rcp_f32 v222, v222
    v_mfma_f32_16x16x32_bf16 v[60:63], v[188:191], a[188:191], v[60:63]
    s_waitcnt lgkmcnt(10)
    ds_read_b64_tr_b16 v[184:185], v216 offset:51200
    ds_read_b64_tr_b16 v[186:187], v216 offset:51712
    v_mfma_f32_16x16x32_bf16 v[0:3], v[160:163], a[192:195], v[0:3]
    s_add_u32 s73, s78, 884736
    buffer_load_dword v255, v244, s[16:19], s73 offen
    s_waitcnt lgkmcnt(10)
    v_mfma_f32_16x16x32_bf16 v[0:3], v[164:167], a[208:211], v[0:3]
    ds_read_b64_tr_b16 v[188:189], v216 offset:59392
    ds_read_b64_tr_b16 v[190:191], v216 offset:59904
    v_mfma_f32_16x16x32_bf16 v[4:7], v[160:163], a[196:199], v[4:7]
    v_mul_f32 v226, v226, v222
    v_fmaak_f32 v223, v223, v208, 0xc0135761
    v_mfma_f32_16x16x32_bf16 v[4:7], v[164:167], a[212:215], v[4:7]
    v_mul_f32 v223, v223, v105
    v_exp_f32 v223, v223
    v_mfma_f32_16x16x32_bf16 v[8:11], v[160:163], a[200:203], v[8:11]
    v_mul_f32 v227, v105, v121
    v_add_f32 v223, 1.0, v223
    v_mfma_f32_16x16x32_bf16 v[8:11], v[164:167], a[216:219], v[8:11]
    buffer_load_dwordx4 v210, s[12:15], s71 offen lds
    v_mfma_f32_16x16x32_bf16 v[12:15], v[160:163], a[204:207], v[12:15]
    v_rcp_f32 v223, v223
    v_mfma_f32_16x16x32_bf16 v[12:15], v[164:167], a[220:223], v[12:15]
    s_waitcnt lgkmcnt(10)
    v_mul_f32 v227, v227, v223
    v_mul_f32 v224, v106, v106
    v_mfma_f32_16x16x32_bf16 v[16:19], v[168:171], a[192:195], v[16:19]
    s_waitcnt lgkmcnt(8)
    v_fmaak_f32 v224, v224, v208, 0xc0135761
    v_mul_f32 v224, v224, v106
    v_mfma_f32_16x16x32_bf16 v[16:19], v[172:175], a[208:211], v[16:19]
    v_exp_f32 v224, v224
    v_mfma_f32_16x16x32_bf16 v[20:23], v[168:171], a[196:199], v[20:23]
    s_waitcnt vmcnt(13)
    v_mul_f32 v228, v106, v122
    v_add_f32 v224, 1.0, v224
    v_mfma_f32_16x16x32_bf16 v[20:23], v[172:175], a[212:215], v[20:23]
    s_barrier
    v_rcp_f32 v224, v224
    v_mfma_f32_16x16x32_bf16 v[24:27], v[168:171], a[200:203], v[24:27]
    buffer_load_dwordx4 v211, s[12:15], s71 offen offset:1024 lds
    v_mfma_f32_16x16x32_bf16 v[24:27], v[172:175], a[216:219], v[24:27]
    s_add_u32 m0, s42, 86016
    s_nop 0
    buffer_load_dwordx4 v236, s[16:19], s93 offen lds
    v_mfma_f32_16x16x32_bf16 v[28:31], v[168:171], a[204:207], v[28:31]
    s_add_u32 m0, s42, 86016
    ds_read_b64_tr_b16 v[160:161], v214 offset:0
    ds_read_b64_tr_b16 v[162:163], v214 offset:512
    v_mul_f32 v228, v228, v224
    v_mfma_f32_16x16x32_bf16 v[28:31], v[172:175], a[220:223], v[28:31]
    s_waitcnt lgkmcnt(8)
    ds_read_b64_tr_b16 v[164:165], v214 offset:8192
    ds_read_b64_tr_b16 v[166:167], v214 offset:8704
    v_mfma_f32_16x16x32_bf16 v[32:35], v[176:179], a[192:195], v[32:35]
    s_waitcnt lgkmcnt(8)
    ds_read_b64_tr_b16 v[168:169], v214 offset:2048
    ds_read_b64_tr_b16 v[170:171], v214 offset:2560
    v_mfma_f32_16x16x32_bf16 v[32:35], v[180:183], a[208:211], v[32:35]
    buffer_load_dwordx4 v237, s[16:19], s93 offen offset:1024 lds
    v_mfma_f32_16x16x32_bf16 v[36:39], v[176:179], a[196:199], v[36:39]
    ds_read_b64_tr_b16 v[172:173], v214 offset:10240
    ds_read_b64_tr_b16 v[174:175], v214 offset:10752
    v_mfma_f32_16x16x32_bf16 v[36:39], v[180:183], a[212:215], v[36:39]
    s_add_u32 m0, s40, 32768
    s_add_u32 s70, s44, 590208
    v_mul_f32 v225, v107, v107
    v_mfma_f32_16x16x32_bf16 v[40:43], v[176:179], a[200:203], v[40:43]
    v_fmaak_f32 v225, v225, v208, 0xc0135761
    v_mul_f32 v225, v225, v107
    v_mfma_f32_16x16x32_bf16 v[40:43], v[180:183], a[216:219], v[40:43]
    v_exp_f32 v225, v225
    v_mul_f32 v229, v107, v123
    v_mfma_f32_16x16x32_bf16 v[44:47], v[176:179], a[204:207], v[44:47]
    buffer_load_dwordx4 v210, s[8:11], s70 offen lds
    v_mfma_f32_16x16x32_bf16 v[44:47], v[180:183], a[220:223], v[44:47]
    s_waitcnt lgkmcnt(10)
    ds_read_b64_tr_b16 v[176:177], v217 offset:0
    ds_read_b64_tr_b16 v[178:179], v217 offset:512
    v_mfma_f32_16x16x32_bf16 v[48:51], v[184:187], a[192:195], v[48:51]
    s_waitcnt lgkmcnt(10)
    ds_read_b64_tr_b16 v[180:181], v217 offset:8192
    ds_read_b64_tr_b16 v[182:183], v217 offset:8704
    v_mfma_f32_16x16x32_bf16 v[48:51], v[188:191], a[208:211], v[48:51]
    v_add_f32 v225, 1.0, v225
    v_cvt_pk_bf16_f32 v202, v226, v227
    v_mfma_f32_16x16x32_bf16 v[52:55], v[184:187], a[196:199], v[52:55]
    v_rcp_f32 v225, v225
    v_mfma_f32_16x16x32_bf16 v[52:55], v[188:191], a[212:215], v[52:55]
    buffer_load_dwordx4 v211, s[8:11], s70 offen offset:1024 lds
    v_mul_f32 v229, v229, v225
    v_mfma_f32_16x16x32_bf16 v[56:59], v[184:187], a[200:203], v[56:59]
    s_add_u32 m0, s40, 34816
    v_cvt_pk_bf16_f32 v203, v228, v229
    v_mul_f32 v192, v76, v76
    v_mfma_f32_16x16x32_bf16 v[56:59], v[188:191], a[216:219], v[56:59]
    v_fmaak_f32 v192, v192, v208, 0xc0135761
    v_mul_f32 v192, v192, v76
    v_mfma_f32_16x16x32_bf16 v[60:63], v[184:187], a[204:207], v[60:63]
    v_exp_f32 v192, v192
    v_mfma_f32_16x16x32_bf16 v[60:63], v[188:191], a[220:223], v[60:63]
    s_waitcnt lgkmcnt(10)
    ds_read_b64_tr_b16 v[184:185], v217 offset:2048
    ds_read_b64_tr_b16 v[186:187], v217 offset:2560
    v_mfma_f32_16x16x32_bf16 v[0:3], v[160:163], a[224:227], v[0:3]
    s_waitcnt lgkmcnt(10)
    buffer_load_dwordx4 v210, s[12:15], s70 offen lds
    v_mfma_f32_16x16x32_bf16 v[0:3], v[164:167], a[240:243], v[0:3]
    ds_read_b64_tr_b16 v[188:189], v217 offset:10240
    ds_read_b64_tr_b16 v[190:191], v217 offset:10752
    v_mul_f32 v196, v76, v92
    v_mfma_f32_16x16x32_bf16 v[4:7], v[160:163], a[228:231], v[4:7]
    v_add_f32 v192, 1.0, v192
    v_mul_f32 v193, v77, v77
    v_mfma_f32_16x16x32_bf16 v[4:7], v[164:167], a[244:247], v[4:7]
    v_rcp_f32 v192, v192
    v_mfma_f32_16x16x32_bf16 v[8:11], v[160:163], a[232:235], v[8:11]
    v_mul_f32 v196, v196, v192
    v_fmaak_f32 v193, v193, v208, 0xc0135761
    v_mfma_f32_16x16x32_bf16 v[8:11], v[164:167], a[248:251], v[8:11]
    buffer_load_dwordx4 v211, s[12:15], s70 offen offset:1024 lds
    v_mfma_f32_16x16x32_bf16 v[12:15], v[160:163], a[236:239], v[12:15]
    s_add_u32 m0, s42, 86016
    v_mul_f32 v193, v193, v77
    v_exp_f32 v193, v193
    v_mfma_f32_16x16x32_bf16 v[12:15], v[164:167], a[252:255], v[12:15]
    s_waitcnt lgkmcnt(10)
    v_mul_f32 v197, v77, v93
    v_add_f32 v193, 1.0, v193
    v_mfma_f32_16x16x32_bf16 v[16:19], v[168:171], a[224:227], v[16:19]
    s_waitcnt lgkmcnt(8)
    v_rcp_f32 v193, v193
    v_mfma_f32_16x16x32_bf16 v[16:19], v[172:175], a[240:243], v[16:19]
    v_mul_f32 v197, v197, v193
    v_mul_f32 v194, v78, v78
    v_mfma_f32_16x16x32_bf16 v[20:23], v[168:171], a[228:231], v[20:23]
    s_waitcnt vmcnt(14)
    buffer_store_dwordx4 v[200:203], v209, s[20:23], s97 offen sc1
    v_mfma_f32_16x16x32_bf16 v[20:23], v[172:175], a[244:247], v[20:23]
    s_barrier
    v_fmaak_f32 v194, v194, v208, 0xc0135761
    v_mul_f32 v194, v194, v78
    v_mfma_f32_16x16x32_bf16 v[24:27], v[168:171], a[232:235], v[24:27]
    ds_read_b64_tr_b16 v[160:161], v213 offset:0
    ds_read_b64_tr_b16 v[162:163], v213 offset:512
    v_mfma_f32_16x16x32_bf16 v[24:27], v[172:175], a[248:251], v[24:27]
    buffer_load_dwordx4 v238, s[16:19], s93 offen offset:2048 lds
    v_mfma_f32_16x16x32_bf16 v[28:31], v[168:171], a[236:239], v[28:31]
    s_add_u32 m0, s42, 86016
    ds_read_b64_tr_b16 v[164:165], v213 offset:8192
    ds_read_b64_tr_b16 v[166:167], v213 offset:8704
    v_mfma_f32_16x16x32_bf16 v[28:31], v[172:175], a[252:255], v[28:31]
    s_waitcnt lgkmcnt(10)
    ds_read_b64_tr_b16 v[168:169], v213 offset:2048
    ds_read_b64_tr_b16 v[170:171], v213 offset:2560
    v_mul_f32 v198, v78, v94
    v_mfma_f32_16x16x32_bf16 v[32:35], v[176:179], a[224:227], v[32:35]
    s_waitcnt lgkmcnt(10)
    ds_read_b64_tr_b16 v[172:173], v213 offset:10240
    ds_read_b64_tr_b16 v[174:175], v213 offset:10752
    v_mfma_f32_16x16x32_bf16 v[32:35], v[180:183], a[240:243], v[32:35]
    buffer_load_dwordx4 v239, s[16:19], s93 offen offset:3072 lds
    v_mfma_f32_16x16x32_bf16 v[36:39], v[176:179], a[228:231], v[36:39]
    s_add_u32 m0, s40, 49152
    s_add_u32 s71, s44, 1180032
    v_mul_f32 v195, v79, v79
    v_mfma_f32_16x16x32_bf16 v[36:39], v[180:183], a[244:247], v[36:39]
    v_exp_f32 v194, v194
    v_mfma_f32_16x16x32_bf16 v[40:43], v[176:179], a[232:235], v[40:43]
    v_add_f32 v194, 1.0, v194
    v_rcp_f32 v194, v194
    v_mfma_f32_16x16x32_bf16 v[40:43], v[180:183], a[248:251], v[40:43]
    v_mul_f32 v198, v198, v194
    v_fmaak_f32 v195, v195, v208, 0xc0135761
    v_mfma_f32_16x16x32_bf16 v[44:47], v[176:179], a[236:239], v[44:47]
    buffer_load_dwordx4 v210, s[8:11], s71 offen lds
    v_mfma_f32_16x16x32_bf16 v[44:47], v[180:183], a[252:255], v[44:47]
    s_waitcnt lgkmcnt(10)
    ds_read_b64_tr_b16 v[176:177], v216 offset:0
    ds_read_b64_tr_b16 v[178:179], v216 offset:512
    v_mfma_f32_16x16x32_bf16 v[48:51], v[184:187], a[224:227], v[48:51]
    s_waitcnt lgkmcnt(10)
    ds_read_b64_tr_b16 v[180:181], v216 offset:8192
    ds_read_b64_tr_b16 v[182:183], v216 offset:8704
    v_mfma_f32_16x16x32_bf16 v[48:51], v[188:191], a[240:243], v[48:51]
    v_mul_f32 v195, v195, v79
    v_exp_f32 v195, v195
    v_mfma_f32_16x16x32_bf16 v[52:55], v[184:187], a[228:231], v[52:55]
    v_mul_f32 v199, v79, v95
    v_add_f32 v195, 1.0, v195
    v_mfma_f32_16x16x32_bf16 v[52:55], v[188:191], a[244:247], v[52:55]
    buffer_load_dwordx4 v211, s[8:11], s71 offen offset:1024 lds
    v_mfma_f32_16x16x32_bf16 v[56:59], v[184:187], a[232:235], v[56:59]
    s_add_u32 m0, s40, 51200
    v_rcp_f32 v195, v195
    v_mfma_f32_16x16x32_bf16 v[56:59], v[188:191], a[248:251], v[56:59]
    v_mul_f32 v199, v199, v195
    v_cvt_pk_bf16_f32 v204, v196, v197
    v_cvt_pk_bf16_f32 v205, v198, v199
    v_mfma_f32_16x16x32_bf16 v[60:63], v[184:187], a[236:239], v[60:63]
    v_mul_f32 v222, v108, v108
    v_fmaak_f32 v222, v222, v208, 0xc0135761
    v_mfma_f32_16x16x32_bf16 v[60:63], v[188:191], a[252:255], v[60:63]
    s_waitcnt lgkmcnt(10)
    ds_read_b64_tr_b16 v[184:185], v216 offset:2048
    ds_read_b64_tr_b16 v[186:187], v216 offset:2560
    v_mfma_f32_16x16x32_bf16 v[0:3], v[160:163], v[128:131], v[0:3]
    s_waitcnt lgkmcnt(10)
    buffer_load_dwordx4 v210, s[12:15], s71 offen lds
    v_mfma_f32_16x16x32_bf16 v[0:3], v[164:167], v[144:147], v[0:3]
    ds_read_b64_tr_b16 v[188:189], v216 offset:10240
    ds_read_b64_tr_b16 v[190:191], v216 offset:10752
    v_mfma_f32_16x16x32_bf16 v[4:7], v[160:163], v[132:135], v[4:7]
    v_mul_f32 v222, v222, v108
    v_exp_f32 v222, v222
    v_mfma_f32_16x16x32_bf16 v[4:7], v[164:167], v[148:151], v[4:7]
    v_mul_f32 v226, v108, v124
    v_add_f32 v222, 1.0, v222
    v_mfma_f32_16x16x32_bf16 v[8:11], v[160:163], v[136:139], v[8:11]
    v_rcp_f32 v222, v222
    v_mfma_f32_16x16x32_bf16 v[8:11], v[164:167], v[152:155], v[8:11]
    buffer_load_dwordx4 v211, s[12:15], s71 offen offset:1024 lds
    v_mfma_f32_16x16x32_bf16 v[12:15], v[160:163], v[140:143], v[12:15]
    s_add_u32 m0, s42, 90112
    v_mul_f32 v226, v226, v222
    v_mul_f32 v223, v109, v109
    v_fmaak_f32 v223, v223, v208, 0xc0135761
    v_mfma_f32_16x16x32_bf16 v[12:15], v[164:167], v[156:159], v[12:15]
    s_waitcnt lgkmcnt(10)
    v_mul_f32 v223, v223, v109
    v_mul_f32 v227, v109, v125
    v_mfma_f32_16x16x32_bf16 v[16:19], v[168:171], v[128:131], v[16:19]
    s_waitcnt lgkmcnt(8)
    v_exp_f32 v223, v223
    v_mfma_f32_16x16x32_bf16 v[16:19], v[172:175], v[144:147], v[16:19]
    v_add_f32 v223, 1.0, v223
    v_mul_f32 v224, v110, v110
    v_mfma_f32_16x16x32_bf16 v[20:23], v[168:171], v[132:135], v[20:23]
    s_waitcnt vmcnt(13)
    v_rcp_f32 v223, v223
    v_mfma_f32_16x16x32_bf16 v[20:23], v[172:175], v[148:151], v[20:23]
    s_barrier
    v_mul_f32 v227, v227, v223
    v_fmaak_f32 v224, v224, v208, 0xc0135761
    v_mfma_f32_16x16x32_bf16 v[24:27], v[168:171], v[136:139], v[24:27]
    buffer_load_dwordx4 v240, s[16:19], s93 offen lds
    v_mfma_f32_16x16x32_bf16 v[24:27], v[172:175], v[152:155], v[24:27]
    ds_read_b64_tr_b16 v[160:161], v213 offset:16384
    ds_read_b64_tr_b16 v[162:163], v213 offset:16896
    v_mfma_f32_16x16x32_bf16 v[28:31], v[168:171], v[140:143], v[28:31]
    ds_read_b64_tr_b16 v[164:165], v213 offset:24576
    ds_read_b64_tr_b16 v[166:167], v213 offset:25088
    v_mfma_f32_16x16x32_bf16 v[28:31], v[172:175], v[156:159], v[28:31]
    s_waitcnt lgkmcnt(10)
    ds_read_b64_tr_b16 v[168:169], v213 offset:18432
    ds_read_b64_tr_b16 v[170:171], v213 offset:18944
    v_mul_f32 v224, v224, v110
    v_mfma_f32_16x16x32_bf16 v[32:35], v[176:179], v[128:131], v[32:35]
    s_waitcnt lgkmcnt(10)
    ds_read_b64_tr_b16 v[172:173], v213 offset:26624
    ds_read_b64_tr_b16 v[174:175], v213 offset:27136
    v_mfma_f32_16x16x32_bf16 v[32:35], v[180:183], v[144:147], v[32:35]
    s_add_u32 m0, s40, 65536
    s_add_u32 s70, s44, 1769856
    v_mul_f32 v228, v110, v126
    v_mfma_f32_16x16x32_bf16 v[36:39], v[176:179], v[132:135], v[36:39]
    buffer_load_dwordx4 v210, s[8:11], s70 offen lds
    v_mul_f32 v225, v111, v111
    v_mfma_f32_16x16x32_bf16 v[36:39], v[180:183], v[148:151], v[36:39]
    v_exp_f32 v224, v224
    v_mfma_f32_16x16x32_bf16 v[40:43], v[176:179], v[136:139], v[40:43]
    v_add_f32 v224, 1.0, v224
    v_rcp_f32 v224, v224
    v_mfma_f32_16x16x32_bf16 v[40:43], v[180:183], v[152:155], v[40:43]
    v_mul_f32 v228, v228, v224
    v_fmaak_f32 v225, v225, v208, 0xc0135761
    v_mfma_f32_16x16x32_bf16 v[44:47], v[176:179], v[140:143], v[44:47]
    v_mul_f32 v225, v225, v111
    v_mul_f32 v229, v111, v127
    v_mfma_f32_16x16x32_bf16 v[44:47], v[180:183], v[156:159], v[44:47]
    s_waitcnt lgkmcnt(10)
    buffer_load_dword v244, v243, s[28:31], 0 offen sc1
    v_mfma_f32_16x16x32_bf16 v[48:51], v[184:187], v[128:131], v[48:51]
    s_waitcnt lgkmcnt(8)
    ds_read_b64_tr_b16 v[176:177], v216 offset:16384
    ds_read_b64_tr_b16 v[178:179], v216 offset:16896
    v_mfma_f32_16x16x32_bf16 v[48:51], v[188:191], v[144:147], v[48:51]
    ds_read_b64_tr_b16 v[180:181], v216 offset:24576
    ds_read_b64_tr_b16 v[182:183], v216 offset:25088
    v_cvt_pk_bf16_f32 v206, v226, v227
    v_mfma_f32_16x16x32_bf16 v[52:55], v[184:187], v[132:135], v[52:55]
    v_exp_f32 v225, v225
    v_mfma_f32_16x16x32_bf16 v[52:55], v[188:191], v[148:151], v[52:55]
    v_add_f32 v225, 1.0, v225
    v_mfma_f32_16x16x32_bf16 v[56:59], v[184:187], v[136:139], v[56:59]
    buffer_load_dwordx4 v211, s[8:11], s70 offen offset:1024 lds
    v_mfma_f32_16x16x32_bf16 v[56:59], v[188:191], v[152:155], v[56:59]
    s_add_u32 m0, s40, 67584
    v_rcp_f32 v225, v225
    v_mfma_f32_16x16x32_bf16 v[60:63], v[184:187], v[140:143], v[60:63]
    v_mul_f32 v229, v229, v225
    v_cvt_pk_bf16_f32 v207, v228, v229
    v_mfma_f32_16x16x32_bf16 v[60:63], v[188:191], v[156:159], v[60:63]
    s_waitcnt lgkmcnt(10)
    buffer_store_dwordx4 v[204:207], v209, s[20:23], s98 offen sc1
    ds_read_b64_tr_b16 v[184:185], v216 offset:18432
    ds_read_b64_tr_b16 v[186:187], v216 offset:18944
    v_mfma_f32_16x16x32_bf16 v[64:67], v[160:163], a[0:3], 0
    s_waitcnt lgkmcnt(10)
    ds_read_b64_tr_b16 v[188:189], v216 offset:26624
    ds_read_b64_tr_b16 v[190:191], v216 offset:27136
    v_mfma_f32_16x16x32_bf16 v[64:67], v[164:167], a[16:19], v[64:67]
    v_mfma_f32_16x16x32_bf16 v[68:71], v[160:163], a[4:7], 0
    v_mfma_f32_16x16x32_bf16 v[68:71], v[164:167], a[20:23], v[68:71]
    s_add_u32 s97, s46, 4096
    v_mul_f32 v192, v0, v0
    v_fmaak_f32 v192, v192, v208, 0xc0135761
    v_mfma_f32_16x16x32_bf16 v[72:75], v[160:163], a[8:11], 0
    buffer_load_dwordx4 v210, s[12:15], s70 offen lds
    v_mfma_f32_16x16x32_bf16 v[72:75], v[164:167], a[24:27], v[72:75]
    v_mul_f32 v192, v192, v0
    v_mul_f32 v196, v0, v16
    v_mfma_f32_16x16x32_bf16 v[76:79], v[160:163], a[12:15], 0
    v_exp_f32 v192, v192
    v_mfma_f32_16x16x32_bf16 v[76:79], v[164:167], a[28:31], v[76:79]
    s_waitcnt lgkmcnt(10)
    v_add_f32 v192, 1.0, v192
    v_mul_f32 v193, v1, v1
    v_mfma_f32_16x16x32_bf16 v[80:83], v[168:171], a[0:3], 0
    s_waitcnt lgkmcnt(8)
    v_rcp_f32 v192, v192
    v_mfma_f32_16x16x32_bf16 v[80:83], v[172:175], a[16:19], v[80:83]
    buffer_load_dwordx4 v211, s[12:15], s70 offen offset:1024 lds
    v_mfma_f32_16x16x32_bf16 v[84:87], v[168:171], a[4:7], 0
    s_waitcnt vmcnt(14)
    v_mul_f32 v196, v196, v192
    v_fmaak_f32 v193, v193, v208, 0xc0135761
    v_mfma_f32_16x16x32_bf16 v[84:87], v[172:175], a[20:23], v[84:87]
    s_barrier
    v_mul_f32 v193, v193, v1
    v_mul_f32 v197, v1, v17
    v_mfma_f32_16x16x32_bf16 v[88:91], v[168:171], a[8:11], 0
    ds_read_b64_tr_b16 v[160:161], v213 offset:32768
    ds_read_b64_tr_b16 v[162:163], v213 offset:33280
    v_mfma_f32_16x16x32_bf16 v[88:91], v[172:175], a[24:27], v[88:91]
    ds_read_b64_tr_b16 v[164:165], v213 offset:40960
    ds_read_b64_tr_b16 v[166:167], v213 offset:41472
    v_mfma_f32_16x16x32_bf16 v[92:95], v[168:171], a[12:15], 0
    s_add_u32 m0, s40, 0
    s_add_u32 s71, s44, 2359680
    v_mul_f32 v194, v2, v2
    v_mfma_f32_16x16x32_bf16 v[92:95], v[172:175], a[28:31], v[92:95]
    s_waitcnt lgkmcnt(10)
    buffer_load_dwordx4 v210, s[8:11], s71 offen lds
    v_mfma_f32_16x16x32_bf16 v[96:99], v[176:179], a[0:3], 0
    s_waitcnt lgkmcnt(8)
    ds_read_b64_tr_b16 v[168:169], v213 offset:34816
    ds_read_b64_tr_b16 v[170:171], v213 offset:35328
    v_mfma_f32_16x16x32_bf16 v[96:99], v[180:183], a[16:19], v[96:99]
    ds_read_b64_tr_b16 v[172:173], v213 offset:43008
    ds_read_b64_tr_b16 v[174:175], v213 offset:43520
    v_mfma_f32_16x16x32_bf16 v[100:103], v[176:179], a[4:7], 0
    v_exp_f32 v193, v193
    v_mfma_f32_16x16x32_bf16 v[100:103], v[180:183], a[20:23], v[100:103]
    v_add_f32 v193, 1.0, v193
    v_fmaak_f32 v194, v194, v208, 0xc0135761
    v_mfma_f32_16x16x32_bf16 v[104:107], v[176:179], a[8:11], 0
    buffer_load_dwordx4 v211, s[8:11], s71 offen offset:1024 lds
    v_mfma_f32_16x16x32_bf16 v[104:107], v[180:183], a[24:27], v[104:107]
    s_add_u32 m0, s40, 2048
    v_rcp_f32 v193, v193
    v_mfma_f32_16x16x32_bf16 v[108:111], v[176:179], a[12:15], 0
    s_add_u32 s98, s47, 4096
    v_mul_f32 v197, v197, v193
    v_mul_f32 v194, v194, v2
    v_mfma_f32_16x16x32_bf16 v[108:111], v[180:183], a[28:31], v[108:111]
    s_waitcnt lgkmcnt(10)
    ds_read_b64_tr_b16 v[176:177], v216 offset:32768
    ds_read_b64_tr_b16 v[178:179], v216 offset:33280
    v_mfma_f32_16x16x32_bf16 v[112:115], v[184:187], a[0:3], 0
    s_waitcnt lgkmcnt(10)
    ds_read_b64_tr_b16 v[180:181], v216 offset:40960
    ds_read_b64_tr_b16 v[182:183], v216 offset:41472
    v_mfma_f32_16x16x32_bf16 v[112:115], v[188:191], a[16:19], v[112:115]
    buffer_load_dwordx4 v210, s[12:15], s71 offen lds
    v_mfma_f32_16x16x32_bf16 v[116:119], v[184:187], a[4:7], 0
    v_lshlrev_b32 v254, 3, v247
    v_mul_f32 v198, v2, v18
    v_mfma_f32_16x16x32_bf16 v[116:119], v[188:191], a[20:23], v[116:119]
    v_exp_f32 v194, v194
    v_mfma_f32_16x16x32_bf16 v[120:123], v[184:187], a[8:11], 0
    v_add_f32 v194, 1.0, v194
    v_mul_f32 v195, v3, v3
    v_mfma_f32_16x16x32_bf16 v[120:123], v[188:191], a[24:27], v[120:123]
    v_rcp_f32 v194, v194
    v_mfma_f32_16x16x32_bf16 v[124:127], v[184:187], a[12:15], 0
    buffer_load_dwordx4 v211, s[12:15], s71 offen offset:1024 lds
    v_mfma_f32_16x16x32_bf16 v[124:127], v[188:191], a[28:31], v[124:127]
    s_waitcnt lgkmcnt(10)
    ds_read_b64_tr_b16 v[184:185], v216 offset:34816
    ds_read_b64_tr_b16 v[186:187], v216 offset:35328
    v_mfma_f32_16x16x32_bf16 v[64:67], v[160:163], a[32:35], v[64:67]
    s_waitcnt lgkmcnt(10)
    ds_read_b64_tr_b16 v[188:189], v216 offset:43008
    ds_read_b64_tr_b16 v[190:191], v216 offset:43520
    v_mfma_f32_16x16x32_bf16 v[64:67], v[164:167], a[48:51], v[64:67]
    v_mul_f32 v198, v198, v194
    v_fmaak_f32 v195, v195, v208, 0xc0135761
    v_mfma_f32_16x16x32_bf16 v[68:71], v[160:163], a[36:39], v[68:71]
    v_mul_f32 v195, v195, v3
    v_mul_f32 v199, v3, v19
    v_mfma_f32_16x16x32_bf16 v[68:71], v[164:167], a[52:55], v[68:71]
    buffer_store_dwordx4 v[248:251], v209, s[24:27], s61 offen sc1
    v_mfma_f32_16x16x32_bf16 v[72:75], v[160:163], a[40:43], v[72:75]
    v_exp_f32 v195, v195
    v_mfma_f32_16x16x32_bf16 v[72:75], v[164:167], a[56:59], v[72:75]
    v_add_f32 v195, 1.0, v195
    v_cvt_pk_bf16_f32 v200, v196, v197
    v_mfma_f32_16x16x32_bf16 v[76:79], v[160:163], a[44:47], v[76:79]
    v_rcp_f32 v195, v195
    v_mfma_f32_16x16x32_bf16 v[76:79], v[164:167], a[60:63], v[76:79]
    s_waitcnt lgkmcnt(10)
    v_mul_f32 v199, v199, v195
    v_cvt_pk_bf16_f32 v201, v198, v199
    v_mfma_f32_16x16x32_bf16 v[80:83], v[168:171], a[32:35], v[80:83]
    s_waitcnt lgkmcnt(8)
    v_mul_f32 v222, v32, v32
    v_fmaak_f32 v222, v222, v208, 0xc0135761
    v_mfma_f32_16x16x32_bf16 v[80:83], v[172:175], a[48:51], v[80:83]
    v_mul_f32 v222, v222, v32
    v_mul_f32 v226, v32, v48
    v_mfma_f32_16x16x32_bf16 v[84:87], v[168:171], a[36:39], v[84:87]
    s_waitcnt vmcnt(7)
    v_exp_f32 v222, v222
    v_mfma_f32_16x16x32_bf16 v[84:87], v[172:175], a[52:55], v[84:87]
    s_barrier
    v_add_f32 v222, 1.0, v222
    v_mul_f32 v223, v33, v33
    v_mfma_f32_16x16x32_bf16 v[88:91], v[168:171], a[40:43], v[88:91]
    ds_read_b64_tr_b16 v[160:161], v213 offset:49152
    ds_read_b64_tr_b16 v[162:163], v213 offset:49664
    v_mfma_f32_16x16x32_bf16 v[88:91], v[172:175], a[56:59], v[88:91]
    ds_read_b64_tr_b16 v[164:165], v213 offset:57344
    ds_read_b64_tr_b16 v[166:167], v213 offset:57856
    v_mfma_f32_16x16x32_bf16 v[92:95], v[168:171], a[44:47], v[92:95]
    s_add_u32 s73, s55, 2
    v_mov_b32 v242, s73
    v_fmaak_f32 v223, v223, v208, 0xc0135761
    v_mfma_f32_16x16x32_bf16 v[92:95], v[172:175], a[60:63], v[92:95]
    s_waitcnt lgkmcnt(10)
    buffer_store_dword v242, v241, s[28:31], 0 offen sc1
    v_mfma_f32_16x16x32_bf16 v[96:99], v[176:179], a[32:35], v[96:99]
    s_waitcnt lgkmcnt(8)
    ds_read_b64_tr_b16 v[168:169], v213 offset:51200
    ds_read_b64_tr_b16 v[170:171], v213 offset:51712
    v_mfma_f32_16x16x32_bf16 v[96:99], v[180:183], a[48:51], v[96:99]
    ds_read_b64_tr_b16 v[172:173], v213 offset:59392
    ds_read_b64_tr_b16 v[174:175], v213 offset:59904
    v_mfma_f32_16x16x32_bf16 v[100:103], v[176:179], a[36:39], v[100:103]
    s_add_u32 m0, s40, 16384
    s_add_u32 s70, s44, 2949504
    v_mul_f32 v223, v223, v33
    v_mfma_f32_16x16x32_bf16 v[100:103], v[180:183], a[52:55], v[100:103]
    v_rcp_f32 v222, v222
    v_mfma_f32_16x16x32_bf16 v[104:107], v[176:179], a[40:43], v[104:107]
    buffer_load_dwordx4 v210, s[8:11], s70 offen lds
    v_mfma_f32_16x16x32_bf16 v[104:107], v[180:183], a[56:59], v[104:107]
    v_exp_f32 v223, v223
    v_mfma_f32_16x16x32_bf16 v[108:111], v[176:179], a[44:47], v[108:111]
    v_mul_f32 v226, v226, v222
    v_mul_f32 v227, v33, v49
    v_mfma_f32_16x16x32_bf16 v[108:111], v[180:183], a[60:63], v[108:111]
    s_waitcnt lgkmcnt(10)
    ds_read_b64_tr_b16 v[176:177], v216 offset:49152
    ds_read_b64_tr_b16 v[178:179], v216 offset:49664
    v_mfma_f32_16x16x32_bf16 v[112:115], v[184:187], a[32:35], v[112:115]
    s_add_u32 s69, s55, 1
    v_subrev_u32 v245, s69, v244
    v_cmp_le_u32 vcc, 8, v245
    s_nop 1
    s_cbranch_vccnz LS_spin0
LS_back0:
    s_waitcnt lgkmcnt(10)
    v_mfma_f32_16x16x32_bf16 v[112:115], v[188:191], a[48:51], v[112:115]
    buffer_load_dwordx4 v211, s[8:11], s70 offen offset:1024 lds
    v_mfma_f32_16x16x32_bf16 v[116:119], v[184:187], a[36:39], v[116:119]
    s_add_u32 m0, s40, 18432
    ds_read_b64_tr_b16 v[180:181], v216 offset:57344
    ds_read_b64_tr_b16 v[182:183], v216 offset:57856
    v_mfma_f32_16x16x32_bf16 v[116:119], v[188:191], a[52:55], v[116:119]
    v_add_f32 v223, 1.0, v223
    v_mul_f32 v224, v34, v34
    v_mfma_f32_16x16x32_bf16 v[120:123], v[184:187], a[40:43], v[120:123]
    s_add_u32 s99, s54, 8192
    v_rcp_f32 v223, v223
    v_mfma_f32_16x16x32_bf16 v[120:123], v[188:191], a[56:59], v[120:123]
    v_mul_f32 v227, v227, v223
    v_fmaak_f32 v224, v224, v208, 0xc0135761
    v_mfma_f32_16x16x32_bf16 v[124:127], v[184:187], a[44:47], v[124:127]
    buffer_load_dwordx4 v210, s[12:15], s70 offen lds
    v_mfma_f32_16x16x32_bf16 v[124:127], v[188:191], a[60:63], v[124:127]
    s_waitcnt lgkmcnt(10)
    ds_read_b64_tr_b16 v[184:185], v216 offset:51200
    ds_read_b64_tr_b16 v[186:187], v216 offset:51712
    v_mfma_f32_16x16x32_bf16 v[64:67], v[160:163], a[64:67], v[64:67]
    s_waitcnt lgkmcnt(10)
    ds_read_b64_tr_b16 v[188:189], v216 offset:59392
    ds_read_b64_tr_b16 v[190:191], v216 offset:59904
    v_mfma_f32_16x16x32_bf16 v[64:67], v[164:167], a[80:83], v[64:67]
    v_mul_f32 v224, v224, v34
    v_mul_f32 v228, v34, v50
    v_mfma_f32_16x16x32_bf16 v[68:71], v[160:163], a[68:71], v[68:71]
    v_exp_f32 v224, v224
    v_mfma_f32_16x16x32_bf16 v[68:71], v[164:167], a[84:87], v[68:71]
    buffer_store_dwordx4 v[248:251], v209, s[24:27], s61 offen offset:1024 sc1
    v_mfma_f32_16x16x32_bf16 v[72:75], v[160:163], a[72:75], v[72:75]
    v_add_f32 v224, 1.0, v224
    v_mul_f32 v225, v35, v35
    v_mfma_f32_16x16x32_bf16 v[72:75], v[164:167], a[88:91], v[72:75]
    v_rcp_f32 v224, v224
    v_mfma_f32_16x16x32_bf16 v[76:79], v[160:163], a[76:79], v[76:79]
    v_mul_f32 v228, v228, v224
    v_fmaak_f32 v225, v225, v208, 0xc0135761
    v_mfma_f32_16x16x32_bf16 v[76:79], v[164:167], a[92:95], v[76:79]
    s_waitcnt lgkmcnt(10)
    v_mul_f32 v225, v225, v35
    v_mul_f32 v229, v35, v51
    v_mfma_f32_16x16x32_bf16 v[80:83], v[168:171], a[64:67], v[80:83]
    s_waitcnt lgkmcnt(8)
    buffer_load_dwordx4 v211, s[12:15], s70 offen offset:1024 lds
    v_mfma_f32_16x16x32_bf16 v[80:83], v[172:175], a[80:83], v[80:83]
    v_exp_f32 v225, v225
    v_mfma_f32_16x16x32_bf16 v[84:87], v[168:171], a[68:71], v[84:87]
    s_waitcnt vmcnt(11)
    v_add_f32 v225, 1.0, v225
    v_cvt_pk_bf16_f32 v202, v226, v227
    v_mfma_f32_16x16x32_bf16 v[84:87], v[172:175], a[84:87], v[84:87]
    s_barrier
    v_rcp_f32 v225, v225
    v_mfma_f32_16x16x32_bf16 v[88:91], v[168:171], a[72:75], v[88:91]
    ds_read_b64_tr_b16 v[160:161], v214 offset:0
    ds_read_b64_tr_b16 v[162:163], v214 offset:512
    v_mfma_f32_16x16x32_bf16 v[88:91], v[172:175], a[88:91], v[88:91]
    buffer_load_dwordx4 a[0:3], v209, s[20:23], s99 offen sc1
    v_mfma_f32_16x16x32_bf16 v[92:95], v[168:171], a[76:79], v[92:95]
    s_add_u32 s100, s54, 155648
    ds_read_b64_tr_b16 v[164:165], v214 offset:8192
    ds_read_b64_tr_b16 v[166:167], v214 offset:8704
    v_mfma_f32_16x16x32_bf16 v[92:95], v[172:175], a[92:95], v[92:95]
    s_waitcnt lgkmcnt(10)
    ds_read_b64_tr_b16 v[168:169], v214 offset:2048
    ds_read_b64_tr_b16 v[170:171], v214 offset:2560
    v_mfma_f32_16x16x32_bf16 v[96:99], v[176:179], a[64:67], v[96:99]
    s_waitcnt lgkmcnt(10)
    ds_read_b64_tr_b16 v[172:173], v214 offset:10240
    ds_read_b64_tr_b16 v[174:175], v214 offset:10752
    v_mfma_f32_16x16x32_bf16 v[96:99], v[180:183], a[80:83], v[96:99]
    s_add_u32 m0, s40, 32768
    s_add_u32 s71, s44, 3539328
    v_mul_f32 v229, v229, v225
    v_mfma_f32_16x16x32_bf16 v[100:103], v[176:179], a[68:71], v[100:103]
    buffer_load_dwordx4 v210, s[8:11], s71 offen lds
    v_mfma_f32_16x16x32_bf16 v[100:103], v[180:183], a[84:87], v[100:103]
    v_cvt_pk_bf16_f32 v203, v228, v229
    v_mul_f32 v192, v4, v4
    v_mfma_f32_16x16x32_bf16 v[104:107], v[176:179], a[72:75], v[104:107]
    v_fmaak_f32 v192, v192, v208, 0xc0135761
    v_mul_f32 v192, v192, v4
    v_mfma_f32_16x16x32_bf16 v[104:107], v[180:183], a[88:91], v[104:107]
    v_exp_f32 v192, v192
    v_mfma_f32_16x16x32_bf16 v[108:111], v[176:179], a[76:79], v[108:111]
    v_mul_f32 v196, v4, v20
    v_add_f32 v192, 1.0, v192
    v_mfma_f32_16x16x32_bf16 v[108:111], v[180:183], a[92:95], v[108:111]
    s_waitcnt lgkmcnt(10)
    buffer_load_dwordx4 v211, s[8:11], s71 offen offset:1024 lds
    v_mfma_f32_16x16x32_bf16 v[112:115], v[184:187], a[64:67], v[112:115]
    s_add_u32 m0, s40, 34816
    ds_read_b64_tr_b16 v[176:177], v217 offset:0
    ds_read_b64_tr_b16 v[178:179], v217 offset:512
    s_waitcnt lgkmcnt(10)
    v_mfma_f32_16x16x32_bf16 v[112:115], v[188:191], a[80:83], v[112:115]
    ds_read_b64_tr_b16 v[180:181], v217 offset:8192
    ds_read_b64_tr_b16 v[182:183], v217 offset:8704
    v_mfma_f32_16x16x32_bf16 v[116:119], v[184:187], a[68:71], v[116:119]
    v_rcp_f32 v192, v192
    v_mfma_f32_16x16x32_bf16 v[116:119], v[188:191], a[84:87], v[116:119]
    v_mul_f32 v196, v196, v192
    v_mul_f32 v193, v5, v5
    v_mfma_f32_16x16x32_bf16 v[120:123], v[184:187], a[72:75], v[120:123]
    buffer_load_dwordx4 v210, s[12:15], s71 offen lds
    v_mfma_f32_16x16x32_bf16 v[120:123], v[188:191], a[88:91], v[120:123]
    v_fmaak_f32 v193, v193, v208, 0xc0135761
    v_mul_f32 v193, v193, v5
    v_mfma_f32_16x16x32_bf16 v[124:127], v[184:187], a[76:79], v[124:127]
    v_exp_f32 v193, v193
    v_mfma_f32_16x16x32_bf16 v[124:127], v[188:191], a[92:95], v[124:127]
    s_waitcnt lgkmcnt(10)
    ds_read_b64_tr_b16 v[184:185], v217 offset:2048
    ds_read_b64_tr_b16 v[186:187], v217 offset:2560
    v_mfma_f32_16x16x32_bf16 v[64:67], v[160:163], a[96:99], v[64:67]
    s_waitcnt lgkmcnt(10)
    ds_read_b64_tr_b16 v[188:189], v217 offset:10240
    ds_read_b64_tr_b16 v[190:191], v217 offset:10752
    v_mfma_f32_16x16x32_bf16 v[64:67], v[164:167], a[112:115], v[64:67]
    buffer_load_dwordx4 v211, s[12:15], s71 offen offset:1024 lds
    v_mfma_f32_16x16x32_bf16 v[68:71], v[160:163], a[100:103], v[68:71]
    v_mul_f32 v197, v5, v21
    v_add_f32 v193, 1.0, v193
    v_mfma_f32_16x16x32_bf16 v[68:71], v[164:167], a[116:119], v[68:71]
    v_rcp_f32 v193, v193
    v_mfma_f32_16x16x32_bf16 v[72:75], v[160:163], a[104:107], v[72:75]
    v_mul_f32 v197, v197, v193
    v_mul_f32 v194, v6, v6
    v_mfma_f32_16x16x32_bf16 v[72:75], v[164:167], a[120:123], v[72:75]
    v_fmaak_f32 v194, v194, v208, 0xc0135761
    v_mul_f32 v194, v194, v6
    v_mfma_f32_16x16x32_bf16 v[76:79], v[160:163], a[108:111], v[76:79]
    buffer_store_dwordx2 v[248:249], v254, s[24:27], s61 offen offset:2048 sc1
    v_mfma_f32_16x16x32_bf16 v[76:79], v[164:167], a[124:127], v[76:79]
    s_waitcnt lgkmcnt(10)
    v_exp_f32 v194, v194
    v_mfma_f32_16x16x32_bf16 v[80:83], v[168:171], a[96:99], v[80:83]
    s_waitcnt lgkmcnt(8)
    v_mul_f32 v198, v6, v22
    v_add_f32 v194, 1.0, v194
    v_mfma_f32_16x16x32_bf16 v[80:83], v[172:175], a[112:115], v[80:83]
    v_rcp_f32 v194, v194
    v_mfma_f32_16x16x32_bf16 v[84:87], v[168:171], a[100:103], v[84:87]
    s_waitcnt vmcnt(13)
    v_mul_f32 v198, v198, v194
    v_mul_f32 v195, v7, v7
    v_mfma_f32_16x16x32_bf16 v[84:87], v[172:175], a[116:119], v[84:87]
    s_barrier
    buffer_store_dwordx4 v[200:203], v209, s[20:23], s97 offen sc1
    v_mfma_f32_16x16x32_bf16 v[88:91], v[168:171], a[104:107], v[88:91]
    s_add_u32 s97, s48, 4096
    ds_read_b64_tr_b16 v[160:161], v213 offset:0
    ds_read_b64_tr_b16 v[162:163], v213 offset:512
    v_mfma_f32_16x16x32_bf16 v[88:91], v[172:175], a[120:123], v[88:91]
    ds_read_b64_tr_b16 v[164:165], v213 offset:8192
    ds_read_b64_tr_b16 v[166:167], v213 offset:8704
    v_mfma_f32_16x16x32_bf16 v[92:95], v[168:171], a[108:111], v[92:95]
    s_add_u32 m0, s40, 49152
    s_add_u32 s70, s44, 4129152
    v_fmaak_f32 v195, v195, v208, 0xc0135761
    v_mfma_f32_16x16x32_bf16 v[92:95], v[172:175], a[124:127], v[92:95]
    s_waitcnt lgkmcnt(10)
    ds_read_b64_tr_b16 v[168:169], v213 offset:2048
    ds_read_b64_tr_b16 v[170:171], v213 offset:2560
    v_mfma_f32_16x16x32_bf16 v[96:99], v[176:179], a[96:99], v[96:99]
    s_waitcnt lgkmcnt(10)
    buffer_load_dwordx4 v210, s[8:11], s70 offen lds
    v_mfma_f32_16x16x32_bf16 v[96:99], v[180:183], a[112:115], v[96:99]
    ds_read_b64_tr_b16 v[172:173], v213 offset:10240
    ds_read_b64_tr_b16 v[174:175], v213 offset:10752
    v_mfma_f32_16x16x32_bf16 v[100:103], v[176:179], a[100:103], v[100:103]
    v_mul_f32 v195, v195, v7
    v_mul_f32 v199, v7, v23
    v_mfma_f32_16x16x32_bf16 v[100:103], v[180:183], a[116:119], v[100:103]
    v_exp_f32 v195, v195
    v_mfma_f32_16x16x32_bf16 v[104:107], v[176:179], a[104:107], v[104:107]
    v_add_f32 v195, 1.0, v195
    v_cvt_pk_bf16_f32 v204, v196, v197
    v_mfma_f32_16x16x32_bf16 v[104:107], v[180:183], a[120:123], v[104:107]
    buffer_load_dwordx4 v211, s[8:11], s70 offen offset:1024 lds
    v_mfma_f32_16x16x32_bf16 v[108:111], v[176:179], a[108:111], v[108:111]
    s_add_u32 m0, s40, 51200
    v_rcp_f32 v195, v195
    v_mfma_f32_16x16x32_bf16 v[108:111], v[180:183], a[124:127], v[108:111]
    s_waitcnt lgkmcnt(10)
    ds_read_b64_tr_b16 v[176:177], v216 offset:0
    ds_read_b64_tr_b16 v[178:179], v216 offset:512
    v_mfma_f32_16x16x32_bf16 v[112:115], v[184:187], a[96:99], v[112:115]
    s_waitcnt lgkmcnt(10)
    ds_read_b64_tr_b16 v[180:181], v216 offset:8192
    ds_read_b64_tr_b16 v[182:183], v216 offset:8704
    v_mfma_f32_16x16x32_bf16 v[112:115], v[188:191], a[112:115], v[112:115]
    v_mul_f32 v199, v199, v195
    v_cvt_pk_bf16_f32 v205, v198, v199
    v_mfma_f32_16x16x32_bf16 v[116:119], v[184:187], a[100:103], v[116:119]
    buffer_load_dwordx4 v210, s[12:15], s70 offen lds
    v_mfma_f32_16x16x32_bf16 v[116:119], v[188:191], a[116:119], v[116:119]
    v_mul_f32 v222, v36, v36
    v_fmaak_f32 v222, v222, v208, 0xc0135761
    v_mfma_f32_16x16x32_bf16 v[120:123], v[184:187], a[104:107], v[120:123]
    v_mul_f32 v222, v222, v36
    v_mul_f32 v226, v36, v52
    v_mfma_f32_16x16x32_bf16 v[120:123], v[188:191], a[120:123], v[120:123]
    v_exp_f32 v222, v222
    v_mfma_f32_16x16x32_bf16 v[124:127], v[184:187], a[108:111], v[124:127]
    v_add_f32 v222, 1.0, v222
    v_mul_f32 v223, v37, v37
    v_mfma_f32_16x16x32_bf16 v[124:127], v[188:191], a[124:127], v[124:127]
    s_waitcnt lgkmcnt(10)
    buffer_load_dwordx4 v211, s[12:15], s70 offen offset:1024 lds
    v_mfma_f32_16x16x32_bf16 v[64:67], v[160:163], a[128:131], v[64:67]
    s_waitcnt lgkmcnt(8)
    ds_read_b64_tr_b16 v[184:185], v216 offset:2048
    ds_read_b64_tr_b16 v[186:187], v216 offset:2560
    v_mfma_f32_16x16x32_bf16 v[64:67], v[164:167], a[144:147], v[64:67]
    ds_read_b64_tr_b16 v[188:189], v216 offset:10240
    ds_read_b64_tr_b16 v[190:191], v216 offset:10752
    v_mfma_f32_16x16x32_bf16 v[68:71], v[160:163], a[132:135], v[68:71]
    v_rcp_f32 v222, v222
    v_mfma_f32_16x16x32_bf16 v[68:71], v[164:167], a[148:151], v[68:71]
    v_mul_f32 v226, v226, v222
    v_fmaak_f32 v223, v223, v208, 0xc0135761
    v_mfma_f32_16x16x32_bf16 v[72:75], v[160:163], a[136:139], v[72:75]
    buffer_load_dword v244, v243, s[28:31], 0 offen sc1
    v_mfma_f32_16x16x32_bf16 v[72:75], v[164:167], a[152:155], v[72:75]
    v_mul_f32 v223, v223, v37
    v_mul_f32 v227, v37, v53
    v_mfma_f32_16x16x32_bf16 v[76:79], v[160:163], a[140:143], v[76:79]
    v_exp_f32 v223, v223
    v_mfma_f32_16x16x32_bf16 v[76:79], v[164:167], a[156:159], v[76:79]
    s_waitcnt lgkmcnt(10)
    v_add_f32 v223, 1.0, v223
    v_mul_f32 v224, v38, v38
    v_mfma_f32_16x16x32_bf16 v[80:83], v[168:171], a[128:131], v[80:83]
    s_waitcnt lgkmcnt(8)
    v_rcp_f32 v223, v223
    v_mfma_f32_16x16x32_bf16 v[80:83], v[172:175], a[144:147], v[80:83]
    buffer_store_dwordx4 v[248:251], v209, s[24:27], s62 offen sc1
    v_mfma_f32_16x16x32_bf16 v[84:87], v[168:171], a[132:135], v[84:87]
    s_waitcnt vmcnt(13)
    v_mul_f32 v227, v227, v223
    v_fmaak_f32 v224, v224, v208, 0xc0135761
    v_mfma_f32_16x16x32_bf16 v[84:87], v[172:175], a[148:151], v[84:87]
    s_barrier
    v_mul_f32 v224, v224, v38
    v_mul_f32 v228, v38, v54
    v_mfma_f32_16x16x32_bf16 v[88:91], v[168:171], a[136:139], v[88:91]
    ds_read_b64_tr_b16 v[160:161], v213 offset:16384
    ds_read_b64_tr_b16 v[162:163], v213 offset:16896
    v_mfma_f32_16x16x32_bf16 v[88:91], v[172:175], a[152:155], v[88:91]
    ds_read_b64_tr_b16 v[164:165], v213 offset:24576
    ds_read_b64_tr_b16 v[166:167], v213 offset:25088
    v_mfma_f32_16x16x32_bf16 v[92:95], v[168:171], a[140:143], v[92:95]
    buffer_load_dwordx4 a[4:7], v209, s[20:23], s100 offen sc1
    v_mfma_f32_16x16x32_bf16 v[92:95], v[172:175], a[156:159], v[92:95]
    s_add_u32 s99, s54, 9216
    ds_read_b64_tr_b16 v[168:169], v213 offset:18432
    ds_read_b64_tr_b16 v[170:171], v213 offset:18944
    s_waitcnt lgkmcnt(12)
    v_mfma_f32_16x16x32_bf16 v[96:99], v[176:179], a[128:131], v[96:99]
    s_waitcnt lgkmcnt(10)
    ds_read_b64_tr_b16 v[172:173], v213 offset:26624
    ds_read_b64_tr_b16 v[174:175], v213 offset:27136
    v_mfma_f32_16x16x32_bf16 v[96:99], v[180:183], a[144:147], v[96:99]
    s_add_u32 m0, s40, 65536
    s_add_u32 s71, s44, 4718976
    v_mul_f32 v225, v39, v39
    v_mfma_f32_16x16x32_bf16 v[100:103], v[176:179], a[132:135], v[100:103]
    v_exp_f32 v224, v224
    v_mfma_f32_16x16x32_bf16 v[100:103], v[180:183], a[148:151], v[100:103]
    buffer_load_dwordx4 v210, s[8:11], s71 offen lds
    v_mfma_f32_16x16x32_bf16 v[104:107], v[176:179], a[136:139], v[104:107]
    v_add_f32 v224, 1.0, v224
    v_fmaak_f32 v225, v225, v208, 0xc0135761
    v_mfma_f32_16x16x32_bf16 v[104:107], v[180:183], a[152:155], v[104:107]
    v_rcp_f32 v224, v224
    v_mfma_f32_16x16x32_bf16 v[108:111], v[176:179], a[140:143], v[108:111]
    v_mul_f32 v228, v228, v224
    v_mul_f32 v225, v225, v39
    v_mfma_f32_16x16x32_bf16 v[108:111], v[180:183], a[156:159], v[108:111]
    s_waitcnt lgkmcnt(10)
    ds_read_b64_tr_b16 v[176:177], v216 offset:16384
    ds_read_b64_tr_b16 v[178:179], v216 offset:16896
    v_mfma_f32_16x16x32_bf16 v[112:115], v[184:187], a[128:131], v[112:115]
    s_waitcnt lgkmcnt(10)
    buffer_load_dwordx4 v211, s[8:11], s71 offen offset:1024 lds
    v_mfma_f32_16x16x32_bf16 v[112:115], v[188:191], a[144:147], v[112:115]
    s_add_u32 m0, s40, 67584
    ds_read_b64_tr_b16 v[180:181], v216 offset:24576
    ds_read_b64_tr_b16 v[182:183], v216 offset:25088
    v_mfma_f32_16x16x32_bf16 v[116:119], v[184:187], a[132:135], v[116:119]
    v_exp_f32 v225, v225
    v_mfma_f32_16x16x32_bf16 v[116:119], v[188:191], a[148:151], v[116:119]
    v_mul_f32 v229, v39, v55
    v_add_f32 v225, 1.0, v225
    v_mfma_f32_16x16x32_bf16 v[120:123], v[184:187], a[136:139], v[120:123]
    v_rcp_f32 v225, v225
    v_mfma_f32_16x16x32_bf16 v[120:123], v[188:191], a[152:155], v[120:123]
    buffer_load_dwordx4 v210, s[12:15], s71 offen lds
    v_mfma_f32_16x16x32_bf16 v[124:127], v[184:187], a[140:143], v[124:127]
    v_mul_f32 v229, v229, v225
    v_cvt_pk_bf16_f32 v206, v226, v227
    v_mfma_f32_16x16x32_bf16 v[124:127], v[188:191], a[156:159], v[124:127]
    s_waitcnt lgkmcnt(10)
    ds_read_b64_tr_b16 v[184:185], v216 offset:18432
    ds_read_b64_tr_b16 v[186:187], v216 offset:18944
    v_mfma_f32_16x16x32_bf16 v[64:67], v[160:163], a[160:163], v[64:67]
    s_waitcnt lgkmcnt(10)
    ds_read_b64_tr_b16 v[188:189], v216 offset:26624
    ds_read_b64_tr_b16 v[190:191], v216 offset:27136
    v_mfma_f32_16x16x32_bf16 v[64:67], v[164:167], a[176:179], v[64:67]
    v_cvt_pk_bf16_f32 v207, v228, v229
    v_mul_f32 v192, v8, v8
    v_mfma_f32_16x16x32_bf16 v[68:71], v[160:163], a[164:167], v[68:71]
    buffer_load_dwordx4 v211, s[12:15], s71 offen offset:1024 lds
    v_mfma_f32_16x16x32_bf16 v[68:71], v[164:167], a[180:183], v[68:71]
    v_fmaak_f32 v192, v192, v208, 0xc0135761
    v_mul_f32 v192, v192, v8
    v_mfma_f32_16x16x32_bf16 v[72:75], v[160:163], a[168:171], v[72:75]
    v_exp_f32 v192, v192
    v_mfma_f32_16x16x32_bf16 v[72:75], v[164:167], a[184:187], v[72:75]
    v_mul_f32 v196, v8, v24
    v_add_f32 v192, 1.0, v192
    v_mfma_f32_16x16x32_bf16 v[76:79], v[160:163], a[172:175], v[76:79]
    v_rcp_f32 v192, v192
    v_mfma_f32_16x16x32_bf16 v[76:79], v[164:167], a[188:191], v[76:79]
    s_waitcnt lgkmcnt(10)
    buffer_store_dwordx4 v[248:251], v209, s[24:27], s62 offen offset:1024 sc1
    v_mfma_f32_16x16x32_bf16 v[80:83], v[168:171], a[160:163], v[80:83]
    s_waitcnt lgkmcnt(8)
    v_mul_f32 v196, v196, v192
    v_mul_f32 v193, v9, v9
    v_mfma_f32_16x16x32_bf16 v[80:83], v[172:175], a[176:179], v[80:83]
    v_fmaak_f32 v193, v193, v208, 0xc0135761
    v_mul_f32 v193, v193, v9
    v_mfma_f32_16x16x32_bf16 v[84:87], v[168:171], a[164:167], v[84:87]
    s_waitcnt vmcnt(14)
    v_exp_f32 v193, v193
    v_mfma_f32_16x16x32_bf16 v[84:87], v[172:175], a[180:183], v[84:87]
    s_barrier
    v_mul_f32 v197, v9, v25
    v_add_f32 v193, 1.0, v193
    v_mfma_f32_16x16x32_bf16 v[88:91], v[168:171], a[168:171], v[88:91]
    buffer_load_dwordx4 a[8:11], v209, s[20:23], s99 offen sc1
    v_mfma_f32_16x16x32_bf16 v[88:91], v[172:175], a[184:187], v[88:91]
    s_add_u32 s100, s54, 156672
    ds_read_b64_tr_b16 v[160:161], v213 offset:32768
    ds_read_b64_tr_b16 v[162:163], v213 offset:33280
    v_mfma_f32_16x16x32_bf16 v[92:95], v[168:171], a[172:175], v[92:95]
    ds_read_b64_tr_b16 v[164:165], v213 offset:40960
    ds_read_b64_tr_b16 v[166:167], v213 offset:41472
    v_mfma_f32_16x16x32_bf16 v[92:95], v[172:175], a[188:191], v[92:95]
    s_waitcnt lgkmcnt(10)
    ds_read_b64_tr_b16 v[168:169], v213 offset:34816
    ds_read_b64_tr_b16 v[170:171], v213 offset:35328
    v_mfma_f32_16x16x32_bf16 v[96:99], v[176:179], a[160:163], v[96:99]
    s_waitcnt lgkmcnt(10)
    ds_read_b64_tr_b16 v[172:173], v213 offset:43008
    ds_read_b64_tr_b16 v[174:175], v213 offset:43520
    v_mfma_f32_16x16x32_bf16 v[96:99], v[180:183], a[176:179], v[96:99]
    buffer_load_dwordx4 a[12:15], v209, s[20:23], s100 offen sc1
    v_mfma_f32_16x16x32_bf16 v[100:103], v[176:179], a[164:167], v[100:103]
    s_add_u32 s99, s54, 26624
    v_rcp_f32 v193, v193
    v_mfma_f32_16x16x32_bf16 v[100:103], v[180:183], a[180:183], v[100:103]
    v_mul_f32 v197, v197, v193
    v_mul_f32 v194, v10, v10
    v_mfma_f32_16x16x32_bf16 v[104:107], v[176:179], a[168:171], v[104:107]
    v_fmaak_f32 v194, v194, v208, 0xc0135761
    v_mul_f32 v194, v194, v10
    v_mfma_f32_16x16x32_bf16 v[104:107], v[180:183], a[184:187], v[104:107]
    v_exp_f32 v194, v194
    v_mfma_f32_16x16x32_bf16 v[108:111], v[176:179], a[172:175], v[108:111]
    buffer_store_dwordx4 v[204:207], v209, s[20:23], s98 offen sc1
    v_mfma_f32_16x16x32_bf16 v[108:111], v[180:183], a[188:191], v[108:111]
    s_waitcnt lgkmcnt(10)
    ds_read_b64_tr_b16 v[176:177], v216 offset:32768
    ds_read_b64_tr_b16 v[178:179], v216 offset:33280
    v_mfma_f32_16x16x32_bf16 v[112:115], v[184:187], a[160:163], v[112:115]
    s_waitcnt lgkmcnt(10)
    ds_read_b64_tr_b16 v[180:181], v216 offset:40960
    ds_read_b64_tr_b16 v[182:183], v216 offset:41472
    v_mfma_f32_16x16x32_bf16 v[112:115], v[188:191], a[176:179], v[112:115]
    v_mul_f32 v198, v10, v26
    v_add_f32 v194, 1.0, v194
    v_mfma_f32_16x16x32_bf16 v[116:119], v[184:187], a[164:167], v[116:119]
    v_rcp_f32 v194, v194
    v_mfma_f32_16x16x32_bf16 v[116:119], v[188:191], a[180:183], v[116:119]
    buffer_load_dwordx4 a[16:19], v209, s[20:23], s99 offen sc1
    v_mfma_f32_16x16x32_bf16 v[120:123], v[184:187], a[168:171], v[120:123]
    s_add_u32 s69, s55, 2
    s_waitcnt vmcnt(11)
    v_subrev_u32 v245, s69, v244
    v_cmp_le_u32 vcc, 8, v245
    s_nop 1
    s_cbranch_vccnz LS_spin1
LS_back1:
    v_mfma_f32_16x16x32_bf16 v[120:123], v[188:191], a[184:187], v[120:123]
    s_add_u32 s100, s54, 174080
    v_mul_f32 v198, v198, v194
    v_mul_f32 v195, v11, v11
    v_mfma_f32_16x16x32_bf16 v[124:127], v[184:187], a[172:175], v[124:127]
    v_fmaak_f32 v195, v195, v208, 0xc0135761
    v_mul_f32 v195, v195, v11
    v_mfma_f32_16x16x32_bf16 v[124:127], v[188:191], a[188:191], v[124:127]
    s_waitcnt lgkmcnt(10)
    ds_read_b64_tr_b16 v[184:185], v216 offset:34816
    ds_read_b64_tr_b16 v[186:187], v216 offset:35328
    v_mfma_f32_16x16x32_bf16 v[64:67], v[160:163], a[192:195], v[64:67]
    s_waitcnt lgkmcnt(10)
    buffer_load_dwordx4 a[20:23], v209, s[20:23], s100 offen sc1
    v_mfma_f32_16x16x32_bf16 v[64:67], v[164:167], a[208:211], v[64:67]
    s_add_u32 s99, s54, 27648
    ds_read_b64_tr_b16 v[188:189], v216 offset:43008
    ds_read_b64_tr_b16 v[190:191], v216 offset:43520
    v_mfma_f32_16x16x32_bf16 v[68:71], v[160:163], a[196:199], v[68:71]
    v_exp_f32 v195, v195
    v_mfma_f32_16x16x32_bf16 v[68:71], v[164:167], a[212:215], v[68:71]
    v_mul_f32 v199, v11, v27
    v_add_f32 v195, 1.0, v195
    v_mfma_f32_16x16x32_bf16 v[72:75], v[160:163], a[200:203], v[72:75]
    v_rcp_f32 v195, v195
    v_mfma_f32_16x16x32_bf16 v[72:75], v[164:167], a[216:219], v[72:75]
    buffer_store_dwordx2 v[248:249], v254, s[24:27], s62 offen offset:2048 sc1
    v_mfma_f32_16x16x32_bf16 v[76:79], v[160:163], a[204:207], v[76:79]
    v_mul_f32 v199, v199, v195
    v_cvt_pk_bf16_f32 v200, v196, v197
    v_mfma_f32_16x16x32_bf16 v[76:79], v[164:167], a[220:223], v[76:79]
    s_waitcnt lgkmcnt(10)
    v_cvt_pk_bf16_f32 v201, v198, v199
    v_mul_f32 v222, v40, v40
    v_mfma_f32_16x16x32_bf16 v[80:83], v[168:171], a[192:195], v[80:83]
    s_waitcnt lgkmcnt(8)
    v_fmaak_f32 v222, v222, v208, 0xc0135761
    v_mul_f32 v222, v222, v40
    v_mfma_f32_16x16x32_bf16 v[80:83], v[172:175], a[208:211], v[80:83]
    v_exp_f32 v222, v222
    v_mfma_f32_16x16x32_bf16 v[84:87], v[168:171], a[196:199], v[84:87]
    v_mul_f32 v226, v40, v56
    v_add_f32 v222, 1.0, v222
    v_mfma_f32_16x16x32_bf16 v[84:87], v[172:175], a[212:215], v[84:87]
    s_barrier
    v_rcp_f32 v222, v222
    v_mfma_f32_16x16x32_bf16 v[88:91], v[168:171], a[200:203], v[88:91]
    buffer_load_dwordx4 a[24:27], v209, s[20:23], s99 offen sc1
    v_mfma_f32_16x16x32_bf16 v[88:91], v[172:175], a[216:219], v[88:91]
    s_add_u32 s100, s54, 175104
    ds_read_b64_tr_b16 v[160:161], v213 offset:49152
    ds_read_b64_tr_b16 v[162:163], v213 offset:49664
    v_mfma_f32_16x16x32_bf16 v[92:95], v[168:171], a[204:207], v[92:95]
    ds_read_b64_tr_b16 v[164:165], v213 offset:57344
    ds_read_b64_tr_b16 v[166:167], v213 offset:57856
    v_mfma_f32_16x16x32_bf16 v[92:95], v[172:175], a[220:223], v[92:95]
    s_waitcnt lgkmcnt(10)
    ds_read_b64_tr_b16 v[168:169], v213 offset:51200
    ds_read_b64_tr_b16 v[170:171], v213 offset:51712
    v_mfma_f32_16x16x32_bf16 v[96:99], v[176:179], a[192:195], v[96:99]
    s_waitcnt lgkmcnt(10)
    ds_read_b64_tr_b16 v[172:173], v213 offset:59392
    ds_read_b64_tr_b16 v[174:175], v213 offset:59904
    v_mfma_f32_16x16x32_bf16 v[96:99], v[180:183], a[208:211], v[96:99]
    buffer_load_dwordx4 a[28:31], v209, s[20:23], s100 offen sc1
    v_mfma_f32_16x16x32_bf16 v[100:103], v[176:179], a[196:199], v[100:103]
    s_add_u32 s99, s54, 0
    v_mul_f32 v226, v226, v222
    v_mul_f32 v223, v41, v41
    v_mfma_f32_16x16x32_bf16 v[100:103], v[180:183], a[212:215], v[100:103]
    v_fmaak_f32 v223, v223, v208, 0xc0135761
    v_mul_f32 v223, v223, v41
    v_mfma_f32_16x16x32_bf16 v[104:107], v[176:179], a[200:203], v[104:107]
    v_exp_f32 v223, v223
    v_mfma_f32_16x16x32_bf16 v[104:107], v[180:183], a[216:219], v[104:107]
    v_mul_f32 v227, v41, v57
    v_add_f32 v223, 1.0, v223
    v_mfma_f32_16x16x32_bf16 v[108:111], v[176:179], a[204:207], v[108:111]
    buffer_load_dwordx4 a[32:35], v209, s[20:23], s99 offen sc1
    v_mfma_f32_16x16x32_bf16 v[108:111], v[180:183], a[220:223], v[108:111]
    s_add_u32 s100, s54, 147456
    ds_read_b64_tr_b16 v[176:177], v216 offset:49152
    ds_read_b64_tr_b16 v[178:179], v216 offset:49664
    s_waitcnt lgkmcnt(12)
    v_mfma_f32_16x16x32_bf16 v[112:115], v[184:187], a[192:195], v[112:115]
    s_waitcnt lgkmcnt(10)
    ds_read_b64_tr_b16 v[180:181], v216 offset:57344
    ds_read_b64_tr_b16 v[182:183], v216 offset:57856
    v_mfma_f32_16x16x32_bf16 v[112:115], v[188:191], a[208:211], v[112:115]
    v_rcp_f32 v223, v223
    v_mfma_f32_16x16x32_bf16 v[116:119], v[184:187], a[196:199], v[116:119]
    v_mul_f32 v227, v227, v223
    v_mul_f32 v224, v42, v42
    v_mfma_f32_16x16x32_bf16 v[116:119], v[188:191], a[212:215], v[116:119]
    buffer_load_dwordx4 a[36:39], v209, s[20:23], s100 offen sc1
    v_mfma_f32_16x16x32_bf16 v[120:123], v[184:187], a[200:203], v[120:123]
    s_add_u32 s99, s54, 1024
    v_fmaak_f32 v224, v224, v208, 0xc0135761
    v_mul_f32 v224, v224, v42
    v_mfma_f32_16x16x32_bf16 v[120:123], v[188:191], a[216:219], v[120:123]
    v_exp_f32 v224, v224
    v_mfma_f32_16x16x32_bf16 v[124:127], v[184:187], a[204:207], v[124:127]
    v_mul_f32 v228, v42, v58
    v_add_f32 v224, 1.0, v224
    v_mfma_f32_16x16x32_bf16 v[124:127], v[188:191], a[220:223], v[124:127]
    s_waitcnt lgkmcnt(10)
    ds_read_b64_tr_b16 v[184:185], v216 offset:51200
    ds_read_b64_tr_b16 v[186:187], v216 offset:51712
    v_mfma_f32_16x16x32_bf16 v[64:67], v[160:163], a[224:227], v[64:67]
    s_waitcnt lgkmcnt(10)
    buffer_load_dwordx4 a[40:43], v209, s[20:23], s99 offen sc1
    v_mfma_f32_16x16x32_bf16 v[64:67], v[164:167], a[240:243], v[64:67]
    s_add_u32 s100, s54, 148480
    ds_read_b64_tr_b16 v[188:189], v216 offset:59392
    ds_read_b64_tr_b16 v[190:191], v216 offset:59904
    v_mfma_f32_16x16x32_bf16 v[68:71], v[160:163], a[228:231], v[68:71]
    v_rcp_f32 v224, v224
    v_mfma_f32_16x16x32_bf16 v[68:71], v[164:167], a[244:247], v[68:71]
    v_mul_f32 v228, v228, v224
    v_mul_f32 v225, v43, v43
    v_mfma_f32_16x16x32_bf16 v[72:75], v[160:163], a[232:235], v[72:75]
    v_fmaak_f32 v225, v225, v208, 0xc0135761
    v_mul_f32 v225, v225, v43
    v_mfma_f32_16x16x32_bf16 v[72:75], v[164:167], a[248:251], v[72:75]
    buffer_store_dwordx4 v[248:251], v209, s[24:27], s63 offen sc1
    v_mfma_f32_16x16x32_bf16 v[76:79], v[160:163], a[236:239], v[76:79]
    v_exp_f32 v225, v225
    v_mfma_f32_16x16x32_bf16 v[76:79], v[164:167], a[252:255], v[76:79]
    s_waitcnt lgkmcnt(10)
    v_mul_f32 v229, v43, v59
    v_add_f32 v225, 1.0, v225
    v_mfma_f32_16x16x32_bf16 v[80:83], v[168:171], a[224:227], v[80:83]
    s_waitcnt lgkmcnt(8)
    v_rcp_f32 v225, v225
    v_mfma_f32_16x16x32_bf16 v[80:83], v[172:175], a[240:243], v[80:83]
    v_mul_f32 v229, v229, v225
    v_cvt_pk_bf16_f32 v202, v226, v227
    v_mfma_f32_16x16x32_bf16 v[84:87], v[168:171], a[228:231], v[84:87]
    s_waitcnt vmcnt(13)
    v_cvt_pk_bf16_f32 v203, v228, v229
    v_mfma_f32_16x16x32_bf16 v[84:87], v[172:175], a[244:247], v[84:87]
    s_barrier
    buffer_store_dwordx4 v[200:203], v209, s[20:23], s97 offen sc1
    v_mfma_f32_16x16x32_bf16 v[88:91], v[168:171], a[232:235], v[88:91]
    ds_read_b64_tr_b16 v[160:161], v214 offset:0
    ds_read_b64_tr_b16 v[162:163], v214 offset:512
    v_mfma_f32_16x16x32_bf16 v[88:91], v[172:175], a[248:251], v[88:91]
    ds_read_b64_tr_b16 v[164:165], v214 offset:8192
    ds_read_b64_tr_b16 v[166:167], v214 offset:8704
    v_mfma_f32_16x16x32_bf16 v[92:95], v[168:171], a[236:239], v[92:95]
    s_add_u32 m0, s42, 0
    s_add_u32 s92, s52, 663552
    v_mfma_f32_16x16x32_bf16 v[92:95], v[172:175], a[252:255], v[92:95]
    s_waitcnt lgkmcnt(10)
    ds_read_b64_tr_b16 v[168:169], v214 offset:2048
    ds_read_b64_tr_b16 v[170:171], v214 offset:2560
    v_mfma_f32_16x16x32_bf16 v[96:99], v[176:179], a[224:227], v[96:99]
    s_waitcnt lgkmcnt(10)
    buffer_load_dwordx4 a[44:47], v209, s[20:23], s100 offen sc1
    v_mfma_f32_16x16x32_bf16 v[96:99], v[180:183], a[240:243], v[96:99]
    s_add_u32 s99, s54, 10240
    ds_read_b64_tr_b16 v[172:173], v214 offset:10240
    ds_read_b64_tr_b16 v[174:175], v214 offset:10752
    v_mfma_f32_16x16x32_bf16 v[100:103], v[176:179], a[228:231], v[100:103]
    v_mfma_f32_16x16x32_bf16 v[100:103], v[180:183], a[244:247], v[100:103]
    v_mfma_f32_16x16x32_bf16 v[104:107], v[176:179], a[232:235], v[104:107]
    v_mfma_f32_16x16x32_bf16 v[104:107], v[180:183], a[248:251], v[104:107]
    buffer_load_dwordx4 a[48:51], v209, s[20:23], s99 offen sc1
    v_mfma_f32_16x16x32_bf16 v[108:111], v[176:179], a[236:239], v[108:111]
    s_add_u32 s100, s54, 157696
    v_mfma_f32_16x16x32_bf16 v[108:111], v[180:183], a[252:255], v[108:111]
    s_waitcnt lgkmcnt(10)
    ds_read_b64_tr_b16 v[176:177], v217 offset:0
    ds_read_b64_tr_b16 v[178:179], v217 offset:512
    v_mfma_f32_16x16x32_bf16 v[112:115], v[184:187], a[224:227], v[112:115]
    s_waitcnt lgkmcnt(10)
    ds_read_b64_tr_b16 v[180:181], v217 offset:8192
    ds_read_b64_tr_b16 v[182:183], v217 offset:8704
    v_mfma_f32_16x16x32_bf16 v[112:115], v[188:191], a[240:243], v[112:115]
    v_mfma_f32_16x16x32_bf16 v[116:119], v[184:187], a[228:231], v[116:119]
    buffer_load_dwordx4 a[52:55], v209, s[20:23], s100 offen sc1
    v_mfma_f32_16x16x32_bf16 v[116:119], v[188:191], a[244:247], v[116:119]
    s_add_u32 s99, s54, 11264
    v_mfma_f32_16x16x32_bf16 v[120:123], v[184:187], a[232:235], v[120:123]
    v_mfma_f32_16x16x32_bf16 v[120:123], v[188:191], a[248:251], v[120:123]
    v_mfma_f32_16x16x32_bf16 v[124:127], v[184:187], a[236:239], v[124:127]
    v_mfma_f32_16x16x32_bf16 v[124:127], v[188:191], a[252:255], v[124:127]
    s_waitcnt lgkmcnt(10)
    buffer_load_dwordx4 a[56:59], v209, s[20:23], s99 offen sc1
    v_mfma_f32_16x16x32_bf16 v[64:67], v[160:163], v[128:131], v[64:67]
    s_add_u32 s100, s54, 158720
    ds_read_b64_tr_b16 v[184:185], v217 offset:2048
    ds_read_b64_tr_b16 v[186:187], v217 offset:2560
    s_waitcnt lgkmcnt(10)
    v_mfma_f32_16x16x32_bf16 v[64:67], v[164:167], v[144:147], v[64:67]
    ds_read_b64_tr_b16 v[188:189], v217 offset:10240
    ds_read_b64_tr_b16 v[190:191], v217 offset:10752
    v_mfma_f32_16x16x32_bf16 v[68:71], v[160:163], v[132:135], v[68:71]
    v_mfma_f32_16x16x32_bf16 v[68:71], v[164:167], v[148:151], v[68:71]
    v_mfma_f32_16x16x32_bf16 v[72:75], v[160:163], v[136:139], v[72:75]
    buffer_store_dwordx4 v[248:251], v209, s[24:27], s63 offen offset:1024 sc1
    v_mfma_f32_16x16x32_bf16 v[72:75], v[164:167], v[152:155], v[72:75]
    v_mfma_f32_16x16x32_bf16 v[76:79], v[160:163], v[140:143], v[76:79]
    v_mfma_f32_16x16x32_bf16 v[76:79], v[164:167], v[156:159], v[76:79]
    s_waitcnt lgkmcnt(10)
    v_mfma_f32_16x16x32_bf16 v[80:83], v[168:171], v[128:131], v[80:83]
    s_waitcnt lgkmcnt(8)
    v_mfma_f32_16x16x32_bf16 v[80:83], v[172:175], v[144:147], v[80:83]
    buffer_store_dwordx2 v[248:249], v254, s[24:27], s63 offen offset:2048 sc1
    v_mfma_f32_16x16x32_bf16 v[84:87], v[168:171], v[132:135], v[84:87]
    v_mfma_f32_16x16x32_bf16 v[84:87], v[172:175], v[148:151], v[84:87]
    s_barrier
    v_mfma_f32_16x16x32_bf16 v[88:91], v[168:171], v[136:139], v[88:91]
    ds_read_b64_tr_b16 v[160:161], v220 offset:53248
    ds_read_b64_tr_b16 v[162:163], v220 offset:57856
    v_mfma_f32_16x16x32_bf16 v[88:91], v[172:175], v[152:155], v[88:91]
    ds_read_b64_tr_b16 v[164:165], v220 offset:62464
    ds_read_b64_tr_b16 v[166:167], v221 offset:1536
    v_mfma_f32_16x16x32_bf16 v[92:95], v[168:171], v[140:143], v[92:95]
    buffer_load_dwordx4 a[60:63], v209, s[20:23], s100 offen sc1
    v_mfma_f32_16x16x32_bf16 v[92:95], v[172:175], v[156:159], v[92:95]
    s_add_u32 s99, s54, 18432
    ds_read_b64_tr_b16 v[168:169], v220 offset:53280
    ds_read_b64_tr_b16 v[170:171], v220 offset:57888
    s_waitcnt lgkmcnt(12)
    v_mfma_f32_16x16x32_bf16 v[96:99], v[176:179], v[128:131], v[96:99]
    s_waitcnt lgkmcnt(10)
    ds_read_b64_tr_b16 v[172:173], v220 offset:62496
    ds_read_b64_tr_b16 v[174:175], v221 offset:1568
    v_mfma_f32_16x16x32_bf16 v[96:99], v[180:183], v[144:147], v[96:99]
    v_mfma_f32_16x16x32_bf16 v[100:103], v[176:179], v[132:135], v[100:103]
    v_mfma_f32_16x16x32_bf16 v[100:103], v[180:183], v[148:151], v[100:103]
    buffer_load_dwordx4 v232, s[16:19], s92 offen lds
    v_mfma_f32_16x16x32_bf16 v[104:107], v[176:179], v[136:139], v[104:107]
    v_mfma_f32_16x16x32_bf16 v[104:107], v[180:183], v[152:155], v[104:107]
    v_mfma_f32_16x16x32_bf16 v[108:111], v[176:179], v[140:143], v[108:111]
    v_mfma_f32_16x16x32_bf16 v[108:111], v[180:183], v[156:159], v[108:111]
    s_waitcnt lgkmcnt(10)
    ds_read_b64_tr_b16 v[176:177], v220 offset:53312
    ds_read_b64_tr_b16 v[178:179], v220 offset:57920
    v_mfma_f32_16x16x32_bf16 v[112:115], v[184:187], v[128:131], v[112:115]
    s_waitcnt lgkmcnt(10)
    buffer_load_dwordx4 v233, s[16:19], s92 offen offset:1024 lds
    v_mfma_f32_16x16x32_bf16 v[112:115], v[188:191], v[144:147], v[112:115]
    ds_read_b64_tr_b16 v[180:181], v220 offset:62528
    ds_read_b64_tr_b16 v[182:183], v221 offset:1600
    v_mfma_f32_16x16x32_bf16 v[116:119], v[184:187], v[132:135], v[116:119]
    v_mfma_f32_16x16x32_bf16 v[116:119], v[188:191], v[148:151], v[116:119]
    v_mfma_f32_16x16x32_bf16 v[120:123], v[184:187], v[136:139], v[120:123]
    v_mfma_f32_16x16x32_bf16 v[120:123], v[188:191], v[152:155], v[120:123]
    buffer_load_dwordx4 v234, s[16:19], s92 offen offset:2048 lds
    v_mfma_f32_16x16x32_bf16 v[124:127], v[184:187], v[140:143], v[124:127]
    v_mfma_f32_16x16x32_bf16 v[124:127], v[188:191], v[156:159], v[124:127]
    s_waitcnt lgkmcnt(10)
    ds_read_b64_tr_b16 v[184:185], v220 offset:53344
    ds_read_b64_tr_b16 v[186:187], v220 offset:57952
    v_pk_mul_f32 v[192:193], v[64:65], v[64:65]
    v_pk_mul_f32 v[194:195], v[66:67], v[66:67]
    v_pk_mul_f32 v[222:223], v[96:97], v[96:97]
    v_pk_mul_f32 v[224:225], v[98:99], v[98:99]
    v_pk_fma_f32 v[192:193], v[192:193], v[208:209], s[84:85] op_sel_hi:[1,0,0]
    v_pk_fma_f32 v[194:195], v[194:195], v[208:209], s[84:85] op_sel_hi:[1,0,0]
    v_pk_fma_f32 v[222:223], v[222:223], v[208:209], s[84:85] op_sel_hi:[1,0,0]
    v_pk_fma_f32 v[224:225], v[224:225], v[208:209], s[84:85] op_sel_hi:[1,0,0]
    v_pk_mul_f32 v[192:193], v[192:193], v[64:65]
    v_pk_mul_f32 v[194:195], v[194:195], v[66:67]
    v_pk_mul_f32 v[222:223], v[222:223], v[96:97]
    v_pk_mul_f32 v[224:225], v[224:225], v[98:99]
    v_exp_f32 v192, v192
    v_exp_f32 v193, v193
    v_exp_f32 v194, v194
    v_exp_f32 v195, v195
    v_exp_f32 v222, v222
    v_exp_f32 v223, v223
    v_exp_f32 v224, v224
    v_exp_f32 v225, v225
    v_pk_mul_f32 v[196:197], v[64:65], v[80:81]
    v_pk_mul_f32 v[198:199], v[66:67], v[82:83]
    v_pk_mul_f32 v[226:227], v[96:97], v[112:113]
    v_pk_mul_f32 v[228:229], v[98:99], v[114:115]
    v_pk_add_f32 v[192:193], v[192:193], 1.0 op_sel_hi:[1,0]
    v_pk_add_f32 v[194:195], v[194:195], 1.0 op_sel_hi:[1,0]
    v_pk_add_f32 v[222:223], v[222:223], 1.0 op_sel_hi:[1,0]
    v_pk_add_f32 v[224:225], v[224:225], 1.0 op_sel_hi:[1,0]
    v_rcp_f32 v192, v192
    v_rcp_f32 v193, v193
    v_rcp_f32 v194, v194
    v_rcp_f32 v195, v195
    v_rcp_f32 v222, v222
    v_rcp_f32 v223, v223
    v_rcp_f32 v224, v224
    v_rcp_f32 v225, v225
    v_pk_mul_f32 v[196:197], v[196:197], v[192:193]
    v_pk_mul_f32 v[198:199], v[198:199], v[194:195]
    v_pk_mul_f32 v[226:227], v[226:227], v[222:223]
    v_pk_mul_f32 v[228:229], v[228:229], v[224:225]
    v_cvt_pk_bf16_f32 v200, v196, v197
    v_cvt_pk_bf16_f32 v201, v198, v199
    v_cvt_pk_bf16_f32 v202, v226, v227
    v_cvt_pk_bf16_f32 v203, v228, v229
    s_add_u32 s97, s46, 6144
    buffer_store_dwordx4 v[200:203], v209, s[20:23], s97 offen sc1
    v_pk_mul_f32 v[192:193], v[68:69], v[68:69]
    v_pk_mul_f32 v[194:195], v[70:71], v[70:71]
    v_pk_mul_f32 v[222:223], v[100:101], v[100:101]
    v_pk_mul_f32 v[224:225], v[102:103], v[102:103]
    v_pk_fma_f32 v[192:193], v[192:193], v[208:209], s[84:85] op_sel_hi:[1,0,0]
    v_pk_fma_f32 v[194:195], v[194:195], v[208:209], s[84:85] op_sel_hi:[1,0,0]
    v_pk_fma_f32 v[222:223], v[222:223], v[208:209], s[84:85] op_sel_hi:[1,0,0]
    v_pk_fma_f32 v[224:225], v[224:225], v[208:209], s[84:85] op_sel_hi:[1,0,0]
    v_pk_mul_f32 v[192:193], v[192:193], v[68:69]
    v_pk_mul_f32 v[194:195], v[194:195], v[70:71]
    v_pk_mul_f32 v[222:223], v[222:223], v[100:101]
    v_pk_mul_f32 v[224:225], v[224:225], v[102:103]
    v_exp_f32 v192, v192
    v_exp_f32 v193, v193
    v_exp_f32 v194, v194
    v_exp_f32 v195, v195
    v_exp_f32 v222, v222
    v_exp_f32 v223, v223
    v_exp_f32 v224, v224
    v_exp_f32 v225, v225
    v_pk_mul_f32 v[196:197], v[68:69], v[84:85]
    v_pk_mul_f32 v[198:199], v[70:71], v[86:87]
    v_pk_mul_f32 v[226:227], v[100:101], v[116:117]
    v_pk_mul_f32 v[228:229], v[102:103], v[118:119]
    v_pk_add_f32 v[192:193], v[192:193], 1.0 op_sel_hi:[1,0]
    v_pk_add_f32 v[194:195], v[194:195], 1.0 op_sel_hi:[1,0]
    v_pk_add_f32 v[222:223], v[222:223], 1.0 op_sel_hi:[1,0]
    v_pk_add_f32 v[224:225], v[224:225], 1.0 op_sel_hi:[1,0]
    v_rcp_f32 v192, v192
    v_rcp_f32 v193, v193
    v_rcp_f32 v194, v194
    v_rcp_f32 v195, v195
    v_rcp_f32 v222, v222
    v_rcp_f32 v223, v223
    v_rcp_f32 v224, v224
    v_rcp_f32 v225, v225
    v_pk_mul_f32 v[196:197], v[196:197], v[192:193]
    v_pk_mul_f32 v[198:199], v[198:199], v[194:195]
    v_pk_mul_f32 v[226:227], v[226:227], v[222:223]
    v_pk_mul_f32 v[228:229], v[228:229], v[224:225]
    v_cvt_pk_bf16_f32 v204, v196, v197
    v_cvt_pk_bf16_f32 v205, v198, v199
    v_cvt_pk_bf16_f32 v206, v226, v227
    v_cvt_pk_bf16_f32 v207, v228, v229
    s_add_u32 s98, s47, 6144
    buffer_store_dwordx4 v[204:207], v209, s[20:23], s98 offen sc1
    v_pk_mul_f32 v[192:193], v[72:73], v[72:73]
    v_pk_mul_f32 v[194:195], v[74:75], v[74:75]
    v_pk_mul_f32 v[222:223], v[104:105], v[104:105]
    v_pk_mul_f32 v[224:225], v[106:107], v[106:107]
    v_pk_fma_f32 v[192:193], v[192:193], v[208:209], s[84:85] op_sel_hi:[1,0,0]
    v_pk_fma_f32 v[194:195], v[194:195], v[208:209], s[84:85] op_sel_hi:[1,0,0]
    v_pk_fma_f32 v[222:223], v[222:223], v[208:209], s[84:85] op_sel_hi:[1,0,0]
    v_pk_fma_f32 v[224:225], v[224:225], v[208:209], s[84:85] op_sel_hi:[1,0,0]
    v_pk_mul_f32 v[192:193], v[192:193], v[72:73]
    v_pk_mul_f32 v[194:195], v[194:195], v[74:75]
    v_pk_mul_f32 v[222:223], v[222:223], v[104:105]
    v_pk_mul_f32 v[224:225], v[224:225], v[106:107]
    v_exp_f32 v192, v192
    v_exp_f32 v193, v193
    v_exp_f32 v194, v194
    v_exp_f32 v195, v195
    v_exp_f32 v222, v222
    v_exp_f32 v223, v223
    v_exp_f32 v224, v224
    v_exp_f32 v225, v225
    v_pk_mul_f32 v[196:197], v[72:73], v[88:89]
    v_pk_mul_f32 v[198:199], v[74:75], v[90:91]
    v_pk_mul_f32 v[226:227], v[104:105], v[120:121]
    v_pk_mul_f32 v[228:229], v[106:107], v[122:123]
    v_pk_add_f32 v[192:193], v[192:193], 1.0 op_sel_hi:[1,0]
    v_pk_add_f32 v[194:195], v[194:195], 1.0 op_sel_hi:[1,0]
    v_pk_add_f32 v[222:223], v[222:223], 1.0 op_sel_hi:[1,0]
    v_pk_add_f32 v[224:225], v[224:225], 1.0 op_sel_hi:[1,0]
    v_rcp_f32 v192, v192
    v_rcp_f32 v193, v193
    v_rcp_f32 v194, v194
    v_rcp_f32 v195, v195
    v_rcp_f32 v222, v222
    v_rcp_f32 v223, v223
    v_rcp_f32 v224, v224
    v_rcp_f32 v225, v225
    v_pk_mul_f32 v[196:197], v[196:197], v[192:193]
    v_pk_mul_f32 v[198:199], v[198:199], v[194:195]
    v_pk_mul_f32 v[226:227], v[226:227], v[222:223]
    v_pk_mul_f32 v[228:229], v[228:229], v[224:225]
    v_cvt_pk_bf16_f32 v200, v196, v197
    v_cvt_pk_bf16_f32 v201, v198, v199
    v_cvt_pk_bf16_f32 v202, v226, v227
    v_cvt_pk_bf16_f32 v203, v228, v229
    s_add_u32 s97, s48, 6144
    buffer_store_dwordx4 v[200:203], v209, s[20:23], s97 offen sc1
    v_pk_mul_f32 v[192:193], v[76:77], v[76:77]
    v_pk_mul_f32 v[194:195], v[78:79], v[78:79]
    v_pk_mul_f32 v[222:223], v[108:109], v[108:109]
    v_pk_mul_f32 v[224:225], v[110:111], v[110:111]
    v_pk_fma_f32 v[192:193], v[192:193], v[208:209], s[84:85] op_sel_hi:[1,0,0]
    v_pk_fma_f32 v[194:195], v[194:195], v[208:209], s[84:85] op_sel_hi:[1,0,0]
    v_pk_fma_f32 v[222:223], v[222:223], v[208:209], s[84:85] op_sel_hi:[1,0,0]
    v_pk_fma_f32 v[224:225], v[224:225], v[208:209], s[84:85] op_sel_hi:[1,0,0]
    v_pk_mul_f32 v[192:193], v[192:193], v[76:77]
    v_pk_mul_f32 v[194:195], v[194:195], v[78:79]
    v_pk_mul_f32 v[222:223], v[222:223], v[108:109]
    v_pk_mul_f32 v[224:225], v[224:225], v[110:111]
    v_exp_f32 v192, v192
    v_exp_f32 v193, v193
    v_exp_f32 v194, v194
    v_exp_f32 v195, v195
    v_exp_f32 v222, v222
    v_exp_f32 v223, v223
    v_exp_f32 v224, v224
    v_exp_f32 v225, v225
    v_pk_mul_f32 v[196:197], v[76:77], v[92:93]
    v_pk_mul_f32 v[198:199], v[78:79], v[94:95]
    v_pk_mul_f32 v[226:227], v[108:109], v[124:125]
    v_pk_mul_f32 v[228:229], v[110:111], v[126:127]
    v_pk_add_f32 v[192:193], v[192:193], 1.0 op_sel_hi:[1,0]
    v_pk_add_f32 v[194:195], v[194:195], 1.0 op_sel_hi:[1,0]
    v_pk_add_f32 v[222:223], v[222:223], 1.0 op_sel_hi:[1,0]
    v_pk_add_f32 v[224:225], v[224:225], 1.0 op_sel_hi:[1,0]
    v_rcp_f32 v192, v192
    v_rcp_f32 v193, v193
    v_rcp_f32 v194, v194
    v_rcp_f32 v195, v195
    v_rcp_f32 v222, v222
    v_rcp_f32 v223, v223
    v_rcp_f32 v224, v224
    v_rcp_f32 v225, v225
    v_pk_mul_f32 v[196:197], v[196:197], v[192:193]
    v_pk_mul_f32 v[198:199], v[198:199], v[194:195]
    v_pk_mul_f32 v[226:227], v[226:227], v[222:223]
    v_pk_mul_f32 v[228:229], v[228:229], v[224:225]
    v_cvt_pk_bf16_f32 v204, v196, v197
    v_cvt_pk_bf16_f32 v205, v198, v199
    v_cvt_pk_bf16_f32 v206, v226, v227
    v_cvt_pk_bf16_f32 v207, v228, v229
    s_add_u32 s98, s49, 6144
    v_mfma_f32_16x16x32_bf16 v[64:67], v[160:163], a[0:3], 0
    s_waitcnt vmcnt(25) lgkmcnt(10)
    ds_read_b64_tr_b16 v[188:189], v220 offset:62560
    ds_read_b64_tr_b16 v[190:191], v221 offset:1632
    v_mfma_f32_16x16x32_bf16 v[64:67], v[164:167], a[8:11], v[64:67]
    v_mul_f32 v192, v12, v12
    v_fmaak_f32 v192, v192, v208, 0xc0135761
    v_mfma_f32_16x16x32_bf16 v[68:71], v[160:163], a[4:7], 0
    s_waitcnt vmcnt(24)
    v_mul_f32 v192, v192, v12
    v_mul_f32 v196, v12, v28
    v_mfma_f32_16x16x32_bf16 v[68:71], v[164:167], a[12:15], v[68:71]
    s_waitcnt lgkmcnt(10)
    buffer_store_dwordx4 v[204:207], v209, s[20:23], s98 offen sc1
    v_mfma_f32_16x16x32_bf16 v[72:75], v[168:171], a[0:3], 0
    s_add_u32 s98, s49, 4096
    ds_read_b64_tr_b16 v[160:161], v220 offset:53376
    ds_read_b64_tr_b16 v[162:163], v220 offset:57984
    s_waitcnt lgkmcnt(10)
    v_mfma_f32_16x16x32_bf16 v[72:75], v[172:175], a[8:11], v[72:75]
    ds_read_b64_tr_b16 v[164:165], v220 offset:62592
    ds_read_b64_tr_b16 v[166:167], v221 offset:1664
    v_mul_f32 v193, v13, v13
    v_mfma_f32_16x16x32_bf16 v[76:79], v[168:171], a[4:7], 0
    v_exp_f32 v192, v192
    v_mfma_f32_16x16x32_bf16 v[76:79], v[172:175], a[12:15], v[76:79]
    s_waitcnt lgkmcnt(10)
    buffer_load_dwordx4 v235, s[16:19], s92 offen offset:3072 lds
    v_mfma_f32_16x16x32_bf16 v[80:83], v[176:179], a[0:3], 0
    s_add_u32 m0, s42, 4096
    ds_read_b64_tr_b16 v[168:169], v220 offset:53408
    ds_read_b64_tr_b16 v[170:171], v220 offset:58016
    v_add_f32 v192, 1.0, v192
    s_waitcnt lgkmcnt(10)
    v_mfma_f32_16x16x32_bf16 v[80:83], v[180:183], a[8:11], v[80:83]
    ds_read_b64_tr_b16 v[172:173], v220 offset:62624
    ds_read_b64_tr_b16 v[174:175], v221 offset:1696
    v_mfma_f32_16x16x32_bf16 v[84:87], v[176:179], a[4:7], 0
    v_rcp_f32 v192, v192
    v_mfma_f32_16x16x32_bf16 v[84:87], v[180:183], a[12:15], v[84:87]
    s_waitcnt lgkmcnt(10)
    buffer_load_dwordx4 v236, s[16:19], s92 offen lds
    v_mul_f32 v196, v196, v192
    v_mfma_f32_16x16x32_bf16 v[88:91], v[184:187], a[0:3], 0
    s_waitcnt lgkmcnt(8)
    ds_read_b64_tr_b16 v[176:177], v220 offset:53440
    ds_read_b64_tr_b16 v[178:179], v220 offset:58048
    v_mfma_f32_16x16x32_bf16 v[88:91], v[188:191], a[8:11], v[88:91]
    ds_read_b64_tr_b16 v[180:181], v220 offset:62656
    ds_read_b64_tr_b16 v[182:183], v221 offset:1728
    v_mfma_f32_16x16x32_bf16 v[92:95], v[184:187], a[4:7], 0
    v_fmaak_f32 v193, v193, v208, 0xc0135761
    v_mul_f32 v193, v193, v13
    v_mul_f32 v197, v13, v29
    v_mfma_f32_16x16x32_bf16 v[92:95], v[188:191], a[12:15], v[92:95]
    s_waitcnt lgkmcnt(10)
    buffer_load_dwordx4 v237, s[16:19], s92 offen offset:1024 lds
    v_mfma_f32_16x16x32_bf16 v[96:99], v[160:163], a[0:3], 0
    s_waitcnt lgkmcnt(8)
    ds_read_b64_tr_b16 v[184:185], v220 offset:53472
    ds_read_b64_tr_b16 v[186:187], v220 offset:58080
    v_mfma_f32_16x16x32_bf16 v[96:99], v[164:167], a[8:11], v[96:99]
    ds_read_b64_tr_b16 v[188:189], v220 offset:62688
    ds_read_b64_tr_b16 v[190:191], v221 offset:1760
    v_mul_f32 v194, v14, v14
    v_mfma_f32_16x16x32_bf16 v[100:103], v[160:163], a[4:7], 0
    v_exp_f32 v193, v193
    v_mfma_f32_16x16x32_bf16 v[100:103], v[164:167], a[12:15], v[100:103]
    s_waitcnt lgkmcnt(10)
    buffer_load_dwordx4 v238, s[16:19], s92 offen offset:2048 lds
    v_mfma_f32_16x16x32_bf16 v[104:107], v[168:171], a[0:3], 0
    s_waitcnt lgkmcnt(8)
    ds_read_b64_tr_b16 v[160:161], v220 offset:53504
    ds_read_b64_tr_b16 v[162:163], v220 offset:58112
    v_add_f32 v193, 1.0, v193
    v_mfma_f32_16x16x32_bf16 v[104:107], v[172:175], a[8:11], v[104:107]
    ds_read_b64_tr_b16 v[164:165], v220 offset:62720
    ds_read_b64_tr_b16 v[166:167], v221 offset:1792
    v_mfma_f32_16x16x32_bf16 v[108:111], v[168:171], a[4:7], 0
    v_rcp_f32 v193, v193
    v_mfma_f32_16x16x32_bf16 v[108:111], v[172:175], a[12:15], v[108:111]
    s_waitcnt lgkmcnt(10)
    buffer_load_dwordx4 v239, s[16:19], s92 offen offset:3072 lds
    v_mfma_f32_16x16x32_bf16 v[112:115], v[176:179], a[0:3], 0
    s_add_u32 m0, s42, 8192
    ds_read_b64_tr_b16 v[168:169], v221 offset:6144
    ds_read_b64_tr_b16 v[170:171], v221 offset:10752
    v_mul_f32 v197, v197, v193
    s_waitcnt lgkmcnt(10)
    v_mfma_f32_16x16x32_bf16 v[112:115], v[180:183], a[8:11], v[112:115]
    ds_read_b64_tr_b16 v[172:173], v221 offset:15360
    ds_read_b64_tr_b16 v[174:175], v221 offset:19968
    v_mfma_f32_16x16x32_bf16 v[116:119], v[176:179], a[4:7], 0
    v_fmaak_f32 v194, v194, v208, 0xc0135761
    v_mul_f32 v194, v194, v14
    v_mfma_f32_16x16x32_bf16 v[116:119], v[180:183], a[12:15], v[116:119]
    s_waitcnt lgkmcnt(10)
    buffer_load_dwordx4 v240, s[16:19], s92 offen lds
    v_mul_f32 v198, v14, v30
    v_mfma_f32_16x16x32_bf16 v[120:123], v[184:187], a[0:3], 0
    s_waitcnt lgkmcnt(8)
    ds_read_b64_tr_b16 v[176:177], v221 offset:6176
    ds_read_b64_tr_b16 v[178:179], v221 offset:10784
    v_mfma_f32_16x16x32_bf16 v[120:123], v[188:191], a[8:11], v[120:123]
    ds_read_b64_tr_b16 v[180:181], v221 offset:15392
    ds_read_b64_tr_b16 v[182:183], v221 offset:20000
    v_mfma_f32_16x16x32_bf16 v[124:127], v[184:187], a[4:7], 0
    v_exp_f32 v194, v194
    v_mul_f32 v195, v15, v15
    v_mfma_f32_16x16x32_bf16 v[124:127], v[188:191], a[12:15], v[124:127]
    s_waitcnt lgkmcnt(10)
    buffer_load_dwordx4 a[64:67], v209, s[20:23], s99 offen sc1
    v_mfma_f32_16x16x32_bf16 v[128:131], v[160:163], a[0:3], 0
    s_add_u32 s100, s54, 165888
    ds_read_b64_tr_b16 v[184:185], v221 offset:6208
    ds_read_b64_tr_b16 v[186:187], v221 offset:10816
    s_waitcnt lgkmcnt(10)
    v_mfma_f32_16x16x32_bf16 v[128:131], v[164:167], a[8:11], v[128:131]
    ds_read_b64_tr_b16 v[188:189], v221 offset:15424
    ds_read_b64_tr_b16 v[190:191], v221 offset:20032
    v_add_f32 v194, 1.0, v194
    v_mfma_f32_16x16x32_bf16 v[132:135], v[160:163], a[4:7], 0
    v_rcp_f32 v194, v194
    v_mfma_f32_16x16x32_bf16 v[132:135], v[164:167], a[12:15], v[132:135]
    s_waitcnt vmcnt(30) lgkmcnt(10)
    buffer_load_dwordx4 a[68:71], v209, s[20:23], s100 offen sc1
    v_mfma_f32_16x16x32_bf16 v[64:67], v[168:171], a[16:19], v[64:67]
    s_add_u32 s99, s54, 19456
    ds_read_b64_tr_b16 v[160:161], v221 offset:6240
    ds_read_b64_tr_b16 v[162:163], v221 offset:10848
    v_mul_f32 v198, v198, v194
    s_waitcnt vmcnt(28) lgkmcnt(10)
    v_mfma_f32_16x16x32_bf16 v[64:67], v[172:175], a[24:27], v[64:67]
    ds_read_b64_tr_b16 v[164:165], v221 offset:15456
    ds_read_b64_tr_b16 v[166:167], v221 offset:20064
    v_mfma_f32_16x16x32_bf16 v[68:71], v[168:171], a[20:23], v[68:71]
    s_waitcnt vmcnt(27)
    v_fmaak_f32 v195, v195, v208, 0xc0135761
    v_mul_f32 v195, v195, v15
    v_mul_f32 v199, v15, v31
    v_mfma_f32_16x16x32_bf16 v[68:71], v[172:175], a[28:31], v[68:71]
    s_waitcnt lgkmcnt(10)
    buffer_load_dwordx4 a[72:75], v209, s[20:23], s99 offen sc1
    v_mfma_f32_16x16x32_bf16 v[72:75], v[176:179], a[16:19], v[72:75]
    s_add_u32 s100, s54, 166912
    ds_read_b64_tr_b16 v[168:169], v221 offset:6272
    ds_read_b64_tr_b16 v[170:171], v221 offset:10880
    s_waitcnt lgkmcnt(10)
    v_mfma_f32_16x16x32_bf16 v[72:75], v[180:183], a[24:27], v[72:75]
    ds_read_b64_tr_b16 v[172:173], v221 offset:15488
    ds_read_b64_tr_b16 v[174:175], v221 offset:20096
    v_mfma_f32_16x16x32_bf16 v[76:79], v[176:179], a[20:23], v[76:79]
    v_exp_f32 v195, v195
    v_cvt_pk_bf16_f32 v204, v196, v197
    v_mfma_f32_16x16x32_bf16 v[76:79], v[180:183], a[28:31], v[76:79]
    s_waitcnt lgkmcnt(10)
    buffer_load_dwordx4 a[76:79], v209, s[20:23], s100 offen sc1
    v_mfma_f32_16x16x32_bf16 v[80:83], v[184:187], a[16:19], v[80:83]
    s_add_u32 s99, s54, 28672
    ds_read_b64_tr_b16 v[176:177], v221 offset:6304
    ds_read_b64_tr_b16 v[178:179], v221 offset:10912
    v_add_f32 v195, 1.0, v195
    s_waitcnt lgkmcnt(10)
    v_mfma_f32_16x16x32_bf16 v[80:83], v[188:191], a[24:27], v[80:83]
    ds_read_b64_tr_b16 v[180:181], v221 offset:15520
    ds_read_b64_tr_b16 v[182:183], v221 offset:20128
    v_mfma_f32_16x16x32_bf16 v[84:87], v[184:187], a[20:23], v[84:87]
    v_rcp_f32 v195, v195
    v_mfma_f32_16x16x32_bf16 v[84:87], v[188:191], a[28:31], v[84:87]
    s_waitcnt lgkmcnt(10)
    buffer_load_dwordx4 a[80:83], v209, s[20:23], s99 offen sc1
    v_mul_f32 v199, v199, v195
    v_mfma_f32_16x16x32_bf16 v[88:91], v[160:163], a[16:19], v[88:91]
    s_add_u32 s100, s54, 176128
    ds_read_b64_tr_b16 v[184:185], v221 offset:6336
    ds_read_b64_tr_b16 v[186:187], v221 offset:10944
    s_waitcnt lgkmcnt(10)
    v_mfma_f32_16x16x32_bf16 v[88:91], v[164:167], a[24:27], v[88:91]
    ds_read_b64_tr_b16 v[188:189], v221 offset:15552
    ds_read_b64_tr_b16 v[190:191], v221 offset:20160
    v_mfma_f32_16x16x32_bf16 v[92:95], v[160:163], a[20:23], v[92:95]
    v_cvt_pk_bf16_f32 v205, v198, v199
    v_mul_f32 v222, v44, v44
    v_fmaak_f32 v222, v222, v208, 0xc0135761
    v_mfma_f32_16x16x32_bf16 v[92:95], v[164:167], a[28:31], v[92:95]
    s_waitcnt lgkmcnt(10)
    buffer_load_dwordx4 a[84:87], v209, s[20:23], s100 offen sc1
    v_mfma_f32_16x16x32_bf16 v[96:99], v[168:171], a[16:19], v[96:99]
    s_add_u32 s99, s54, 29696
    ds_read_b64_tr_b16 v[160:161], v221 offset:6368
    ds_read_b64_tr_b16 v[162:163], v221 offset:10976
    s_waitcnt lgkmcnt(10)
    v_mfma_f32_16x16x32_bf16 v[96:99], v[172:175], a[24:27], v[96:99]
    ds_read_b64_tr_b16 v[164:165], v221 offset:15584
    ds_read_b64_tr_b16 v[166:167], v221 offset:20192
    v_mul_f32 v222, v222, v44
    v_mfma_f32_16x16x32_bf16 v[100:103], v[168:171], a[20:23], v[100:103]
    v_exp_f32 v222, v222
    v_mfma_f32_16x16x32_bf16 v[100:103], v[172:175], a[28:31], v[100:103]
    s_waitcnt lgkmcnt(10)
    buffer_load_dwordx4 a[88:91], v209, s[20:23], s99 offen sc1
    v_mfma_f32_16x16x32_bf16 v[104:107], v[176:179], a[16:19], v[104:107]
    s_waitcnt lgkmcnt(8)
    ds_read_b64_tr_b16 v[168:169], v221 offset:6400
    ds_read_b64_tr_b16 v[170:171], v221 offset:11008
    v_mul_f32 v226, v44, v60
    v_mfma_f32_16x16x32_bf16 v[104:107], v[180:183], a[24:27], v[104:107]
    s_barrier
    ds_read_b64_tr_b16 v[172:173], v221 offset:15616
    ds_read_b64_tr_b16 v[174:175], v221 offset:20224
    v_mfma_f32_16x16x32_bf16 v[108:111], v[176:179], a[20:23], v[108:111]
    s_add_u32 s100, s54, 177152
    s_add_u32 m0, s42, 36864
    s_add_u32 s93, s52, 73728
    v_mfma_f32_16x16x32_bf16 v[108:111], v[180:183], a[28:31], v[108:111]
    s_waitcnt lgkmcnt(10)
    buffer_load_dwordx4 a[92:95], v209, s[20:23], s100 offen sc1
    v_add_f32 v222, 1.0, v222
    v_mfma_f32_16x16x32_bf16 v[112:115], v[184:187], a[16:19], v[112:115]
    s_add_u32 s99, s54, 2048
    ds_read_b64_tr_b16 v[176:177], v220 offset:16384
    ds_read_b64_tr_b16 v[178:179], v220 offset:20992
    s_waitcnt lgkmcnt(10)
    v_mfma_f32_16x16x32_bf16 v[112:115], v[188:191], a[24:27], v[112:115]
    ds_read_b64_tr_b16 v[180:181], v220 offset:25600
    ds_read_b64_tr_b16 v[182:183], v220 offset:30208
    v_mul_f32 v223, v45, v45
    v_mfma_f32_16x16x32_bf16 v[116:119], v[184:187], a[20:23], v[116:119]
    v_rcp_f32 v222, v222
    v_mfma_f32_16x16x32_bf16 v[116:119], v[188:191], a[28:31], v[116:119]
    s_waitcnt lgkmcnt(10)
    buffer_load_dwordx4 v232, s[16:19], s93 offen lds
    v_mfma_f32_16x16x32_bf16 v[120:123], v[160:163], a[16:19], v[120:123]
    s_waitcnt lgkmcnt(8)
    ds_read_b64_tr_b16 v[184:185], v220 offset:16416
    ds_read_b64_tr_b16 v[186:187], v220 offset:21024
    v_mul_f32 v226, v226, v222
    v_mfma_f32_16x16x32_bf16 v[120:123], v[164:167], a[24:27], v[120:123]
    ds_read_b64_tr_b16 v[188:189], v220 offset:25632
    ds_read_b64_tr_b16 v[190:191], v220 offset:30240
    v_mfma_f32_16x16x32_bf16 v[124:127], v[160:163], a[20:23], v[124:127]
    v_fmaak_f32 v223, v223, v208, 0xc0135761
    v_mul_f32 v223, v223, v45
    v_mul_f32 v227, v45, v61
    v_mfma_f32_16x16x32_bf16 v[124:127], v[164:167], a[28:31], v[124:127]
    s_waitcnt lgkmcnt(10)
    buffer_load_dwordx4 v233, s[16:19], s93 offen offset:1024 lds
    v_mfma_f32_16x16x32_bf16 v[128:131], v[168:171], a[16:19], v[128:131]
    s_waitcnt lgkmcnt(8)
    ds_read_b64_tr_b16 v[160:161], v220 offset:16448
    ds_read_b64_tr_b16 v[162:163], v220 offset:21056
    v_mul_f32 v224, v46, v46
    v_mfma_f32_16x16x32_bf16 v[128:131], v[172:175], a[24:27], v[128:131]
    ds_read_b64_tr_b16 v[164:165], v220 offset:25664
    ds_read_b64_tr_b16 v[166:167], v220 offset:30272
    v_mfma_f32_16x16x32_bf16 v[132:135], v[168:171], a[20:23], v[132:135]
    v_exp_f32 v223, v223
    v_mfma_f32_16x16x32_bf16 v[132:135], v[172:175], a[28:31], v[132:135]
    s_waitcnt vmcnt(34) lgkmcnt(10)
    buffer_load_dwordx4 v234, s[16:19], s93 offen offset:2048 lds
    v_add_f32 v223, 1.0, v223
    v_mfma_f32_16x16x32_bf16 v[64:67], v[176:179], a[32:35], v[64:67]
    s_waitcnt vmcnt(33) lgkmcnt(8)
    ds_read_b64_tr_b16 v[168:169], v220 offset:16480
    ds_read_b64_tr_b16 v[170:171], v220 offset:21088
    v_mfma_f32_16x16x32_bf16 v[64:67], v[180:183], a[40:43], v[64:67]
    ds_read_b64_tr_b16 v[172:173], v220 offset:25696
    ds_read_b64_tr_b16 v[174:175], v220 offset:30304
    v_fmaak_f32 v224, v224, v208, 0xc0135761
    v_mfma_f32_16x16x32_bf16 v[68:71], v[176:179], a[36:39], v[68:71]
    s_waitcnt vmcnt(30)
    v_rcp_f32 v223, v223
    v_mfma_f32_16x16x32_bf16 v[68:71], v[180:183], a[44:47], v[68:71]
    s_waitcnt lgkmcnt(10)
    buffer_load_dwordx4 v235, s[16:19], s93 offen offset:3072 lds
    v_mul_f32 v227, v227, v223
    v_mfma_f32_16x16x32_bf16 v[72:75], v[184:187], a[32:35], v[72:75]
    s_add_u32 m0, s42, 40960
    ds_read_b64_tr_b16 v[176:177], v220 offset:16512
    ds_read_b64_tr_b16 v[178:179], v220 offset:21120
    s_waitcnt lgkmcnt(10)
    v_mfma_f32_16x16x32_bf16 v[72:75], v[188:191], a[40:43], v[72:75]
    ds_read_b64_tr_b16 v[180:181], v220 offset:25728
    ds_read_b64_tr_b16 v[182:183], v220 offset:30336
    v_mfma_f32_16x16x32_bf16 v[76:79], v[184:187], a[36:39], v[76:79]
    v_mul_f32 v224, v224, v46
    v_exp_f32 v224, v224
    v_mfma_f32_16x16x32_bf16 v[76:79], v[188:191], a[44:47], v[76:79]
    s_waitcnt lgkmcnt(10)
    buffer_load_dwordx4 v236, s[16:19], s93 offen lds
    v_mfma_f32_16x16x32_bf16 v[80:83], v[160:163], a[32:35], v[80:83]
    s_waitcnt lgkmcnt(8)
    ds_read_b64_tr_b16 v[184:185], v220 offset:16544
    ds_read_b64_tr_b16 v[186:187], v220 offset:21152
    v_mul_f32 v228, v46, v62
    v_mfma_f32_16x16x32_bf16 v[80:83], v[164:167], a[40:43], v[80:83]
    ds_read_b64_tr_b16 v[188:189], v220 offset:25760
    ds_read_b64_tr_b16 v[190:191], v220 offset:30368
    v_mfma_f32_16x16x32_bf16 v[84:87], v[160:163], a[36:39], v[84:87]
    v_add_f32 v224, 1.0, v224
    v_rcp_f32 v224, v224
    v_mfma_f32_16x16x32_bf16 v[84:87], v[164:167], a[44:47], v[84:87]
    s_waitcnt lgkmcnt(10)
    buffer_load_dwordx4 v237, s[16:19], s93 offen offset:1024 lds
    v_mfma_f32_16x16x32_bf16 v[88:91], v[168:171], a[32:35], v[88:91]
    s_waitcnt lgkmcnt(8)
    ds_read_b64_tr_b16 v[160:161], v220 offset:16576
    ds_read_b64_tr_b16 v[162:163], v220 offset:21184
    v_mul_f32 v228, v228, v224
    v_mfma_f32_16x16x32_bf16 v[88:91], v[172:175], a[40:43], v[88:91]
    ds_read_b64_tr_b16 v[164:165], v220 offset:25792
    ds_read_b64_tr_b16 v[166:167], v220 offset:30400
    v_mfma_f32_16x16x32_bf16 v[92:95], v[168:171], a[36:39], v[92:95]
    v_mul_f32 v225, v47, v47
    v_fmaak_f32 v225, v225, v208, 0xc0135761
    v_mul_f32 v225, v225, v47
    v_mfma_f32_16x16x32_bf16 v[92:95], v[172:175], a[44:47], v[92:95]
    s_waitcnt lgkmcnt(10)
    buffer_load_dwordx4 v238, s[16:19], s93 offen offset:2048 lds
    v_mfma_f32_16x16x32_bf16 v[96:99], v[176:179], a[32:35], v[96:99]
    s_waitcnt lgkmcnt(8)
    ds_read_b64_tr_b16 v[168:169], v220 offset:16608
    ds_read_b64_tr_b16 v[170:171], v220 offset:21216
    v_mfma_f32_16x16x32_bf16 v[96:99], v[180:183], a[40:43], v[96:99]
    ds_read_b64_tr_b16 v[172:173], v220 offset:25824
    ds_read_b64_tr_b16 v[174:175], v220 offset:30432
    v_mul_f32 v229, v47, v63
    v_mfma_f32_16x16x32_bf16 v[100:103], v[176:179], a[36:39], v[100:103]
    v_exp_f32 v225, v225
    v_mfma_f32_16x16x32_bf16 v[100:103], v[180:183], a[44:47], v[100:103]
    s_waitcnt lgkmcnt(10)
    buffer_load_dwordx4 v239, s[16:19], s93 offen offset:3072 lds
    v_add_f32 v225, 1.0, v225
    v_mfma_f32_16x16x32_bf16 v[104:107], v[184:187], a[32:35], v[104:107]
    s_add_u32 m0, s42, 45056
    ds_read_b64_tr_b16 v[176:177], v220 offset:16640
    ds_read_b64_tr_b16 v[178:179], v220 offset:21248
    s_waitcnt lgkmcnt(10)
    v_mfma_f32_16x16x32_bf16 v[104:107], v[188:191], a[40:43], v[104:107]
    ds_read_b64_tr_b16 v[180:181], v220 offset:25856
    ds_read_b64_tr_b16 v[182:183], v220 offset:30464
    v_cvt_pk_bf16_f32 v206, v226, v227
    v_mfma_f32_16x16x32_bf16 v[108:111], v[184:187], a[36:39], v[108:111]
    v_rcp_f32 v225, v225
    v_mfma_f32_16x16x32_bf16 v[108:111], v[188:191], a[44:47], v[108:111]
    s_waitcnt lgkmcnt(10)
    buffer_load_dwordx4 v240, s[16:19], s93 offen lds
    v_mfma_f32_16x16x32_bf16 v[112:115], v[160:163], a[32:35], v[112:115]
    s_waitcnt lgkmcnt(8)
    ds_read_b64_tr_b16 v[184:185], v220 offset:34816
    ds_read_b64_tr_b16 v[186:187], v220 offset:39424
    v_mul_f32 v229, v229, v225
    v_mfma_f32_16x16x32_bf16 v[112:115], v[164:167], a[40:43], v[112:115]
    ds_read_b64_tr_b16 v[188:189], v220 offset:44032
    ds_read_b64_tr_b16 v[190:191], v220 offset:48640
    v_cvt_pk_bf16_f32 v207, v228, v229
    v_mfma_f32_16x16x32_bf16 v[116:119], v[160:163], a[36:39], v[116:119]
    v_mfma_f32_16x16x32_bf16 v[116:119], v[164:167], a[44:47], v[116:119]
    s_waitcnt lgkmcnt(10)
    buffer_store_dwordx4 v[204:207], v209, s[20:23], s98 offen sc1
    v_mfma_f32_16x16x32_bf16 v[120:123], v[168:171], a[32:35], v[120:123]
    s_waitcnt lgkmcnt(8)
    ds_read_b64_tr_b16 v[160:161], v220 offset:34848
    ds_read_b64_tr_b16 v[162:163], v220 offset:39456
    v_mfma_f32_16x16x32_bf16 v[120:123], v[172:175], a[40:43], v[120:123]
    ds_read_b64_tr_b16 v[164:165], v220 offset:44064
    ds_read_b64_tr_b16 v[166:167], v220 offset:48672
    v_mfma_f32_16x16x32_bf16 v[124:127], v[168:171], a[36:39], v[124:127]
    v_mfma_f32_16x16x32_bf16 v[124:127], v[172:175], a[44:47], v[124:127]
    s_waitcnt lgkmcnt(10)
    buffer_load_dwordx4 a[96:99], v209, s[20:23], s99 offen sc1
    v_mfma_f32_16x16x32_bf16 v[128:131], v[176:179], a[32:35], v[128:131]
    s_add_u32 s100, s54, 149504
    ds_read_b64_tr_b16 v[168:169], v220 offset:34880
    ds_read_b64_tr_b16 v[170:171], v220 offset:39488
    s_waitcnt lgkmcnt(10)
    v_mfma_f32_16x16x32_bf16 v[128:131], v[180:183], a[40:43], v[128:131]
    ds_read_b64_tr_b16 v[172:173], v220 offset:44096
    ds_read_b64_tr_b16 v[174:175], v220 offset:48704
    v_mfma_f32_16x16x32_bf16 v[132:135], v[176:179], a[36:39], v[132:135]
    v_mfma_f32_16x16x32_bf16 v[132:135], v[180:183], a[44:47], v[132:135]
    s_waitcnt vmcnt(37) lgkmcnt(10)
    buffer_load_dwordx4 a[100:103], v209, s[20:23], s100 offen sc1
    v_mfma_f32_16x16x32_bf16 v[64:67], v[184:187], a[48:51], v[64:67]
    s_add_u32 s99, s54, 3072
    ds_read_b64_tr_b16 v[176:177], v220 offset:34912
    ds_read_b64_tr_b16 v[178:179], v220 offset:39520
    s_waitcnt vmcnt(36) lgkmcnt(10)
    v_mfma_f32_16x16x32_bf16 v[64:67], v[188:191], a[56:59], v[64:67]
    ds_read_b64_tr_b16 v[180:181], v220 offset:44128
    ds_read_b64_tr_b16 v[182:183], v220 offset:48736
    v_mfma_f32_16x16x32_bf16 v[68:71], v[184:187], a[52:55], v[68:71]
    s_waitcnt vmcnt(33)
    v_mfma_f32_16x16x32_bf16 v[68:71], v[188:191], a[60:63], v[68:71]
    s_waitcnt lgkmcnt(10)
    buffer_load_dwordx4 a[104:107], v209, s[20:23], s99 offen sc1
    v_mfma_f32_16x16x32_bf16 v[72:75], v[160:163], a[48:51], v[72:75]
    s_add_u32 s100, s54, 150528
    ds_read_b64_tr_b16 v[184:185], v220 offset:34944
    ds_read_b64_tr_b16 v[186:187], v220 offset:39552
    s_waitcnt lgkmcnt(10)
    v_mfma_f32_16x16x32_bf16 v[72:75], v[164:167], a[56:59], v[72:75]
    ds_read_b64_tr_b16 v[188:189], v220 offset:44160
    ds_read_b64_tr_b16 v[190:191], v220 offset:48768
    v_mfma_f32_16x16x32_bf16 v[76:79], v[160:163], a[52:55], v[76:79]
    v_mfma_f32_16x16x32_bf16 v[76:79], v[164:167], a[60:63], v[76:79]
    s_waitcnt lgkmcnt(10)
    buffer_load_dwordx4 a[108:111], v209, s[20:23], s100 offen sc1
    v_mfma_f32_16x16x32_bf16 v[80:83], v[168:171], a[48:51], v[80:83]
    s_add_u32 s99, s54, 12288
    ds_read_b64_tr_b16 v[160:161], v220 offset:34976
    ds_read_b64_tr_b16 v[162:163], v220 offset:39584
    s_waitcnt lgkmcnt(10)
    v_mfma_f32_16x16x32_bf16 v[80:83], v[172:175], a[56:59], v[80:83]
    ds_read_b64_tr_b16 v[164:165], v220 offset:44192
    ds_read_b64_tr_b16 v[166:167], v220 offset:48800
    v_mfma_f32_16x16x32_bf16 v[84:87], v[168:171], a[52:55], v[84:87]
    v_mfma_f32_16x16x32_bf16 v[84:87], v[172:175], a[60:63], v[84:87]
    s_waitcnt lgkmcnt(10)
    buffer_load_dwordx4 a[112:115], v209, s[20:23], s99 offen sc1
    v_mfma_f32_16x16x32_bf16 v[88:91], v[176:179], a[48:51], v[88:91]
    s_add_u32 s100, s54, 159744
    ds_read_b64_tr_b16 v[168:169], v220 offset:35008
    ds_read_b64_tr_b16 v[170:171], v220 offset:39616
    s_waitcnt lgkmcnt(10)
    v_mfma_f32_16x16x32_bf16 v[88:91], v[180:183], a[56:59], v[88:91]
    ds_read_b64_tr_b16 v[172:173], v220 offset:44224
    ds_read_b64_tr_b16 v[174:175], v220 offset:48832
    v_mfma_f32_16x16x32_bf16 v[92:95], v[176:179], a[52:55], v[92:95]
    v_mfma_f32_16x16x32_bf16 v[92:95], v[180:183], a[60:63], v[92:95]
    s_waitcnt lgkmcnt(10)
    buffer_load_dwordx4 a[116:119], v209, s[20:23], s100 offen sc1
    v_mfma_f32_16x16x32_bf16 v[96:99], v[184:187], a[48:51], v[96:99]
    s_add_u32 s99, s54, 13312
    ds_read_b64_tr_b16 v[176:177], v220 offset:35040
    ds_read_b64_tr_b16 v[178:179], v220 offset:39648
    s_waitcnt lgkmcnt(10)
    v_mfma_f32_16x16x32_bf16 v[96:99], v[188:191], a[56:59], v[96:99]
    ds_read_b64_tr_b16 v[180:181], v220 offset:44256
    ds_read_b64_tr_b16 v[182:183], v220 offset:48864
    v_mfma_f32_16x16x32_bf16 v[100:103], v[184:187], a[52:55], v[100:103]
    v_mfma_f32_16x16x32_bf16 v[100:103], v[188:191], a[60:63], v[100:103]
    s_waitcnt lgkmcnt(10)
    buffer_load_dwordx4 a[120:123], v209, s[20:23], s99 offen sc1
    v_mfma_f32_16x16x32_bf16 v[104:107], v[160:163], a[48:51], v[104:107]
    s_waitcnt vmcnt(7)
    ds_read_b64_tr_b16 v[184:185], v220 offset:35072
    ds_read_b64_tr_b16 v[186:187], v220 offset:39680
    s_waitcnt lgkmcnt(10)
    v_mfma_f32_16x16x32_bf16 v[104:107], v[164:167], a[56:59], v[104:107]
    s_barrier
    ds_read_b64_tr_b16 v[188:189], v220 offset:44288
    ds_read_b64_tr_b16 v[190:191], v220 offset:48896
    v_mfma_f32_16x16x32_bf16 v[108:111], v[160:163], a[52:55], v[108:111]
    s_add_u32 s100, s54, 160768
    s_add_u32 s74, s55, 4
    v_mov_b32 v242, s74
    v_mfma_f32_16x16x32_bf16 v[108:111], v[164:167], a[60:63], v[108:111]
    s_waitcnt lgkmcnt(10)
    buffer_store_dword v242, v241, s[28:31], 0 offen sc1
    v_mfma_f32_16x16x32_bf16 v[112:115], v[168:171], a[48:51], v[112:115]
    s_waitcnt lgkmcnt(8)
    ds_read_b64_tr_b16 v[160:161], v219 offset:0
    ds_read_b64_tr_b16 v[162:163], v219 offset:4608
    v_mfma_f32_16x16x32_bf16 v[112:115], v[172:175], a[56:59], v[112:115]
    ds_read_b64_tr_b16 v[164:165], v219 offset:9216
    ds_read_b64_tr_b16 v[166:167], v219 offset:13824
    v_mfma_f32_16x16x32_bf16 v[116:119], v[168:171], a[52:55], v[116:119]
    s_add_u32 m0, s42, 118784
    s_add_u32 s92, s52, 737280
    v_mfma_f32_16x16x32_bf16 v[116:119], v[172:175], a[60:63], v[116:119]
    s_waitcnt lgkmcnt(10)
    buffer_store_dword v242, v241, s[28:31], s90 offen sc1
    v_mfma_f32_16x16x32_bf16 v[120:123], v[176:179], a[48:51], v[120:123]
    s_waitcnt lgkmcnt(8)
    ds_read_b64_tr_b16 v[168:169], v219 offset:32
    ds_read_b64_tr_b16 v[170:171], v219 offset:4640
    v_mfma_f32_16x16x32_bf16 v[120:123], v[180:183], a[56:59], v[120:123]
    ds_read_b64_tr_b16 v[172:173], v219 offset:9248
    ds_read_b64_tr_b16 v[174:175], v219 offset:13856
    v_mfma_f32_16x16x32_bf16 v[124:127], v[176:179], a[52:55], v[124:127]
    v_mfma_f32_16x16x32_bf16 v[124:127], v[180:183], a[60:63], v[124:127]
    s_waitcnt lgkmcnt(10)
    buffer_load_dwordx4 a[124:127], v209, s[20:23], s100 offen sc1
    v_mfma_f32_16x16x32_bf16 v[128:131], v[184:187], a[48:51], v[128:131]
    s_add_u32 s99, s54, 20480
    ds_read_b64_tr_b16 v[176:177], v219 offset:64
    ds_read_b64_tr_b16 v[178:179], v219 offset:4672
    s_waitcnt lgkmcnt(10)
    v_mfma_f32_16x16x32_bf16 v[128:131], v[188:191], a[56:59], v[128:131]
    ds_read_b64_tr_b16 v[180:181], v219 offset:9280
    ds_read_b64_tr_b16 v[182:183], v219 offset:13888
    v_mfma_f32_16x16x32_bf16 v[132:135], v[184:187], a[52:55], v[132:135]
    v_mfma_f32_16x16x32_bf16 v[132:135], v[188:191], a[60:63], v[132:135]
    s_waitcnt lgkmcnt(10)
    buffer_load_dwordx4 v232, s[16:19], s92 offen lds
    v_mfma_f32_16x16x32_bf16 v[64:67], v[160:163], a[64:67], v[64:67]
    s_waitcnt lgkmcnt(8)
    ds_read_b64_tr_b16 v[184:185], v219 offset:96
    ds_read_b64_tr_b16 v[186:187], v219 offset:4704
    v_mfma_f32_16x16x32_bf16 v[64:67], v[164:167], a[72:75], v[64:67]
    s_barrier
    ds_read_b64_tr_b16 v[188:189], v219 offset:9312
    ds_read_b64_tr_b16 v[190:191], v219 offset:13920
    v_mfma_f32_16x16x32_bf16 v[68:71], v[160:163], a[68:71], v[68:71]
    v_mfma_f32_16x16x32_bf16 v[68:71], v[164:167], a[76:79], v[68:71]
    s_waitcnt lgkmcnt(10)
    buffer_load_dword v244, v243, s[28:31], 0 offen sc1
    v_mfma_f32_16x16x32_bf16 v[72:75], v[168:171], a[64:67], v[72:75]
    s_waitcnt lgkmcnt(8)
    ds_read_b64_tr_b16 v[160:161], v219 offset:128
    ds_read_b64_tr_b16 v[162:163], v219 offset:4736
    v_mfma_f32_16x16x32_bf16 v[72:75], v[172:175], a[72:75], v[72:75]
    ds_read_b64_tr_b16 v[164:165], v219 offset:9344
    ds_read_b64_tr_b16 v[166:167], v219 offset:13952
    v_mfma_f32_16x16x32_bf16 v[76:79], v[168:171], a[68:71], v[76:79]
    v_mfma_f32_16x16x32_bf16 v[76:79], v[172:175], a[76:79], v[76:79]
    s_waitcnt lgkmcnt(10)
    buffer_load_dwordx4 v233, s[16:19], s92 offen offset:1024 lds
    v_mfma_f32_16x16x32_bf16 v[80:83], v[176:179], a[64:67], v[80:83]
    s_waitcnt lgkmcnt(8)
    ds_read_b64_tr_b16 v[168:169], v219 offset:160
    ds_read_b64_tr_b16 v[170:171], v219 offset:4768
    v_mfma_f32_16x16x32_bf16 v[80:83], v[180:183], a[72:75], v[80:83]
    ds_read_b64_tr_b16 v[172:173], v219 offset:9376
    ds_read_b64_tr_b16 v[174:175], v219 offset:13984
    v_mfma_f32_16x16x32_bf16 v[84:87], v[176:179], a[68:71], v[84:87]
    v_mfma_f32_16x16x32_bf16 v[84:87], v[180:183], a[76:79], v[84:87]
    s_waitcnt lgkmcnt(10)
    buffer_load_dwordx4 v234, s[16:19], s92 offen offset:2048 lds
    v_mfma_f32_16x16x32_bf16 v[88:91], v[184:187], a[64:67], v[88:91]
    s_waitcnt lgkmcnt(8)
    ds_read_b64_tr_b16 v[176:177], v219 offset:192
    ds_read_b64_tr_b16 v[178:179], v219 offset:4800
    v_mfma_f32_16x16x32_bf16 v[88:91], v[188:191], a[72:75], v[88:91]
    ds_read_b64_tr_b16 v[180:181], v219 offset:9408
    ds_read_b64_tr_b16 v[182:183], v219 offset:14016
    v_mfma_f32_16x16x32_bf16 v[92:95], v[184:187], a[68:71], v[92:95]
    v_mfma_f32_16x16x32_bf16 v[92:95], v[188:191], a[76:79], v[92:95]
    s_waitcnt lgkmcnt(10)
    buffer_load_dwordx4 v235, s[16:19], s92 offen offset:3072 lds
    v_mfma_f32_16x16x32_bf16 v[96:99], v[160:163], a[64:67], v[96:99]
    s_add_u32 m0, s42, 122880
    ds_read_b64_tr_b16 v[184:185], v219 offset:224
    ds_read_b64_tr_b16 v[186:187], v219 offset:4832
    s_waitcnt lgkmcnt(10)
    v_mfma_f32_16x16x32_bf16 v[96:99], v[164:167], a[72:75], v[96:99]
    ds_read_b64_tr_b16 v[188:189], v219 offset:9440
    ds_read_b64_tr_b16 v[190:191], v219 offset:14048
    v_mfma_f32_16x16x32_bf16 v[100:103], v[160:163], a[68:71], v[100:103]
    v_mfma_f32_16x16x32_bf16 v[100:103], v[164:167], a[76:79], v[100:103]
    s_waitcnt lgkmcnt(10)
    buffer_load_dwordx4 v236, s[16:19], s92 offen lds
    v_mfma_f32_16x16x32_bf16 v[104:107], v[168:171], a[64:67], v[104:107]
    s_waitcnt lgkmcnt(8)
    ds_read_b64_tr_b16 v[160:161], v219 offset:256
    ds_read_b64_tr_b16 v[162:163], v219 offset:4864
    v_mfma_f32_16x16x32_bf16 v[104:107], v[172:175], a[72:75], v[104:107]
    ds_read_b64_tr_b16 v[164:165], v219 offset:9472
    ds_read_b64_tr_b16 v[166:167], v219 offset:14080
    v_mfma_f32_16x16x32_bf16 v[108:111], v[168:171], a[68:71], v[108:111]
    v_mfma_f32_16x16x32_bf16 v[108:111], v[172:175], a[76:79], v[108:111]
    s_waitcnt lgkmcnt(10)
    buffer_load_dwordx4 v237, s[16:19], s92 offen offset:1024 lds
    v_mfma_f32_16x16x32_bf16 v[112:115], v[176:179], a[64:67], v[112:115]
    s_waitcnt lgkmcnt(8)
    ds_read_b64_tr_b16 v[168:169], v219 offset:18432
    ds_read_b64_tr_b16 v[170:171], v219 offset:23040
    v_mfma_f32_16x16x32_bf16 v[112:115], v[180:183], a[72:75], v[112:115]
    ds_read_b64_tr_b16 v[172:173], v219 offset:27648
    ds_read_b64_tr_b16 v[174:175], v219 offset:32256
    v_mfma_f32_16x16x32_bf16 v[116:119], v[176:179], a[68:71], v[116:119]
    v_mfma_f32_16x16x32_bf16 v[116:119], v[180:183], a[76:79], v[116:119]
    s_waitcnt lgkmcnt(10)
    buffer_load_dwordx4 v238, s[16:19], s92 offen offset:2048 lds
    v_mfma_f32_16x16x32_bf16 v[120:123], v[184:187], a[64:67], v[120:123]
    s_waitcnt lgkmcnt(8)
    ds_read_b64_tr_b16 v[176:177], v219 offset:18464
    ds_read_b64_tr_b16 v[178:179], v219 offset:23072
    v_mfma_f32_16x16x32_bf16 v[120:123], v[188:191], a[72:75], v[120:123]
    ds_read_b64_tr_b16 v[180:181], v219 offset:27680
    ds_read_b64_tr_b16 v[182:183], v219 offset:32288
    v_mfma_f32_16x16x32_bf16 v[124:127], v[184:187], a[68:71], v[124:127]
    v_mfma_f32_16x16x32_bf16 v[124:127], v[188:191], a[76:79], v[124:127]
    s_waitcnt lgkmcnt(10)
    buffer_load_dwordx4 v239, s[16:19], s92 offen offset:3072 lds
    v_mfma_f32_16x16x32_bf16 v[128:131], v[160:163], a[64:67], v[128:131]
    s_add_u32 m0, s42, 126976
    ds_read_b64_tr_b16 v[184:185], v219 offset:18496
    ds_read_b64_tr_b16 v[186:187], v219 offset:23104
    s_waitcnt lgkmcnt(10)
    v_mfma_f32_16x16x32_bf16 v[128:131], v[164:167], a[72:75], v[128:131]
    ds_read_b64_tr_b16 v[188:189], v219 offset:27712
    ds_read_b64_tr_b16 v[190:191], v219 offset:32320
    v_mfma_f32_16x16x32_bf16 v[132:135], v[160:163], a[68:71], v[132:135]
    v_mfma_f32_16x16x32_bf16 v[132:135], v[164:167], a[76:79], v[132:135]
    s_waitcnt lgkmcnt(10)
    buffer_load_dwordx4 v240, s[16:19], s92 offen lds
    v_mfma_f32_16x16x32_bf16 v[64:67], v[168:171], a[80:83], v[64:67]
    s_and_b32 s74, s37, 7
    s_xor_b32 s74, s74, 0
    s_or_b32 s74, s74, s39
    s_xor_b32 s75, s36, 0
    s_or_b32 s74, s74, s75
    s_cmp_eq_u32 s74, 0
    s_cbranch_scc0 LS_backwb0
    buffer_wbl2 sc1
LS_backwb0:
    s_waitcnt lgkmcnt(8)
    v_mfma_f32_16x16x32_bf16 v[64:67], v[172:175], a[88:91], v[64:67]
    ds_read_b64_tr_b16 v[160:161], v219 offset:18528
    ds_read_b64_tr_b16 v[162:163], v219 offset:23136
    v_mfma_f32_16x16x32_bf16 v[68:71], v[168:171], a[84:87], v[68:71]
    ds_read_b64_tr_b16 v[164:165], v219 offset:27744
    ds_read_b64_tr_b16 v[166:167], v219 offset:32352
    v_mfma_f32_16x16x32_bf16 v[68:71], v[172:175], a[92:95], v[68:71]
    s_waitcnt lgkmcnt(10)
    buffer_load_dwordx4 a[128:131], v209, s[20:23], s99 offen sc1
    v_mfma_f32_16x16x32_bf16 v[72:75], v[176:179], a[80:83], v[72:75]
    s_add_u32 s100, s54, 167936
    ds_read_b64_tr_b16 v[168:169], v219 offset:18560
    ds_read_b64_tr_b16 v[170:171], v219 offset:23168
    s_waitcnt lgkmcnt(10)
    v_mfma_f32_16x16x32_bf16 v[72:75], v[180:183], a[88:91], v[72:75]
    s_add_u32 s69, s55, 4
    s_waitcnt vmcnt(9)
    v_subrev_u32 v245, s69, v244
    v_cmp_le_u32 vcc, 8, v245
    s_nop 1
    s_cbranch_vccnz LS_spin2
LS_back2:
    v_mfma_f32_16x16x32_bf16 v[76:79], v[176:179], a[84:87], v[76:79]
    ds_read_b64_tr_b16 v[172:173], v219 offset:27776
    ds_read_b64_tr_b16 v[174:175], v219 offset:32384
    v_mfma_f32_16x16x32_bf16 v[76:79], v[180:183], a[92:95], v[76:79]
    s_waitcnt lgkmcnt(10)
    buffer_load_dwordx4 a[132:135], v209, s[20:23], s100 offen sc1
    v_mfma_f32_16x16x32_bf16 v[80:83], v[184:187], a[80:83], v[80:83]
    s_add_u32 s99, s54, 21504
    ds_read_b64_tr_b16 v[176:177], v219 offset:18592
    ds_read_b64_tr_b16 v[178:179], v219 offset:23200
    s_waitcnt lgkmcnt(10)
    v_mfma_f32_16x16x32_bf16 v[80:83], v[188:191], a[88:91], v[80:83]
    ds_read_b64_tr_b16 v[180:181], v219 offset:27808
    ds_read_b64_tr_b16 v[182:183], v219 offset:32416
    v_mfma_f32_16x16x32_bf16 v[84:87], v[184:187], a[84:87], v[84:87]
    s_add_u32 m0, s42, 81920
    s_add_u32 s93, s52, 147456
    v_mfma_f32_16x16x32_bf16 v[84:87], v[188:191], a[92:95], v[84:87]
    s_waitcnt lgkmcnt(10)
    buffer_load_dwordx4 a[136:139], v209, s[20:23], s99 offen sc1
    v_mfma_f32_16x16x32_bf16 v[88:91], v[160:163], a[80:83], v[88:91]
    s_add_u32 s100, s54, 168960
    ds_read_b64_tr_b16 v[184:185], v219 offset:18624
    ds_read_b64_tr_b16 v[186:187], v219 offset:23232
    s_waitcnt lgkmcnt(10)
    v_mfma_f32_16x16x32_bf16 v[88:91], v[164:167], a[88:91], v[88:91]
    ds_read_b64_tr_b16 v[188:189], v219 offset:27840
    ds_read_b64_tr_b16 v[190:191], v219 offset:32448
    v_mfma_f32_16x16x32_bf16 v[92:95], v[160:163], a[84:87], v[92:95]
    v_mfma_f32_16x16x32_bf16 v[92:95], v[164:167], a[92:95], v[92:95]
    s_waitcnt lgkmcnt(10)
    buffer_load_dwordx4 a[140:143], v209, s[20:23], s100 offen sc1
    v_mfma_f32_16x16x32_bf16 v[96:99], v[168:171], a[80:83], v[96:99]
    s_add_u32 s99, s54, 30720
    ds_read_b64_tr_b16 v[160:161], v219 offset:18656
    ds_read_b64_tr_b16 v[162:163], v219 offset:23264
    s_waitcnt lgkmcnt(10)
    v_mfma_f32_16x16x32_bf16 v[96:99], v[172:175], a[88:91], v[96:99]
    ds_read_b64_tr_b16 v[164:165], v219 offset:27872
    ds_read_b64_tr_b16 v[166:167], v219 offset:32480
    v_mfma_f32_16x16x32_bf16 v[100:103], v[168:171], a[84:87], v[100:103]
    v_mfma_f32_16x16x32_bf16 v[100:103], v[172:175], a[92:95], v[100:103]
    s_waitcnt lgkmcnt(10)
    buffer_load_dwordx4 a[144:147], v209, s[20:23], s99 offen sc1
    v_mfma_f32_16x16x32_bf16 v[104:107], v[176:179], a[80:83], v[104:107]
    s_waitcnt lgkmcnt(8)
    ds_read_b64_tr_b16 v[168:169], v219 offset:18688
    ds_read_b64_tr_b16 v[170:171], v219 offset:23296
    v_mfma_f32_16x16x32_bf16 v[104:107], v[180:183], a[88:91], v[104:107]
    s_barrier
    ds_read_b64_tr_b16 v[172:173], v219 offset:27904
    ds_read_b64_tr_b16 v[174:175], v219 offset:32512
    v_mfma_f32_16x16x32_bf16 v[108:111], v[176:179], a[84:87], v[108:111]
    s_add_u32 s100, s54, 178176
    v_mfma_f32_16x16x32_bf16 v[108:111], v[180:183], a[92:95], v[108:111]
    s_waitcnt lgkmcnt(10)
    buffer_load_dwordx4 a[148:151], v209, s[20:23], s100 offen sc1
    v_mfma_f32_16x16x32_bf16 v[112:115], v[184:187], a[80:83], v[112:115]
    s_add_u32 s99, s54, 31744
    ds_read_b64_tr_b16 v[176:177], v219 offset:36864
    ds_read_b64_tr_b16 v[178:179], v219 offset:41472
    s_waitcnt lgkmcnt(10)
    v_mfma_f32_16x16x32_bf16 v[112:115], v[188:191], a[88:91], v[112:115]
    ds_read_b64_tr_b16 v[180:181], v219 offset:46080
    ds_read_b64_tr_b16 v[182:183], v219 offset:50688
    v_mfma_f32_16x16x32_bf16 v[116:119], v[184:187], a[84:87], v[116:119]
    v_mfma_f32_16x16x32_bf16 v[116:119], v[188:191], a[92:95], v[116:119]
    s_waitcnt lgkmcnt(10)
    buffer_load_dwordx4 a[152:155], v209, s[20:23], s99 offen sc1
    v_mfma_f32_16x16x32_bf16 v[120:123], v[160:163], a[80:83], v[120:123]
    s_add_u32 s100, s54, 179200
    ds_read_b64_tr_b16 v[184:185], v219 offset:36896
    ds_read_b64_tr_b16 v[186:187], v219 offset:41504
    s_waitcnt lgkmcnt(10)
    v_mfma_f32_16x16x32_bf16 v[120:123], v[164:167], a[88:91], v[120:123]
    ds_read_b64_tr_b16 v[188:189], v219 offset:46112
    ds_read_b64_tr_b16 v[190:191], v219 offset:50720
    v_mfma_f32_16x16x32_bf16 v[124:127], v[160:163], a[84:87], v[124:127]
    v_mfma_f32_16x16x32_bf16 v[124:127], v[164:167], a[92:95], v[124:127]
    s_waitcnt lgkmcnt(10)
    buffer_load_dwordx4 a[156:159], v209, s[20:23], s100 offen sc1
    v_mfma_f32_16x16x32_bf16 v[128:131], v[168:171], a[80:83], v[128:131]
    s_add_u32 s99, s54, 4096
    ds_read_b64_tr_b16 v[160:161], v219 offset:36928
    ds_read_b64_tr_b16 v[162:163], v219 offset:41536
    s_waitcnt lgkmcnt(10)
    v_mfma_f32_16x16x32_bf16 v[128:131], v[172:175], a[88:91], v[128:131]
    ds_read_b64_tr_b16 v[164:165], v219 offset:46144
    ds_read_b64_tr_b16 v[166:167], v219 offset:50752
    v_mfma_f32_16x16x32_bf16 v[132:135], v[168:171], a[84:87], v[132:135]
    v_mfma_f32_16x16x32_bf16 v[132:135], v[172:175], a[92:95], v[132:135]
    s_waitcnt lgkmcnt(10)
    buffer_load_dwordx4 v232, s[16:19], s93 offen lds
    v_mfma_f32_16x16x32_bf16 v[64:67], v[176:179], a[96:99], v[64:67]
    s_waitcnt lgkmcnt(8)
    ds_read_b64_tr_b16 v[168:169], v219 offset:36960
    ds_read_b64_tr_b16 v[170:171], v219 offset:41568
    v_mfma_f32_16x16x32_bf16 v[64:67], v[180:183], a[104:107], v[64:67]
    s_barrier
    ds_read_b64_tr_b16 v[172:173], v219 offset:46176
    ds_read_b64_tr_b16 v[174:175], v219 offset:50784
    v_mfma_f32_16x16x32_bf16 v[68:71], v[176:179], a[100:103], v[68:71]
    v_mfma_f32_16x16x32_bf16 v[68:71], v[180:183], a[108:111], v[68:71]
    s_waitcnt lgkmcnt(10)
    buffer_load_dwordx4 v233, s[16:19], s93 offen offset:1024 lds
    v_mfma_f32_16x16x32_bf16 v[72:75], v[184:187], a[96:99], v[72:75]
    s_waitcnt lgkmcnt(8)
    ds_read_b64_tr_b16 v[176:177], v219 offset:36992
    ds_read_b64_tr_b16 v[178:179], v219 offset:41600
    v_mfma_f32_16x16x32_bf16 v[72:75], v[188:191], a[104:107], v[72:75]
    ds_read_b64_tr_b16 v[180:181], v219 offset:46208
    ds_read_b64_tr_b16 v[182:183], v219 offset:50816
    v_mfma_f32_16x16x32_bf16 v[76:79], v[184:187], a[100:103], v[76:79]
    v_mfma_f32_16x16x32_bf16 v[76:79], v[188:191], a[108:111], v[76:79]
    s_waitcnt lgkmcnt(10)
    buffer_load_dwordx4 v234, s[16:19], s93 offen offset:2048 lds
    v_mfma_f32_16x16x32_bf16 v[80:83], v[160:163], a[96:99], v[80:83]
    s_waitcnt lgkmcnt(8)
    ds_read_b64_tr_b16 v[184:185], v219 offset:37024
    ds_read_b64_tr_b16 v[186:187], v219 offset:41632
    v_mfma_f32_16x16x32_bf16 v[80:83], v[164:167], a[104:107], v[80:83]
    ds_read_b64_tr_b16 v[188:189], v219 offset:46240
    ds_read_b64_tr_b16 v[190:191], v219 offset:50848
    v_mfma_f32_16x16x32_bf16 v[84:87], v[160:163], a[100:103], v[84:87]
    v_mfma_f32_16x16x32_bf16 v[84:87], v[164:167], a[108:111], v[84:87]
    s_waitcnt lgkmcnt(10)
    buffer_load_dwordx4 v235, s[16:19], s93 offen offset:3072 lds
    v_mfma_f32_16x16x32_bf16 v[88:91], v[168:171], a[96:99], v[88:91]
    s_add_u32 m0, s42, 86016
    ds_read_b64_tr_b16 v[160:161], v219 offset:37056
    ds_read_b64_tr_b16 v[162:163], v219 offset:41664
    s_waitcnt lgkmcnt(10)
    v_mfma_f32_16x16x32_bf16 v[88:91], v[172:175], a[104:107], v[88:91]
    ds_read_b64_tr_b16 v[164:165], v219 offset:46272
    ds_read_b64_tr_b16 v[166:167], v219 offset:50880
    v_mfma_f32_16x16x32_bf16 v[92:95], v[168:171], a[100:103], v[92:95]
    v_mfma_f32_16x16x32_bf16 v[92:95], v[172:175], a[108:111], v[92:95]
    s_waitcnt lgkmcnt(10)
    buffer_load_dwordx4 v236, s[16:19], s93 offen lds
    v_mfma_f32_16x16x32_bf16 v[96:99], v[176:179], a[96:99], v[96:99]
    s_waitcnt lgkmcnt(8)
    ds_read_b64_tr_b16 v[168:169], v219 offset:37088
    ds_read_b64_tr_b16 v[170:171], v219 offset:41696
    v_mfma_f32_16x16x32_bf16 v[96:99], v[180:183], a[104:107], v[96:99]
    ds_read_b64_tr_b16 v[172:173], v219 offset:46304
    ds_read_b64_tr_b16 v[174:175], v219 offset:50912
    v_mfma_f32_16x16x32_bf16 v[100:103], v[176:179], a[100:103], v[100:103]
    v_mfma_f32_16x16x32_bf16 v[100:103], v[180:183], a[108:111], v[100:103]
    s_waitcnt lgkmcnt(10)
    buffer_load_dwordx4 v237, s[16:19], s93 offen offset:1024 lds
    v_mfma_f32_16x16x32_bf16 v[104:107], v[184:187], a[96:99], v[104:107]
    s_waitcnt lgkmcnt(8)
    ds_read_b64_tr_b16 v[176:177], v219 offset:37120
    ds_read_b64_tr_b16 v[178:179], v219 offset:41728
    v_mfma_f32_16x16x32_bf16 v[104:107], v[188:191], a[104:107], v[104:107]
    ds_read_b64_tr_b16 v[180:181], v219 offset:46336
    ds_read_b64_tr_b16 v[182:183], v219 offset:50944
    v_mfma_f32_16x16x32_bf16 v[108:111], v[184:187], a[100:103], v[108:111]
    v_mfma_f32_16x16x32_bf16 v[108:111], v[188:191], a[108:111], v[108:111]
    s_waitcnt lgkmcnt(10)
    buffer_load_dwordx4 v238, s[16:19], s93 offen offset:2048 lds
    v_mfma_f32_16x16x32_bf16 v[112:115], v[160:163], a[96:99], v[112:115]
    s_waitcnt lgkmcnt(8)
    ds_read_b64_tr_b16 v[184:185], v219 offset:55296
    ds_read_b64_tr_b16 v[186:187], v219 offset:59904
    v_mfma_f32_16x16x32_bf16 v[112:115], v[164:167], a[104:107], v[112:115]
    ds_read_b64_tr_b16 v[188:189], v219 offset:64512
    ds_read_b64_tr_b16 v[190:191], v220 offset:3584
    v_mfma_f32_16x16x32_bf16 v[116:119], v[160:163], a[100:103], v[116:119]
    v_mfma_f32_16x16x32_bf16 v[116:119], v[164:167], a[108:111], v[116:119]
    s_waitcnt lgkmcnt(10)
    buffer_load_dwordx4 v239, s[16:19], s93 offen offset:3072 lds
    v_mfma_f32_16x16x32_bf16 v[120:123], v[168:171], a[96:99], v[120:123]
    s_add_u32 m0, s42, 90112
    ds_read_b64_tr_b16 v[160:161], v219 offset:55328
    ds_read_b64_tr_b16 v[162:163], v219 offset:59936
    s_waitcnt lgkmcnt(10)
    v_mfma_f32_16x16x32_bf16 v[120:123], v[172:175], a[104:107], v[120:123]
    ds_read_b64_tr_b16 v[164:165], v219 offset:64544
    ds_read_b64_tr_b16 v[166:167], v220 offset:3616
    v_mfma_f32_16x16x32_bf16 v[124:127], v[168:171], a[100:103], v[124:127]
    v_mfma_f32_16x16x32_bf16 v[124:127], v[172:175], a[108:111], v[124:127]
    s_waitcnt lgkmcnt(10)
    buffer_load_dwordx4 v240, s[16:19], s93 offen lds
    v_mfma_f32_16x16x32_bf16 v[128:131], v[176:179], a[96:99], v[128:131]
    s_waitcnt lgkmcnt(8)
    ds_read_b64_tr_b16 v[168:169], v219 offset:55360
    ds_read_b64_tr_b16 v[170:171], v219 offset:59968
    v_mfma_f32_16x16x32_bf16 v[128:131], v[180:183], a[104:107], v[128:131]
    ds_read_b64_tr_b16 v[172:173], v219 offset:64576
    ds_read_b64_tr_b16 v[174:175], v220 offset:3648
    v_mfma_f32_16x16x32_bf16 v[132:135], v[176:179], a[100:103], v[132:135]
    s_add_u32 m0, s42, 0
    s_add_u32 s92, s52, 811008
    v_mfma_f32_16x16x32_bf16 v[132:135], v[180:183], a[108:111], v[132:135]
    s_waitcnt lgkmcnt(10)
    buffer_load_dwordx4 a[160:163], v209, s[20:23], s99 offen sc1
    v_mfma_f32_16x16x32_bf16 v[64:67], v[184:187], a[112:115], v[64:67]
    s_add_u32 s100, s54, 151552
    ds_read_b64_tr_b16 v[176:177], v219 offset:55392
    ds_read_b64_tr_b16 v[178:179], v219 offset:60000
    s_waitcnt lgkmcnt(10)
    v_mfma_f32_16x16x32_bf16 v[64:67], v[188:191], a[120:123], v[64:67]
    ds_read_b64_tr_b16 v[180:181], v219 offset:64608
    ds_read_b64_tr_b16 v[182:183], v220 offset:3680
    v_mfma_f32_16x16x32_bf16 v[68:71], v[184:187], a[116:119], v[68:71]
    v_mfma_f32_16x16x32_bf16 v[68:71], v[188:191], a[124:127], v[68:71]
    s_waitcnt lgkmcnt(10)
    buffer_load_dwordx4 a[164:167], v209, s[20:23], s100 offen sc1
    v_mfma_f32_16x16x32_bf16 v[72:75], v[160:163], a[112:115], v[72:75]
    s_add_u32 s99, s54, 5120
    ds_read_b64_tr_b16 v[184:185], v219 offset:55424
    ds_read_b64_tr_b16 v[186:187], v219 offset:60032
    s_waitcnt lgkmcnt(10)
    v_mfma_f32_16x16x32_bf16 v[72:75], v[164:167], a[120:123], v[72:75]
    ds_read_b64_tr_b16 v[188:189], v219 offset:64640
    ds_read_b64_tr_b16 v[190:191], v220 offset:3712
    v_mfma_f32_16x16x32_bf16 v[76:79], v[160:163], a[116:119], v[76:79]
    v_mfma_f32_16x16x32_bf16 v[76:79], v[164:167], a[124:127], v[76:79]
    s_waitcnt lgkmcnt(10)
    buffer_load_dwordx4 a[168:171], v209, s[20:23], s99 offen sc1
    v_mfma_f32_16x16x32_bf16 v[80:83], v[168:171], a[112:115], v[80:83]
    s_add_u32 s100, s54, 152576
    ds_read_b64_tr_b16 v[160:161], v219 offset:55456
    ds_read_b64_tr_b16 v[162:163], v219 offset:60064
    s_waitcnt lgkmcnt(10)
    v_mfma_f32_16x16x32_bf16 v[80:83], v[172:175], a[120:123], v[80:83]
    ds_read_b64_tr_b16 v[164:165], v219 offset:64672
    ds_read_b64_tr_b16 v[166:167], v220 offset:3744
    v_mfma_f32_16x16x32_bf16 v[84:87], v[168:171], a[116:119], v[84:87]
    v_mfma_f32_16x16x32_bf16 v[84:87], v[172:175], a[124:127], v[84:87]
    s_waitcnt lgkmcnt(10)
    buffer_load_dwordx4 a[172:175], v209, s[20:23], s100 offen sc1
    v_mfma_f32_16x16x32_bf16 v[88:91], v[176:179], a[112:115], v[88:91]
    s_add_u32 s99, s54, 14336
    ds_read_b64_tr_b16 v[168:169], v219 offset:55488
    ds_read_b64_tr_b16 v[170:171], v219 offset:60096
    s_waitcnt lgkmcnt(10)
    v_mfma_f32_16x16x32_bf16 v[88:91], v[180:183], a[120:123], v[88:91]
    ds_read_b64_tr_b16 v[172:173], v219 offset:64704
    ds_read_b64_tr_b16 v[174:175], v220 offset:3776
    v_mfma_f32_16x16x32_bf16 v[92:95], v[176:179], a[116:119], v[92:95]
    v_mfma_f32_16x16x32_bf16 v[92:95], v[180:183], a[124:127], v[92:95]
    s_waitcnt lgkmcnt(10)
    buffer_load_dwordx4 a[176:179], v209, s[20:23], s99 offen sc1
    v_mfma_f32_16x16x32_bf16 v[96:99], v[184:187], a[112:115], v[96:99]
    s_add_u32 s100, s54, 161792
    ds_read_b64_tr_b16 v[176:177], v219 offset:55520
    ds_read_b64_tr_b16 v[178:179], v219 offset:60128
    s_waitcnt lgkmcnt(10)
    v_mfma_f32_16x16x32_bf16 v[96:99], v[188:191], a[120:123], v[96:99]
    ds_read_b64_tr_b16 v[180:181], v219 offset:64736
    ds_read_b64_tr_b16 v[182:183], v220 offset:3808
    v_mfma_f32_16x16x32_bf16 v[100:103], v[184:187], a[116:119], v[100:103]
    v_mfma_f32_16x16x32_bf16 v[100:103], v[188:191], a[124:127], v[100:103]
    s_waitcnt lgkmcnt(10)
    buffer_load_dwordx4 a[180:183], v209, s[20:23], s100 offen sc1
    v_mfma_f32_16x16x32_bf16 v[104:107], v[160:163], a[112:115], v[104:107]
    s_waitcnt vmcnt(23)
    ds_read_b64_tr_b16 v[184:185], v219 offset:55552
    ds_read_b64_tr_b16 v[186:187], v219 offset:60160
    s_waitcnt lgkmcnt(10)
    v_mfma_f32_16x16x32_bf16 v[104:107], v[164:167], a[120:123], v[104:107]
    s_barrier
    ds_read_b64_tr_b16 v[188:189], v219 offset:64768
    ds_read_b64_tr_b16 v[190:191], v220 offset:3840
    v_mfma_f32_16x16x32_bf16 v[108:111], v[160:163], a[116:119], v[108:111]
    s_add_u32 s99, s54, 15360
    v_mfma_f32_16x16x32_bf16 v[108:111], v[164:167], a[124:127], v[108:111]
    s_waitcnt lgkmcnt(10)
    buffer_load_dwordx4 a[184:187], v209, s[20:23], s99 offen sc1
    v_mfma_f32_16x16x32_bf16 v[112:115], v[168:171], a[112:115], v[112:115]
    s_add_u32 s100, s54, 162816
    ds_read_b64_tr_b16 v[160:161], v220 offset:53248
    ds_read_b64_tr_b16 v[162:163], v220 offset:57856
    s_waitcnt lgkmcnt(10)
    v_mfma_f32_16x16x32_bf16 v[112:115], v[172:175], a[120:123], v[112:115]
    ds_read_b64_tr_b16 v[164:165], v220 offset:62464
    ds_read_b64_tr_b16 v[166:167], v221 offset:1536
    v_mfma_f32_16x16x32_bf16 v[116:119], v[168:171], a[116:119], v[116:119]
    v_mfma_f32_16x16x32_bf16 v[116:119], v[172:175], a[124:127], v[116:119]
    s_waitcnt lgkmcnt(10)
    buffer_load_dwordx4 a[188:191], v209, s[20:23], s100 offen sc1
    v_mfma_f32_16x16x32_bf16 v[120:123], v[176:179], a[112:115], v[120:123]
    s_add_u32 s99, s54, 22528
    ds_read_b64_tr_b16 v[168:169], v220 offset:53280
    ds_read_b64_tr_b16 v[170:171], v220 offset:57888
    s_waitcnt lgkmcnt(10)
    v_mfma_f32_16x16x32_bf16 v[120:123], v[180:183], a[120:123], v[120:123]
    ds_read_b64_tr_b16 v[172:173], v220 offset:62496
    ds_read_b64_tr_b16 v[174:175], v221 offset:1568
    v_mfma_f32_16x16x32_bf16 v[124:127], v[176:179], a[116:119], v[124:127]
    v_mfma_f32_16x16x32_bf16 v[124:127], v[180:183], a[124:127], v[124:127]
    s_waitcnt lgkmcnt(10)
    buffer_load_dwordx4 v232, s[16:19], s92 offen lds
    v_mfma_f32_16x16x32_bf16 v[128:131], v[184:187], a[112:115], v[128:131]
    s_waitcnt lgkmcnt(8)
    ds_read_b64_tr_b16 v[176:177], v220 offset:53312
    ds_read_b64_tr_b16 v[178:179], v220 offset:57920
    v_mfma_f32_16x16x32_bf16 v[128:131], v[188:191], a[120:123], v[128:131]
    ds_read_b64_tr_b16 v[180:181], v220 offset:62528
    ds_read_b64_tr_b16 v[182:183], v221 offset:1600
    v_mfma_f32_16x16x32_bf16 v[132:135], v[184:187], a[116:119], v[132:135]
    v_mfma_f32_16x16x32_bf16 v[132:135], v[188:191], a[124:127], v[132:135]
    s_waitcnt vmcnt(25) lgkmcnt(10)
    buffer_load_dwordx4 v233, s[16:19], s92 offen offset:1024 lds
    v_mfma_f32_16x16x32_bf16 v[64:67], v[160:163], a[128:131], v[64:67]
    s_waitcnt vmcnt(24) lgkmcnt(8)
    ds_read_b64_tr_b16 v[184:185], v220 offset:53344
    ds_read_b64_tr_b16 v[186:187], v220 offset:57952
    v_mfma_f32_16x16x32_bf16 v[64:67], v[164:167], a[136:139], v[64:67]
    s_barrier
    ds_read_b64_tr_b16 v[188:189], v220 offset:62560
    ds_read_b64_tr_b16 v[190:191], v221 offset:1632
    v_mfma_f32_16x16x32_bf16 v[68:71], v[160:163], a[132:135], v[68:71]
    s_waitcnt vmcnt(23)
    v_mfma_f32_16x16x32_bf16 v[68:71], v[164:167], a[140:143], v[68:71]
    s_waitcnt lgkmcnt(10)
    buffer_load_dwordx4 v234, s[16:19], s92 offen offset:2048 lds
    v_mfma_f32_16x16x32_bf16 v[72:75], v[168:171], a[128:131], v[72:75]
    s_waitcnt lgkmcnt(8)
    ds_read_b64_tr_b16 v[160:161], v220 offset:53376
    ds_read_b64_tr_b16 v[162:163], v220 offset:57984
    v_mfma_f32_16x16x32_bf16 v[72:75], v[172:175], a[136:139], v[72:75]
    ds_read_b64_tr_b16 v[164:165], v220 offset:62592
    ds_read_b64_tr_b16 v[166:167], v221 offset:1664
    v_mfma_f32_16x16x32_bf16 v[76:79], v[168:171], a[132:135], v[76:79]
    v_mfma_f32_16x16x32_bf16 v[76:79], v[172:175], a[140:143], v[76:79]
    s_waitcnt lgkmcnt(10)
    buffer_load_dwordx4 v235, s[16:19], s92 offen offset:3072 lds
    v_mfma_f32_16x16x32_bf16 v[80:83], v[176:179], a[128:131], v[80:83]
    s_add_u32 m0, s42, 4096
    ds_read_b64_tr_b16 v[168:169], v220 offset:53408
    ds_read_b64_tr_b16 v[170:171], v220 offset:58016
    s_waitcnt lgkmcnt(10)
    v_mfma_f32_16x16x32_bf16 v[80:83], v[180:183], a[136:139], v[80:83]
    ds_read_b64_tr_b16 v[172:173], v220 offset:62624
    ds_read_b64_tr_b16 v[174:175], v221 offset:1696
    v_mfma_f32_16x16x32_bf16 v[84:87], v[176:179], a[132:135], v[84:87]
    v_mfma_f32_16x16x32_bf16 v[84:87], v[180:183], a[140:143], v[84:87]
    s_waitcnt lgkmcnt(10)
    buffer_load_dwordx4 v236, s[16:19], s92 offen lds
    v_mfma_f32_16x16x32_bf16 v[88:91], v[184:187], a[128:131], v[88:91]
    s_waitcnt lgkmcnt(8)
    ds_read_b64_tr_b16 v[176:177], v220 offset:53440
    ds_read_b64_tr_b16 v[178:179], v220 offset:58048
    v_mfma_f32_16x16x32_bf16 v[88:91], v[188:191], a[136:139], v[88:91]
    ds_read_b64_tr_b16 v[180:181], v220 offset:62656
    ds_read_b64_tr_b16 v[182:183], v221 offset:1728
    v_mfma_f32_16x16x32_bf16 v[92:95], v[184:187], a[132:135], v[92:95]
    v_mfma_f32_16x16x32_bf16 v[92:95], v[188:191], a[140:143], v[92:95]
    s_waitcnt lgkmcnt(10)
    buffer_load_dwordx4 v237, s[16:19], s92 offen offset:1024 lds
    v_mfma_f32_16x16x32_bf16 v[96:99], v[160:163], a[128:131], v[96:99]
    s_waitcnt lgkmcnt(8)
    ds_read_b64_tr_b16 v[184:185], v220 offset:53472
    ds_read_b64_tr_b16 v[186:187], v220 offset:58080
    v_mfma_f32_16x16x32_bf16 v[96:99], v[164:167], a[136:139], v[96:99]
    ds_read_b64_tr_b16 v[188:189], v220 offset:62688
    ds_read_b64_tr_b16 v[190:191], v221 offset:1760
    v_mfma_f32_16x16x32_bf16 v[100:103], v[160:163], a[132:135], v[100:103]
    v_mfma_f32_16x16x32_bf16 v[100:103], v[164:167], a[140:143], v[100:103]
    s_waitcnt lgkmcnt(10)
    buffer_load_dwordx4 v238, s[16:19], s92 offen offset:2048 lds
    v_mfma_f32_16x16x32_bf16 v[104:107], v[168:171], a[128:131], v[104:107]
    s_waitcnt lgkmcnt(8)
    ds_read_b64_tr_b16 v[160:161], v220 offset:53504
    ds_read_b64_tr_b16 v[162:163], v220 offset:58112
    v_mfma_f32_16x16x32_bf16 v[104:107], v[172:175], a[136:139], v[104:107]
    ds_read_b64_tr_b16 v[164:165], v220 offset:62720
    ds_read_b64_tr_b16 v[166:167], v221 offset:1792
    v_mfma_f32_16x16x32_bf16 v[108:111], v[168:171], a[132:135], v[108:111]
    v_mfma_f32_16x16x32_bf16 v[108:111], v[172:175], a[140:143], v[108:111]
    s_waitcnt lgkmcnt(10)
    buffer_load_dwordx4 v239, s[16:19], s92 offen offset:3072 lds
    v_mfma_f32_16x16x32_bf16 v[112:115], v[176:179], a[128:131], v[112:115]
    s_add_u32 m0, s42, 8192
    ds_read_b64_tr_b16 v[168:169], v221 offset:6144
    ds_read_b64_tr_b16 v[170:171], v221 offset:10752
    s_waitcnt lgkmcnt(10)
    v_mfma_f32_16x16x32_bf16 v[112:115], v[180:183], a[136:139], v[112:115]
    ds_read_b64_tr_b16 v[172:173], v221 offset:15360
    ds_read_b64_tr_b16 v[174:175], v221 offset:19968
    v_mfma_f32_16x16x32_bf16 v[116:119], v[176:179], a[132:135], v[116:119]
    v_mfma_f32_16x16x32_bf16 v[116:119], v[180:183], a[140:143], v[116:119]
    s_waitcnt lgkmcnt(10)
    buffer_load_dwordx4 v240, s[16:19], s92 offen lds
    v_mfma_f32_16x16x32_bf16 v[120:123], v[184:187], a[128:131], v[120:123]
    s_waitcnt lgkmcnt(8)
    ds_read_b64_tr_b16 v[176:177], v221 offset:6176
    ds_read_b64_tr_b16 v[178:179], v221 offset:10784
    v_mfma_f32_16x16x32_bf16 v[120:123], v[188:191], a[136:139], v[120:123]
    ds_read_b64_tr_b16 v[180:181], v221 offset:15392
    ds_read_b64_tr_b16 v[182:183], v221 offset:20000
    v_mfma_f32_16x16x32_bf16 v[124:127], v[184:187], a[132:135], v[124:127]
    s_add_u32 m0, s42, 36864
    s_add_u32 s93, s52, 221184
    v_mfma_f32_16x16x32_bf16 v[124:127], v[188:191], a[140:143], v[124:127]
    s_waitcnt lgkmcnt(10)
    buffer_load_dwordx4 a[192:195], v209, s[20:23], s99 offen sc1
    v_mfma_f32_16x16x32_bf16 v[128:131], v[160:163], a[128:131], v[128:131]
    s_add_u32 s100, s54, 169984
    ds_read_b64_tr_b16 v[184:185], v221 offset:6208
    ds_read_b64_tr_b16 v[186:187], v221 offset:10816
    s_waitcnt lgkmcnt(10)
    v_mfma_f32_16x16x32_bf16 v[128:131], v[164:167], a[136:139], v[128:131]
    ds_read_b64_tr_b16 v[188:189], v221 offset:15424
    ds_read_b64_tr_b16 v[190:191], v221 offset:20032
    v_mfma_f32_16x16x32_bf16 v[132:135], v[160:163], a[132:135], v[132:135]
    v_mfma_f32_16x16x32_bf16 v[132:135], v[164:167], a[140:143], v[132:135]
    s_waitcnt vmcnt(30) lgkmcnt(10)
    buffer_load_dwordx4 a[196:199], v209, s[20:23], s100 offen sc1
    v_mfma_f32_16x16x32_bf16 v[64:67], v[168:171], a[144:147], v[64:67]
    s_add_u32 s99, s54, 23552
    ds_read_b64_tr_b16 v[160:161], v221 offset:6240
    ds_read_b64_tr_b16 v[162:163], v221 offset:10848
    s_waitcnt vmcnt(29) lgkmcnt(10)
    v_mfma_f32_16x16x32_bf16 v[64:67], v[172:175], a[152:155], v[64:67]
    ds_read_b64_tr_b16 v[164:165], v221 offset:15456
    ds_read_b64_tr_b16 v[166:167], v221 offset:20064
    v_mfma_f32_16x16x32_bf16 v[68:71], v[168:171], a[148:151], v[68:71]
    s_waitcnt vmcnt(28)
    v_mfma_f32_16x16x32_bf16 v[68:71], v[172:175], a[156:159], v[68:71]
    s_waitcnt lgkmcnt(10)
    buffer_load_dwordx4 a[200:203], v209, s[20:23], s99 offen sc1
    v_mfma_f32_16x16x32_bf16 v[72:75], v[176:179], a[144:147], v[72:75]
    s_add_u32 s100, s54, 171008
    ds_read_b64_tr_b16 v[168:169], v221 offset:6272
    ds_read_b64_tr_b16 v[170:171], v221 offset:10880
    s_waitcnt lgkmcnt(10)
    v_mfma_f32_16x16x32_bf16 v[72:75], v[180:183], a[152:155], v[72:75]
    ds_read_b64_tr_b16 v[172:173], v221 offset:15488
    ds_read_b64_tr_b16 v[174:175], v221 offset:20096
    v_mfma_f32_16x16x32_bf16 v[76:79], v[176:179], a[148:151], v[76:79]
    v_mfma_f32_16x16x32_bf16 v[76:79], v[180:183], a[156:159], v[76:79]
    s_waitcnt lgkmcnt(10)
    buffer_load_dwordx4 a[204:207], v209, s[20:23], s100 offen sc1
    v_mfma_f32_16x16x32_bf16 v[80:83], v[184:187], a[144:147], v[80:83]
    s_add_u32 s99, s54, 32768
    ds_read_b64_tr_b16 v[176:177], v221 offset:6304
    ds_read_b64_tr_b16 v[178:179], v221 offset:10912
    s_waitcnt lgkmcnt(10)
    v_mfma_f32_16x16x32_bf16 v[80:83], v[188:191], a[152:155], v[80:83]
    ds_read_b64_tr_b16 v[180:181], v221 offset:15520
    ds_read_b64_tr_b16 v[182:183], v221 offset:20128
    v_mfma_f32_16x16x32_bf16 v[84:87], v[184:187], a[148:151], v[84:87]
    v_mfma_f32_16x16x32_bf16 v[84:87], v[188:191], a[156:159], v[84:87]
    s_waitcnt lgkmcnt(10)
    buffer_load_dwordx4 a[208:211], v209, s[20:23], s99 offen sc1
    v_mfma_f32_16x16x32_bf16 v[88:91], v[160:163], a[144:147], v[88:91]
    s_add_u32 s100, s54, 180224
    ds_read_b64_tr_b16 v[184:185], v221 offset:6336
    ds_read_b64_tr_b16 v[186:187], v221 offset:10944
    s_waitcnt lgkmcnt(10)
    v_mfma_f32_16x16x32_bf16 v[88:91], v[164:167], a[152:155], v[88:91]
    ds_read_b64_tr_b16 v[188:189], v221 offset:15552
    ds_read_b64_tr_b16 v[190:191], v221 offset:20160
    v_mfma_f32_16x16x32_bf16 v[92:95], v[160:163], a[148:151], v[92:95]
    v_mfma_f32_16x16x32_bf16 v[92:95], v[164:167], a[156:159], v[92:95]
    s_waitcnt lgkmcnt(10)
    buffer_load_dwordx4 a[212:215], v209, s[20:23], s100 offen sc1
    v_mfma_f32_16x16x32_bf16 v[96:99], v[168:171], a[144:147], v[96:99]
    s_add_u32 s99, s54, 33792
    ds_read_b64_tr_b16 v[160:161], v221 offset:6368
    ds_read_b64_tr_b16 v[162:163], v221 offset:10976
    s_waitcnt lgkmcnt(10)
    v_mfma_f32_16x16x32_bf16 v[96:99], v[172:175], a[152:155], v[96:99]
    ds_read_b64_tr_b16 v[164:165], v221 offset:15584
    ds_read_b64_tr_b16 v[166:167], v221 offset:20192
    v_mfma_f32_16x16x32_bf16 v[100:103], v[168:171], a[148:151], v[100:103]
    v_mfma_f32_16x16x32_bf16 v[100:103], v[172:175], a[156:159], v[100:103]
    s_waitcnt lgkmcnt(10)
    buffer_load_dwordx4 a[216:219], v209, s[20:23], s99 offen sc1
    v_mfma_f32_16x16x32_bf16 v[104:107], v[176:179], a[144:147], v[104:107]
    s_waitcnt vmcnt(24)
    ds_read_b64_tr_b16 v[168:169], v221 offset:6400
    ds_read_b64_tr_b16 v[170:171], v221 offset:11008
    s_waitcnt lgkmcnt(10)
    v_mfma_f32_16x16x32_bf16 v[104:107], v[180:183], a[152:155], v[104:107]
    s_barrier
    ds_read_b64_tr_b16 v[172:173], v221 offset:15616
    ds_read_b64_tr_b16 v[174:175], v221 offset:20224
    v_mfma_f32_16x16x32_bf16 v[108:111], v[176:179], a[148:151], v[108:111]
    s_add_u32 s100, s54, 181248
    v_mfma_f32_16x16x32_bf16 v[108:111], v[180:183], a[156:159], v[108:111]
    s_waitcnt lgkmcnt(10)
    buffer_load_dwordx4 a[220:223], v209, s[20:23], s100 offen sc1
    v_mfma_f32_16x16x32_bf16 v[112:115], v[184:187], a[144:147], v[112:115]
    s_add_u32 s99, s54, 6144
    ds_read_b64_tr_b16 v[176:177], v220 offset:16448
    ds_read_b64_tr_b16 v[178:179], v220 offset:21056
    s_waitcnt lgkmcnt(10)
    v_mfma_f32_16x16x32_bf16 v[112:115], v[188:191], a[152:155], v[112:115]
    ds_read_b64_tr_b16 v[180:181], v220 offset:25664
    ds_read_b64_tr_b16 v[182:183], v220 offset:30272
    v_mfma_f32_16x16x32_bf16 v[116:119], v[184:187], a[148:151], v[116:119]
    v_mfma_f32_16x16x32_bf16 v[116:119], v[188:191], a[156:159], v[116:119]
    s_waitcnt lgkmcnt(10)
    buffer_load_dwordx4 v232, s[16:19], s93 offen lds
    v_mfma_f32_16x16x32_bf16 v[120:123], v[160:163], a[144:147], v[120:123]
    s_waitcnt lgkmcnt(8)
    ds_read_b64_tr_b16 v[184:185], v220 offset:16480
    ds_read_b64_tr_b16 v[186:187], v220 offset:21088
    v_mfma_f32_16x16x32_bf16 v[120:123], v[164:167], a[152:155], v[120:123]
    ds_read_b64_tr_b16 v[188:189], v220 offset:25696
    ds_read_b64_tr_b16 v[190:191], v220 offset:30304
    v_mfma_f32_16x16x32_bf16 v[124:127], v[160:163], a[148:151], v[124:127]
    v_mfma_f32_16x16x32_bf16 v[124:127], v[164:167], a[156:159], v[124:127]
    s_waitcnt lgkmcnt(10)
    buffer_load_dwordx4 v233, s[16:19], s93 offen offset:1024 lds
    v_mfma_f32_16x16x32_bf16 v[128:131], v[168:171], a[144:147], v[128:131]
    s_waitcnt lgkmcnt(8)
    ds_read_b64_tr_b16 v[160:161], v220 offset:16512
    ds_read_b64_tr_b16 v[162:163], v220 offset:21120
    v_mfma_f32_16x16x32_bf16 v[128:131], v[172:175], a[152:155], v[128:131]
    ds_read_b64_tr_b16 v[164:165], v220 offset:25728
    ds_read_b64_tr_b16 v[166:167], v220 offset:30336
    v_mfma_f32_16x16x32_bf16 v[132:135], v[168:171], a[148:151], v[132:135]
    v_mfma_f32_16x16x32_bf16 v[132:135], v[172:175], a[156:159], v[132:135]
    s_waitcnt vmcnt(26) lgkmcnt(10)
    buffer_load_dwordx4 v234, s[16:19], s93 offen offset:2048 lds
    v_mfma_f32_16x16x32_bf16 v[80:83], v[176:179], a[160:163], v[80:83]
    s_waitcnt vmcnt(25) lgkmcnt(8)
    ds_read_b64_tr_b16 v[168:169], v220 offset:16544
    ds_read_b64_tr_b16 v[170:171], v220 offset:21152
    v_mfma_f32_16x16x32_bf16 v[80:83], v[180:183], a[168:171], v[80:83]
    s_barrier
    ds_read_b64_tr_b16 v[172:173], v220 offset:25760
    ds_read_b64_tr_b16 v[174:175], v220 offset:30368
    v_mfma_f32_16x16x32_bf16 v[84:87], v[176:179], a[164:167], v[84:87]
    s_waitcnt vmcnt(24)
    v_mfma_f32_16x16x32_bf16 v[84:87], v[180:183], a[172:175], v[84:87]
    s_waitcnt lgkmcnt(10)
    buffer_load_dwordx4 v235, s[16:19], s93 offen offset:3072 lds
    v_mfma_f32_16x16x32_bf16 v[88:91], v[184:187], a[160:163], v[88:91]
    s_add_u32 m0, s42, 40960
    ds_read_b64_tr_b16 v[176:177], v220 offset:16576
    ds_read_b64_tr_b16 v[178:179], v220 offset:21184
    s_waitcnt lgkmcnt(10)
    v_mfma_f32_16x16x32_bf16 v[88:91], v[188:191], a[168:171], v[88:91]
    ds_read_b64_tr_b16 v[180:181], v220 offset:25792
    ds_read_b64_tr_b16 v[182:183], v220 offset:30400
    v_mfma_f32_16x16x32_bf16 v[92:95], v[184:187], a[164:167], v[92:95]
    v_mfma_f32_16x16x32_bf16 v[92:95], v[188:191], a[172:175], v[92:95]
    s_waitcnt lgkmcnt(10)
    buffer_load_dwordx4 v236, s[16:19], s93 offen lds
    v_mfma_f32_16x16x32_bf16 v[96:99], v[160:163], a[160:163], v[96:99]
    s_waitcnt lgkmcnt(8)
    ds_read_b64_tr_b16 v[184:185], v220 offset:16608
    ds_read_b64_tr_b16 v[186:187], v220 offset:21216
    v_mfma_f32_16x16x32_bf16 v[96:99], v[164:167], a[168:171], v[96:99]
    ds_read_b64_tr_b16 v[188:189], v220 offset:25824
    ds_read_b64_tr_b16 v[190:191], v220 offset:30432
    v_mfma_f32_16x16x32_bf16 v[100:103], v[160:163], a[164:167], v[100:103]
    v_mfma_f32_16x16x32_bf16 v[100:103], v[164:167], a[172:175], v[100:103]
    s_waitcnt lgkmcnt(10)
    buffer_load_dwordx4 v237, s[16:19], s93 offen offset:1024 lds
    v_mfma_f32_16x16x32_bf16 v[104:107], v[168:171], a[160:163], v[104:107]
    s_waitcnt lgkmcnt(8)
    ds_read_b64_tr_b16 v[160:161], v220 offset:16640
    ds_read_b64_tr_b16 v[162:163], v220 offset:21248
    v_mfma_f32_16x16x32_bf16 v[104:107], v[172:175], a[168:171], v[104:107]
    ds_read_b64_tr_b16 v[164:165], v220 offset:25856
    ds_read_b64_tr_b16 v[166:167], v220 offset:30464
    v_mfma_f32_16x16x32_bf16 v[108:111], v[168:171], a[164:167], v[108:111]
    v_mfma_f32_16x16x32_bf16 v[108:111], v[172:175], a[172:175], v[108:111]
    s_waitcnt lgkmcnt(10)
    buffer_load_dwordx4 v238, s[16:19], s93 offen offset:2048 lds
    v_mfma_f32_16x16x32_bf16 v[112:115], v[176:179], a[160:163], v[112:115]
    s_waitcnt lgkmcnt(8)
    ds_read_b64_tr_b16 v[168:169], v220 offset:34880
    ds_read_b64_tr_b16 v[170:171], v220 offset:39488
    v_mfma_f32_16x16x32_bf16 v[112:115], v[180:183], a[168:171], v[112:115]
    ds_read_b64_tr_b16 v[172:173], v220 offset:44096
    ds_read_b64_tr_b16 v[174:175], v220 offset:48704
    v_mfma_f32_16x16x32_bf16 v[116:119], v[176:179], a[164:167], v[116:119]
    v_mfma_f32_16x16x32_bf16 v[116:119], v[180:183], a[172:175], v[116:119]
    s_waitcnt lgkmcnt(10)
    buffer_load_dwordx4 v239, s[16:19], s93 offen offset:3072 lds
    v_mfma_f32_16x16x32_bf16 v[120:123], v[184:187], a[160:163], v[120:123]
    s_add_u32 m0, s42, 45056
    ds_read_b64_tr_b16 v[176:177], v220 offset:34912
    ds_read_b64_tr_b16 v[178:179], v220 offset:39520
    s_waitcnt lgkmcnt(10)
    v_mfma_f32_16x16x32_bf16 v[120:123], v[188:191], a[168:171], v[120:123]
    ds_read_b64_tr_b16 v[180:181], v220 offset:44128
    ds_read_b64_tr_b16 v[182:183], v220 offset:48736
    v_mfma_f32_16x16x32_bf16 v[124:127], v[184:187], a[164:167], v[124:127]
    v_mfma_f32_16x16x32_bf16 v[124:127], v[188:191], a[172:175], v[124:127]
    s_waitcnt lgkmcnt(10)
    buffer_load_dwordx4 v240, s[16:19], s93 offen lds
    v_mfma_f32_16x16x32_bf16 v[128:131], v[160:163], a[160:163], v[128:131]
    s_waitcnt lgkmcnt(8)
    ds_read_b64_tr_b16 v[184:185], v220 offset:34944
    ds_read_b64_tr_b16 v[186:187], v220 offset:39552
    v_mfma_f32_16x16x32_bf16 v[128:131], v[164:167], a[168:171], v[128:131]
    ds_read_b64_tr_b16 v[188:189], v220 offset:44160
    ds_read_b64_tr_b16 v[190:191], v220 offset:48768
    v_mfma_f32_16x16x32_bf16 v[132:135], v[160:163], a[164:167], v[132:135]
    s_add_u32 m0, s42, 118784
    s_add_u32 s92, s52, 884736
    v_mfma_f32_16x16x32_bf16 v[132:135], v[164:167], a[172:175], v[132:135]
    s_waitcnt vmcnt(29) lgkmcnt(10)
    buffer_load_dwordx4 v232, s[16:19], s92 offen lds
    v_mfma_f32_16x16x32_bf16 v[80:83], v[168:171], a[176:179], v[80:83]
    s_waitcnt vmcnt(28) lgkmcnt(8)
    ds_read_b64_tr_b16 v[160:161], v220 offset:34976
    ds_read_b64_tr_b16 v[162:163], v220 offset:39584
    v_mfma_f32_16x16x32_bf16 v[80:83], v[172:175], a[184:187], v[80:83]
    ds_read_b64_tr_b16 v[164:165], v220 offset:44192
    ds_read_b64_tr_b16 v[166:167], v220 offset:48800
    v_mfma_f32_16x16x32_bf16 v[84:87], v[168:171], a[180:183], v[84:87]
    s_waitcnt vmcnt(27)
    v_mfma_f32_16x16x32_bf16 v[84:87], v[172:175], a[188:191], v[84:87]
    s_waitcnt lgkmcnt(10)
    buffer_load_dwordx4 v233, s[16:19], s92 offen offset:1024 lds
    v_mfma_f32_16x16x32_bf16 v[88:91], v[176:179], a[176:179], v[88:91]
    s_waitcnt lgkmcnt(8)
    ds_read_b64_tr_b16 v[168:169], v220 offset:35008
    ds_read_b64_tr_b16 v[170:171], v220 offset:39616
    v_mfma_f32_16x16x32_bf16 v[88:91], v[180:183], a[184:187], v[88:91]
    ds_read_b64_tr_b16 v[172:173], v220 offset:44224
    ds_read_b64_tr_b16 v[174:175], v220 offset:48832
    v_mfma_f32_16x16x32_bf16 v[92:95], v[176:179], a[180:183], v[92:95]
    v_mfma_f32_16x16x32_bf16 v[92:95], v[180:183], a[188:191], v[92:95]
    s_waitcnt lgkmcnt(10)
    buffer_load_dwordx4 v234, s[16:19], s92 offen offset:2048 lds
    v_mfma_f32_16x16x32_bf16 v[96:99], v[184:187], a[176:179], v[96:99]
    s_waitcnt lgkmcnt(8)
    ds_read_b64_tr_b16 v[176:177], v220 offset:35040
    ds_read_b64_tr_b16 v[178:179], v220 offset:39648
    v_mfma_f32_16x16x32_bf16 v[96:99], v[188:191], a[184:187], v[96:99]
    ds_read_b64_tr_b16 v[180:181], v220 offset:44256
    ds_read_b64_tr_b16 v[182:183], v220 offset:48864
    v_mfma_f32_16x16x32_bf16 v[100:103], v[184:187], a[180:183], v[100:103]
    v_mfma_f32_16x16x32_bf16 v[100:103], v[188:191], a[188:191], v[100:103]
    s_waitcnt lgkmcnt(10)
    buffer_load_dwordx4 v235, s[16:19], s92 offen offset:3072 lds
    v_mfma_f32_16x16x32_bf16 v[104:107], v[160:163], a[176:179], v[104:107]
    s_waitcnt vmcnt(21)
    ds_read_b64_tr_b16 v[184:185], v220 offset:35072
    ds_read_b64_tr_b16 v[186:187], v220 offset:39680
    s_waitcnt lgkmcnt(10)
    v_mfma_f32_16x16x32_bf16 v[104:107], v[164:167], a[184:187], v[104:107]
    s_barrier
    ds_read_b64_tr_b16 v[188:189], v220 offset:44288
    ds_read_b64_tr_b16 v[190:191], v220 offset:48896
    v_mfma_f32_16x16x32_bf16 v[108:111], v[160:163], a[180:183], v[108:111]
    s_add_u32 m0, s42, 122880
    v_mfma_f32_16x16x32_bf16 v[108:111], v[164:167], a[188:191], v[108:111]
    s_waitcnt lgkmcnt(10)
    buffer_load_dword v244, v246, s[28:31], s90 offen sc1
    v_mfma_f32_16x16x32_bf16 v[112:115], v[168:171], a[176:179], v[112:115]
    s_waitcnt lgkmcnt(8)
    ds_read_b64_tr_b16 v[160:161], v219 offset:64
    ds_read_b64_tr_b16 v[162:163], v219 offset:4672
    v_mfma_f32_16x16x32_bf16 v[112:115], v[172:175], a[184:187], v[112:115]
    ds_read_b64_tr_b16 v[164:165], v219 offset:9280
    ds_read_b64_tr_b16 v[166:167], v219 offset:13888
    v_mfma_f32_16x16x32_bf16 v[116:119], v[168:171], a[180:183], v[116:119]
    v_mfma_f32_16x16x32_bf16 v[116:119], v[172:175], a[188:191], v[116:119]
    s_waitcnt lgkmcnt(10)
    buffer_load_dwordx4 v236, s[16:19], s92 offen lds
    v_mfma_f32_16x16x32_bf16 v[120:123], v[176:179], a[176:179], v[120:123]
    s_waitcnt lgkmcnt(8)
    ds_read_b64_tr_b16 v[168:169], v219 offset:96
    ds_read_b64_tr_b16 v[170:171], v219 offset:4704
    v_mfma_f32_16x16x32_bf16 v[120:123], v[180:183], a[184:187], v[120:123]
    ds_read_b64_tr_b16 v[172:173], v219 offset:9312
    ds_read_b64_tr_b16 v[174:175], v219 offset:13920
    v_mfma_f32_16x16x32_bf16 v[124:127], v[176:179], a[180:183], v[124:127]
    v_mfma_f32_16x16x32_bf16 v[124:127], v[180:183], a[188:191], v[124:127]
    s_waitcnt lgkmcnt(10)
    buffer_load_dwordx4 v237, s[16:19], s92 offen offset:1024 lds
    v_mfma_f32_16x16x32_bf16 v[128:131], v[184:187], a[176:179], v[128:131]
    s_waitcnt lgkmcnt(8)
    ds_read_b64_tr_b16 v[176:177], v219 offset:128
    ds_read_b64_tr_b16 v[178:179], v219 offset:4736
    v_mfma_f32_16x16x32_bf16 v[128:131], v[188:191], a[184:187], v[128:131]
    ds_read_b64_tr_b16 v[180:181], v219 offset:9344
    ds_read_b64_tr_b16 v[182:183], v219 offset:13952
    v_mfma_f32_16x16x32_bf16 v[132:135], v[184:187], a[180:183], v[132:135]
    v_mfma_f32_16x16x32_bf16 v[132:135], v[188:191], a[188:191], v[132:135]
    s_waitcnt vmcnt(23) lgkmcnt(10)
    buffer_load_dwordx4 v238, s[16:19], s92 offen offset:2048 lds
    v_mfma_f32_16x16x32_bf16 v[80:83], v[160:163], a[192:195], v[80:83]
    s_waitcnt vmcnt(22) lgkmcnt(8)
    ds_read_b64_tr_b16 v[184:185], v219 offset:160
    ds_read_b64_tr_b16 v[186:187], v219 offset:4768
    v_mfma_f32_16x16x32_bf16 v[80:83], v[164:167], a[200:203], v[80:83]
    ds_read_b64_tr_b16 v[188:189], v219 offset:9376
    ds_read_b64_tr_b16 v[190:191], v219 offset:13984
    v_mfma_f32_16x16x32_bf16 v[84:87], v[160:163], a[196:199], v[84:87]
    s_waitcnt vmcnt(21)
    v_mfma_f32_16x16x32_bf16 v[84:87], v[164:167], a[204:207], v[84:87]
    s_waitcnt lgkmcnt(10)
    buffer_load_dwordx4 v239, s[16:19], s92 offen offset:3072 lds
    v_mfma_f32_16x16x32_bf16 v[88:91], v[168:171], a[192:195], v[88:91]
    s_add_u32 m0, s42, 126976
    ds_read_b64_tr_b16 v[160:161], v219 offset:192
    ds_read_b64_tr_b16 v[162:163], v219 offset:4800
    s_waitcnt lgkmcnt(10)
    v_mfma_f32_16x16x32_bf16 v[88:91], v[172:175], a[200:203], v[88:91]
    ds_read_b64_tr_b16 v[164:165], v219 offset:9408
    ds_read_b64_tr_b16 v[166:167], v219 offset:14016
    v_mfma_f32_16x16x32_bf16 v[92:95], v[168:171], a[196:199], v[92:95]
    v_mfma_f32_16x16x32_bf16 v[92:95], v[172:175], a[204:207], v[92:95]
    s_waitcnt lgkmcnt(10)
    buffer_load_dwordx4 v240, s[16:19], s92 offen lds
    v_mfma_f32_16x16x32_bf16 v[96:99], v[176:179], a[192:195], v[96:99]
    s_waitcnt lgkmcnt(8)
    ds_read_b64_tr_b16 v[168:169], v219 offset:224
    ds_read_b64_tr_b16 v[170:171], v219 offset:4832
    v_mfma_f32_16x16x32_bf16 v[96:99], v[180:183], a[200:203], v[96:99]
    ds_read_b64_tr_b16 v[172:173], v219 offset:9440
    ds_read_b64_tr_b16 v[174:175], v219 offset:14048
    v_mfma_f32_16x16x32_bf16 v[100:103], v[176:179], a[196:199], v[100:103]
    v_mfma_f32_16x16x32_bf16 v[100:103], v[180:183], a[204:207], v[100:103]
    s_waitcnt lgkmcnt(10)
    buffer_load_dwordx4 a[224:227], v209, s[20:23], s99 offen sc1
    v_mfma_f32_16x16x32_bf16 v[104:107], v[184:187], a[192:195], v[104:107]
    s_add_u32 s100, s54, 153600
    ds_read_b64_tr_b16 v[176:177], v219 offset:256
    ds_read_b64_tr_b16 v[178:179], v219 offset:4864
    s_waitcnt lgkmcnt(10)
    v_mfma_f32_16x16x32_bf16 v[104:107], v[188:191], a[200:203], v[104:107]
    ds_read_b64_tr_b16 v[180:181], v219 offset:9472
    ds_read_b64_tr_b16 v[182:183], v219 offset:14080
    v_mfma_f32_16x16x32_bf16 v[108:111], v[184:187], a[196:199], v[108:111]
    v_mfma_f32_16x16x32_bf16 v[108:111], v[188:191], a[204:207], v[108:111]
    s_waitcnt lgkmcnt(10)
    buffer_load_dwordx4 a[228:231], v209, s[20:23], s100 offen sc1
    v_mfma_f32_16x16x32_bf16 v[112:115], v[160:163], a[192:195], v[112:115]
    s_add_u32 s99, s54, 7168
    ds_read_b64_tr_b16 v[184:185], v219 offset:18496
    ds_read_b64_tr_b16 v[186:187], v219 offset:23104
    s_waitcnt lgkmcnt(10)
    v_mfma_f32_16x16x32_bf16 v[112:115], v[164:167], a[200:203], v[112:115]
    ds_read_b64_tr_b16 v[188:189], v219 offset:27712
    ds_read_b64_tr_b16 v[190:191], v219 offset:32320
    v_mfma_f32_16x16x32_bf16 v[116:119], v[160:163], a[196:199], v[116:119]
    v_mfma_f32_16x16x32_bf16 v[116:119], v[164:167], a[204:207], v[116:119]
    s_waitcnt lgkmcnt(10)
    buffer_load_dwordx4 a[232:235], v209, s[20:23], s99 offen sc1
    v_mfma_f32_16x16x32_bf16 v[120:123], v[168:171], a[192:195], v[120:123]
    s_add_u32 s100, s54, 154624
    ds_read_b64_tr_b16 v[160:161], v219 offset:18528
    ds_read_b64_tr_b16 v[162:163], v219 offset:23136
    s_waitcnt lgkmcnt(10)
    v_mfma_f32_16x16x32_bf16 v[120:123], v[172:175], a[200:203], v[120:123]
    ds_read_b64_tr_b16 v[164:165], v219 offset:27744
    ds_read_b64_tr_b16 v[166:167], v219 offset:32352
    v_mfma_f32_16x16x32_bf16 v[124:127], v[168:171], a[196:199], v[124:127]
    v_mfma_f32_16x16x32_bf16 v[124:127], v[172:175], a[204:207], v[124:127]
    s_waitcnt lgkmcnt(10)
    buffer_load_dwordx4 a[236:239], v209, s[20:23], s100 offen sc1
    v_mfma_f32_16x16x32_bf16 v[128:131], v[176:179], a[192:195], v[128:131]
    s_add_u32 s99, s54, 16384
    ds_read_b64_tr_b16 v[168:169], v219 offset:18560
    ds_read_b64_tr_b16 v[170:171], v219 offset:23168
    s_waitcnt lgkmcnt(10)
    v_mfma_f32_16x16x32_bf16 v[128:131], v[180:183], a[200:203], v[128:131]
    ds_read_b64_tr_b16 v[172:173], v219 offset:27776
    ds_read_b64_tr_b16 v[174:175], v219 offset:32384
    v_mfma_f32_16x16x32_bf16 v[132:135], v[176:179], a[196:199], v[132:135]
    v_mfma_f32_16x16x32_bf16 v[132:135], v[180:183], a[204:207], v[132:135]
    s_waitcnt vmcnt(26) lgkmcnt(10)
    buffer_load_dwordx4 a[240:243], v209, s[20:23], s99 offen sc1
    v_mfma_f32_16x16x32_bf16 v[80:83], v[184:187], a[208:211], v[80:83]
    s_add_u32 s100, s54, 163840
    ds_read_b64_tr_b16 v[176:177], v219 offset:18592
    ds_read_b64_tr_b16 v[178:179], v219 offset:23200
    s_waitcnt vmcnt(25) lgkmcnt(10)
    v_mfma_f32_16x16x32_bf16 v[80:83], v[188:191], a[216:219], v[80:83]
    ds_read_b64_tr_b16 v[180:181], v219 offset:27808
    ds_read_b64_tr_b16 v[182:183], v219 offset:32416
    v_mfma_f32_16x16x32_bf16 v[84:87], v[184:187], a[212:215], v[84:87]
    s_waitcnt vmcnt(24)
    v_mfma_f32_16x16x32_bf16 v[84:87], v[188:191], a[220:223], v[84:87]
    s_waitcnt lgkmcnt(10)
    buffer_load_dwordx4 a[244:247], v209, s[20:23], s100 offen sc1
    s_add_u32 s99, s54, 17408
    buffer_load_dwordx4 a[248:251], v209, s[20:23], s99 offen sc1
    s_add_u32 s100, s54, 164864
    v_mfma_f32_16x16x32_bf16 v[88:91], v[160:163], a[208:211], v[88:91]
    s_waitcnt lgkmcnt(8)
    ds_read_b64_tr_b16 v[184:185], v219 offset:18624
    ds_read_b64_tr_b16 v[186:187], v219 offset:23232
    v_mfma_f32_16x16x32_bf16 v[88:91], v[164:167], a[216:219], v[88:91]
    buffer_load_dwordx4 a[252:255], v209, s[20:23], s100 offen sc1
    v_mfma_f32_16x16x32_bf16 v[92:95], v[160:163], a[212:215], v[92:95]
    s_add_u32 s99, s54, 24576
    buffer_load_dwordx4 a[0:3], v209, s[20:23], s99 offen sc1
    s_add_u32 s100, s54, 172032
    v_mfma_f32_16x16x32_bf16 v[92:95], v[164:167], a[220:223], v[92:95]
    s_waitcnt lgkmcnt(8)
    buffer_load_dwordx4 a[4:7], v209, s[20:23], s100 offen sc1
    s_add_u32 s99, s54, 25600
    buffer_load_dwordx4 a[8:11], v209, s[20:23], s99 offen sc1
    s_add_u32 s100, s54, 173056
    v_mfma_f32_16x16x32_bf16 v[96:99], v[168:171], a[208:211], v[96:99]
    s_waitcnt lgkmcnt(6)
    ds_read_b64_tr_b16 v[188:189], v219 offset:27840
    ds_read_b64_tr_b16 v[190:191], v219 offset:32448
    v_mfma_f32_16x16x32_bf16 v[96:99], v[172:175], a[216:219], v[96:99]
    buffer_load_dwordx4 a[12:15], v209, s[20:23], s100 offen sc1
    v_mfma_f32_16x16x32_bf16 v[100:103], v[168:171], a[212:215], v[100:103]
    s_add_u32 s99, s54, 34816
    buffer_load_dwordx4 a[16:19], v209, s[20:23], s99 offen sc1
    s_add_u32 s100, s54, 182272
    v_mfma_f32_16x16x32_bf16 v[100:103], v[172:175], a[220:223], v[100:103]
    s_waitcnt lgkmcnt(6)
    buffer_load_dwordx4 a[20:23], v209, s[20:23], s100 offen sc1
    s_add_u32 s99, s54, 35840
    buffer_load_dwordx4 a[24:27], v209, s[20:23], s99 offen sc1
    s_add_u32 s100, s54, 183296
    v_mfma_f32_16x16x32_bf16 v[104:107], v[176:179], a[208:211], v[104:107]
    s_waitcnt vmcnt(25)
    ds_read_b64_tr_b16 v[160:161], v219 offset:18656
    ds_read_b64_tr_b16 v[162:163], v219 offset:23264
    s_waitcnt lgkmcnt(6)
    v_mfma_f32_16x16x32_bf16 v[104:107], v[180:183], a[216:219], v[104:107]
    s_barrier
    buffer_load_dwordx4 a[28:31], v209, s[20:23], s100 offen sc1
    ds_read_b64_tr_b16 v[164:165], v219 offset:27872
    ds_read_b64_tr_b16 v[166:167], v219 offset:32480
    v_mfma_f32_16x16x32_bf16 v[108:111], v[176:179], a[212:215], v[108:111]
    ds_read_b64_tr_b16 v[168:169], v219 offset:18688
    ds_read_b64_tr_b16 v[170:171], v219 offset:23296
    v_mfma_f32_16x16x32_bf16 v[108:111], v[180:183], a[220:223], v[108:111]
    s_waitcnt lgkmcnt(8)
    ds_read_b64_tr_b16 v[172:173], v219 offset:27904
    ds_read_b64_tr_b16 v[174:175], v219 offset:32512
    v_mfma_f32_16x16x32_bf16 v[112:115], v[184:187], a[208:211], v[112:115]
    s_waitcnt lgkmcnt(8)
    ds_read_b64_tr_b16 v[176:177], v219 offset:36928
    ds_read_b64_tr_b16 v[178:179], v219 offset:41536
    v_mfma_f32_16x16x32_bf16 v[112:115], v[188:191], a[216:219], v[112:115]
    ds_read_b64_tr_b16 v[180:181], v219 offset:46144
    ds_read_b64_tr_b16 v[182:183], v219 offset:50752
    v_mfma_f32_16x16x32_bf16 v[116:119], v[184:187], a[212:215], v[116:119]
    v_mfma_f32_16x16x32_bf16 v[116:119], v[188:191], a[220:223], v[116:119]
    s_waitcnt lgkmcnt(10)
    ds_read_b64_tr_b16 v[184:185], v219 offset:55360
    ds_read_b64_tr_b16 v[186:187], v219 offset:59968
    v_mfma_f32_16x16x32_bf16 v[120:123], v[160:163], a[208:211], v[120:123]
    s_waitcnt vmcnt(16)
    ds_read_b64_tr_b16 v[188:189], v219 offset:64576
    ds_read_b64_tr_b16 v[190:191], v220 offset:3648
    s_waitcnt lgkmcnt(12)
    v_mfma_f32_16x16x32_bf16 v[120:123], v[164:167], a[216:219], v[120:123]
    s_barrier
    v_mfma_f32_16x16x32_bf16 v[124:127], v[160:163], a[212:215], v[124:127]
    v_mfma_f32_16x16x32_bf16 v[124:127], v[164:167], a[220:223], v[124:127]
    s_waitcnt lgkmcnt(10)
    ds_read_b64_tr_b16 v[160:161], v220 offset:53312
    ds_read_b64_tr_b16 v[162:163], v220 offset:57920
    v_mfma_f32_16x16x32_bf16 v[128:131], v[168:171], a[208:211], v[128:131]
    s_waitcnt lgkmcnt(10)
    ds_read_b64_tr_b16 v[164:165], v220 offset:62528
    ds_read_b64_tr_b16 v[166:167], v221 offset:1600
    v_mfma_f32_16x16x32_bf16 v[128:131], v[172:175], a[216:219], v[128:131]
    v_mfma_f32_16x16x32_bf16 v[132:135], v[168:171], a[212:215], v[132:135]
    v_mfma_f32_16x16x32_bf16 v[132:135], v[172:175], a[220:223], v[132:135]
    s_waitcnt vmcnt(15) lgkmcnt(10)
    ds_read_b64_tr_b16 v[168:169], v221 offset:6208
    ds_read_b64_tr_b16 v[170:171], v221 offset:10816
    v_mfma_f32_16x16x32_bf16 v[80:83], v[176:179], a[224:227], v[80:83]
    s_waitcnt vmcnt(13) lgkmcnt(10)
    ds_read_b64_tr_b16 v[172:173], v221 offset:15424
    ds_read_b64_tr_b16 v[174:175], v221 offset:20032
    v_mfma_f32_16x16x32_bf16 v[80:83], v[180:183], a[232:235], v[80:83]
    v_mfma_f32_16x16x32_bf16 v[84:87], v[176:179], a[228:231], v[84:87]
    s_waitcnt vmcnt(12)
    v_mfma_f32_16x16x32_bf16 v[84:87], v[180:183], a[236:239], v[84:87]
    s_waitcnt vmcnt(11) lgkmcnt(10)
    ds_read_b64_tr_b16 v[176:177], v219 offset:36960
    ds_read_b64_tr_b16 v[178:179], v219 offset:41568
    v_mfma_f32_16x16x32_bf16 v[80:83], v[184:187], a[240:243], v[80:83]
    s_add_u32 s69, s55, 3
    v_subrev_u32 v245, s69, v244
    v_cmp_le_u32 vcc, 8, v245
    s_nop 1
    s_cbranch_vccnz LS_spin4
LS_back4:
    s_waitcnt vmcnt(9) lgkmcnt(10)
    v_mfma_f32_16x16x32_bf16 v[80:83], v[188:191], a[248:251], v[80:83]
    ds_read_b64_tr_b16 v[180:181], v219 offset:46176
    ds_read_b64_tr_b16 v[182:183], v219 offset:50784
    v_mfma_f32_16x16x32_bf16 v[84:87], v[184:187], a[244:247], v[84:87]
    s_waitcnt vmcnt(8)
    v_mfma_f32_16x16x32_bf16 v[84:87], v[188:191], a[252:255], v[84:87]
    s_waitcnt vmcnt(7) lgkmcnt(10)
    ds_read_b64_tr_b16 v[184:185], v219 offset:55392
    ds_read_b64_tr_b16 v[186:187], v219 offset:60000
    v_mfma_f32_16x16x32_bf16 v[80:83], v[160:163], a[0:3], v[80:83]
    s_waitcnt vmcnt(5) lgkmcnt(10)
    ds_read_b64_tr_b16 v[188:189], v219 offset:64608
    ds_read_b64_tr_b16 v[190:191], v220 offset:3680
    v_mfma_f32_16x16x32_bf16 v[80:83], v[164:167], a[8:11], v[80:83]
    v_mfma_f32_16x16x32_bf16 v[84:87], v[160:163], a[4:7], v[84:87]
    s_waitcnt vmcnt(4)
    v_mfma_f32_16x16x32_bf16 v[84:87], v[164:167], a[12:15], v[84:87]
    s_waitcnt vmcnt(3) lgkmcnt(10)
    ds_read_b64_tr_b16 v[160:161], v220 offset:53344
    ds_read_b64_tr_b16 v[162:163], v220 offset:57952
    v_mfma_f32_16x16x32_bf16 v[80:83], v[168:171], a[16:19], v[80:83]
    s_waitcnt vmcnt(1) lgkmcnt(10)
    ds_read_b64_tr_b16 v[164:165], v220 offset:62560
    ds_read_b64_tr_b16 v[166:167], v221 offset:1632
    v_mfma_f32_16x16x32_bf16 v[80:83], v[172:175], a[24:27], v[80:83]
    v_mfma_f32_16x16x32_bf16 v[84:87], v[168:171], a[20:23], v[84:87]
    s_waitcnt vmcnt(0)
    v_mfma_f32_16x16x32_bf16 v[84:87], v[172:175], a[28:31], v[84:87]
    s_waitcnt lgkmcnt(10)
    ds_read_b64_tr_b16 v[168:169], v221 offset:6240
    ds_read_b64_tr_b16 v[170:171], v221 offset:10848
    v_mfma_f32_16x16x32_bf16 v[88:91], v[176:179], a[224:227], v[88:91]
    s_waitcnt lgkmcnt(10)
    ds_read_b64_tr_b16 v[172:173], v221 offset:15456
    ds_read_b64_tr_b16 v[174:175], v221 offset:20064
    v_mfma_f32_16x16x32_bf16 v[88:91], v[180:183], a[232:235], v[88:91]
    v_mfma_f32_16x16x32_bf16 v[92:95], v[176:179], a[228:231], v[92:95]
    v_mfma_f32_16x16x32_bf16 v[92:95], v[180:183], a[236:239], v[92:95]
    s_waitcnt lgkmcnt(10)
    ds_read_b64_tr_b16 v[176:177], v219 offset:36992
    ds_read_b64_tr_b16 v[178:179], v219 offset:41600
    v_mfma_f32_16x16x32_bf16 v[88:91], v[184:187], a[240:243], v[88:91]
    s_waitcnt lgkmcnt(10)
    ds_read_b64_tr_b16 v[180:181], v219 offset:46208
    ds_read_b64_tr_b16 v[182:183], v219 offset:50816
    v_mfma_f32_16x16x32_bf16 v[88:91], v[188:191], a[248:251], v[88:91]
    v_cvt_pk_bf16_f32 v8, v80, v81
    v_cvt_pk_bf16_f32 v9, v82, v83
    v_mfma_f32_16x16x32_bf16 v[92:95], v[184:187], a[244:247], v[92:95]
    v_min_u32 v8, -2, v8
    v_min_u32 v9, -2, v9
    v_mfma_f32_16x16x32_bf16 v[92:95], v[188:191], a[252:255], v[92:95]
    s_waitcnt lgkmcnt(10)
    ds_read_b64_tr_b16 v[184:185], v219 offset:55424
    ds_read_b64_tr_b16 v[186:187], v219 offset:60032
    v_mfma_f32_16x16x32_bf16 v[88:91], v[160:163], a[0:3], v[88:91]
    s_waitcnt lgkmcnt(10)
    ds_read_b64_tr_b16 v[188:189], v219 offset:64640
    ds_read_b64_tr_b16 v[190:191], v220 offset:3712
    v_mfma_f32_16x16x32_bf16 v[88:91], v[164:167], a[8:11], v[88:91]
    v_cvt_pk_bf16_f32 v10, v84, v85
    v_cvt_pk_bf16_f32 v11, v86, v87
    v_mfma_f32_16x16x32_bf16 v[92:95], v[160:163], a[4:7], v[92:95]
    v_min_u32 v10, -2, v10
    v_min_u32 v11, -2, v11
    v_mfma_f32_16x16x32_bf16 v[92:95], v[164:167], a[12:15], v[92:95]
    s_waitcnt lgkmcnt(10)
    buffer_store_dwordx4 v[8:11], v209, s[24:27], s56 offen sc1
    v_mfma_f32_16x16x32_bf16 v[88:91], v[168:171], a[16:19], v[88:91]
    s_waitcnt lgkmcnt(8)
    ds_read_b64_tr_b16 v[160:161], v220 offset:53376
    ds_read_b64_tr_b16 v[162:163], v220 offset:57984
    v_mfma_f32_16x16x32_bf16 v[88:91], v[172:175], a[24:27], v[88:91]
    ds_read_b64_tr_b16 v[164:165], v220 offset:62592
    ds_read_b64_tr_b16 v[166:167], v221 offset:1664
    v_mfma_f32_16x16x32_bf16 v[92:95], v[168:171], a[20:23], v[92:95]
    v_mfma_f32_16x16x32_bf16 v[92:95], v[172:175], a[28:31], v[92:95]
    s_waitcnt lgkmcnt(10)
    ds_read_b64_tr_b16 v[168:169], v221 offset:6272
    ds_read_b64_tr_b16 v[170:171], v221 offset:10880
    v_mfma_f32_16x16x32_bf16 v[96:99], v[176:179], a[224:227], v[96:99]
    s_waitcnt lgkmcnt(10)
    ds_read_b64_tr_b16 v[172:173], v221 offset:15488
    ds_read_b64_tr_b16 v[174:175], v221 offset:20096
    v_mfma_f32_16x16x32_bf16 v[96:99], v[180:183], a[232:235], v[96:99]
    v_mfma_f32_16x16x32_bf16 v[100:103], v[176:179], a[228:231], v[100:103]
    v_mfma_f32_16x16x32_bf16 v[100:103], v[180:183], a[236:239], v[100:103]
    s_waitcnt lgkmcnt(10)
    ds_read_b64_tr_b16 v[176:177], v219 offset:37024
    ds_read_b64_tr_b16 v[178:179], v219 offset:41632
    v_mfma_f32_16x16x32_bf16 v[96:99], v[184:187], a[240:243], v[96:99]
    s_waitcnt lgkmcnt(10)
    ds_read_b64_tr_b16 v[180:181], v219 offset:46240
    ds_read_b64_tr_b16 v[182:183], v219 offset:50848
    v_mfma_f32_16x16x32_bf16 v[96:99], v[188:191], a[248:251], v[96:99]
    v_cvt_pk_bf16_f32 v12, v88, v89
    v_cvt_pk_bf16_f32 v13, v90, v91
    v_mfma_f32_16x16x32_bf16 v[100:103], v[184:187], a[244:247], v[100:103]
    v_min_u32 v12, -2, v12
    v_min_u32 v13, -2, v13
    v_mfma_f32_16x16x32_bf16 v[100:103], v[188:191], a[252:255], v[100:103]
    s_waitcnt lgkmcnt(10)
    ds_read_b64_tr_b16 v[184:185], v219 offset:55456
    ds_read_b64_tr_b16 v[186:187], v219 offset:60064
    v_mfma_f32_16x16x32_bf16 v[96:99], v[160:163], a[0:3], v[96:99]
    s_waitcnt lgkmcnt(10)
    ds_read_b64_tr_b16 v[188:189], v219 offset:64672
    ds_read_b64_tr_b16 v[190:191], v220 offset:3744
    v_mfma_f32_16x16x32_bf16 v[96:99], v[164:167], a[8:11], v[96:99]
    v_cvt_pk_bf16_f32 v14, v92, v93
    v_cvt_pk_bf16_f32 v15, v94, v95
    v_mfma_f32_16x16x32_bf16 v[100:103], v[160:163], a[4:7], v[100:103]
    v_min_u32 v14, -2, v14
    v_min_u32 v15, -2, v15
    v_mfma_f32_16x16x32_bf16 v[100:103], v[164:167], a[12:15], v[100:103]
    s_waitcnt lgkmcnt(10)
    buffer_store_dwordx4 v[12:15], v209, s[24:27], s56 offen offset:1024 sc1
    v_mfma_f32_16x16x32_bf16 v[96:99], v[168:171], a[16:19], v[96:99]
    s_waitcnt lgkmcnt(8)
    ds_read_b64_tr_b16 v[160:161], v220 offset:53408
    ds_read_b64_tr_b16 v[162:163], v220 offset:58016
    v_mfma_f32_16x16x32_bf16 v[96:99], v[172:175], a[24:27], v[96:99]
    ds_read_b64_tr_b16 v[164:165], v220 offset:62624
    ds_read_b64_tr_b16 v[166:167], v221 offset:1696
    v_mfma_f32_16x16x32_bf16 v[100:103], v[168:171], a[20:23], v[100:103]
    v_mfma_f32_16x16x32_bf16 v[100:103], v[172:175], a[28:31], v[100:103]
    s_waitcnt lgkmcnt(10)
    ds_read_b64_tr_b16 v[168:169], v221 offset:6304
    ds_read_b64_tr_b16 v[170:171], v221 offset:10912
    v_mfma_f32_16x16x32_bf16 v[104:107], v[176:179], a[224:227], v[104:107]
    s_waitcnt lgkmcnt(10)
    ds_read_b64_tr_b16 v[172:173], v221 offset:15520
    ds_read_b64_tr_b16 v[174:175], v221 offset:20128
    v_mfma_f32_16x16x32_bf16 v[104:107], v[180:183], a[232:235], v[104:107]
    v_mfma_f32_16x16x32_bf16 v[108:111], v[176:179], a[228:231], v[108:111]
    v_mfma_f32_16x16x32_bf16 v[108:111], v[180:183], a[236:239], v[108:111]
    s_waitcnt lgkmcnt(10)
    ds_read_b64_tr_b16 v[176:177], v219 offset:37056
    ds_read_b64_tr_b16 v[178:179], v219 offset:41664
    v_mfma_f32_16x16x32_bf16 v[104:107], v[184:187], a[240:243], v[104:107]
    s_waitcnt lgkmcnt(10)
    ds_read_b64_tr_b16 v[180:181], v219 offset:46272
    ds_read_b64_tr_b16 v[182:183], v219 offset:50880
    v_mfma_f32_16x16x32_bf16 v[104:107], v[188:191], a[248:251], v[104:107]
    v_cvt_pk_bf16_f32 v16, v96, v97
    v_cvt_pk_bf16_f32 v17, v98, v99
    v_mfma_f32_16x16x32_bf16 v[108:111], v[184:187], a[244:247], v[108:111]
    v_min_u32 v16, -2, v16
    v_min_u32 v17, -2, v17
    v_mfma_f32_16x16x32_bf16 v[108:111], v[188:191], a[252:255], v[108:111]
    s_waitcnt lgkmcnt(10)
    ds_read_b64_tr_b16 v[184:185], v219 offset:55488
    ds_read_b64_tr_b16 v[186:187], v219 offset:60096
    v_mfma_f32_16x16x32_bf16 v[104:107], v[160:163], a[0:3], v[104:107]
    s_waitcnt lgkmcnt(10)
    ds_read_b64_tr_b16 v[188:189], v219 offset:64704
    ds_read_b64_tr_b16 v[190:191], v220 offset:3776
    v_mfma_f32_16x16x32_bf16 v[104:107], v[164:167], a[8:11], v[104:107]
    v_cvt_pk_bf16_f32 v18, v100, v101
    v_cvt_pk_bf16_f32 v19, v102, v103
    v_mfma_f32_16x16x32_bf16 v[108:111], v[160:163], a[4:7], v[108:111]
    v_min_u32 v18, -2, v18
    v_min_u32 v19, -2, v19
    v_mfma_f32_16x16x32_bf16 v[108:111], v[164:167], a[12:15], v[108:111]
    s_waitcnt lgkmcnt(10)
    buffer_store_dwordx4 v[16:19], v209, s[24:27], s57 offen sc1
    v_mfma_f32_16x16x32_bf16 v[104:107], v[168:171], a[16:19], v[104:107]
    s_waitcnt lgkmcnt(8)
    ds_read_b64_tr_b16 v[160:161], v220 offset:53440
    ds_read_b64_tr_b16 v[162:163], v220 offset:58048
    v_mfma_f32_16x16x32_bf16 v[104:107], v[172:175], a[24:27], v[104:107]
    ds_read_b64_tr_b16 v[164:165], v220 offset:62656
    ds_read_b64_tr_b16 v[166:167], v221 offset:1728
    v_mfma_f32_16x16x32_bf16 v[108:111], v[168:171], a[20:23], v[108:111]
    v_mfma_f32_16x16x32_bf16 v[108:111], v[172:175], a[28:31], v[108:111]
    s_waitcnt lgkmcnt(10)
    ds_read_b64_tr_b16 v[168:169], v221 offset:6336
    ds_read_b64_tr_b16 v[170:171], v221 offset:10944
    v_mfma_f32_16x16x32_bf16 v[112:115], v[176:179], a[224:227], v[112:115]
    s_waitcnt lgkmcnt(10)
    ds_read_b64_tr_b16 v[172:173], v221 offset:15552
    ds_read_b64_tr_b16 v[174:175], v221 offset:20160
    v_mfma_f32_16x16x32_bf16 v[112:115], v[180:183], a[232:235], v[112:115]
    v_mfma_f32_16x16x32_bf16 v[116:119], v[176:179], a[228:231], v[116:119]
    v_mfma_f32_16x16x32_bf16 v[116:119], v[180:183], a[236:239], v[116:119]
    s_waitcnt lgkmcnt(10)
    ds_read_b64_tr_b16 v[176:177], v219 offset:37088
    ds_read_b64_tr_b16 v[178:179], v219 offset:41696
    v_mfma_f32_16x16x32_bf16 v[112:115], v[184:187], a[240:243], v[112:115]
    s_waitcnt lgkmcnt(10)
    ds_read_b64_tr_b16 v[180:181], v219 offset:46304
    ds_read_b64_tr_b16 v[182:183], v219 offset:50912
    v_mfma_f32_16x16x32_bf16 v[112:115], v[188:191], a[248:251], v[112:115]
    v_cvt_pk_bf16_f32 v20, v104, v105
    v_cvt_pk_bf16_f32 v21, v106, v107
    v_mfma_f32_16x16x32_bf16 v[116:119], v[184:187], a[244:247], v[116:119]
    v_min_u32 v20, -2, v20
    v_min_u32 v21, -2, v21
    v_mfma_f32_16x16x32_bf16 v[116:119], v[188:191], a[252:255], v[116:119]
    s_waitcnt lgkmcnt(10)
    ds_read_b64_tr_b16 v[184:185], v219 offset:55520
    ds_read_b64_tr_b16 v[186:187], v219 offset:60128
    v_mfma_f32_16x16x32_bf16 v[112:115], v[160:163], a[0:3], v[112:115]
    s_waitcnt lgkmcnt(10)
    ds_read_b64_tr_b16 v[188:189], v219 offset:64736
    ds_read_b64_tr_b16 v[190:191], v220 offset:3808
    v_mfma_f32_16x16x32_bf16 v[112:115], v[164:167], a[8:11], v[112:115]
    v_cvt_pk_bf16_f32 v22, v108, v109
    v_cvt_pk_bf16_f32 v23, v110, v111
    v_mfma_f32_16x16x32_bf16 v[116:119], v[160:163], a[4:7], v[116:119]
    v_min_u32 v22, -2, v22
    v_min_u32 v23, -2, v23
    v_mfma_f32_16x16x32_bf16 v[116:119], v[164:167], a[12:15], v[116:119]
    s_waitcnt lgkmcnt(10)
    buffer_store_dwordx4 v[20:23], v209, s[24:27], s57 offen offset:1024 sc1
    v_mfma_f32_16x16x32_bf16 v[112:115], v[168:171], a[16:19], v[112:115]
    s_waitcnt lgkmcnt(8)
    ds_read_b64_tr_b16 v[160:161], v220 offset:53472
    ds_read_b64_tr_b16 v[162:163], v220 offset:58080
    v_mfma_f32_16x16x32_bf16 v[112:115], v[172:175], a[24:27], v[112:115]
    ds_read_b64_tr_b16 v[164:165], v220 offset:62688
    ds_read_b64_tr_b16 v[166:167], v221 offset:1760
    v_mfma_f32_16x16x32_bf16 v[116:119], v[168:171], a[20:23], v[116:119]
    v_mfma_f32_16x16x32_bf16 v[116:119], v[172:175], a[28:31], v[116:119]
    s_waitcnt lgkmcnt(10)
    ds_read_b64_tr_b16 v[168:169], v221 offset:6368
    ds_read_b64_tr_b16 v[170:171], v221 offset:10976
    v_mfma_f32_16x16x32_bf16 v[120:123], v[176:179], a[224:227], v[120:123]
    s_waitcnt lgkmcnt(10)
    ds_read_b64_tr_b16 v[172:173], v221 offset:15584
    ds_read_b64_tr_b16 v[174:175], v221 offset:20192
    v_mfma_f32_16x16x32_bf16 v[120:123], v[180:183], a[232:235], v[120:123]
    v_mfma_f32_16x16x32_bf16 v[124:127], v[176:179], a[228:231], v[124:127]
    v_mfma_f32_16x16x32_bf16 v[124:127], v[180:183], a[236:239], v[124:127]
    s_waitcnt lgkmcnt(10)
    ds_read_b64_tr_b16 v[176:177], v219 offset:37120
    ds_read_b64_tr_b16 v[178:179], v219 offset:41728
    v_mfma_f32_16x16x32_bf16 v[120:123], v[184:187], a[240:243], v[120:123]
    s_waitcnt lgkmcnt(10)
    ds_read_b64_tr_b16 v[180:181], v219 offset:46336
    ds_read_b64_tr_b16 v[182:183], v219 offset:50944
    v_mfma_f32_16x16x32_bf16 v[120:123], v[188:191], a[248:251], v[120:123]
    v_cvt_pk_bf16_f32 v24, v112, v113
    v_cvt_pk_bf16_f32 v25, v114, v115
    v_mfma_f32_16x16x32_bf16 v[124:127], v[184:187], a[244:247], v[124:127]
    v_min_u32 v24, -2, v24
    v_min_u32 v25, -2, v25
    v_mfma_f32_16x16x32_bf16 v[124:127], v[188:191], a[252:255], v[124:127]
    s_waitcnt lgkmcnt(10)
    ds_read_b64_tr_b16 v[184:185], v219 offset:55552
    ds_read_b64_tr_b16 v[186:187], v219 offset:60160
    v_mfma_f32_16x16x32_bf16 v[120:123], v[160:163], a[0:3], v[120:123]
    s_waitcnt lgkmcnt(10)
    ds_read_b64_tr_b16 v[188:189], v219 offset:64768
    ds_read_b64_tr_b16 v[190:191], v220 offset:3840
    v_mfma_f32_16x16x32_bf16 v[120:123], v[164:167], a[8:11], v[120:123]
    v_cvt_pk_bf16_f32 v26, v116, v117
    v_cvt_pk_bf16_f32 v27, v118, v119
    v_mfma_f32_16x16x32_bf16 v[124:127], v[160:163], a[4:7], v[124:127]
    v_min_u32 v26, -2, v26
    v_min_u32 v27, -2, v27
    v_mfma_f32_16x16x32_bf16 v[124:127], v[164:167], a[12:15], v[124:127]
    s_waitcnt lgkmcnt(10)
    buffer_store_dwordx4 v[24:27], v209, s[24:27], s58 offen sc1
    v_mfma_f32_16x16x32_bf16 v[120:123], v[168:171], a[16:19], v[120:123]
    s_waitcnt lgkmcnt(8)
    ds_read_b64_tr_b16 v[160:161], v220 offset:53504
    ds_read_b64_tr_b16 v[162:163], v220 offset:58112
    v_mfma_f32_16x16x32_bf16 v[120:123], v[172:175], a[24:27], v[120:123]
    ds_read_b64_tr_b16 v[164:165], v220 offset:62720
    ds_read_b64_tr_b16 v[166:167], v221 offset:1792
    v_mfma_f32_16x16x32_bf16 v[124:127], v[168:171], a[20:23], v[124:127]
    v_mfma_f32_16x16x32_bf16 v[124:127], v[172:175], a[28:31], v[124:127]
    s_waitcnt lgkmcnt(10)
    ds_read_b64_tr_b16 v[168:169], v221 offset:6400
    ds_read_b64_tr_b16 v[170:171], v221 offset:11008
    v_mfma_f32_16x16x32_bf16 v[128:131], v[176:179], a[224:227], v[128:131]
    s_waitcnt lgkmcnt(10)
    ds_read_b64_tr_b16 v[172:173], v221 offset:15616
    ds_read_b64_tr_b16 v[174:175], v221 offset:20224
    v_mfma_f32_16x16x32_bf16 v[128:131], v[180:183], a[232:235], v[128:131]
    v_mfma_f32_16x16x32_bf16 v[132:135], v[176:179], a[228:231], v[132:135]
    v_mfma_f32_16x16x32_bf16 v[132:135], v[180:183], a[236:239], v[132:135]
    s_waitcnt lgkmcnt(10)
    ds_read_b64_tr_b16 v[176:177], v220 offset:16384
    ds_read_b64_tr_b16 v[178:179], v220 offset:20992
    v_mfma_f32_16x16x32_bf16 v[128:131], v[184:187], a[240:243], v[128:131]
    s_waitcnt lgkmcnt(10)
    ds_read_b64_tr_b16 v[180:181], v220 offset:25600
    ds_read_b64_tr_b16 v[182:183], v220 offset:30208
    v_mfma_f32_16x16x32_bf16 v[128:131], v[188:191], a[248:251], v[128:131]
    v_cvt_pk_bf16_f32 v28, v120, v121
    v_cvt_pk_bf16_f32 v29, v122, v123
    v_mfma_f32_16x16x32_bf16 v[132:135], v[184:187], a[244:247], v[132:135]
    v_min_u32 v28, -2, v28
    v_min_u32 v29, -2, v29
    v_mfma_f32_16x16x32_bf16 v[132:135], v[188:191], a[252:255], v[132:135]
    s_waitcnt lgkmcnt(10)
    ds_read_b64_tr_b16 v[184:185], v220 offset:34816
    ds_read_b64_tr_b16 v[186:187], v220 offset:39424
    v_mfma_f32_16x16x32_bf16 v[128:131], v[160:163], a[0:3], v[128:131]
    s_waitcnt lgkmcnt(10)
    ds_read_b64_tr_b16 v[188:189], v220 offset:44032
    ds_read_b64_tr_b16 v[190:191], v220 offset:48640
    v_mfma_f32_16x16x32_bf16 v[128:131], v[164:167], a[8:11], v[128:131]
    v_cvt_pk_bf16_f32 v30, v124, v125
    v_cvt_pk_bf16_f32 v31, v126, v127
    v_mfma_f32_16x16x32_bf16 v[132:135], v[160:163], a[4:7], v[132:135]
    v_min_u32 v30, -2, v30
    v_min_u32 v31, -2, v31
    v_mfma_f32_16x16x32_bf16 v[132:135], v[164:167], a[12:15], v[132:135]
    s_waitcnt lgkmcnt(10)
    buffer_store_dwordx4 v[28:31], v209, s[24:27], s58 offen offset:1024 sc1
    v_mfma_f32_16x16x32_bf16 v[128:131], v[168:171], a[16:19], v[128:131]
    s_waitcnt lgkmcnt(8)
    ds_read_b64_tr_b16 v[160:161], v219 offset:0
    ds_read_b64_tr_b16 v[162:163], v219 offset:4608
    v_mfma_f32_16x16x32_bf16 v[128:131], v[172:175], a[24:27], v[128:131]
    ds_read_b64_tr_b16 v[164:165], v219 offset:9216
    ds_read_b64_tr_b16 v[166:167], v219 offset:13824
    v_mfma_f32_16x16x32_bf16 v[132:135], v[168:171], a[20:23], v[132:135]
    v_lshlrev_b32 v36, 3, v247
    v_mfma_f32_16x16x32_bf16 v[132:135], v[172:175], a[28:31], v[132:135]
    s_waitcnt lgkmcnt(10)
    ds_read_b64_tr_b16 v[168:169], v219 offset:18432
    ds_read_b64_tr_b16 v[170:171], v219 offset:23040
    v_mfma_f32_16x16x32_bf16 v[64:67], v[176:179], a[160:163], v[64:67]
    s_waitcnt lgkmcnt(10)
    ds_read_b64_tr_b16 v[172:173], v219 offset:27648
    ds_read_b64_tr_b16 v[174:175], v219 offset:32256
    v_mfma_f32_16x16x32_bf16 v[64:67], v[180:183], a[168:171], v[64:67]
    v_mfma_f32_16x16x32_bf16 v[68:71], v[176:179], a[164:167], v[68:71]
    v_mfma_f32_16x16x32_bf16 v[68:71], v[180:183], a[172:175], v[68:71]
    s_waitcnt lgkmcnt(10)
    ds_read_b64_tr_b16 v[176:177], v219 offset:36864
    ds_read_b64_tr_b16 v[178:179], v219 offset:41472
    v_mfma_f32_16x16x32_bf16 v[64:67], v[184:187], a[176:179], v[64:67]
    s_waitcnt lgkmcnt(10)
    ds_read_b64_tr_b16 v[180:181], v219 offset:46080
    ds_read_b64_tr_b16 v[182:183], v219 offset:50688
    v_mfma_f32_16x16x32_bf16 v[64:67], v[188:191], a[184:187], v[64:67]
    v_cvt_pk_bf16_f32 v32, v128, v129
    v_cvt_pk_bf16_f32 v33, v130, v131
    v_mfma_f32_16x16x32_bf16 v[68:71], v[184:187], a[180:183], v[68:71]
    v_min_u32 v32, -2, v32
    v_min_u32 v33, -2, v33
    v_mfma_f32_16x16x32_bf16 v[68:71], v[188:191], a[188:191], v[68:71]
    s_waitcnt lgkmcnt(10)
    buffer_store_dwordx2 v[32:33], v36, s[24:27], s59 offen sc1
    v_mfma_f32_16x16x32_bf16 v[64:67], v[160:163], a[192:195], v[64:67]
    s_waitcnt lgkmcnt(8)
    ds_read_b64_tr_b16 v[184:185], v219 offset:55296
    ds_read_b64_tr_b16 v[186:187], v219 offset:59904
    v_mfma_f32_16x16x32_bf16 v[64:67], v[164:167], a[200:203], v[64:67]
    ds_read_b64_tr_b16 v[188:189], v219 offset:64512
    ds_read_b64_tr_b16 v[190:191], v220 offset:3584
    v_mfma_f32_16x16x32_bf16 v[68:71], v[160:163], a[196:199], v[68:71]
    v_cvt_pk_bf16_f32 v34, v132, v133
    v_cvt_pk_bf16_f32 v35, v134, v135
    v_mfma_f32_16x16x32_bf16 v[68:71], v[164:167], a[204:207], v[68:71]
    s_waitcnt lgkmcnt(10)
    ds_read_b64_tr_b16 v[160:161], v220 offset:53248
    ds_read_b64_tr_b16 v[162:163], v220 offset:57856
    v_mfma_f32_16x16x32_bf16 v[64:67], v[168:171], a[208:211], v[64:67]
    s_waitcnt lgkmcnt(10)
    ds_read_b64_tr_b16 v[164:165], v220 offset:62464
    ds_read_b64_tr_b16 v[166:167], v221 offset:1536
    v_mfma_f32_16x16x32_bf16 v[64:67], v[172:175], a[216:219], v[64:67]
    v_min_u32 v34, -2, v34
    v_min_u32 v35, -2, v35
    v_mfma_f32_16x16x32_bf16 v[68:71], v[168:171], a[212:215], v[68:71]
    buffer_store_dwordx2 v[34:35], v36, s[24:27], s60 offen sc1
    v_mfma_f32_16x16x32_bf16 v[68:71], v[172:175], a[220:223], v[68:71]
    s_waitcnt lgkmcnt(10)
    ds_read_b64_tr_b16 v[168:169], v221 offset:6144
    ds_read_b64_tr_b16 v[170:171], v221 offset:10752
    v_mfma_f32_16x16x32_bf16 v[64:67], v[176:179], a[224:227], v[64:67]
    s_waitcnt lgkmcnt(10)
    ds_read_b64_tr_b16 v[172:173], v221 offset:15360
    ds_read_b64_tr_b16 v[174:175], v221 offset:19968
    v_mfma_f32_16x16x32_bf16 v[64:67], v[180:183], a[232:235], v[64:67]
    s_cmp_eq_u32 s38, 1
    s_cselect_b64 s[92:93], -1, 0
    v_cndmask_b32 v40, v128, v132, s[92:93]
    v_mfma_f32_16x16x32_bf16 v[68:71], v[176:179], a[228:231], v[68:71]
    v_cndmask_b32 v41, v129, v133, s[92:93]
    v_cndmask_b32 v42, v130, v134, s[92:93]
    v_mfma_f32_16x16x32_bf16 v[68:71], v[180:183], a[236:239], v[68:71]
    s_waitcnt lgkmcnt(10)
    ds_read_b64_tr_b16 v[176:177], v220 offset:16416
    ds_read_b64_tr_b16 v[178:179], v220 offset:21024
    v_mfma_f32_16x16x32_bf16 v[64:67], v[184:187], a[240:243], v[64:67]
    s_waitcnt lgkmcnt(10)
    ds_read_b64_tr_b16 v[180:181], v220 offset:25632
    ds_read_b64_tr_b16 v[182:183], v220 offset:30240
    v_mfma_f32_16x16x32_bf16 v[64:67], v[188:191], a[248:251], v[64:67]
    v_cndmask_b32 v43, v131, v135, s[92:93]
    v_and_b32 v44, 15, v247
    v_mfma_f32_16x16x32_bf16 v[68:71], v[184:187], a[244:247], v[68:71]
    v_mul_u32_u24 v44, 1152, v44
    v_lshrrev_b32 v45, 4, v247
    v_mfma_f32_16x16x32_bf16 v[68:71], v[188:191], a[252:255], v[68:71]
    s_waitcnt lgkmcnt(10)
    ds_read_b64_tr_b16 v[184:185], v220 offset:34848
    ds_read_b64_tr_b16 v[186:187], v220 offset:39456
    v_mfma_f32_16x16x32_bf16 v[64:67], v[160:163], a[0:3], v[64:67]
    s_waitcnt lgkmcnt(10)
    ds_read_b64_tr_b16 v[188:189], v220 offset:44064
    ds_read_b64_tr_b16 v[190:191], v220 offset:48672
    v_mfma_f32_16x16x32_bf16 v[64:67], v[164:167], a[8:11], v[64:67]
    v_lshl_add_u32 v46, v45, 3, v44
    v_mfma_f32_16x16x32_bf16 v[68:71], v[160:163], a[4:7], v[68:71]
    v_mfma_f32_16x16x32_bf16 v[68:71], v[164:167], a[12:15], v[68:71]
    s_waitcnt lgkmcnt(10)
    ds_read_b64_tr_b16 v[160:161], v219 offset:32
    ds_read_b64_tr_b16 v[162:163], v219 offset:4640
    v_mfma_f32_16x16x32_bf16 v[64:67], v[168:171], a[16:19], v[64:67]
    s_waitcnt lgkmcnt(10)
    ds_read_b64_tr_b16 v[164:165], v219 offset:9248
    ds_read_b64_tr_b16 v[166:167], v219 offset:13856
    v_mfma_f32_16x16x32_bf16 v[64:67], v[172:175], a[24:27], v[64:67]
    v_mfma_f32_16x16x32_bf16 v[68:71], v[168:171], a[20:23], v[68:71]
    v_mfma_f32_16x16x32_bf16 v[68:71], v[172:175], a[28:31], v[68:71]
    s_waitcnt lgkmcnt(10)
    ds_read_b64_tr_b16 v[168:169], v219 offset:18464
    ds_read_b64_tr_b16 v[170:171], v219 offset:23072
    v_mfma_f32_16x16x32_bf16 v[72:75], v[176:179], a[160:163], v[72:75]
    s_waitcnt lgkmcnt(10)
    ds_read_b64_tr_b16 v[172:173], v219 offset:27680
    ds_read_b64_tr_b16 v[174:175], v219 offset:32288
    v_mfma_f32_16x16x32_bf16 v[72:75], v[180:183], a[168:171], v[72:75]
    v_mfma_f32_16x16x32_bf16 v[76:79], v[176:179], a[164:167], v[76:79]
    v_mfma_f32_16x16x32_bf16 v[76:79], v[180:183], a[172:175], v[76:79]
    s_waitcnt lgkmcnt(10)
    ds_read_b64_tr_b16 v[176:177], v219 offset:36896
    ds_read_b64_tr_b16 v[178:179], v219 offset:41504
    v_mfma_f32_16x16x32_bf16 v[72:75], v[184:187], a[176:179], v[72:75]
    s_waitcnt lgkmcnt(10)
    ds_read_b64_tr_b16 v[180:181], v219 offset:46112
    ds_read_b64_tr_b16 v[182:183], v219 offset:50720
    v_mfma_f32_16x16x32_bf16 v[72:75], v[188:191], a[184:187], v[72:75]
    v_mfma_f32_16x16x32_bf16 v[76:79], v[184:187], a[180:183], v[76:79]
    v_mfma_f32_16x16x32_bf16 v[76:79], v[188:191], a[188:191], v[76:79]
    s_waitcnt lgkmcnt(10)
    ds_read_b64_tr_b16 v[184:185], v219 offset:55328
    ds_read_b64_tr_b16 v[186:187], v219 offset:59936
    v_mfma_f32_16x16x32_bf16 v[72:75], v[160:163], a[192:195], v[72:75]
    s_waitcnt lgkmcnt(10)
    ds_read_b64_tr_b16 v[188:189], v219 offset:64544
    ds_read_b64_tr_b16 v[190:191], v220 offset:3616
    v_mfma_f32_16x16x32_bf16 v[72:75], v[164:167], a[200:203], v[72:75]
    v_mfma_f32_16x16x32_bf16 v[76:79], v[160:163], a[196:199], v[76:79]
    v_mfma_f32_16x16x32_bf16 v[76:79], v[164:167], a[204:207], v[76:79]
    s_waitcnt lgkmcnt(10)
    ds_read_b64_tr_b16 v[160:161], v220 offset:53280
    ds_read_b64_tr_b16 v[162:163], v220 offset:57888
    v_mfma_f32_16x16x32_bf16 v[72:75], v[168:171], a[208:211], v[72:75]
    s_waitcnt lgkmcnt(10)
    ds_read_b64_tr_b16 v[164:165], v220 offset:62496
    ds_read_b64_tr_b16 v[166:167], v221 offset:1568
    v_mfma_f32_16x16x32_bf16 v[72:75], v[172:175], a[216:219], v[72:75]
    v_mfma_f32_16x16x32_bf16 v[76:79], v[168:171], a[212:215], v[76:79]
    v_mfma_f32_16x16x32_bf16 v[76:79], v[172:175], a[220:223], v[76:79]
    s_waitcnt lgkmcnt(10)
    ds_read_b64_tr_b16 v[168:169], v221 offset:6176
    ds_read_b64_tr_b16 v[170:171], v221 offset:10784
    v_mfma_f32_16x16x32_bf16 v[72:75], v[176:179], a[224:227], v[72:75]
    s_waitcnt lgkmcnt(10)
    ds_read_b64_tr_b16 v[172:173], v221 offset:15392
    ds_read_b64_tr_b16 v[174:175], v221 offset:20000
    v_mfma_f32_16x16x32_bf16 v[72:75], v[180:183], a[232:235], v[72:75]
    v_mfma_f32_16x16x32_bf16 v[76:79], v[176:179], a[228:231], v[76:79]
    v_mfma_f32_16x16x32_bf16 v[76:79], v[180:183], a[236:239], v[76:79]
    s_waitcnt lgkmcnt(10)
    v_mfma_f32_16x16x32_bf16 v[72:75], v[184:187], a[240:243], v[72:75]
    s_waitcnt lgkmcnt(8)
    v_mfma_f32_16x16x32_bf16 v[72:75], v[188:191], a[248:251], v[72:75]
    v_mfma_f32_16x16x32_bf16 v[76:79], v[184:187], a[244:247], v[76:79]
    v_mfma_f32_16x16x32_bf16 v[76:79], v[188:191], a[252:255], v[76:79]
    s_waitcnt lgkmcnt(6)
    v_mfma_f32_16x16x32_bf16 v[72:75], v[160:163], a[0:3], v[72:75]
    s_waitcnt lgkmcnt(4)
    v_mfma_f32_16x16x32_bf16 v[72:75], v[164:167], a[8:11], v[72:75]
    v_mfma_f32_16x16x32_bf16 v[76:79], v[160:163], a[4:7], v[76:79]
    v_mfma_f32_16x16x32_bf16 v[76:79], v[164:167], a[12:15], v[76:79]
    s_waitcnt lgkmcnt(2)
    v_mfma_f32_16x16x32_bf16 v[72:75], v[168:171], a[16:19], v[72:75]
    s_waitcnt lgkmcnt(0)
    v_mfma_f32_16x16x32_bf16 v[72:75], v[172:175], a[24:27], v[72:75]
    v_mfma_f32_16x16x32_bf16 v[76:79], v[168:171], a[20:23], v[76:79]
    v_mfma_f32_16x16x32_bf16 v[76:79], v[172:175], a[28:31], v[76:79]
LS_rx:
    buffer_load_dwordx4 v[136:139], v209, s[24:27], s61 offen sc1
    buffer_load_dwordx4 v[140:143], v209, s[24:27], s61 offen offset:1024 sc1
    buffer_load_dwordx2 v[48:49], v36, s[24:27], s64 offen sc1
    buffer_load_dwordx4 v[144:147], v209, s[24:27], s62 offen sc1
    buffer_load_dwordx4 v[148:151], v209, s[24:27], s62 offen offset:1024 sc1
    buffer_load_dwordx2 v[50:51], v36, s[24:27], s65 offen sc1
    buffer_load_dwordx4 v[152:155], v209, s[24:27], s63 offen sc1
    buffer_load_dwordx4 v[156:159], v209, s[24:27], s63 offen offset:1024 sc1
    buffer_load_dwordx2 v[52:53], v36, s[24:27], s66 offen sc1
    s_waitcnt vmcnt(0)
    v_max3_u32 v47, v136, v137, v138
    v_max3_u32 v47, v47, v139, v140
    v_max3_u32 v47, v47, v141, v142
    v_max3_u32 v47, v47, v143, v144
    v_max3_u32 v47, v47, v145, v146
    v_max3_u32 v47, v47, v147, v148
    v_max3_u32 v47, v47, v149, v150
    v_max3_u32 v47, v47, v151, v152
    v_max3_u32 v47, v47, v153, v154
    v_max3_u32 v47, v47, v155, v156
    v_max3_u32 v47, v47, v157, v158
    v_max3_u32 v47, v47, v159, v48
    v_max3_u32 v47, v47, v49, v50
    v_max3_u32 v47, v47, v51, v52
    v_max_u32 v47, v47, v53
    v_cmp_eq_u32 vcc, -1, v47
    s_nop 1
    s_cbranch_vccz LS_rx_ok
    s_sub_u32 s96, s96, 1
    s_cbranch_scc0 LS_rx
    s_mov_b32 s96, 0
LS_rx_ok:
    v_and_b32 v44, 15, v247
    v_mul_u32_u24 v44, 1152, v44
    v_lshrrev_b32 v45, 4, v247
    v_lshl_add_u32 v39, v45, 4, v44
    v_lshlrev_b32 v184, 16, v136
    v_and_b32 v185, 0xffff0000, v136
    v_pk_add_f32 v[64:65], v[64:65], v[184:185]
    v_lshlrev_b32 v186, 16, v137
    v_and_b32 v187, 0xffff0000, v137
    v_pk_add_f32 v[66:67], v[66:67], v[186:187]
    v_lshlrev_b32 v188, 16, v144
    v_and_b32 v189, 0xffff0000, v144
    v_pk_add_f32 v[64:65], v[64:65], v[188:189]
    v_lshlrev_b32 v190, 16, v145
    v_and_b32 v191, 0xffff0000, v145
    v_pk_add_f32 v[66:67], v[66:67], v[190:191]
    v_lshlrev_b32 v184, 16, v152
    v_and_b32 v185, 0xffff0000, v152
    v_pk_add_f32 v[64:65], v[64:65], v[184:185]
    v_lshlrev_b32 v186, 16, v153
    v_and_b32 v187, 0xffff0000, v153
    v_pk_add_f32 v[66:67], v[66:67], v[186:187]
    v_lshlrev_b32 v188, 16, v140
    v_and_b32 v189, 0xffff0000, v140
    v_pk_add_f32 v[72:73], v[72:73], v[188:189]
    v_lshlrev_b32 v190, 16, v141
    v_and_b32 v191, 0xffff0000, v141
    v_pk_add_f32 v[74:75], v[74:75], v[190:191]
    v_lshlrev_b32 v184, 16, v148
    v_and_b32 v185, 0xffff0000, v148
    v_pk_add_f32 v[72:73], v[72:73], v[184:185]
    v_lshlrev_b32 v186, 16, v149
    v_and_b32 v187, 0xffff0000, v149
    v_pk_add_f32 v[74:75], v[74:75], v[186:187]
    v_lshlrev_b32 v188, 16, v156
    v_and_b32 v189, 0xffff0000, v156
    v_pk_add_f32 v[72:73], v[72:73], v[188:189]
    v_lshlrev_b32 v190, 16, v157
    v_and_b32 v191, 0xffff0000, v157
    v_pk_add_f32 v[74:75], v[74:75], v[190:191]
    v_cvt_pk_bf16_f32 v0, v64, v65
    v_cvt_pk_bf16_f32 v1, v66, v67
    v_cvt_pk_bf16_f32 v2, v72, v73
    v_cvt_pk_bf16_f32 v3, v74, v75
    s_nop 1
    v_permlane32_swap_b32 v0, v2
    v_permlane32_swap_b32 v1, v3
    s_nop 1
    v_permlane16_swap_b32 v0, v2
    v_permlane16_swap_b32 v1, v3
    s_nop 1
    s_add_u32 s74, s67, 0
    buffer_store_dwordx4 v[0:3], v39, s[32:35], s74 offen sc0 sc1
    v_lshlrev_b32 v184, 16, v138
    v_and_b32 v185, 0xffff0000, v138
    v_pk_add_f32 v[68:69], v[68:69], v[184:185]
    v_lshlrev_b32 v186, 16, v139
    v_and_b32 v187, 0xffff0000, v139
    v_pk_add_f32 v[70:71], v[70:71], v[186:187]
    v_lshlrev_b32 v188, 16, v146
    v_and_b32 v189, 0xffff0000, v146
    v_pk_add_f32 v[68:69], v[68:69], v[188:189]
    v_lshlrev_b32 v190, 16, v147
    v_and_b32 v191, 0xffff0000, v147
    v_pk_add_f32 v[70:71], v[70:71], v[190:191]
    v_lshlrev_b32 v184, 16, v154
    v_and_b32 v185, 0xffff0000, v154
    v_pk_add_f32 v[68:69], v[68:69], v[184:185]
    v_lshlrev_b32 v186, 16, v155
    v_and_b32 v187, 0xffff0000, v155
    v_pk_add_f32 v[70:71], v[70:71], v[186:187]
    v_lshlrev_b32 v188, 16, v142
    v_and_b32 v189, 0xffff0000, v142
    v_pk_add_f32 v[76:77], v[76:77], v[188:189]
    v_lshlrev_b32 v190, 16, v143
    v_and_b32 v191, 0xffff0000, v143
    v_pk_add_f32 v[78:79], v[78:79], v[190:191]
    v_lshlrev_b32 v184, 16, v150
    v_and_b32 v185, 0xffff0000, v150
    v_pk_add_f32 v[76:77], v[76:77], v[184:185]
    v_lshlrev_b32 v186, 16, v151
    v_and_b32 v187, 0xffff0000, v151
    v_pk_add_f32 v[78:79], v[78:79], v[186:187]
    v_lshlrev_b32 v188, 16, v158
    v_and_b32 v189, 0xffff0000, v158
    v_pk_add_f32 v[76:77], v[76:77], v[188:189]
    v_lshlrev_b32 v190, 16, v159
    v_and_b32 v191, 0xffff0000, v159
    v_pk_add_f32 v[78:79], v[78:79], v[190:191]
    v_cvt_pk_bf16_f32 v4, v68, v69
    v_cvt_pk_bf16_f32 v5, v70, v71
    v_cvt_pk_bf16_f32 v6, v76, v77
    v_cvt_pk_bf16_f32 v7, v78, v79
    s_nop 1
    v_permlane32_swap_b32 v4, v6
    v_permlane32_swap_b32 v5, v7
    s_nop 1
    v_permlane16_swap_b32 v4, v6
    v_permlane16_swap_b32 v5, v7
    s_nop 1
    s_add_u32 s75, s67, 18432
    buffer_store_dwordx4 v[4:7], v39, s[32:35], s75 offen sc0 sc1
    v_lshlrev_b32 v184, 16, v48
    v_and_b32 v185, 0xffff0000, v48
    v_pk_add_f32 v[40:41], v[40:41], v[184:185]
    v_lshlrev_b32 v186, 16, v49
    v_and_b32 v187, 0xffff0000, v49
    v_pk_add_f32 v[42:43], v[42:43], v[186:187]
    v_lshlrev_b32 v188, 16, v50
    v_and_b32 v189, 0xffff0000, v50
    v_pk_add_f32 v[40:41], v[40:41], v[188:189]
    v_lshlrev_b32 v190, 16, v51
    v_and_b32 v191, 0xffff0000, v51
    v_pk_add_f32 v[42:43], v[42:43], v[190:191]
    v_lshlrev_b32 v184, 16, v52
    v_and_b32 v185, 0xffff0000, v52
    v_pk_add_f32 v[40:41], v[40:41], v[184:185]
    v_lshlrev_b32 v186, 16, v53
    v_and_b32 v187, 0xffff0000, v53
    v_pk_add_f32 v[42:43], v[42:43], v[186:187]
    v_cvt_pk_bf16_f32 v8, v40, v41
    v_cvt_pk_bf16_f32 v9, v42, v43
    buffer_store_dwordx2 v[8:9], v46, s[32:35], s68 offen sc0 sc1
    s_or_b32 s72, s38, s39
    s_cmp_eq_u32 s72, 0
    s_cselect_b32 s72, 0, 0x80000000
    v_and_b32 v44, 0x80000000, v241
    v_or_b32 v44, v44, v253
    v_or_b32 v44, s72, v44
    s_add_u32 s73, s55, 7
    v_mov_b32 v45, s73
    buffer_store_dword v45, v44, s[28:31], 0 offen sc1
    s_endpgm
LS_spin0:
    s_sub_u32 s96, s96, 1
    s_cbranch_scc1 LS_giveup0
    s_sleep 1
    buffer_load_dword v244, v243, s[28:31], 0 offen sc1
    s_waitcnt vmcnt(0)
    v_subrev_u32 v245, s69, v244
    v_cmp_le_u32 vcc, 8, v245
    s_nop 1
    s_cbranch_vccnz LS_spin0
    s_branch LS_back0
LS_giveup0:
    s_mov_b32 s96, 0
    s_branch LS_back0
LS_spin1:
    s_sub_u32 s96, s96, 1
    s_cbranch_scc1 LS_giveup1
    s_sleep 1
    buffer_load_dword v244, v243, s[28:31], 0 offen sc1
    s_waitcnt vmcnt(0)
    v_subrev_u32 v245, s69, v244
    v_cmp_le_u32 vcc, 8, v245
    s_nop 1
    s_cbranch_vccnz LS_spin1
    s_branch LS_back1
LS_giveup1:
    s_mov_b32 s96, 0
    s_branch LS_back1
LS_spin2:
    s_sub_u32 s96, s96, 1
    s_cbranch_scc1 LS_giveup2
    s_sleep 1
    buffer_load_dword v244, v243, s[28:31], 0 offen sc1
    s_waitcnt vmcnt(0)
    v_subrev_u32 v245, s69, v244
    v_cmp_le_u32 vcc, 8, v245
    s_nop 1
    s_cbranch_vccnz LS_spin2
    s_branch LS_back2
LS_giveup2:
    s_mov_b32 s96, 0
    s_branch LS_back2
LS_spin4:
    s_sub_u32 s96, s96, 1
    s_cbranch_scc1 LS_giveup4
    s_sleep 1
    buffer_load_dword v244, v246, s[28:31], s90 offen sc1
    s_waitcnt vmcnt(0)
    v_subrev_u32 v245, s69, v244
    v_cmp_le_u32 vcc, 8, v245
    s_nop 1
    s_cbranch_vccnz LS_spin4
    s_branch LS_back4
LS_giveup4:
    s_mov_b32 s96, 0
    s_branch LS_back4
L_codeend:
    s_endpgm

.section .rodata,"a"
.p2align 6
.amdhsa_kernel standalone__geglu_ffn__prompt_kernel
  .amdhsa_next_free_vgpr 512
  .amdhsa_next_free_sgpr 102
  .amdhsa_accum_offset 256
  .amdhsa_group_segment_fixed_size 0
  .amdhsa_kernarg_size 56
  .amdhsa_user_sgpr_count 2
  .amdhsa_user_sgpr_kernarg_segment_ptr 1
  .amdhsa_system_sgpr_workgroup_id_x 1
.end_amdhsa_kernel
.text
```
